```python
import torch

def _softmax(x, axis=-1):
    return torch.softmax(x, dim=axis)
def _gelu(x):
    return torch.nn.functional.gelu(x, approximate="tanh")
def _silu(x):
    return torch.nn.functional.silu(x)
def _sigmoid(x):
    return torch.sigmoid(x)
def _layernorm(x, axis=-1, eps=1e-5):
    m = x.mean(dim=axis, keepdim=True)
    v = x.var(dim=axis, keepdim=True, unbiased=False)
    return (x - m) / torch.sqrt(v + eps)
def _scatter_add(tgt, idx, src, axis=0):
    return tgt.clone().index_add_(axis, idx, src)
def _segment_sum(src, seg, n):
    out = torch.zeros((n,) + src.shape[1:], dtype=src.dtype)
    return out.index_add_(0, seg, src)
def _pad(x, pw):
    flat = tuple(v for pair in reversed(pw) for v in pair)
    return torch.nn.functional.pad(x, flat)

kernel_name = 'concat_heads__mha_block_cached__gqa_block_cached__near_ridge'

def setup_inputs():

    _w = (lambda a: (lambda t: t.to(torch.bfloat16) if t.is_floating_point() else t)(torch.as_tensor(a)))
    def _A_setup():
        B, Sq, D = 8, 240, 1024
        H, Sk, Dh = 32, 1024, 128
        return {
            "x": _w((lambda *s: torch.randn(*s, dtype=torch.bfloat16) * 0.8)(B, Sq, D)),
            "k_cache": _w((lambda *s: torch.randn(*s, dtype=torch.bfloat16) * 0.8)(B, H, Sk, Dh)),
            "v_cache": _w((lambda *s: torch.randn(*s, dtype=torch.bfloat16) * 0.05)(B, H, Sk, Dh)),
            "wq": _w((lambda *s: torch.randn(*s, dtype=torch.bfloat16) * 0.8)(D, H * Dh) * (D ** -0.5)),
            "wo": _w((lambda *s: torch.randn(*s, dtype=torch.bfloat16) * 0.05)(H * Dh, D) * ((H * Dh) ** -0.5)),
        }
    _A_in = _A_setup()

    def _B_setup():
        B, Sq, D = 8, 240, 1024
        Hq, Hkv, Sk, Dh = 32, 32, 1024, 128
        assert Hq % Hkv == 0, (Hq, Hkv)
        return {
            "x": _w((lambda *s: torch.randn(*s, dtype=torch.bfloat16) * 0.8)(B, Sq, D)),
            "k_cache": _w((lambda *s: torch.randn(*s, dtype=torch.bfloat16) * 0.8)(B, Hkv, Sk, Dh)),
            "v_cache": _w((lambda *s: torch.randn(*s, dtype=torch.bfloat16) * 0.05)(B, Hkv, Sk, Dh)),
            "wq": _w((lambda *s: torch.randn(*s, dtype=torch.bfloat16) * 0.8)(D, Hq * Dh) * (D ** -0.5)),
            "wo": _w((lambda *s: torch.randn(*s, dtype=torch.bfloat16) * 0.05)(Hq * Dh, D) * ((Hq * Dh) ** -0.5)),
        }
    _B_in = _B_setup()

    return {
        "A_x": _A_in["x"],
        "A_k_cache": _A_in["k_cache"],
        "A_v_cache": _A_in["v_cache"],
        "A_wq": _A_in["wq"],
        "A_wo": _A_in["wo"],
        "B_x": _B_in["x"],
        "B_k_cache": _B_in["k_cache"],
        "B_v_cache": _B_in["v_cache"],
        "B_wq": _B_in["wq"],
        "B_wo": _B_in["wo"],
    }

def reference(A_x, A_k_cache, A_v_cache, A_wq, A_wo, B_x, B_k_cache, B_v_cache, B_wq, B_wo):
    def _A_ref(x, k_cache, v_cache, wq, wo):
        B, Sq, D = x.shape
        H, Dh = 32, 128
        q = (lambda x, *d: x.permute(*d))((x @ wq).reshape(B, Sq, H, Dh), 0, 2, 1, 3)
        scores = torch.einsum("bhqd,bhkd->bhqk", q, k_cache) * (Dh ** -0.5)
        p = _softmax(scores, axis=-1)
        o = torch.einsum("bhqk,bhkd->bhqd", p, v_cache)
        return (lambda x, *d: x.permute(*d))(o, 0, 2, 1, 3).reshape(B, Sq, H * Dh) @ wo

    def _B_ref(x, k_cache, v_cache, wq, wo):
        B, Sq, D = x.shape
        Hq, Dh = 32, 128
        Hkv = k_cache.shape[1]
        rep = Hq // Hkv
        q = (lambda x, *d: x.permute(*d))((x @ wq).reshape(B, Sq, Hq, Dh), 0, 2, 1, 3)
        k = (lambda x, n, axis: torch.repeat_interleave(x, n, dim=axis))(k_cache, rep, axis=1)
        v = (lambda x, n, axis: torch.repeat_interleave(x, n, dim=axis))(v_cache, rep, axis=1)
        scores = torch.einsum("bhqd,bhkd->bhqk", q, k) * (Dh ** -0.5)
        p = _softmax(scores, axis=-1)
        o = torch.einsum("bhqk,bhkd->bhqd", p, v)
        return (lambda x, *d: x.permute(*d))(o, 0, 2, 1, 3).reshape(B, Sq, Hq * Dh) @ wo

    a = _A_ref(A_x, A_k_cache, A_v_cache, A_wq, A_wo)
    b = _B_ref(B_x, B_k_cache, B_v_cache, B_wq, B_wo)
    return torch.concatenate([a, b], axis=-1)
```

```asm
; @launch grid=(256,1,1) block=(256,1,1) lds=163840
.amdgcn_target "amdgcn-amd-amdhsa--gfx950"
.text
.globl concat_heads__mha_block_cached__gqa_block_cached__near_ridge_kernel
.p2align 12
.type concat_heads__mha_block_cached__gqa_block_cached__near_ridge_kernel,@function
concat_heads__mha_block_cached__gqa_block_cached__near_ridge_kernel:
s_cmp_ge_u32 s2, 256
s_cbranch_scc1 L_end1
s_mov_b32 s42, 0
L_restart:
s_load_dwordx8 s[44:51], s[0:1], 0
s_load_dwordx8 s[56:63], s[0:1], 40
s_load_dwordx2 s[64:65], s[0:1], 96
s_load_dwordx2 s[52:53], s[0:1], 32
s_load_dwordx2 s[54:55], s[0:1], 72
s_and_b32 s4, s2, 7
s_lshr_b32 s5, s2, 3
s_lshr_b32 s6, s4, 2
s_bfe_u32 s7, s4, 0x10001
s_lshl_b32 s7, s7, 2
s_and_b32 s28, s5, 3
s_add_u32 s7, s7, s28
s_and_b32 s28, s4, 1
s_lshl_b32 s28, s28, 3
s_lshr_b32 s29, s5, 2
s_add_u32 s68, s28, s29
s_mul_i32 s100, s2, 11
s_lshr_b32 s100, s100, 1
s_and_b32 s100, s100, 31
s_lshl_b32 s100, s100, 11
s_and_b32 s92, s5, 15
s_lshl_b32 s92, s92, 1
s_or_b32 s92, s92, 1
s_lshl_b32 s92, s92, 11
v_and_b32 v1, 63, v0
v_lshrrev_b32 v27, 6, v0
s_nop 0
v_readfirstlane_b32 s3, v27
v_lshrrev_b32 v27, 4, v1
v_and_b32 v28, 15, v1
v_lshrrev_b32 v29, 2, v28
v_and_b32 v30, 3, v28
s_lshl_b32 s28, s3, 17
v_lshlrev_b32 v2, 15, v27
v_lshl_add_u32 v2, v28, 4, v2
v_add_u32 v2, s28, v2
v_add_u32 v3, 8192, v2
v_add_u32 v4, 16384, v2
v_add_u32 v5, 24576, v2
v_lshrrev_b32 v31, 3, v1
s_lshl_b32 s28, s3, 6
v_add_u32 v31, s28, v31
v_lshlrev_b32 v31, 11, v31
v_and_b32 v8, 7, v1
v_xor_b32 v8, v8, v27
v_xor_b32 v9, 4, v8
v_lshl_add_u32 v6, v8, 4, v31
v_lshl_add_u32 v7, v9, 4, v31
v_add_u32 v7, 16384, v7
v_add_u32 v8, 32768, v6
v_add_u32 v9, 32768, v7
v_add_u32 v10, 65536, v6
v_add_u32 v11, 65536, v7
v_add_u32 v12, 98304, v6
v_add_u32 v13, 98304, v7
v_lshrrev_b32 v31, 1, v27
v_lshl_add_u32 v31, v31, 2, v29
v_mul_u32_u24 v14, 1088, v31
v_and_b32 v31, 1, v27
v_lshl_add_u32 v14, v31, 9, v14
v_lshl_add_u32 v14, v30, 4, v14
v_lshrrev_b32 v31, 1, v28
v_xor_b32 v31, v31, v27
v_lshlrev_b32 v31, 4, v31
v_lshl_add_u32 v16, v28, 7, v31
v_mul_u32_u24 v18, 1088, v29
v_lshl_add_u32 v18, v30, 8, v18
v_xor_b32 v31, v27, v30
v_lshl_add_u32 v18, v31, 4, v18
v_mul_u32_u24 v19, 1088, v29
v_lshl_add_u32 v19, v27, 8, v19
v_lshl_add_u32 v19, v30, 3, v19
v_and_b32 v31, 1, v27
v_lshlrev_b32 v31, 5, v31
v_sub_u32 v20, v19, v31
v_add_u32 v19, v19, v31
v_xor_b32 v31, v28, v27
v_lshlrev_b32 v31, 4, v31
v_lshl_add_u32 v24, v27, 8, v31
v_and_b32 v31, 1, v27
v_lshlrev_b32 v31, 1, v31
v_xor_b32 v31, v28, v31
v_lshlrev_b32 v31, 4, v31
v_and_b32 v30, 1, v27
s_mov_b32 s28, 1024
v_mad_u32_u24 v25, v30, s28, v31
v_and_b32 v24, 0xff, v24
s_mov_b32 s28, 256
v_mad_u32_u24 v24, v30, s28, v24
v_lshrrev_b32 v30, 1, v27
s_mov_b32 s28, 65536
v_mad_u32_u24 v25, v30, s28, v25
s_mov_b32 s28, 512
v_mad_u32_u24 v24, v30, s28, v24
s_and_b32 s29, s3, 1
s_mul_i32 s28, s29, 65536
v_add_u32 v24, s28, v24
s_mul_i32 s28, s29, 512
v_add_u32 v25, s28, v25
s_lshr_b32 s29, s3, 1
s_mul_i32 s28, s29, 131072
v_add_u32 v24, s28, v24
v_add_u32 v25, s28, v25
s_mul_i32 s70, s3, 2176
s_add_u32 s71, s70, 139264
s_lshl_b32 s28, s3, 19
v_lshlrev_b32 v26, 4, v1
v_add_u32 v26, s28, v26
v_lshlrev_b32 v31, 8, v28
v_lshl_add_u32 v31, v27, 4, v31
s_mul_i32 s33, s3, 4352
v_mov_b32 v27, 0
v_mov_b32 v28, 163832
ds_write_b32 v28, v27
s_waitcnt lgkmcnt(0)
s_cmp_eq_u32 s6, 0
s_cselect_b64 s[44:45], s[44:45], s[56:57]
s_cselect_b64 s[46:47], s[46:47], s[58:59]
s_cselect_b64 s[48:49], s[48:49], s[60:61]
s_cselect_b64 s[50:51], s[50:51], s[62:63]
s_cselect_b64 s[52:53], s[52:53], s[54:55]
s_mov_b64 s[56:57], s[52:53]
s_load_dwordx2 s[58:59], s[0:1], 80
s_load_dwordx2 s[60:61], s[0:1], 88
s_mov_b32 s62, 256
s_mov_b32 s63, 0x20000
s_lshl_b32 s28, s7, 4
s_add_u32 s28, s28, s68
s_lshl_b32 s28, s28, 16
s_add_u32 s52, s52, s28
s_addc_u32 s53, s53, 0
s_mov_b32 s54, 65536
s_mov_b32 s55, 0x20000
s_mul_i32 s28, s7, 491520
s_add_u32 s8, s44, s28
s_addc_u32 s9, s45, 0
s_mov_b32 s10, 491520
s_mov_b32 s11, 0x20000
s_and_b32 s28, s68, 7
s_lshl_b32 s28, s28, 1
s_lshr_b32 s29, s68, 3
s_xor_b32 s29, s29, 1
s_add_u32 s28, s28, s29
s_lshl_b32 s28, s28, 9
s_add_u32 s12, s50, s28
s_addc_u32 s13, s51, 0
s_sub_u32 s14, 8388608, s28
s_mov_b32 s15, 0x20000
s_cmp_eq_u32 s3, 3
s_cbranch_scc1 L_w3
s_lshl_b32 s34, s3, 13
s_add_u32 s35, s34, 24576
v_add_u32 v16, s34, v16
v_xor_b32 v17, 64, v16
s_add_u32 s29, s33, 52224
s_mov_b32 s30, 256
s_add_u32 m0, s29, 0
s_nop 0
buffer_load_dwordx4 v2, s[12:15], s30 offen  lds
s_add_u32 m0, s29, 1088
s_nop 0
buffer_load_dwordx4 v3, s[12:15], s30 offen  lds
s_add_u32 m0, s29, 2176
s_nop 0
buffer_load_dwordx4 v4, s[12:15], s30 offen  lds
s_add_u32 m0, s29, 3264
s_nop 0
buffer_load_dwordx4 v5, s[12:15], s30 offen  lds
s_mov_b32 s31, 0
s_add_u32 m0, s34, 0
s_nop 0
buffer_load_dwordx4 v6, s[8:11], s31 offen  lds
s_add_u32 m0, s34, 1024
s_nop 0
buffer_load_dwordx4 v7, s[8:11], s31 offen  lds
s_add_u32 m0, s34, 2048
s_nop 0
buffer_load_dwordx4 v8, s[8:11], s31 offen  lds
s_add_u32 m0, s34, 3072
s_nop 0
buffer_load_dwordx4 v9, s[8:11], s31 offen  lds
s_add_u32 m0, s34, 4096
s_nop 0
buffer_load_dwordx4 v10, s[8:11], s31 offen  lds
s_add_u32 m0, s34, 5120
s_nop 0
buffer_load_dwordx4 v11, s[8:11], s31 offen  lds
s_add_u32 m0, s34, 6144
s_nop 0
buffer_load_dwordx4 v12, s[8:11], s31 offen  lds
s_add_u32 m0, s34, 7168
s_nop 0
buffer_load_dwordx4 v13, s[8:11], s31 offen  lds
s_mov_b32 s31, 128
s_add_u32 m0, s35, 0
s_nop 0
buffer_load_dwordx4 v6, s[8:11], s31 offen  lds
s_add_u32 m0, s35, 1024
s_nop 0
buffer_load_dwordx4 v7, s[8:11], s31 offen  lds
s_add_u32 m0, s35, 2048
s_nop 0
buffer_load_dwordx4 v8, s[8:11], s31 offen  lds
s_add_u32 m0, s35, 3072
s_nop 0
buffer_load_dwordx4 v9, s[8:11], s31 offen  lds
s_add_u32 m0, s35, 4096
s_nop 0
buffer_load_dwordx4 v10, s[8:11], s31 offen  lds
s_add_u32 m0, s35, 5120
s_nop 0
buffer_load_dwordx4 v11, s[8:11], s31 offen  lds
s_add_u32 m0, s35, 6144
s_nop 0
buffer_load_dwordx4 v12, s[8:11], s31 offen  lds
s_add_u32 m0, s35, 7168
s_nop 0
buffer_load_dwordx4 v13, s[8:11], s31 offen  lds
s_and_b32 s29, s68, 7
s_lshl_b32 s29, s29, 2
s_lshl_b32 s28, s7, 5
s_add_u32 s28, s28, s29
s_lshr_b32 s29, s68, 3
s_xor_b32 s29, s29, 1
s_lshl_b32 s29, s29, 1
s_add_u32 s28, s28, s29
s_lshl_b32 s28, s28, 18
s_add_u32 s16, s46, s28
s_addc_u32 s17, s47, 0
s_mov_b32 s18, 524288
s_mov_b32 s19, 0x20000
s_add_u32 s20, s48, s28
s_addc_u32 s21, s49, 0
s_mov_b32 s22, 524288
s_mov_b32 s23, 0x20000
s_mul_i32 s28, s6, 120
s_mul_i32 s29, s7, 15
s_add_u32 s28, s28, s29
s_lshl_b32 s28, s28, 17
s_lshl_b32 s29, s68, 11
s_add_u32 s28, s28, s29
s_add_u32 s24, s64, s28
s_addc_u32 s25, s65, 0
s_sub_u32 s26, 1966080, s29
s_mov_b32 s27, 0x20000
s_mov_b64 s[46:47], 0
s_add_u32 s29, s33, 69632
s_mov_b32 s30, 524544
s_add_u32 m0, s29, 0
s_nop 0
buffer_load_dwordx4 v2, s[12:15], s30 offen  lds
s_add_u32 m0, s29, 1088
s_nop 0
buffer_load_dwordx4 v3, s[12:15], s30 offen  lds
s_add_u32 m0, s29, 2176
s_nop 0
buffer_load_dwordx4 v4, s[12:15], s30 offen  lds
s_add_u32 m0, s29, 3264
s_nop 0
buffer_load_dwordx4 v5, s[12:15], s30 offen  lds
s_add_u32 s29, s33, 87040
s_mov_b32 s30, 0
s_add_u32 m0, s29, 0
s_nop 0
buffer_load_dwordx4 v2, s[12:15], s30 offen  lds
s_add_u32 m0, s29, 1088
s_nop 0
buffer_load_dwordx4 v3, s[12:15], s30 offen  lds
s_add_u32 m0, s29, 2176
s_nop 0
buffer_load_dwordx4 v4, s[12:15], s30 offen  lds
s_add_u32 m0, s29, 3264
s_nop 0
buffer_load_dwordx4 v5, s[12:15], s30 offen  lds
s_add_u32 s29, s33, 104448
s_mov_b32 s30, 524288
s_add_u32 m0, s29, 0
s_nop 0
buffer_load_dwordx4 v2, s[12:15], s30 offen  lds
s_add_u32 m0, s29, 1088
s_nop 0
buffer_load_dwordx4 v3, s[12:15], s30 offen  lds
s_add_u32 m0, s29, 2176
s_nop 0
buffer_load_dwordx4 v4, s[12:15], s30 offen  lds
s_add_u32 m0, s29, 3264
s_nop 0
buffer_load_dwordx4 v5, s[12:15], s30 offen  lds
s_mov_b32 s37, 0
buffer_load_dwordx4 v[32:35], v31, s[16:19], s37 offen offset:0
buffer_load_dwordx4 v[36:39], v31, s[16:19], s37 offen offset:64
buffer_load_dwordx4 v[40:43], v31, s[16:19], s37 offen offset:128
buffer_load_dwordx4 v[44:47], v31, s[16:19], s37 offen offset:192
s_mov_b32 s37, 262144
buffer_load_dwordx4 v[48:51], v31, s[16:19], s37 offen offset:0
buffer_load_dwordx4 v[52:55], v31, s[16:19], s37 offen offset:64
buffer_load_dwordx4 v[56:59], v31, s[16:19], s37 offen offset:128
buffer_load_dwordx4 v[60:63], v31, s[16:19], s37 offen offset:192
s_getpc_b64 s[98:99]
L_pc0:
s_sub_u32 s98, s98, L_pc0-concat_heads__mha_block_cached__gqa_block_cached__near_ridge_kernel
s_subb_u32 s99, s99, 0
s_lshr_b32 s69, s2, 3
s_lshl_b32 s69, s69, 2
s_add_u32 s69, s69, s3
s_lshl_b32 s69, s69, 10
v_and_b32 v124, 7, v1
v_lshlrev_b32 v124, 7, v124
v_add_u32 v124, s69, v124
v_min_u32 v124, L_endall-4-concat_heads__mha_block_cached__gqa_block_cached__near_ridge_kernel, v124
v_mov_b32 v123, s99
v_add_co_u32 v122, vcc, s98, v124
s_nop 1
v_addc_co_u32 v123, vcc, 0, v123, vcc
global_load_dword v127, v[122:123], off
s_lshl_b32 s37, s3, 3
v_add_u32 v126, s37, v1
v_lshlrev_b32 v126, 7, v126
v_mov_b32 v124, 0x40000000
v_cmp_gt_u32 vcc, 8, v1
s_nop 1
v_cndmask_b32 v126, v124, v126, vcc
s_mov_b32 s69, 0
s_and_b32 s50, s5, 3
s_lshl_b32 s50, s50, 2
s_add_u32 s50, s50, s3
s_lshl_b32 s50, s50, 3
v_lshrrev_b32 v122, 2, v1
v_add_u32 v122, s50, v122
v_lshlrev_b32 v122, 13, v122
v_and_b32 v124, 3, v1
v_lshl_add_u32 v122, v124, 7, v122
v_mov_b32 v124, 0x40000000
v_cmp_gt_u32 vcc, 32, v1
s_nop 1
v_cndmask_b32 v122, v124, v122, vcc
s_lshl_b32 s51, s3, 4
v_add_u32 v121, s51, v1
s_lshr_b32 s51, s5, 2
s_mul_i32 s51, s51, 30
v_lshrrev_b32 v123, 1, v121
v_add_u32 v123, s51, v123
v_lshlrev_b32 v123, 11, v123
v_and_b32 v120, 1, v121
v_lshl_add_u32 v123, v120, 7, v123
v_cmp_gt_u32 vcc, 16, v1
s_nop 1
v_cndmask_b32 v123, v124, v123, vcc
v_cmp_gt_u32 vcc, 60, v121
s_nop 1
v_cndmask_b32 v123, v124, v123, vcc
s_mov_b32 s50, 0x100000
s_mov_b32 s51, 256
buffer_load_dword v127, v122, s[12:15], s50 offen
buffer_load_dword v127, v123, s[8:11], s51 offen
s_mov_b32 s50, 0x200000
s_mov_b32 s51, 512
s_mul_i32 s37, s3, 16
v_add_u32 v124, s37, v1
s_lshl_b32 s37, s3, 16
v_lshlrev_b32 v125, 7, v1
v_add_u32 v125, s37, v125
v_mov_b32 v124, 0x40000000
v_cmp_gt_u32 vcc, 16, v1
s_nop 1
v_cndmask_b32 v125, v124, v125, vcc
s_mov_b32 s49, s100
s_add_u32 s29, s33, 121856
s_mov_b32 s30, 1048832
s_mov_b32 s31, 256
s_mov_b32 s28, 52224
v_add_u32 v15, s28, v14
s_waitcnt vmcnt(31)
s_waitcnt lgkmcnt(0)
s_barrier
ds_read_b128 a[128:131], v16 offset:0
ds_read_b128 a[132:135], v17 offset:0
ds_read_b128 a[136:139], v16 offset:2048
ds_read_b128 a[140:143], v17 offset:2048
ds_read_b128 a[144:147], v16 offset:4096
ds_read_b128 a[148:151], v17 offset:4096
ds_read_b128 a[152:155], v16 offset:6144
ds_read_b128 a[156:159], v17 offset:6144
ds_read_b64_tr_b16 a[192:193], v15 offset:0
ds_read_b64_tr_b16 a[194:195], v15 offset:256
ds_read_b64_tr_b16 a[196:197], v15 offset:8704
ds_read_b64_tr_b16 a[198:199], v15 offset:8960
ds_read_b64_tr_b16 a[200:201], v15 offset:8
ds_read_b64_tr_b16 a[202:203], v15 offset:264
ds_read_b64_tr_b16 a[204:205], v15 offset:8712
s_waitcnt lgkmcnt(14)
ds_read_b64_tr_b16 a[206:207], v15 offset:8968
s_waitcnt lgkmcnt(4)
v_mfma_f32_16x16x32_bf16 a[0:3], a[192:195], a[128:131], 0
ds_read_b64_tr_b16 a[208:209], v15 offset:64
v_mfma_f32_16x16x32_bf16 a[0:3], a[196:199], a[132:135], a[0:3]
ds_read_b64_tr_b16 a[210:211], v15 offset:320
v_mfma_f32_16x16x32_bf16 a[32:35], a[192:195], a[136:139], 0
ds_read_b64_tr_b16 a[212:213], v15 offset:8768
v_mfma_f32_16x16x32_bf16 a[32:35], a[196:199], a[140:143], a[32:35]
s_add_u32 m0, s29, 0
ds_read_b64_tr_b16 a[214:215], v15 offset:9024
v_mfma_f32_16x16x32_bf16 a[64:67], a[192:195], a[144:147], 0
buffer_load_dwordx4 v2, s[12:15], s30 offen  lds
v_mfma_f32_16x16x32_bf16 a[64:67], a[196:199], a[148:151], a[64:67]
s_add_u32 m0, s29, 1088
v_mfma_f32_16x16x32_bf16 a[96:99], a[192:195], a[152:155], 0
buffer_load_dwordx4 v3, s[12:15], s30 offen  lds
v_mfma_f32_16x16x32_bf16 a[96:99], a[196:199], a[156:159], a[96:99]
s_waitcnt lgkmcnt(4)
v_mfma_f32_16x16x32_bf16 a[4:7], a[200:203], a[128:131], 0
ds_read_b64_tr_b16 a[216:217], v15 offset:72
v_mfma_f32_16x16x32_bf16 a[4:7], a[204:207], a[132:135], a[4:7]
ds_read_b64_tr_b16 a[218:219], v15 offset:328
v_mfma_f32_16x16x32_bf16 a[36:39], a[200:203], a[136:139], 0
ds_read_b64_tr_b16 a[220:221], v15 offset:8776
v_mfma_f32_16x16x32_bf16 a[36:39], a[204:207], a[140:143], a[36:39]
s_add_u32 m0, s29, 2176
ds_read_b64_tr_b16 a[222:223], v15 offset:9032
v_mfma_f32_16x16x32_bf16 a[68:71], a[200:203], a[144:147], 0
buffer_load_dwordx4 v4, s[12:15], s30 offen  lds
v_mfma_f32_16x16x32_bf16 a[68:71], a[204:207], a[148:151], a[68:71]
s_add_u32 m0, s29, 3264
v_mfma_f32_16x16x32_bf16 a[100:103], a[200:203], a[152:155], 0
buffer_load_dwordx4 v5, s[12:15], s30 offen  lds
v_mfma_f32_16x16x32_bf16 a[100:103], a[204:207], a[156:159], a[100:103]
s_waitcnt lgkmcnt(4)
v_mfma_f32_16x16x32_bf16 a[8:11], a[208:211], a[128:131], 0
ds_read_b64_tr_b16 a[192:193], v15 offset:128
v_mfma_f32_16x16x32_bf16 a[8:11], a[212:215], a[132:135], a[8:11]
s_add_u32 s30, s30, 0x80000
ds_read_b64_tr_b16 a[194:195], v15 offset:384
v_mfma_f32_16x16x32_bf16 a[40:43], a[208:211], a[136:139], 0
ds_read_b64_tr_b16 a[196:197], v15 offset:8832
v_mfma_f32_16x16x32_bf16 a[40:43], a[212:215], a[140:143], a[40:43]
s_waitcnt vmcnt(27)
s_add_u32 m0, s34, 0
ds_read_b64_tr_b16 a[198:199], v15 offset:9088
v_mfma_f32_16x16x32_bf16 a[72:75], a[208:211], a[144:147], 0
buffer_load_dwordx4 v6, s[8:11], s31 offen  lds
v_mfma_f32_16x16x32_bf16 a[72:75], a[212:215], a[148:151], a[72:75]
s_add_u32 m0, s34, 1024
ds_read_b128 a[160:163], v16 offset:24576
v_mfma_f32_16x16x32_bf16 a[104:107], a[208:211], a[152:155], 0
buffer_load_dwordx4 v7, s[8:11], s31 offen  lds
v_mfma_f32_16x16x32_bf16 a[104:107], a[212:215], a[156:159], a[104:107]
s_waitcnt lgkmcnt(5)
ds_read_b128 a[164:167], v17 offset:24576
v_mfma_f32_16x16x32_bf16 a[12:15], a[216:219], a[128:131], 0
ds_read_b64_tr_b16 a[200:201], v15 offset:136
v_mfma_f32_16x16x32_bf16 a[12:15], a[220:223], a[132:135], a[12:15]
ds_read_b64_tr_b16 a[202:203], v15 offset:392
v_mfma_f32_16x16x32_bf16 a[44:47], a[216:219], a[136:139], 0
ds_read_b64_tr_b16 a[204:205], v15 offset:8840
v_mfma_f32_16x16x32_bf16 a[44:47], a[220:223], a[140:143], a[44:47]
s_add_u32 m0, s34, 2048
ds_read_b64_tr_b16 a[206:207], v15 offset:9096
v_mfma_f32_16x16x32_bf16 a[76:79], a[216:219], a[144:147], 0
buffer_load_dwordx4 v8, s[8:11], s31 offen  lds
v_mfma_f32_16x16x32_bf16 a[76:79], a[220:223], a[148:151], a[76:79]
s_add_u32 m0, s34, 3072
ds_read_b128 a[168:171], v16 offset:26624
v_mfma_f32_16x16x32_bf16 a[108:111], a[216:219], a[152:155], 0
buffer_load_dwordx4 v9, s[8:11], s31 offen  lds
v_mfma_f32_16x16x32_bf16 a[108:111], a[220:223], a[156:159], a[108:111]
s_waitcnt lgkmcnt(7)
ds_read_b128 a[172:175], v17 offset:26624
v_mfma_f32_16x16x32_bf16 a[16:19], a[192:195], a[128:131], 0
s_add_u32 s37, s28, 17408
ds_read_b64_tr_b16 a[208:209], v15 offset:192
v_mfma_f32_16x16x32_bf16 a[16:19], a[196:199], a[132:135], a[16:19]
s_cmp_eq_u32 s37, 139264
ds_read_b64_tr_b16 a[210:211], v15 offset:448
v_mfma_f32_16x16x32_bf16 a[48:51], a[192:195], a[136:139], 0
s_cselect_b32 s36, 52224, s37
ds_read_b64_tr_b16 a[212:213], v15 offset:8896
v_mfma_f32_16x16x32_bf16 a[48:51], a[196:199], a[140:143], a[48:51]
s_add_u32 m0, s34, 4096
ds_read_b64_tr_b16 a[214:215], v15 offset:9152
v_mfma_f32_16x16x32_bf16 a[80:83], a[192:195], a[144:147], 0
buffer_load_dwordx4 v10, s[8:11], s31 offen  lds
v_mfma_f32_16x16x32_bf16 a[80:83], a[196:199], a[148:151], a[80:83]
s_add_u32 m0, s34, 5120
ds_read_b128 a[176:179], v16 offset:28672
v_mfma_f32_16x16x32_bf16 a[112:115], a[192:195], a[152:155], 0
buffer_load_dwordx4 v11, s[8:11], s31 offen  lds
v_mfma_f32_16x16x32_bf16 a[112:115], a[196:199], a[156:159], a[112:115]
s_waitcnt lgkmcnt(7)
ds_read_b128 a[180:183], v17 offset:28672
v_mfma_f32_16x16x32_bf16 a[20:23], a[200:203], a[128:131], 0
ds_read_b64_tr_b16 a[216:217], v15 offset:200
v_mfma_f32_16x16x32_bf16 a[20:23], a[204:207], a[132:135], a[20:23]
ds_read_b64_tr_b16 a[218:219], v15 offset:456
v_mfma_f32_16x16x32_bf16 a[52:55], a[200:203], a[136:139], 0
ds_read_b64_tr_b16 a[220:221], v15 offset:8904
v_mfma_f32_16x16x32_bf16 a[52:55], a[204:207], a[140:143], a[52:55]
s_add_u32 m0, s34, 6144
ds_read_b64_tr_b16 a[222:223], v15 offset:9160
v_mfma_f32_16x16x32_bf16 a[84:87], a[200:203], a[144:147], 0
buffer_load_dwordx4 v12, s[8:11], s31 offen  lds
v_mfma_f32_16x16x32_bf16 a[84:87], a[204:207], a[148:151], a[84:87]
s_add_u32 m0, s34, 7168
ds_read_b128 a[184:187], v16 offset:30720
v_mfma_f32_16x16x32_bf16 a[116:119], a[200:203], a[152:155], 0
buffer_load_dwordx4 v13, s[8:11], s31 offen  lds
v_mfma_f32_16x16x32_bf16 a[116:119], a[204:207], a[156:159], a[116:119]
ds_read_b128 a[188:191], v17 offset:30720
s_waitcnt vmcnt(31) lgkmcnt(2)
s_barrier
v_add_u32 v15, s36, v14
v_mfma_f32_16x16x32_bf16 a[24:27], a[208:211], a[128:131], 0
ds_read_b64_tr_b16 a[192:193], v15 offset:0
v_mfma_f32_16x16x32_bf16 a[24:27], a[212:215], a[132:135], a[24:27]
s_add_u32 s29, s28, s33
ds_read_b64_tr_b16 a[194:195], v15 offset:256
v_mfma_f32_16x16x32_bf16 a[56:59], a[208:211], a[136:139], 0
s_mov_b32 s28, s36
ds_read_b64_tr_b16 a[196:197], v15 offset:8704
v_mfma_f32_16x16x32_bf16 a[56:59], a[212:215], a[140:143], a[56:59]
ds_read_b64_tr_b16 a[198:199], v15 offset:8960
v_mfma_f32_16x16x32_bf16 a[88:91], a[208:211], a[144:147], 0
v_mfma_f32_16x16x32_bf16 a[88:91], a[212:215], a[148:151], a[88:91]
s_add_u32 s31, s31, 128
v_mfma_f32_16x16x32_bf16 a[120:123], a[208:211], a[152:155], 0
v_mfma_f32_16x16x32_bf16 a[120:123], a[212:215], a[156:159], a[120:123]
v_mfma_f32_16x16x32_bf16 a[28:31], a[216:219], a[128:131], 0
ds_read_b64_tr_b16 a[200:201], v15 offset:8
v_mfma_f32_16x16x32_bf16 a[28:31], a[220:223], a[132:135], a[28:31]
ds_read_b64_tr_b16 a[202:203], v15 offset:264
v_mfma_f32_16x16x32_bf16 a[60:63], a[216:219], a[136:139], 0
ds_read_b64_tr_b16 a[204:205], v15 offset:8712
buffer_load_dword v127, v122, s[12:15], s50 offen
v_mfma_f32_16x16x32_bf16 a[60:63], a[220:223], a[140:143], a[60:63]
ds_read_b64_tr_b16 a[206:207], v15 offset:8968
v_mfma_f32_16x16x32_bf16 a[92:95], a[216:219], a[144:147], 0
s_add_u32 s50, s50, 0x100000
v_mfma_f32_16x16x32_bf16 a[92:95], a[220:223], a[148:151], a[92:95]
v_mfma_f32_16x16x32_bf16 a[124:127], a[216:219], a[152:155], 0
v_mfma_f32_16x16x32_bf16 a[124:127], a[220:223], a[156:159], a[124:127]
s_waitcnt lgkmcnt(4)
v_mfma_f32_16x16x32_bf16 a[0:3], a[192:195], a[160:163], a[0:3]
ds_read_b64_tr_b16 a[208:209], v15 offset:64
v_mfma_f32_16x16x32_bf16 a[0:3], a[196:199], a[164:167], a[0:3]
ds_read_b64_tr_b16 a[210:211], v15 offset:320
v_mfma_f32_16x16x32_bf16 a[32:35], a[192:195], a[168:171], a[32:35]
ds_read_b64_tr_b16 a[212:213], v15 offset:8768
v_mfma_f32_16x16x32_bf16 a[32:35], a[196:199], a[172:175], a[32:35]
s_add_u32 m0, s29, 0
ds_read_b64_tr_b16 a[214:215], v15 offset:9024
v_mfma_f32_16x16x32_bf16 a[64:67], a[192:195], a[176:179], a[64:67]
buffer_load_dwordx4 v2, s[12:15], s30 offen  lds
v_mfma_f32_16x16x32_bf16 a[64:67], a[196:199], a[180:183], a[64:67]
s_add_u32 m0, s29, 1088
v_mfma_f32_16x16x32_bf16 a[96:99], a[192:195], a[184:187], a[96:99]
buffer_load_dwordx4 v3, s[12:15], s30 offen  lds
v_mfma_f32_16x16x32_bf16 a[96:99], a[196:199], a[188:191], a[96:99]
s_waitcnt lgkmcnt(4)
v_mfma_f32_16x16x32_bf16 a[4:7], a[200:203], a[160:163], a[4:7]
ds_read_b64_tr_b16 a[216:217], v15 offset:72
v_mfma_f32_16x16x32_bf16 a[4:7], a[204:207], a[164:167], a[4:7]
ds_read_b64_tr_b16 a[218:219], v15 offset:328
v_mfma_f32_16x16x32_bf16 a[36:39], a[200:203], a[168:171], a[36:39]
ds_read_b64_tr_b16 a[220:221], v15 offset:8776
v_mfma_f32_16x16x32_bf16 a[36:39], a[204:207], a[172:175], a[36:39]
s_add_u32 m0, s29, 2176
ds_read_b64_tr_b16 a[222:223], v15 offset:9032
v_mfma_f32_16x16x32_bf16 a[68:71], a[200:203], a[176:179], a[68:71]
buffer_load_dwordx4 v4, s[12:15], s30 offen  lds
v_mfma_f32_16x16x32_bf16 a[68:71], a[204:207], a[180:183], a[68:71]
s_add_u32 m0, s29, 3264
v_mfma_f32_16x16x32_bf16 a[100:103], a[200:203], a[184:187], a[100:103]
buffer_load_dwordx4 v5, s[12:15], s30 offen  lds
v_mfma_f32_16x16x32_bf16 a[100:103], a[204:207], a[188:191], a[100:103]
s_waitcnt lgkmcnt(4)
v_mfma_f32_16x16x32_bf16 a[8:11], a[208:211], a[160:163], a[8:11]
ds_read_b64_tr_b16 a[192:193], v15 offset:128
v_mfma_f32_16x16x32_bf16 a[8:11], a[212:215], a[164:167], a[8:11]
s_add_u32 s30, s30, 0xfff7ff00
ds_read_b64_tr_b16 a[194:195], v15 offset:384
v_mfma_f32_16x16x32_bf16 a[40:43], a[208:211], a[168:171], a[40:43]
ds_read_b64_tr_b16 a[196:197], v15 offset:8832
v_mfma_f32_16x16x32_bf16 a[40:43], a[212:215], a[172:175], a[40:43]
s_add_u32 m0, s35, 0
ds_read_b64_tr_b16 a[198:199], v15 offset:9088
v_mfma_f32_16x16x32_bf16 a[72:75], a[208:211], a[176:179], a[72:75]
buffer_load_dwordx4 v6, s[8:11], s31 offen  lds
v_mfma_f32_16x16x32_bf16 a[72:75], a[212:215], a[180:183], a[72:75]
s_add_u32 m0, s35, 1024
v_mfma_f32_16x16x32_bf16 a[104:107], a[208:211], a[184:187], a[104:107]
buffer_load_dwordx4 v7, s[8:11], s31 offen  lds
v_mfma_f32_16x16x32_bf16 a[104:107], a[212:215], a[188:191], a[104:107]
s_waitcnt lgkmcnt(4)
v_mfma_f32_16x16x32_bf16 a[12:15], a[216:219], a[160:163], a[12:15]
ds_read_b64_tr_b16 a[200:201], v15 offset:136
v_mfma_f32_16x16x32_bf16 a[12:15], a[220:223], a[164:167], a[12:15]
ds_read_b64_tr_b16 a[202:203], v15 offset:392
v_mfma_f32_16x16x32_bf16 a[44:47], a[216:219], a[168:171], a[44:47]
ds_read_b64_tr_b16 a[204:205], v15 offset:8840
v_mfma_f32_16x16x32_bf16 a[44:47], a[220:223], a[172:175], a[44:47]
s_add_u32 m0, s35, 2048
ds_read_b64_tr_b16 a[206:207], v15 offset:9096
v_mfma_f32_16x16x32_bf16 a[76:79], a[216:219], a[176:179], a[76:79]
buffer_load_dwordx4 v8, s[8:11], s31 offen  lds
v_mfma_f32_16x16x32_bf16 a[76:79], a[220:223], a[180:183], a[76:79]
s_add_u32 m0, s35, 3072
v_mfma_f32_16x16x32_bf16 a[108:111], a[216:219], a[184:187], a[108:111]
buffer_load_dwordx4 v9, s[8:11], s31 offen  lds
v_mfma_f32_16x16x32_bf16 a[108:111], a[220:223], a[188:191], a[108:111]
s_waitcnt lgkmcnt(4)
v_mfma_f32_16x16x32_bf16 a[16:19], a[192:195], a[160:163], a[16:19]
s_add_u32 s37, s28, 17408
ds_read_b64_tr_b16 a[208:209], v15 offset:192
v_mfma_f32_16x16x32_bf16 a[16:19], a[196:199], a[164:167], a[16:19]
s_cmp_eq_u32 s37, 139264
ds_read_b64_tr_b16 a[210:211], v15 offset:448
v_mfma_f32_16x16x32_bf16 a[48:51], a[192:195], a[168:171], a[48:51]
s_cselect_b32 s36, 52224, s37
ds_read_b64_tr_b16 a[212:213], v15 offset:8896
v_mfma_f32_16x16x32_bf16 a[48:51], a[196:199], a[172:175], a[48:51]
s_add_u32 m0, s35, 4096
ds_read_b64_tr_b16 a[214:215], v15 offset:9152
v_mfma_f32_16x16x32_bf16 a[80:83], a[192:195], a[176:179], a[80:83]
buffer_load_dwordx4 v10, s[8:11], s31 offen  lds
v_mfma_f32_16x16x32_bf16 a[80:83], a[196:199], a[180:183], a[80:83]
s_add_u32 m0, s35, 5120
v_mfma_f32_16x16x32_bf16 a[112:115], a[192:195], a[184:187], a[112:115]
buffer_load_dwordx4 v11, s[8:11], s31 offen  lds
v_mfma_f32_16x16x32_bf16 a[112:115], a[196:199], a[188:191], a[112:115]
s_waitcnt lgkmcnt(4)
v_mfma_f32_16x16x32_bf16 a[20:23], a[200:203], a[160:163], a[20:23]
ds_read_b64_tr_b16 a[216:217], v15 offset:200
v_mfma_f32_16x16x32_bf16 a[20:23], a[204:207], a[164:167], a[20:23]
ds_read_b64_tr_b16 a[218:219], v15 offset:456
v_mfma_f32_16x16x32_bf16 a[52:55], a[200:203], a[168:171], a[52:55]
ds_read_b64_tr_b16 a[220:221], v15 offset:8904
v_mfma_f32_16x16x32_bf16 a[52:55], a[204:207], a[172:175], a[52:55]
s_add_u32 m0, s35, 6144
ds_read_b64_tr_b16 a[222:223], v15 offset:9160
v_mfma_f32_16x16x32_bf16 a[84:87], a[200:203], a[176:179], a[84:87]
buffer_load_dwordx4 v12, s[8:11], s31 offen  lds
v_mfma_f32_16x16x32_bf16 a[84:87], a[204:207], a[180:183], a[84:87]
s_add_u32 m0, s35, 7168
v_mfma_f32_16x16x32_bf16 a[116:119], a[200:203], a[184:187], a[116:119]
buffer_load_dwordx4 v13, s[8:11], s31 offen  lds
v_mfma_f32_16x16x32_bf16 a[116:119], a[204:207], a[188:191], a[116:119]
s_waitcnt vmcnt(40) lgkmcnt(0)
s_barrier
v_add_u32 v15, s36, v14
v_mfma_f32_16x16x32_bf16 a[24:27], a[208:211], a[160:163], a[24:27]
ds_read_b64_tr_b16 a[192:193], v15 offset:0
v_mfma_f32_16x16x32_bf16 a[24:27], a[212:215], a[164:167], a[24:27]
s_add_u32 s29, s28, s33
ds_read_b64_tr_b16 a[194:195], v15 offset:256
v_mfma_f32_16x16x32_bf16 a[56:59], a[208:211], a[168:171], a[56:59]
s_mov_b32 s28, s36
ds_read_b64_tr_b16 a[196:197], v15 offset:8704
v_mfma_f32_16x16x32_bf16 a[56:59], a[212:215], a[172:175], a[56:59]
ds_read_b64_tr_b16 a[198:199], v15 offset:8960
v_mfma_f32_16x16x32_bf16 a[88:91], a[208:211], a[176:179], a[88:91]
v_mfma_f32_16x16x32_bf16 a[88:91], a[212:215], a[180:183], a[88:91]
s_add_u32 s31, s31, 128
v_mfma_f32_16x16x32_bf16 a[120:123], a[208:211], a[184:187], a[120:123]
v_mfma_f32_16x16x32_bf16 a[120:123], a[212:215], a[188:191], a[120:123]
v_mfma_f32_16x16x32_bf16 a[28:31], a[216:219], a[160:163], a[28:31]
ds_read_b64_tr_b16 a[200:201], v15 offset:8
v_mfma_f32_16x16x32_bf16 a[28:31], a[220:223], a[164:167], a[28:31]
ds_read_b64_tr_b16 a[202:203], v15 offset:264
v_mfma_f32_16x16x32_bf16 a[60:63], a[216:219], a[168:171], a[60:63]
ds_read_b64_tr_b16 a[204:205], v15 offset:8712
buffer_load_dword v127, v123, s[8:11], s51 offen
v_mfma_f32_16x16x32_bf16 a[60:63], a[220:223], a[172:175], a[60:63]
ds_read_b64_tr_b16 a[206:207], v15 offset:8968
v_mfma_f32_16x16x32_bf16 a[92:95], a[216:219], a[176:179], a[92:95]
s_add_u32 s51, s51, 256
v_mfma_f32_16x16x32_bf16 a[92:95], a[220:223], a[180:183], a[92:95]
v_mfma_f32_16x16x32_bf16 a[124:127], a[216:219], a[184:187], a[124:127]
v_mfma_f32_16x16x32_bf16 a[124:127], a[220:223], a[188:191], a[124:127]
s_waitcnt lgkmcnt(4)
v_mfma_f32_16x16x32_bf16 v[128:131], a[192:195], a[128:131], 0
ds_read_b64_tr_b16 a[208:209], v15 offset:64
v_mfma_f32_16x16x32_bf16 v[128:131], a[196:199], a[132:135], v[128:131]
ds_read_b64_tr_b16 a[210:211], v15 offset:320
v_mfma_f32_16x16x32_bf16 v[160:163], a[192:195], a[136:139], 0
ds_read_b64_tr_b16 a[212:213], v15 offset:8768
v_mfma_f32_16x16x32_bf16 v[160:163], a[196:199], a[140:143], v[160:163]
s_add_u32 m0, s29, 0
ds_read_b64_tr_b16 a[214:215], v15 offset:9024
v_mfma_f32_16x16x32_bf16 v[192:195], a[192:195], a[144:147], 0
buffer_load_dwordx4 v2, s[12:15], s30 offen  lds
v_mfma_f32_16x16x32_bf16 v[192:195], a[196:199], a[148:151], v[192:195]
s_add_u32 m0, s29, 1088
v_mfma_f32_16x16x32_bf16 v[224:227], a[192:195], a[152:155], 0
buffer_load_dwordx4 v3, s[12:15], s30 offen  lds
v_mfma_f32_16x16x32_bf16 v[224:227], a[196:199], a[156:159], v[224:227]
s_waitcnt lgkmcnt(4)
v_mfma_f32_16x16x32_bf16 v[132:135], a[200:203], a[128:131], 0
ds_read_b64_tr_b16 a[216:217], v15 offset:72
v_mfma_f32_16x16x32_bf16 v[132:135], a[204:207], a[132:135], v[132:135]
ds_read_b64_tr_b16 a[218:219], v15 offset:328
v_mfma_f32_16x16x32_bf16 v[164:167], a[200:203], a[136:139], 0
ds_read_b64_tr_b16 a[220:221], v15 offset:8776
v_mfma_f32_16x16x32_bf16 v[164:167], a[204:207], a[140:143], v[164:167]
s_add_u32 m0, s29, 2176
ds_read_b64_tr_b16 a[222:223], v15 offset:9032
v_mfma_f32_16x16x32_bf16 v[196:199], a[200:203], a[144:147], 0
buffer_load_dwordx4 v4, s[12:15], s30 offen  lds
v_mfma_f32_16x16x32_bf16 v[196:199], a[204:207], a[148:151], v[196:199]
s_add_u32 m0, s29, 3264
v_mfma_f32_16x16x32_bf16 v[228:231], a[200:203], a[152:155], 0
buffer_load_dwordx4 v5, s[12:15], s30 offen  lds
v_mfma_f32_16x16x32_bf16 v[228:231], a[204:207], a[156:159], v[228:231]
s_waitcnt lgkmcnt(4)
v_mfma_f32_16x16x32_bf16 v[136:139], a[208:211], a[128:131], 0
ds_read_b64_tr_b16 a[192:193], v15 offset:128
v_mfma_f32_16x16x32_bf16 v[136:139], a[212:215], a[132:135], v[136:139]
s_add_u32 s30, s30, 0x80000
ds_read_b64_tr_b16 a[194:195], v15 offset:384
v_mfma_f32_16x16x32_bf16 v[168:171], a[208:211], a[136:139], 0
ds_read_b64_tr_b16 a[196:197], v15 offset:8832
v_mfma_f32_16x16x32_bf16 v[168:171], a[212:215], a[140:143], v[168:171]
ds_read_b64_tr_b16 a[198:199], v15 offset:9088
v_mfma_f32_16x16x32_bf16 v[200:203], a[208:211], a[144:147], 0
v_mfma_f32_16x16x32_bf16 v[200:203], a[212:215], a[148:151], v[200:203]
v_mfma_f32_16x16x32_bf16 v[232:235], a[208:211], a[152:155], 0
v_mfma_f32_16x16x32_bf16 v[232:235], a[212:215], a[156:159], v[232:235]
s_waitcnt lgkmcnt(4)
v_mfma_f32_16x16x32_bf16 v[140:143], a[216:219], a[128:131], 0
ds_read_b64_tr_b16 a[200:201], v15 offset:136
v_mfma_f32_16x16x32_bf16 v[140:143], a[220:223], a[132:135], v[140:143]
ds_read_b64_tr_b16 a[202:203], v15 offset:392
v_mfma_f32_16x16x32_bf16 v[172:175], a[216:219], a[136:139], 0
ds_read_b64_tr_b16 a[204:205], v15 offset:8840
v_mfma_f32_16x16x32_bf16 v[172:175], a[220:223], a[140:143], v[172:175]
ds_read_b64_tr_b16 a[206:207], v15 offset:9096
v_mfma_f32_16x16x32_bf16 v[204:207], a[216:219], a[144:147], 0
v_mfma_f32_16x16x32_bf16 v[204:207], a[220:223], a[148:151], v[204:207]
v_mfma_f32_16x16x32_bf16 v[236:239], a[216:219], a[152:155], 0
v_mfma_f32_16x16x32_bf16 v[236:239], a[220:223], a[156:159], v[236:239]
s_waitcnt lgkmcnt(4)
v_mfma_f32_16x16x32_bf16 v[144:147], a[192:195], a[128:131], 0
s_add_u32 s37, s28, 17408
ds_read_b64_tr_b16 a[208:209], v15 offset:192
v_mfma_f32_16x16x32_bf16 v[144:147], a[196:199], a[132:135], v[144:147]
s_cmp_eq_u32 s37, 139264
ds_read_b64_tr_b16 a[210:211], v15 offset:448
v_mfma_f32_16x16x32_bf16 v[176:179], a[192:195], a[136:139], 0
s_cselect_b32 s36, 52224, s37
ds_read_b64_tr_b16 a[212:213], v15 offset:8896
v_mfma_f32_16x16x32_bf16 v[176:179], a[196:199], a[140:143], v[176:179]
ds_read_b64_tr_b16 a[214:215], v15 offset:9152
v_mfma_f32_16x16x32_bf16 v[208:211], a[192:195], a[144:147], 0
v_mfma_f32_16x16x32_bf16 v[208:211], a[196:199], a[148:151], v[208:211]
v_mfma_f32_16x16x32_bf16 v[240:243], a[192:195], a[152:155], 0
v_mfma_f32_16x16x32_bf16 v[240:243], a[196:199], a[156:159], v[240:243]
s_waitcnt lgkmcnt(4)
v_mfma_f32_16x16x32_bf16 v[148:151], a[200:203], a[128:131], 0
ds_read_b64_tr_b16 a[216:217], v15 offset:200
v_mfma_f32_16x16x32_bf16 v[148:151], a[204:207], a[132:135], v[148:151]
ds_read_b64_tr_b16 a[218:219], v15 offset:456
v_mfma_f32_16x16x32_bf16 v[180:183], a[200:203], a[136:139], 0
ds_read_b64_tr_b16 a[220:221], v15 offset:8904
v_mfma_f32_16x16x32_bf16 v[180:183], a[204:207], a[140:143], v[180:183]
ds_read_b64_tr_b16 a[222:223], v15 offset:9160
v_mfma_f32_16x16x32_bf16 v[212:215], a[200:203], a[144:147], 0
v_mfma_f32_16x16x32_bf16 v[212:215], a[204:207], a[148:151], v[212:215]
v_mfma_f32_16x16x32_bf16 v[244:247], a[200:203], a[152:155], 0
v_mfma_f32_16x16x32_bf16 v[244:247], a[204:207], a[156:159], v[244:247]
s_waitcnt vmcnt(41) lgkmcnt(0)
s_barrier
v_add_u32 v15, s36, v14
v_mfma_f32_16x16x32_bf16 v[152:155], a[208:211], a[128:131], 0
ds_read_b64_tr_b16 a[192:193], v15 offset:0
v_mfma_f32_16x16x32_bf16 v[152:155], a[212:215], a[132:135], v[152:155]
s_add_u32 s29, s28, s33
ds_read_b64_tr_b16 a[194:195], v15 offset:256
v_mfma_f32_16x16x32_bf16 v[184:187], a[208:211], a[136:139], 0
s_mov_b32 s28, s36
ds_read_b64_tr_b16 a[196:197], v15 offset:8704
buffer_load_dword v127, v126, s[52:55], s69 offen
v_mfma_f32_16x16x32_bf16 v[184:187], a[212:215], a[140:143], v[184:187]
ds_read_b64_tr_b16 a[198:199], v15 offset:8960
v_mfma_f32_16x16x32_bf16 v[216:219], a[208:211], a[144:147], 0
v_mfma_f32_16x16x32_bf16 v[216:219], a[212:215], a[148:151], v[216:219]
v_mfma_f32_16x16x32_bf16 v[248:251], a[208:211], a[152:155], 0
v_mfma_f32_16x16x32_bf16 v[248:251], a[212:215], a[156:159], v[248:251]
v_mfma_f32_16x16x32_bf16 v[156:159], a[216:219], a[128:131], 0
ds_read_b64_tr_b16 a[200:201], v15 offset:8
v_mfma_f32_16x16x32_bf16 v[156:159], a[220:223], a[132:135], v[156:159]
s_add_u32 s69, s69, 4096
ds_read_b64_tr_b16 a[202:203], v15 offset:264
v_mfma_f32_16x16x32_bf16 v[188:191], a[216:219], a[136:139], 0
ds_read_b64_tr_b16 a[204:205], v15 offset:8712
v_mfma_f32_16x16x32_bf16 v[188:191], a[220:223], a[140:143], v[188:191]
ds_read_b64_tr_b16 a[206:207], v15 offset:8968
v_mfma_f32_16x16x32_bf16 v[220:223], a[216:219], a[144:147], 0
v_mfma_f32_16x16x32_bf16 v[220:223], a[220:223], a[148:151], v[220:223]
v_mfma_f32_16x16x32_bf16 v[252:255], a[216:219], a[152:155], 0
v_mfma_f32_16x16x32_bf16 v[252:255], a[220:223], a[156:159], v[252:255]
s_waitcnt lgkmcnt(4)
v_mfma_f32_16x16x32_bf16 v[128:131], a[192:195], a[160:163], v[128:131]
ds_read_b64_tr_b16 a[208:209], v15 offset:64
v_mfma_f32_16x16x32_bf16 v[128:131], a[196:199], a[164:167], v[128:131]
ds_read_b64_tr_b16 a[210:211], v15 offset:320
v_mfma_f32_16x16x32_bf16 v[160:163], a[192:195], a[168:171], v[160:163]
ds_read_b64_tr_b16 a[212:213], v15 offset:8768
v_mfma_f32_16x16x32_bf16 v[160:163], a[196:199], a[172:175], v[160:163]
s_add_u32 m0, s29, 0
ds_read_b64_tr_b16 a[214:215], v15 offset:9024
v_mfma_f32_16x16x32_bf16 v[192:195], a[192:195], a[176:179], v[192:195]
buffer_load_dwordx4 v2, s[12:15], s30 offen  lds
v_mfma_f32_16x16x32_bf16 v[192:195], a[196:199], a[180:183], v[192:195]
s_add_u32 m0, s29, 1088
v_mfma_f32_16x16x32_bf16 v[224:227], a[192:195], a[184:187], v[224:227]
buffer_load_dwordx4 v3, s[12:15], s30 offen  lds
v_mfma_f32_16x16x32_bf16 v[224:227], a[196:199], a[188:191], v[224:227]
s_waitcnt lgkmcnt(4)
v_mfma_f32_16x16x32_bf16 v[132:135], a[200:203], a[160:163], v[132:135]
ds_read_b64_tr_b16 a[216:217], v15 offset:72
v_mfma_f32_16x16x32_bf16 v[132:135], a[204:207], a[164:167], v[132:135]
ds_read_b64_tr_b16 a[218:219], v15 offset:328
v_mfma_f32_16x16x32_bf16 v[164:167], a[200:203], a[168:171], v[164:167]
ds_read_b64_tr_b16 a[220:221], v15 offset:8776
v_mfma_f32_16x16x32_bf16 v[164:167], a[204:207], a[172:175], v[164:167]
s_add_u32 m0, s29, 2176
ds_read_b64_tr_b16 a[222:223], v15 offset:9032
v_mfma_f32_16x16x32_bf16 v[196:199], a[200:203], a[176:179], v[196:199]
buffer_load_dwordx4 v4, s[12:15], s30 offen  lds
v_mfma_f32_16x16x32_bf16 v[196:199], a[204:207], a[180:183], v[196:199]
s_add_u32 m0, s29, 3264
v_mfma_f32_16x16x32_bf16 v[228:231], a[200:203], a[184:187], v[228:231]
buffer_load_dwordx4 v5, s[12:15], s30 offen  lds
v_mfma_f32_16x16x32_bf16 v[228:231], a[204:207], a[188:191], v[228:231]
s_waitcnt lgkmcnt(4)
v_mfma_f32_16x16x32_bf16 v[136:139], a[208:211], a[160:163], v[136:139]
ds_read_b64_tr_b16 a[192:193], v15 offset:128
v_mfma_f32_16x16x32_bf16 v[136:139], a[212:215], a[164:167], v[136:139]
s_add_u32 s30, s30, 0x80100
ds_read_b64_tr_b16 a[194:195], v15 offset:384
v_mfma_f32_16x16x32_bf16 v[168:171], a[208:211], a[168:171], v[168:171]
ds_read_b64_tr_b16 a[196:197], v15 offset:8832
buffer_load_dword v127, v125, s[16:19], s49 offen
v_mfma_f32_16x16x32_bf16 v[168:171], a[212:215], a[172:175], v[168:171]
s_waitcnt vmcnt(24)
ds_read_b64_tr_b16 a[198:199], v15 offset:9088
v_mfma_f32_16x16x32_bf16 v[200:203], a[208:211], a[176:179], v[200:203]
ds_read_b128 a[128:131], v16 offset:0
v_mfma_f32_16x16x32_bf16 v[200:203], a[212:215], a[180:183], v[200:203]
v_mfma_f32_16x16x32_bf16 v[232:235], a[208:211], a[184:187], v[232:235]
ds_read_b128 a[132:135], v17 offset:0
v_mfma_f32_16x16x32_bf16 v[232:235], a[212:215], a[188:191], v[232:235]
s_waitcnt lgkmcnt(6)
v_mfma_f32_16x16x32_bf16 v[140:143], a[216:219], a[160:163], v[140:143]
ds_read_b64_tr_b16 a[200:201], v15 offset:136
v_mfma_f32_16x16x32_bf16 v[140:143], a[220:223], a[164:167], v[140:143]
ds_read_b64_tr_b16 a[202:203], v15 offset:392
v_mfma_f32_16x16x32_bf16 v[172:175], a[216:219], a[168:171], v[172:175]
ds_read_b64_tr_b16 a[204:205], v15 offset:8840
buffer_load_dword v127, v125, s[20:23], s49 offen
s_add_u32 s49, s49, s92
s_and_b32 s49, s49, 0xf800
v_mfma_f32_16x16x32_bf16 v[172:175], a[220:223], a[172:175], v[172:175]
ds_read_b64_tr_b16 a[206:207], v15 offset:9096
v_mfma_f32_16x16x32_bf16 v[204:207], a[216:219], a[176:179], v[204:207]
ds_read_b128 a[136:139], v16 offset:2048
v_mfma_f32_16x16x32_bf16 v[204:207], a[220:223], a[180:183], v[204:207]
v_mfma_f32_16x16x32_bf16 v[236:239], a[216:219], a[184:187], v[236:239]
ds_read_b128 a[140:143], v17 offset:2048
v_mfma_f32_16x16x32_bf16 v[236:239], a[220:223], a[188:191], v[236:239]
s_waitcnt lgkmcnt(8)
v_mfma_f32_16x16x32_bf16 v[144:147], a[192:195], a[160:163], v[144:147]
s_add_u32 s37, s28, 17408
ds_read_b64_tr_b16 a[208:209], v15 offset:192
v_mfma_f32_16x16x32_bf16 v[144:147], a[196:199], a[164:167], v[144:147]
s_cmp_eq_u32 s37, 139264
ds_read_b64_tr_b16 a[210:211], v15 offset:448
v_mfma_f32_16x16x32_bf16 v[176:179], a[192:195], a[168:171], v[176:179]
s_cselect_b32 s36, 52224, s37
ds_read_b64_tr_b16 a[212:213], v15 offset:8896
v_mfma_f32_16x16x32_bf16 v[176:179], a[196:199], a[172:175], v[176:179]
ds_read_b64_tr_b16 a[214:215], v15 offset:9152
v_mfma_f32_16x16x32_bf16 v[208:211], a[192:195], a[176:179], v[208:211]
ds_read_b128 a[144:147], v16 offset:4096
v_mfma_f32_16x16x32_bf16 v[208:211], a[196:199], a[180:183], v[208:211]
v_mfma_f32_16x16x32_bf16 v[240:243], a[192:195], a[184:187], v[240:243]
ds_read_b128 a[148:151], v17 offset:4096
v_mfma_f32_16x16x32_bf16 v[240:243], a[196:199], a[188:191], v[240:243]
s_waitcnt lgkmcnt(8)
v_mfma_f32_16x16x32_bf16 v[148:151], a[200:203], a[160:163], v[148:151]
ds_read_b64_tr_b16 a[216:217], v15 offset:200
v_mfma_f32_16x16x32_bf16 v[148:151], a[204:207], a[164:167], v[148:151]
ds_read_b64_tr_b16 a[218:219], v15 offset:456
v_mfma_f32_16x16x32_bf16 v[180:183], a[200:203], a[168:171], v[180:183]
ds_read_b64_tr_b16 a[220:221], v15 offset:8904
v_mfma_f32_16x16x32_bf16 v[180:183], a[204:207], a[172:175], v[180:183]
ds_read_b64_tr_b16 a[222:223], v15 offset:9160
v_mfma_f32_16x16x32_bf16 v[212:215], a[200:203], a[176:179], v[212:215]
ds_read_b128 a[152:155], v16 offset:6144
v_mfma_f32_16x16x32_bf16 v[212:215], a[204:207], a[180:183], v[212:215]
v_mfma_f32_16x16x32_bf16 v[244:247], a[200:203], a[184:187], v[244:247]
ds_read_b128 a[156:159], v17 offset:6144
v_mfma_f32_16x16x32_bf16 v[244:247], a[204:207], a[188:191], v[244:247]
s_waitcnt lgkmcnt(2)
s_barrier
v_add_u32 v15, s36, v14
v_mfma_f32_16x16x32_bf16 v[152:155], a[208:211], a[160:163], v[152:155]
ds_read_b64_tr_b16 a[192:193], v15 offset:0
v_mfma_f32_16x16x32_bf16 v[152:155], a[212:215], a[164:167], v[152:155]
s_add_u32 s29, s28, s33
ds_read_b64_tr_b16 a[194:195], v15 offset:256
v_mfma_f32_16x16x32_bf16 v[184:187], a[208:211], a[168:171], v[184:187]
s_mov_b32 s28, s36
ds_read_b64_tr_b16 a[196:197], v15 offset:8704
buffer_load_dword v127, v126, s[52:55], s69 offen
v_mfma_f32_16x16x32_bf16 v[184:187], a[212:215], a[172:175], v[184:187]
ds_read_b64_tr_b16 a[198:199], v15 offset:8960
v_mfma_f32_16x16x32_bf16 v[216:219], a[208:211], a[176:179], v[216:219]
v_mfma_f32_16x16x32_bf16 v[216:219], a[212:215], a[180:183], v[216:219]
v_mfma_f32_16x16x32_bf16 v[248:251], a[208:211], a[184:187], v[248:251]
v_mfma_f32_16x16x32_bf16 v[248:251], a[212:215], a[188:191], v[248:251]
v_mfma_f32_16x16x32_bf16 v[156:159], a[216:219], a[160:163], v[156:159]
ds_read_b64_tr_b16 a[200:201], v15 offset:8
v_mfma_f32_16x16x32_bf16 v[156:159], a[220:223], a[164:167], v[156:159]
s_add_u32 s69, s69, 4096
ds_read_b64_tr_b16 a[202:203], v15 offset:264
v_mfma_f32_16x16x32_bf16 v[188:191], a[216:219], a[168:171], v[188:191]
ds_read_b64_tr_b16 a[204:205], v15 offset:8712
v_mfma_f32_16x16x32_bf16 v[188:191], a[220:223], a[172:175], v[188:191]
ds_read_b64_tr_b16 a[206:207], v15 offset:8968
v_mfma_f32_16x16x32_bf16 v[220:223], a[216:219], a[176:179], v[220:223]
v_mfma_f32_16x16x32_bf16 v[220:223], a[220:223], a[180:183], v[220:223]
s_sub_u32 s32, s32, 1
v_mfma_f32_16x16x32_bf16 v[252:255], a[216:219], a[184:187], v[252:255]
s_cmp_lg_u32 s32, 0
v_mfma_f32_16x16x32_bf16 v[252:255], a[220:223], a[188:191], v[252:255]
s_waitcnt lgkmcnt(4)
s_mov_b32 s32, 6
L_qp:
v_mfma_f32_16x16x32_bf16 a[0:3], a[192:195], a[128:131], a[0:3]
ds_read_b64_tr_b16 a[208:209], v15 offset:64
v_mfma_f32_16x16x32_bf16 a[0:3], a[196:199], a[132:135], a[0:3]
ds_read_b64_tr_b16 a[210:211], v15 offset:320
v_mfma_f32_16x16x32_bf16 a[32:35], a[192:195], a[136:139], a[32:35]
ds_read_b64_tr_b16 a[212:213], v15 offset:8768
v_mfma_f32_16x16x32_bf16 a[32:35], a[196:199], a[140:143], a[32:35]
s_add_u32 m0, s29, 0
ds_read_b64_tr_b16 a[214:215], v15 offset:9024
v_mfma_f32_16x16x32_bf16 a[64:67], a[192:195], a[144:147], a[64:67]
buffer_load_dwordx4 v2, s[12:15], s30 offen  lds
v_mfma_f32_16x16x32_bf16 a[64:67], a[196:199], a[148:151], a[64:67]
s_add_u32 m0, s29, 1088
v_mfma_f32_16x16x32_bf16 a[96:99], a[192:195], a[152:155], a[96:99]
buffer_load_dwordx4 v3, s[12:15], s30 offen  lds
v_mfma_f32_16x16x32_bf16 a[96:99], a[196:199], a[156:159], a[96:99]
s_waitcnt lgkmcnt(4)
v_mfma_f32_16x16x32_bf16 a[4:7], a[200:203], a[128:131], a[4:7]
ds_read_b64_tr_b16 a[216:217], v15 offset:72
v_mfma_f32_16x16x32_bf16 a[4:7], a[204:207], a[132:135], a[4:7]
ds_read_b64_tr_b16 a[218:219], v15 offset:328
v_mfma_f32_16x16x32_bf16 a[36:39], a[200:203], a[136:139], a[36:39]
ds_read_b64_tr_b16 a[220:221], v15 offset:8776
v_mfma_f32_16x16x32_bf16 a[36:39], a[204:207], a[140:143], a[36:39]
s_add_u32 m0, s29, 2176
ds_read_b64_tr_b16 a[222:223], v15 offset:9032
v_mfma_f32_16x16x32_bf16 a[68:71], a[200:203], a[144:147], a[68:71]
buffer_load_dwordx4 v4, s[12:15], s30 offen  lds
v_mfma_f32_16x16x32_bf16 a[68:71], a[204:207], a[148:151], a[68:71]
s_add_u32 m0, s29, 3264
v_mfma_f32_16x16x32_bf16 a[100:103], a[200:203], a[152:155], a[100:103]
buffer_load_dwordx4 v5, s[12:15], s30 offen  lds
v_mfma_f32_16x16x32_bf16 a[100:103], a[204:207], a[156:159], a[100:103]
s_waitcnt lgkmcnt(4)
v_mfma_f32_16x16x32_bf16 a[8:11], a[208:211], a[128:131], a[8:11]
ds_read_b64_tr_b16 a[192:193], v15 offset:128
v_mfma_f32_16x16x32_bf16 a[8:11], a[212:215], a[132:135], a[8:11]
s_add_u32 s30, s30, 0x80000
ds_read_b64_tr_b16 a[194:195], v15 offset:384
v_mfma_f32_16x16x32_bf16 a[40:43], a[208:211], a[136:139], a[40:43]
ds_read_b64_tr_b16 a[196:197], v15 offset:8832
v_mfma_f32_16x16x32_bf16 a[40:43], a[212:215], a[140:143], a[40:43]
s_waitcnt vmcnt(17)
s_add_u32 m0, s34, 0
ds_read_b64_tr_b16 a[198:199], v15 offset:9088
v_mfma_f32_16x16x32_bf16 a[72:75], a[208:211], a[144:147], a[72:75]
buffer_load_dwordx4 v6, s[8:11], s31 offen  lds
v_mfma_f32_16x16x32_bf16 a[72:75], a[212:215], a[148:151], a[72:75]
s_add_u32 m0, s34, 1024
ds_read_b128 a[160:163], v16 offset:24576
v_mfma_f32_16x16x32_bf16 a[104:107], a[208:211], a[152:155], a[104:107]
buffer_load_dwordx4 v7, s[8:11], s31 offen  lds
v_mfma_f32_16x16x32_bf16 a[104:107], a[212:215], a[156:159], a[104:107]
s_waitcnt lgkmcnt(5)
ds_read_b128 a[164:167], v17 offset:24576
v_mfma_f32_16x16x32_bf16 a[12:15], a[216:219], a[128:131], a[12:15]
ds_read_b64_tr_b16 a[200:201], v15 offset:136
v_mfma_f32_16x16x32_bf16 a[12:15], a[220:223], a[132:135], a[12:15]
ds_read_b64_tr_b16 a[202:203], v15 offset:392
v_mfma_f32_16x16x32_bf16 a[44:47], a[216:219], a[136:139], a[44:47]
ds_read_b64_tr_b16 a[204:205], v15 offset:8840
v_mfma_f32_16x16x32_bf16 a[44:47], a[220:223], a[140:143], a[44:47]
s_add_u32 m0, s34, 2048
ds_read_b64_tr_b16 a[206:207], v15 offset:9096
v_mfma_f32_16x16x32_bf16 a[76:79], a[216:219], a[144:147], a[76:79]
buffer_load_dwordx4 v8, s[8:11], s31 offen  lds
v_mfma_f32_16x16x32_bf16 a[76:79], a[220:223], a[148:151], a[76:79]
s_add_u32 m0, s34, 3072
ds_read_b128 a[168:171], v16 offset:26624
v_mfma_f32_16x16x32_bf16 a[108:111], a[216:219], a[152:155], a[108:111]
buffer_load_dwordx4 v9, s[8:11], s31 offen  lds
v_mfma_f32_16x16x32_bf16 a[108:111], a[220:223], a[156:159], a[108:111]
s_waitcnt lgkmcnt(7)
ds_read_b128 a[172:175], v17 offset:26624
v_mfma_f32_16x16x32_bf16 a[16:19], a[192:195], a[128:131], a[16:19]
s_add_u32 s37, s28, 17408
ds_read_b64_tr_b16 a[208:209], v15 offset:192
v_mfma_f32_16x16x32_bf16 a[16:19], a[196:199], a[132:135], a[16:19]
s_cmp_eq_u32 s37, 139264
ds_read_b64_tr_b16 a[210:211], v15 offset:448
v_mfma_f32_16x16x32_bf16 a[48:51], a[192:195], a[136:139], a[48:51]
s_cselect_b32 s36, 52224, s37
ds_read_b64_tr_b16 a[212:213], v15 offset:8896
v_mfma_f32_16x16x32_bf16 a[48:51], a[196:199], a[140:143], a[48:51]
s_add_u32 m0, s34, 4096
ds_read_b64_tr_b16 a[214:215], v15 offset:9152
v_mfma_f32_16x16x32_bf16 a[80:83], a[192:195], a[144:147], a[80:83]
buffer_load_dwordx4 v10, s[8:11], s31 offen  lds
v_mfma_f32_16x16x32_bf16 a[80:83], a[196:199], a[148:151], a[80:83]
s_add_u32 m0, s34, 5120
ds_read_b128 a[176:179], v16 offset:28672
v_mfma_f32_16x16x32_bf16 a[112:115], a[192:195], a[152:155], a[112:115]
buffer_load_dwordx4 v11, s[8:11], s31 offen  lds
v_mfma_f32_16x16x32_bf16 a[112:115], a[196:199], a[156:159], a[112:115]
s_waitcnt lgkmcnt(7)
ds_read_b128 a[180:183], v17 offset:28672
v_mfma_f32_16x16x32_bf16 a[20:23], a[200:203], a[128:131], a[20:23]
ds_read_b64_tr_b16 a[216:217], v15 offset:200
v_mfma_f32_16x16x32_bf16 a[20:23], a[204:207], a[132:135], a[20:23]
ds_read_b64_tr_b16 a[218:219], v15 offset:456
v_mfma_f32_16x16x32_bf16 a[52:55], a[200:203], a[136:139], a[52:55]
ds_read_b64_tr_b16 a[220:221], v15 offset:8904
v_mfma_f32_16x16x32_bf16 a[52:55], a[204:207], a[140:143], a[52:55]
s_add_u32 m0, s34, 6144
ds_read_b64_tr_b16 a[222:223], v15 offset:9160
v_mfma_f32_16x16x32_bf16 a[84:87], a[200:203], a[144:147], a[84:87]
buffer_load_dwordx4 v12, s[8:11], s31 offen  lds
v_mfma_f32_16x16x32_bf16 a[84:87], a[204:207], a[148:151], a[84:87]
s_add_u32 m0, s34, 7168
ds_read_b128 a[184:187], v16 offset:30720
v_mfma_f32_16x16x32_bf16 a[116:119], a[200:203], a[152:155], a[116:119]
buffer_load_dwordx4 v13, s[8:11], s31 offen  lds
v_mfma_f32_16x16x32_bf16 a[116:119], a[204:207], a[156:159], a[116:119]
ds_read_b128 a[188:191], v17 offset:30720
s_waitcnt lgkmcnt(2)
s_barrier
v_add_u32 v15, s36, v14
v_mfma_f32_16x16x32_bf16 a[24:27], a[208:211], a[128:131], a[24:27]
ds_read_b64_tr_b16 a[192:193], v15 offset:0
v_mfma_f32_16x16x32_bf16 a[24:27], a[212:215], a[132:135], a[24:27]
s_add_u32 s29, s28, s33
ds_read_b64_tr_b16 a[194:195], v15 offset:256
v_mfma_f32_16x16x32_bf16 a[56:59], a[208:211], a[136:139], a[56:59]
s_mov_b32 s28, s36
ds_read_b64_tr_b16 a[196:197], v15 offset:8704
v_mfma_f32_16x16x32_bf16 a[56:59], a[212:215], a[140:143], a[56:59]
ds_read_b64_tr_b16 a[198:199], v15 offset:8960
v_mfma_f32_16x16x32_bf16 a[88:91], a[208:211], a[144:147], a[88:91]
v_mfma_f32_16x16x32_bf16 a[88:91], a[212:215], a[148:151], a[88:91]
s_add_u32 s31, s31, 128
v_mfma_f32_16x16x32_bf16 a[120:123], a[208:211], a[152:155], a[120:123]
v_mfma_f32_16x16x32_bf16 a[120:123], a[212:215], a[156:159], a[120:123]
v_mfma_f32_16x16x32_bf16 a[28:31], a[216:219], a[128:131], a[28:31]
ds_read_b64_tr_b16 a[200:201], v15 offset:8
v_mfma_f32_16x16x32_bf16 a[28:31], a[220:223], a[132:135], a[28:31]
ds_read_b64_tr_b16 a[202:203], v15 offset:264
v_mfma_f32_16x16x32_bf16 a[60:63], a[216:219], a[136:139], a[60:63]
ds_read_b64_tr_b16 a[204:205], v15 offset:8712
buffer_load_dword v127, v122, s[12:15], s50 offen
v_mfma_f32_16x16x32_bf16 a[60:63], a[220:223], a[140:143], a[60:63]
ds_read_b64_tr_b16 a[206:207], v15 offset:8968
v_mfma_f32_16x16x32_bf16 a[92:95], a[216:219], a[144:147], a[92:95]
s_add_u32 s50, s50, 0x100000
v_mfma_f32_16x16x32_bf16 a[92:95], a[220:223], a[148:151], a[92:95]
v_mfma_f32_16x16x32_bf16 a[124:127], a[216:219], a[152:155], a[124:127]
v_mfma_f32_16x16x32_bf16 a[124:127], a[220:223], a[156:159], a[124:127]
s_waitcnt lgkmcnt(4)
v_mfma_f32_16x16x32_bf16 a[0:3], a[192:195], a[160:163], a[0:3]
ds_read_b64_tr_b16 a[208:209], v15 offset:64
v_mfma_f32_16x16x32_bf16 a[0:3], a[196:199], a[164:167], a[0:3]
ds_read_b64_tr_b16 a[210:211], v15 offset:320
v_mfma_f32_16x16x32_bf16 a[32:35], a[192:195], a[168:171], a[32:35]
ds_read_b64_tr_b16 a[212:213], v15 offset:8768
v_mfma_f32_16x16x32_bf16 a[32:35], a[196:199], a[172:175], a[32:35]
s_add_u32 m0, s29, 0
ds_read_b64_tr_b16 a[214:215], v15 offset:9024
v_mfma_f32_16x16x32_bf16 a[64:67], a[192:195], a[176:179], a[64:67]
buffer_load_dwordx4 v2, s[12:15], s30 offen  lds
v_mfma_f32_16x16x32_bf16 a[64:67], a[196:199], a[180:183], a[64:67]
s_add_u32 m0, s29, 1088
v_mfma_f32_16x16x32_bf16 a[96:99], a[192:195], a[184:187], a[96:99]
buffer_load_dwordx4 v3, s[12:15], s30 offen  lds
v_mfma_f32_16x16x32_bf16 a[96:99], a[196:199], a[188:191], a[96:99]
s_waitcnt lgkmcnt(4)
v_mfma_f32_16x16x32_bf16 a[4:7], a[200:203], a[160:163], a[4:7]
ds_read_b64_tr_b16 a[216:217], v15 offset:72
v_mfma_f32_16x16x32_bf16 a[4:7], a[204:207], a[164:167], a[4:7]
ds_read_b64_tr_b16 a[218:219], v15 offset:328
v_mfma_f32_16x16x32_bf16 a[36:39], a[200:203], a[168:171], a[36:39]
ds_read_b64_tr_b16 a[220:221], v15 offset:8776
v_mfma_f32_16x16x32_bf16 a[36:39], a[204:207], a[172:175], a[36:39]
s_add_u32 m0, s29, 2176
ds_read_b64_tr_b16 a[222:223], v15 offset:9032
v_mfma_f32_16x16x32_bf16 a[68:71], a[200:203], a[176:179], a[68:71]
buffer_load_dwordx4 v4, s[12:15], s30 offen  lds
v_mfma_f32_16x16x32_bf16 a[68:71], a[204:207], a[180:183], a[68:71]
s_add_u32 m0, s29, 3264
v_mfma_f32_16x16x32_bf16 a[100:103], a[200:203], a[184:187], a[100:103]
buffer_load_dwordx4 v5, s[12:15], s30 offen  lds
v_mfma_f32_16x16x32_bf16 a[100:103], a[204:207], a[188:191], a[100:103]
s_waitcnt lgkmcnt(4)
v_mfma_f32_16x16x32_bf16 a[8:11], a[208:211], a[160:163], a[8:11]
ds_read_b64_tr_b16 a[192:193], v15 offset:128
v_mfma_f32_16x16x32_bf16 a[8:11], a[212:215], a[164:167], a[8:11]
s_add_u32 s30, s30, 0xfff7ff00
ds_read_b64_tr_b16 a[194:195], v15 offset:384
v_mfma_f32_16x16x32_bf16 a[40:43], a[208:211], a[168:171], a[40:43]
ds_read_b64_tr_b16 a[196:197], v15 offset:8832
v_mfma_f32_16x16x32_bf16 a[40:43], a[212:215], a[172:175], a[40:43]
s_add_u32 m0, s35, 0
ds_read_b64_tr_b16 a[198:199], v15 offset:9088
v_mfma_f32_16x16x32_bf16 a[72:75], a[208:211], a[176:179], a[72:75]
buffer_load_dwordx4 v6, s[8:11], s31 offen  lds
v_mfma_f32_16x16x32_bf16 a[72:75], a[212:215], a[180:183], a[72:75]
s_add_u32 m0, s35, 1024
v_mfma_f32_16x16x32_bf16 a[104:107], a[208:211], a[184:187], a[104:107]
buffer_load_dwordx4 v7, s[8:11], s31 offen  lds
v_mfma_f32_16x16x32_bf16 a[104:107], a[212:215], a[188:191], a[104:107]
s_waitcnt lgkmcnt(4)
v_mfma_f32_16x16x32_bf16 a[12:15], a[216:219], a[160:163], a[12:15]
ds_read_b64_tr_b16 a[200:201], v15 offset:136
v_mfma_f32_16x16x32_bf16 a[12:15], a[220:223], a[164:167], a[12:15]
ds_read_b64_tr_b16 a[202:203], v15 offset:392
v_mfma_f32_16x16x32_bf16 a[44:47], a[216:219], a[168:171], a[44:47]
ds_read_b64_tr_b16 a[204:205], v15 offset:8840
v_mfma_f32_16x16x32_bf16 a[44:47], a[220:223], a[172:175], a[44:47]
s_add_u32 m0, s35, 2048
ds_read_b64_tr_b16 a[206:207], v15 offset:9096
v_mfma_f32_16x16x32_bf16 a[76:79], a[216:219], a[176:179], a[76:79]
buffer_load_dwordx4 v8, s[8:11], s31 offen  lds
v_mfma_f32_16x16x32_bf16 a[76:79], a[220:223], a[180:183], a[76:79]
s_add_u32 m0, s35, 3072
v_mfma_f32_16x16x32_bf16 a[108:111], a[216:219], a[184:187], a[108:111]
buffer_load_dwordx4 v9, s[8:11], s31 offen  lds
v_mfma_f32_16x16x32_bf16 a[108:111], a[220:223], a[188:191], a[108:111]
s_waitcnt lgkmcnt(4)
v_mfma_f32_16x16x32_bf16 a[16:19], a[192:195], a[160:163], a[16:19]
s_add_u32 s37, s28, 17408
ds_read_b64_tr_b16 a[208:209], v15 offset:192
v_mfma_f32_16x16x32_bf16 a[16:19], a[196:199], a[164:167], a[16:19]
s_cmp_eq_u32 s37, 139264
ds_read_b64_tr_b16 a[210:211], v15 offset:448
v_mfma_f32_16x16x32_bf16 a[48:51], a[192:195], a[168:171], a[48:51]
s_cselect_b32 s36, 52224, s37
ds_read_b64_tr_b16 a[212:213], v15 offset:8896
v_mfma_f32_16x16x32_bf16 a[48:51], a[196:199], a[172:175], a[48:51]
s_add_u32 m0, s35, 4096
ds_read_b64_tr_b16 a[214:215], v15 offset:9152
v_mfma_f32_16x16x32_bf16 a[80:83], a[192:195], a[176:179], a[80:83]
buffer_load_dwordx4 v10, s[8:11], s31 offen  lds
v_mfma_f32_16x16x32_bf16 a[80:83], a[196:199], a[180:183], a[80:83]
s_add_u32 m0, s35, 5120
v_mfma_f32_16x16x32_bf16 a[112:115], a[192:195], a[184:187], a[112:115]
buffer_load_dwordx4 v11, s[8:11], s31 offen  lds
v_mfma_f32_16x16x32_bf16 a[112:115], a[196:199], a[188:191], a[112:115]
s_waitcnt lgkmcnt(4)
v_mfma_f32_16x16x32_bf16 a[20:23], a[200:203], a[160:163], a[20:23]
ds_read_b64_tr_b16 a[216:217], v15 offset:200
v_mfma_f32_16x16x32_bf16 a[20:23], a[204:207], a[164:167], a[20:23]
ds_read_b64_tr_b16 a[218:219], v15 offset:456
v_mfma_f32_16x16x32_bf16 a[52:55], a[200:203], a[168:171], a[52:55]
ds_read_b64_tr_b16 a[220:221], v15 offset:8904
v_mfma_f32_16x16x32_bf16 a[52:55], a[204:207], a[172:175], a[52:55]
s_add_u32 m0, s35, 6144
ds_read_b64_tr_b16 a[222:223], v15 offset:9160
v_mfma_f32_16x16x32_bf16 a[84:87], a[200:203], a[176:179], a[84:87]
buffer_load_dwordx4 v12, s[8:11], s31 offen  lds
v_mfma_f32_16x16x32_bf16 a[84:87], a[204:207], a[180:183], a[84:87]
s_add_u32 m0, s35, 7168
v_mfma_f32_16x16x32_bf16 a[116:119], a[200:203], a[184:187], a[116:119]
buffer_load_dwordx4 v13, s[8:11], s31 offen  lds
v_mfma_f32_16x16x32_bf16 a[116:119], a[204:207], a[188:191], a[116:119]
s_waitcnt vmcnt(33) lgkmcnt(0)
s_barrier
v_add_u32 v15, s36, v14
v_mfma_f32_16x16x32_bf16 a[24:27], a[208:211], a[160:163], a[24:27]
ds_read_b64_tr_b16 a[192:193], v15 offset:0
v_mfma_f32_16x16x32_bf16 a[24:27], a[212:215], a[164:167], a[24:27]
s_add_u32 s29, s28, s33
ds_read_b64_tr_b16 a[194:195], v15 offset:256
v_mfma_f32_16x16x32_bf16 a[56:59], a[208:211], a[168:171], a[56:59]
s_mov_b32 s28, s36
ds_read_b64_tr_b16 a[196:197], v15 offset:8704
v_mfma_f32_16x16x32_bf16 a[56:59], a[212:215], a[172:175], a[56:59]
ds_read_b64_tr_b16 a[198:199], v15 offset:8960
v_mfma_f32_16x16x32_bf16 a[88:91], a[208:211], a[176:179], a[88:91]
v_mfma_f32_16x16x32_bf16 a[88:91], a[212:215], a[180:183], a[88:91]
s_add_u32 s31, s31, 128
v_mfma_f32_16x16x32_bf16 a[120:123], a[208:211], a[184:187], a[120:123]
v_mfma_f32_16x16x32_bf16 a[120:123], a[212:215], a[188:191], a[120:123]
v_mfma_f32_16x16x32_bf16 a[28:31], a[216:219], a[160:163], a[28:31]
ds_read_b64_tr_b16 a[200:201], v15 offset:8
v_mfma_f32_16x16x32_bf16 a[28:31], a[220:223], a[164:167], a[28:31]
ds_read_b64_tr_b16 a[202:203], v15 offset:264
v_mfma_f32_16x16x32_bf16 a[60:63], a[216:219], a[168:171], a[60:63]
ds_read_b64_tr_b16 a[204:205], v15 offset:8712
buffer_load_dword v127, v123, s[8:11], s51 offen
v_mfma_f32_16x16x32_bf16 a[60:63], a[220:223], a[172:175], a[60:63]
ds_read_b64_tr_b16 a[206:207], v15 offset:8968
v_mfma_f32_16x16x32_bf16 a[92:95], a[216:219], a[176:179], a[92:95]
s_add_u32 s51, s51, 256
v_mfma_f32_16x16x32_bf16 a[92:95], a[220:223], a[180:183], a[92:95]
v_mfma_f32_16x16x32_bf16 a[124:127], a[216:219], a[184:187], a[124:127]
v_mfma_f32_16x16x32_bf16 a[124:127], a[220:223], a[188:191], a[124:127]
s_waitcnt lgkmcnt(4)
v_mfma_f32_16x16x32_bf16 v[128:131], a[192:195], a[128:131], v[128:131]
ds_read_b64_tr_b16 a[208:209], v15 offset:64
v_mfma_f32_16x16x32_bf16 v[128:131], a[196:199], a[132:135], v[128:131]
ds_read_b64_tr_b16 a[210:211], v15 offset:320
v_mfma_f32_16x16x32_bf16 v[160:163], a[192:195], a[136:139], v[160:163]
ds_read_b64_tr_b16 a[212:213], v15 offset:8768
v_mfma_f32_16x16x32_bf16 v[160:163], a[196:199], a[140:143], v[160:163]
s_add_u32 m0, s29, 0
ds_read_b64_tr_b16 a[214:215], v15 offset:9024
v_mfma_f32_16x16x32_bf16 v[192:195], a[192:195], a[144:147], v[192:195]
buffer_load_dwordx4 v2, s[12:15], s30 offen  lds
v_mfma_f32_16x16x32_bf16 v[192:195], a[196:199], a[148:151], v[192:195]
s_add_u32 m0, s29, 1088
v_mfma_f32_16x16x32_bf16 v[224:227], a[192:195], a[152:155], v[224:227]
buffer_load_dwordx4 v3, s[12:15], s30 offen  lds
v_mfma_f32_16x16x32_bf16 v[224:227], a[196:199], a[156:159], v[224:227]
s_waitcnt lgkmcnt(4)
v_mfma_f32_16x16x32_bf16 v[132:135], a[200:203], a[128:131], v[132:135]
ds_read_b64_tr_b16 a[216:217], v15 offset:72
v_mfma_f32_16x16x32_bf16 v[132:135], a[204:207], a[132:135], v[132:135]
ds_read_b64_tr_b16 a[218:219], v15 offset:328
v_mfma_f32_16x16x32_bf16 v[164:167], a[200:203], a[136:139], v[164:167]
ds_read_b64_tr_b16 a[220:221], v15 offset:8776
v_mfma_f32_16x16x32_bf16 v[164:167], a[204:207], a[140:143], v[164:167]
s_add_u32 m0, s29, 2176
ds_read_b64_tr_b16 a[222:223], v15 offset:9032
v_mfma_f32_16x16x32_bf16 v[196:199], a[200:203], a[144:147], v[196:199]
buffer_load_dwordx4 v4, s[12:15], s30 offen  lds
v_mfma_f32_16x16x32_bf16 v[196:199], a[204:207], a[148:151], v[196:199]
s_add_u32 m0, s29, 3264
v_mfma_f32_16x16x32_bf16 v[228:231], a[200:203], a[152:155], v[228:231]
buffer_load_dwordx4 v5, s[12:15], s30 offen  lds
v_mfma_f32_16x16x32_bf16 v[228:231], a[204:207], a[156:159], v[228:231]
s_waitcnt lgkmcnt(4)
v_mfma_f32_16x16x32_bf16 v[136:139], a[208:211], a[128:131], v[136:139]
ds_read_b64_tr_b16 a[192:193], v15 offset:128
v_mfma_f32_16x16x32_bf16 v[136:139], a[212:215], a[132:135], v[136:139]
s_add_u32 s30, s30, 0x80000
ds_read_b64_tr_b16 a[194:195], v15 offset:384
v_mfma_f32_16x16x32_bf16 v[168:171], a[208:211], a[136:139], v[168:171]
ds_read_b64_tr_b16 a[196:197], v15 offset:8832
v_mfma_f32_16x16x32_bf16 v[168:171], a[212:215], a[140:143], v[168:171]
ds_read_b64_tr_b16 a[198:199], v15 offset:9088
v_mfma_f32_16x16x32_bf16 v[200:203], a[208:211], a[144:147], v[200:203]
v_mfma_f32_16x16x32_bf16 v[200:203], a[212:215], a[148:151], v[200:203]
v_mfma_f32_16x16x32_bf16 v[232:235], a[208:211], a[152:155], v[232:235]
v_mfma_f32_16x16x32_bf16 v[232:235], a[212:215], a[156:159], v[232:235]
s_waitcnt lgkmcnt(4)
v_mfma_f32_16x16x32_bf16 v[140:143], a[216:219], a[128:131], v[140:143]
ds_read_b64_tr_b16 a[200:201], v15 offset:136
v_mfma_f32_16x16x32_bf16 v[140:143], a[220:223], a[132:135], v[140:143]
ds_read_b64_tr_b16 a[202:203], v15 offset:392
v_mfma_f32_16x16x32_bf16 v[172:175], a[216:219], a[136:139], v[172:175]
ds_read_b64_tr_b16 a[204:205], v15 offset:8840
v_mfma_f32_16x16x32_bf16 v[172:175], a[220:223], a[140:143], v[172:175]
ds_read_b64_tr_b16 a[206:207], v15 offset:9096
v_mfma_f32_16x16x32_bf16 v[204:207], a[216:219], a[144:147], v[204:207]
v_mfma_f32_16x16x32_bf16 v[204:207], a[220:223], a[148:151], v[204:207]
v_mfma_f32_16x16x32_bf16 v[236:239], a[216:219], a[152:155], v[236:239]
v_mfma_f32_16x16x32_bf16 v[236:239], a[220:223], a[156:159], v[236:239]
s_waitcnt lgkmcnt(4)
v_mfma_f32_16x16x32_bf16 v[144:147], a[192:195], a[128:131], v[144:147]
s_add_u32 s37, s28, 17408
ds_read_b64_tr_b16 a[208:209], v15 offset:192
v_mfma_f32_16x16x32_bf16 v[144:147], a[196:199], a[132:135], v[144:147]
s_cmp_eq_u32 s37, 139264
ds_read_b64_tr_b16 a[210:211], v15 offset:448
v_mfma_f32_16x16x32_bf16 v[176:179], a[192:195], a[136:139], v[176:179]
s_cselect_b32 s36, 52224, s37
ds_read_b64_tr_b16 a[212:213], v15 offset:8896
v_mfma_f32_16x16x32_bf16 v[176:179], a[196:199], a[140:143], v[176:179]
ds_read_b64_tr_b16 a[214:215], v15 offset:9152
v_mfma_f32_16x16x32_bf16 v[208:211], a[192:195], a[144:147], v[208:211]
v_mfma_f32_16x16x32_bf16 v[208:211], a[196:199], a[148:151], v[208:211]
v_mfma_f32_16x16x32_bf16 v[240:243], a[192:195], a[152:155], v[240:243]
v_mfma_f32_16x16x32_bf16 v[240:243], a[196:199], a[156:159], v[240:243]
s_waitcnt lgkmcnt(4)
v_mfma_f32_16x16x32_bf16 v[148:151], a[200:203], a[128:131], v[148:151]
ds_read_b64_tr_b16 a[216:217], v15 offset:200
v_mfma_f32_16x16x32_bf16 v[148:151], a[204:207], a[132:135], v[148:151]
ds_read_b64_tr_b16 a[218:219], v15 offset:456
v_mfma_f32_16x16x32_bf16 v[180:183], a[200:203], a[136:139], v[180:183]
ds_read_b64_tr_b16 a[220:221], v15 offset:8904
v_mfma_f32_16x16x32_bf16 v[180:183], a[204:207], a[140:143], v[180:183]
ds_read_b64_tr_b16 a[222:223], v15 offset:9160
v_mfma_f32_16x16x32_bf16 v[212:215], a[200:203], a[144:147], v[212:215]
v_mfma_f32_16x16x32_bf16 v[212:215], a[204:207], a[148:151], v[212:215]
v_mfma_f32_16x16x32_bf16 v[244:247], a[200:203], a[152:155], v[244:247]
v_mfma_f32_16x16x32_bf16 v[244:247], a[204:207], a[156:159], v[244:247]
s_waitcnt vmcnt(33) lgkmcnt(0)
s_barrier
v_add_u32 v15, s36, v14
v_mfma_f32_16x16x32_bf16 v[152:155], a[208:211], a[128:131], v[152:155]
ds_read_b64_tr_b16 a[192:193], v15 offset:0
v_mfma_f32_16x16x32_bf16 v[152:155], a[212:215], a[132:135], v[152:155]
s_add_u32 s29, s28, s33
ds_read_b64_tr_b16 a[194:195], v15 offset:256
v_mfma_f32_16x16x32_bf16 v[184:187], a[208:211], a[136:139], v[184:187]
s_mov_b32 s28, s36
ds_read_b64_tr_b16 a[196:197], v15 offset:8704
buffer_load_dword v127, v126, s[52:55], s69 offen
v_mfma_f32_16x16x32_bf16 v[184:187], a[212:215], a[140:143], v[184:187]
ds_read_b64_tr_b16 a[198:199], v15 offset:8960
v_mfma_f32_16x16x32_bf16 v[216:219], a[208:211], a[144:147], v[216:219]
v_mfma_f32_16x16x32_bf16 v[216:219], a[212:215], a[148:151], v[216:219]
v_mfma_f32_16x16x32_bf16 v[248:251], a[208:211], a[152:155], v[248:251]
v_mfma_f32_16x16x32_bf16 v[248:251], a[212:215], a[156:159], v[248:251]
v_mfma_f32_16x16x32_bf16 v[156:159], a[216:219], a[128:131], v[156:159]
ds_read_b64_tr_b16 a[200:201], v15 offset:8
v_mfma_f32_16x16x32_bf16 v[156:159], a[220:223], a[132:135], v[156:159]
s_add_u32 s69, s69, 4096
ds_read_b64_tr_b16 a[202:203], v15 offset:264
v_mfma_f32_16x16x32_bf16 v[188:191], a[216:219], a[136:139], v[188:191]
ds_read_b64_tr_b16 a[204:205], v15 offset:8712
v_mfma_f32_16x16x32_bf16 v[188:191], a[220:223], a[140:143], v[188:191]
ds_read_b64_tr_b16 a[206:207], v15 offset:8968
v_mfma_f32_16x16x32_bf16 v[220:223], a[216:219], a[144:147], v[220:223]
v_mfma_f32_16x16x32_bf16 v[220:223], a[220:223], a[148:151], v[220:223]
v_mfma_f32_16x16x32_bf16 v[252:255], a[216:219], a[152:155], v[252:255]
v_mfma_f32_16x16x32_bf16 v[252:255], a[220:223], a[156:159], v[252:255]
s_waitcnt lgkmcnt(4)
v_mfma_f32_16x16x32_bf16 v[128:131], a[192:195], a[160:163], v[128:131]
ds_read_b64_tr_b16 a[208:209], v15 offset:64
v_mfma_f32_16x16x32_bf16 v[128:131], a[196:199], a[164:167], v[128:131]
ds_read_b64_tr_b16 a[210:211], v15 offset:320
v_mfma_f32_16x16x32_bf16 v[160:163], a[192:195], a[168:171], v[160:163]
ds_read_b64_tr_b16 a[212:213], v15 offset:8768
v_mfma_f32_16x16x32_bf16 v[160:163], a[196:199], a[172:175], v[160:163]
s_add_u32 m0, s29, 0
ds_read_b64_tr_b16 a[214:215], v15 offset:9024
v_mfma_f32_16x16x32_bf16 v[192:195], a[192:195], a[176:179], v[192:195]
buffer_load_dwordx4 v2, s[12:15], s30 offen  lds
v_mfma_f32_16x16x32_bf16 v[192:195], a[196:199], a[180:183], v[192:195]
s_add_u32 m0, s29, 1088
v_mfma_f32_16x16x32_bf16 v[224:227], a[192:195], a[184:187], v[224:227]
buffer_load_dwordx4 v3, s[12:15], s30 offen  lds
v_mfma_f32_16x16x32_bf16 v[224:227], a[196:199], a[188:191], v[224:227]
s_waitcnt lgkmcnt(4)
v_mfma_f32_16x16x32_bf16 v[132:135], a[200:203], a[160:163], v[132:135]
ds_read_b64_tr_b16 a[216:217], v15 offset:72
v_mfma_f32_16x16x32_bf16 v[132:135], a[204:207], a[164:167], v[132:135]
ds_read_b64_tr_b16 a[218:219], v15 offset:328
v_mfma_f32_16x16x32_bf16 v[164:167], a[200:203], a[168:171], v[164:167]
ds_read_b64_tr_b16 a[220:221], v15 offset:8776
v_mfma_f32_16x16x32_bf16 v[164:167], a[204:207], a[172:175], v[164:167]
s_add_u32 m0, s29, 2176
ds_read_b64_tr_b16 a[222:223], v15 offset:9032
v_mfma_f32_16x16x32_bf16 v[196:199], a[200:203], a[176:179], v[196:199]
buffer_load_dwordx4 v4, s[12:15], s30 offen  lds
v_mfma_f32_16x16x32_bf16 v[196:199], a[204:207], a[180:183], v[196:199]
s_add_u32 m0, s29, 3264
v_mfma_f32_16x16x32_bf16 v[228:231], a[200:203], a[184:187], v[228:231]
buffer_load_dwordx4 v5, s[12:15], s30 offen  lds
v_mfma_f32_16x16x32_bf16 v[228:231], a[204:207], a[188:191], v[228:231]
s_waitcnt lgkmcnt(4)
v_mfma_f32_16x16x32_bf16 v[136:139], a[208:211], a[160:163], v[136:139]
ds_read_b64_tr_b16 a[192:193], v15 offset:128
v_mfma_f32_16x16x32_bf16 v[136:139], a[212:215], a[164:167], v[136:139]
s_add_u32 s30, s30, 0x80100
ds_read_b64_tr_b16 a[194:195], v15 offset:384
v_mfma_f32_16x16x32_bf16 v[168:171], a[208:211], a[168:171], v[168:171]
ds_read_b64_tr_b16 a[196:197], v15 offset:8832
buffer_load_dword v127, v125, s[16:19], s49 offen
v_mfma_f32_16x16x32_bf16 v[168:171], a[212:215], a[172:175], v[168:171]
s_waitcnt vmcnt(24)
ds_read_b64_tr_b16 a[198:199], v15 offset:9088
v_mfma_f32_16x16x32_bf16 v[200:203], a[208:211], a[176:179], v[200:203]
ds_read_b128 a[128:131], v16 offset:0
v_mfma_f32_16x16x32_bf16 v[200:203], a[212:215], a[180:183], v[200:203]
v_mfma_f32_16x16x32_bf16 v[232:235], a[208:211], a[184:187], v[232:235]
ds_read_b128 a[132:135], v17 offset:0
v_mfma_f32_16x16x32_bf16 v[232:235], a[212:215], a[188:191], v[232:235]
s_waitcnt lgkmcnt(6)
v_mfma_f32_16x16x32_bf16 v[140:143], a[216:219], a[160:163], v[140:143]
ds_read_b64_tr_b16 a[200:201], v15 offset:136
v_mfma_f32_16x16x32_bf16 v[140:143], a[220:223], a[164:167], v[140:143]
ds_read_b64_tr_b16 a[202:203], v15 offset:392
v_mfma_f32_16x16x32_bf16 v[172:175], a[216:219], a[168:171], v[172:175]
ds_read_b64_tr_b16 a[204:205], v15 offset:8840
buffer_load_dword v127, v125, s[20:23], s49 offen
s_add_u32 s49, s49, s92
s_and_b32 s49, s49, 0xf800
v_mfma_f32_16x16x32_bf16 v[172:175], a[220:223], a[172:175], v[172:175]
ds_read_b64_tr_b16 a[206:207], v15 offset:9096
v_mfma_f32_16x16x32_bf16 v[204:207], a[216:219], a[176:179], v[204:207]
ds_read_b128 a[136:139], v16 offset:2048
v_mfma_f32_16x16x32_bf16 v[204:207], a[220:223], a[180:183], v[204:207]
v_mfma_f32_16x16x32_bf16 v[236:239], a[216:219], a[184:187], v[236:239]
ds_read_b128 a[140:143], v17 offset:2048
v_mfma_f32_16x16x32_bf16 v[236:239], a[220:223], a[188:191], v[236:239]
s_waitcnt lgkmcnt(8)
v_mfma_f32_16x16x32_bf16 v[144:147], a[192:195], a[160:163], v[144:147]
s_add_u32 s37, s28, 17408
ds_read_b64_tr_b16 a[208:209], v15 offset:192
v_mfma_f32_16x16x32_bf16 v[144:147], a[196:199], a[164:167], v[144:147]
s_cmp_eq_u32 s37, 139264
ds_read_b64_tr_b16 a[210:211], v15 offset:448
v_mfma_f32_16x16x32_bf16 v[176:179], a[192:195], a[168:171], v[176:179]
s_cselect_b32 s36, 52224, s37
ds_read_b64_tr_b16 a[212:213], v15 offset:8896
v_mfma_f32_16x16x32_bf16 v[176:179], a[196:199], a[172:175], v[176:179]
ds_read_b64_tr_b16 a[214:215], v15 offset:9152
v_mfma_f32_16x16x32_bf16 v[208:211], a[192:195], a[176:179], v[208:211]
ds_read_b128 a[144:147], v16 offset:4096
v_mfma_f32_16x16x32_bf16 v[208:211], a[196:199], a[180:183], v[208:211]
v_mfma_f32_16x16x32_bf16 v[240:243], a[192:195], a[184:187], v[240:243]
ds_read_b128 a[148:151], v17 offset:4096
v_mfma_f32_16x16x32_bf16 v[240:243], a[196:199], a[188:191], v[240:243]
s_waitcnt lgkmcnt(8)
v_mfma_f32_16x16x32_bf16 v[148:151], a[200:203], a[160:163], v[148:151]
ds_read_b64_tr_b16 a[216:217], v15 offset:200
v_mfma_f32_16x16x32_bf16 v[148:151], a[204:207], a[164:167], v[148:151]
ds_read_b64_tr_b16 a[218:219], v15 offset:456
v_mfma_f32_16x16x32_bf16 v[180:183], a[200:203], a[168:171], v[180:183]
ds_read_b64_tr_b16 a[220:221], v15 offset:8904
v_mfma_f32_16x16x32_bf16 v[180:183], a[204:207], a[172:175], v[180:183]
ds_read_b64_tr_b16 a[222:223], v15 offset:9160
v_mfma_f32_16x16x32_bf16 v[212:215], a[200:203], a[176:179], v[212:215]
ds_read_b128 a[152:155], v16 offset:6144
v_mfma_f32_16x16x32_bf16 v[212:215], a[204:207], a[180:183], v[212:215]
v_mfma_f32_16x16x32_bf16 v[244:247], a[200:203], a[184:187], v[244:247]
ds_read_b128 a[156:159], v17 offset:6144
v_mfma_f32_16x16x32_bf16 v[244:247], a[204:207], a[188:191], v[244:247]
s_waitcnt lgkmcnt(2)
s_barrier
v_add_u32 v15, s36, v14
v_mfma_f32_16x16x32_bf16 v[152:155], a[208:211], a[160:163], v[152:155]
ds_read_b64_tr_b16 a[192:193], v15 offset:0
v_mfma_f32_16x16x32_bf16 v[152:155], a[212:215], a[164:167], v[152:155]
s_add_u32 s29, s28, s33
ds_read_b64_tr_b16 a[194:195], v15 offset:256
v_mfma_f32_16x16x32_bf16 v[184:187], a[208:211], a[168:171], v[184:187]
s_mov_b32 s28, s36
ds_read_b64_tr_b16 a[196:197], v15 offset:8704
buffer_load_dword v127, v126, s[52:55], s69 offen
v_mfma_f32_16x16x32_bf16 v[184:187], a[212:215], a[172:175], v[184:187]
ds_read_b64_tr_b16 a[198:199], v15 offset:8960
v_mfma_f32_16x16x32_bf16 v[216:219], a[208:211], a[176:179], v[216:219]
v_mfma_f32_16x16x32_bf16 v[216:219], a[212:215], a[180:183], v[216:219]
v_mfma_f32_16x16x32_bf16 v[248:251], a[208:211], a[184:187], v[248:251]
v_mfma_f32_16x16x32_bf16 v[248:251], a[212:215], a[188:191], v[248:251]
v_mfma_f32_16x16x32_bf16 v[156:159], a[216:219], a[160:163], v[156:159]
ds_read_b64_tr_b16 a[200:201], v15 offset:8
v_mfma_f32_16x16x32_bf16 v[156:159], a[220:223], a[164:167], v[156:159]
s_add_u32 s69, s69, 4096
ds_read_b64_tr_b16 a[202:203], v15 offset:264
v_mfma_f32_16x16x32_bf16 v[188:191], a[216:219], a[168:171], v[188:191]
ds_read_b64_tr_b16 a[204:205], v15 offset:8712
v_mfma_f32_16x16x32_bf16 v[188:191], a[220:223], a[172:175], v[188:191]
ds_read_b64_tr_b16 a[206:207], v15 offset:8968
v_mfma_f32_16x16x32_bf16 v[220:223], a[216:219], a[176:179], v[220:223]
v_mfma_f32_16x16x32_bf16 v[220:223], a[220:223], a[180:183], v[220:223]
s_sub_u32 s32, s32, 1
v_mfma_f32_16x16x32_bf16 v[252:255], a[216:219], a[184:187], v[252:255]
s_cmp_lg_u32 s32, 0
v_mfma_f32_16x16x32_bf16 v[252:255], a[220:223], a[188:191], v[252:255]
s_waitcnt lgkmcnt(4)
s_cbranch_scc1 L_qp
v_mfma_f32_16x16x32_bf16 a[0:3], a[192:195], a[128:131], a[0:3]
ds_read_b64_tr_b16 a[208:209], v15 offset:64
v_mfma_f32_16x16x32_bf16 a[0:3], a[196:199], a[132:135], a[0:3]
s_mov_b32 s48, 0x3e0293ee
s_mov_b32 s101, 0
s_mov_b32 s39, s100
s_add_u32 s38, s70, 104448
ds_read_b64_tr_b16 a[210:211], v15 offset:320
v_mfma_f32_16x16x32_bf16 a[32:35], a[192:195], a[136:139], a[32:35]
ds_read_b64_tr_b16 a[212:213], v15 offset:8768
v_mfma_f32_16x16x32_bf16 a[32:35], a[196:199], a[140:143], a[32:35]
ds_read_b64_tr_b16 a[214:215], v15 offset:9024
v_mfma_f32_16x16x32_bf16 a[64:67], a[192:195], a[144:147], a[64:67]
v_mfma_f32_16x16x32_bf16 a[64:67], a[196:199], a[148:151], a[64:67]
v_mfma_f32_16x16x32_bf16 a[96:99], a[192:195], a[152:155], a[96:99]
v_mfma_f32_16x16x32_bf16 a[96:99], a[196:199], a[156:159], a[96:99]
s_waitcnt lgkmcnt(4)
v_mfma_f32_16x16x32_bf16 a[4:7], a[200:203], a[128:131], a[4:7]
ds_read_b64_tr_b16 a[216:217], v15 offset:72
v_mfma_f32_16x16x32_bf16 a[4:7], a[204:207], a[132:135], a[4:7]
ds_read_b64_tr_b16 a[218:219], v15 offset:328
v_mfma_f32_16x16x32_bf16 a[36:39], a[200:203], a[136:139], a[36:39]
ds_read_b64_tr_b16 a[220:221], v15 offset:8776
v_mfma_f32_16x16x32_bf16 a[36:39], a[204:207], a[140:143], a[36:39]
ds_read_b64_tr_b16 a[222:223], v15 offset:9032
v_mfma_f32_16x16x32_bf16 a[68:71], a[200:203], a[144:147], a[68:71]
v_mfma_f32_16x16x32_bf16 a[68:71], a[204:207], a[148:151], a[68:71]
v_mfma_f32_16x16x32_bf16 a[100:103], a[200:203], a[152:155], a[100:103]
v_mfma_f32_16x16x32_bf16 a[100:103], a[204:207], a[156:159], a[100:103]
s_waitcnt lgkmcnt(4)
v_mfma_f32_16x16x32_bf16 a[8:11], a[208:211], a[128:131], a[8:11]
ds_read_b64_tr_b16 a[192:193], v15 offset:128
v_mfma_f32_16x16x32_bf16 a[8:11], a[212:215], a[132:135], a[8:11]
ds_read_b64_tr_b16 a[194:195], v15 offset:384
v_mfma_f32_16x16x32_bf16 a[40:43], a[208:211], a[136:139], a[40:43]
ds_read_b64_tr_b16 a[196:197], v15 offset:8832
v_mfma_f32_16x16x32_bf16 a[40:43], a[212:215], a[140:143], a[40:43]
s_waitcnt vmcnt(13)
ds_read_b64_tr_b16 a[198:199], v15 offset:9088
v_mfma_f32_16x16x32_bf16 a[72:75], a[208:211], a[144:147], a[72:75]
v_mfma_f32_16x16x32_bf16 a[72:75], a[212:215], a[148:151], a[72:75]
ds_read_b128 a[160:163], v16 offset:24576
v_mfma_f32_16x16x32_bf16 a[104:107], a[208:211], a[152:155], a[104:107]
v_mfma_f32_16x16x32_bf16 a[104:107], a[212:215], a[156:159], a[104:107]
s_waitcnt lgkmcnt(5)
ds_read_b128 a[164:167], v17 offset:24576
v_mfma_f32_16x16x32_bf16 a[12:15], a[216:219], a[128:131], a[12:15]
ds_read_b64_tr_b16 a[200:201], v15 offset:136
v_mfma_f32_16x16x32_bf16 a[12:15], a[220:223], a[132:135], a[12:15]
ds_read_b64_tr_b16 a[202:203], v15 offset:392
v_mfma_f32_16x16x32_bf16 a[44:47], a[216:219], a[136:139], a[44:47]
ds_read_b64_tr_b16 a[204:205], v15 offset:8840
v_mfma_f32_16x16x32_bf16 a[44:47], a[220:223], a[140:143], a[44:47]
ds_read_b64_tr_b16 a[206:207], v15 offset:9096
v_mfma_f32_16x16x32_bf16 a[76:79], a[216:219], a[144:147], a[76:79]
v_mfma_f32_16x16x32_bf16 a[76:79], a[220:223], a[148:151], a[76:79]
ds_read_b128 a[168:171], v16 offset:26624
v_mfma_f32_16x16x32_bf16 a[108:111], a[216:219], a[152:155], a[108:111]
v_mfma_f32_16x16x32_bf16 a[108:111], a[220:223], a[156:159], a[108:111]
s_waitcnt lgkmcnt(7)
ds_read_b128 a[172:175], v17 offset:26624
v_mfma_f32_16x16x32_bf16 a[16:19], a[192:195], a[128:131], a[16:19]
s_add_u32 s37, s28, 17408
ds_read_b64_tr_b16 a[208:209], v15 offset:192
v_mfma_f32_16x16x32_bf16 a[16:19], a[196:199], a[132:135], a[16:19]
s_cmp_eq_u32 s37, 139264
ds_read_b64_tr_b16 a[210:211], v15 offset:448
v_mfma_f32_16x16x32_bf16 a[48:51], a[192:195], a[136:139], a[48:51]
s_cselect_b32 s36, 52224, s37
ds_read_b64_tr_b16 a[212:213], v15 offset:8896
v_mfma_f32_16x16x32_bf16 a[48:51], a[196:199], a[140:143], a[48:51]
ds_read_b64_tr_b16 a[214:215], v15 offset:9152
v_mfma_f32_16x16x32_bf16 a[80:83], a[192:195], a[144:147], a[80:83]
v_mfma_f32_16x16x32_bf16 a[80:83], a[196:199], a[148:151], a[80:83]
ds_read_b128 a[176:179], v16 offset:28672
v_mfma_f32_16x16x32_bf16 a[112:115], a[192:195], a[152:155], a[112:115]
v_mfma_f32_16x16x32_bf16 a[112:115], a[196:199], a[156:159], a[112:115]
s_waitcnt lgkmcnt(7)
ds_read_b128 a[180:183], v17 offset:28672
v_mfma_f32_16x16x32_bf16 a[20:23], a[200:203], a[128:131], a[20:23]
ds_read_b64_tr_b16 a[216:217], v15 offset:200
v_mfma_f32_16x16x32_bf16 a[20:23], a[204:207], a[132:135], a[20:23]
ds_read_b64_tr_b16 a[218:219], v15 offset:456
v_mfma_f32_16x16x32_bf16 a[52:55], a[200:203], a[136:139], a[52:55]
ds_read_b64_tr_b16 a[220:221], v15 offset:8904
v_mfma_f32_16x16x32_bf16 a[52:55], a[204:207], a[140:143], a[52:55]
ds_read_b64_tr_b16 a[222:223], v15 offset:9160
v_mfma_f32_16x16x32_bf16 a[84:87], a[200:203], a[144:147], a[84:87]
v_mfma_f32_16x16x32_bf16 a[84:87], a[204:207], a[148:151], a[84:87]
ds_read_b128 a[184:187], v16 offset:30720
v_mfma_f32_16x16x32_bf16 a[116:119], a[200:203], a[152:155], a[116:119]
v_mfma_f32_16x16x32_bf16 a[116:119], a[204:207], a[156:159], a[116:119]
ds_read_b128 a[188:191], v17 offset:30720
s_waitcnt lgkmcnt(2)
s_barrier
v_add_u32 v15, s36, v14
v_mfma_f32_16x16x32_bf16 a[24:27], a[208:211], a[128:131], a[24:27]
ds_read_b64_tr_b16 a[192:193], v15 offset:0
v_mfma_f32_16x16x32_bf16 a[24:27], a[212:215], a[132:135], a[24:27]
s_add_u32 s29, s28, s33
ds_read_b64_tr_b16 a[194:195], v15 offset:256
v_mfma_f32_16x16x32_bf16 a[56:59], a[208:211], a[136:139], a[56:59]
s_mov_b32 s28, s36
ds_read_b64_tr_b16 a[196:197], v15 offset:8704
v_mfma_f32_16x16x32_bf16 a[56:59], a[212:215], a[140:143], a[56:59]
ds_read_b64_tr_b16 a[198:199], v15 offset:8960
v_mfma_f32_16x16x32_bf16 a[88:91], a[208:211], a[144:147], a[88:91]
v_mfma_f32_16x16x32_bf16 a[88:91], a[212:215], a[148:151], a[88:91]
v_mfma_f32_16x16x32_bf16 a[120:123], a[208:211], a[152:155], a[120:123]
v_mfma_f32_16x16x32_bf16 a[120:123], a[212:215], a[156:159], a[120:123]
v_mfma_f32_16x16x32_bf16 a[28:31], a[216:219], a[128:131], a[28:31]
ds_read_b64_tr_b16 a[200:201], v15 offset:8
v_mfma_f32_16x16x32_bf16 a[28:31], a[220:223], a[132:135], a[28:31]
ds_read_b64_tr_b16 a[202:203], v15 offset:264
v_mfma_f32_16x16x32_bf16 a[60:63], a[216:219], a[136:139], a[60:63]
ds_read_b64_tr_b16 a[204:205], v15 offset:8712
v_mfma_f32_16x16x32_bf16 a[60:63], a[220:223], a[140:143], a[60:63]
ds_read_b64_tr_b16 a[206:207], v15 offset:8968
v_mfma_f32_16x16x32_bf16 a[92:95], a[216:219], a[144:147], a[92:95]
v_mfma_f32_16x16x32_bf16 a[92:95], a[220:223], a[148:151], a[92:95]
v_mfma_f32_16x16x32_bf16 a[124:127], a[216:219], a[152:155], a[124:127]
v_mfma_f32_16x16x32_bf16 a[124:127], a[220:223], a[156:159], a[124:127]
s_waitcnt lgkmcnt(4)
v_mfma_f32_16x16x32_bf16 a[0:3], a[192:195], a[160:163], a[0:3]
ds_read_b64_tr_b16 a[208:209], v15 offset:64
v_mfma_f32_16x16x32_bf16 a[0:3], a[196:199], a[164:167], a[0:3]
ds_read_b64_tr_b16 a[210:211], v15 offset:320
v_mfma_f32_16x16x32_bf16 a[32:35], a[192:195], a[168:171], a[32:35]
ds_read_b64_tr_b16 a[212:213], v15 offset:8768
v_mfma_f32_16x16x32_bf16 a[32:35], a[196:199], a[172:175], a[32:35]
ds_read_b64_tr_b16 a[214:215], v15 offset:9024
v_mfma_f32_16x16x32_bf16 a[64:67], a[192:195], a[176:179], a[64:67]
v_mfma_f32_16x16x32_bf16 a[64:67], a[196:199], a[180:183], a[64:67]
v_mfma_f32_16x16x32_bf16 a[96:99], a[192:195], a[184:187], a[96:99]
v_mfma_f32_16x16x32_bf16 a[96:99], a[196:199], a[188:191], a[96:99]
s_waitcnt lgkmcnt(4)
v_mfma_f32_16x16x32_bf16 a[4:7], a[200:203], a[160:163], a[4:7]
ds_read_b64_tr_b16 a[216:217], v15 offset:72
v_mfma_f32_16x16x32_bf16 a[4:7], a[204:207], a[164:167], a[4:7]
ds_read_b64_tr_b16 a[218:219], v15 offset:328
v_mfma_f32_16x16x32_bf16 a[36:39], a[200:203], a[168:171], a[36:39]
ds_read_b64_tr_b16 a[220:221], v15 offset:8776
v_mfma_f32_16x16x32_bf16 a[36:39], a[204:207], a[172:175], a[36:39]
ds_read_b64_tr_b16 a[222:223], v15 offset:9032
v_mfma_f32_16x16x32_bf16 a[68:71], a[200:203], a[176:179], a[68:71]
v_mfma_f32_16x16x32_bf16 a[68:71], a[204:207], a[180:183], a[68:71]
v_mfma_f32_16x16x32_bf16 a[100:103], a[200:203], a[184:187], a[100:103]
v_mfma_f32_16x16x32_bf16 a[100:103], a[204:207], a[188:191], a[100:103]
s_waitcnt lgkmcnt(4)
v_mfma_f32_16x16x32_bf16 a[8:11], a[208:211], a[160:163], a[8:11]
ds_read_b64_tr_b16 a[192:193], v15 offset:128
v_mfma_f32_16x16x32_bf16 a[8:11], a[212:215], a[164:167], a[8:11]
ds_read_b64_tr_b16 a[194:195], v15 offset:384
v_mfma_f32_16x16x32_bf16 a[40:43], a[208:211], a[168:171], a[40:43]
ds_read_b64_tr_b16 a[196:197], v15 offset:8832
v_mfma_f32_16x16x32_bf16 a[40:43], a[212:215], a[172:175], a[40:43]
ds_read_b64_tr_b16 a[198:199], v15 offset:9088
v_mfma_f32_16x16x32_bf16 a[72:75], a[208:211], a[176:179], a[72:75]
v_mfma_f32_16x16x32_bf16 a[72:75], a[212:215], a[180:183], a[72:75]
v_mfma_f32_16x16x32_bf16 a[104:107], a[208:211], a[184:187], a[104:107]
v_mfma_f32_16x16x32_bf16 a[104:107], a[212:215], a[188:191], a[104:107]
s_waitcnt lgkmcnt(4)
v_mfma_f32_16x16x32_bf16 a[12:15], a[216:219], a[160:163], a[12:15]
ds_read_b64_tr_b16 a[200:201], v15 offset:136
v_mfma_f32_16x16x32_bf16 a[12:15], a[220:223], a[164:167], a[12:15]
ds_read_b64_tr_b16 a[202:203], v15 offset:392
v_mfma_f32_16x16x32_bf16 a[44:47], a[216:219], a[168:171], a[44:47]
ds_read_b64_tr_b16 a[204:205], v15 offset:8840
v_mfma_f32_16x16x32_bf16 a[44:47], a[220:223], a[172:175], a[44:47]
ds_read_b64_tr_b16 a[206:207], v15 offset:9096
v_mfma_f32_16x16x32_bf16 a[76:79], a[216:219], a[176:179], a[76:79]
v_mfma_f32_16x16x32_bf16 a[76:79], a[220:223], a[180:183], a[76:79]
v_mfma_f32_16x16x32_bf16 a[108:111], a[216:219], a[184:187], a[108:111]
v_mfma_f32_16x16x32_bf16 a[108:111], a[220:223], a[188:191], a[108:111]
s_waitcnt lgkmcnt(4)
v_mfma_f32_16x16x32_bf16 a[16:19], a[192:195], a[160:163], a[16:19]
s_add_u32 s37, s28, 17408
ds_read_b64_tr_b16 a[208:209], v15 offset:192
v_mfma_f32_16x16x32_bf16 a[16:19], a[196:199], a[164:167], a[16:19]
s_cmp_eq_u32 s37, 139264
ds_read_b64_tr_b16 a[210:211], v15 offset:448
v_mfma_f32_16x16x32_bf16 a[48:51], a[192:195], a[168:171], a[48:51]
s_cselect_b32 s36, 52224, s37
ds_read_b64_tr_b16 a[212:213], v15 offset:8896
v_mfma_f32_16x16x32_bf16 a[48:51], a[196:199], a[172:175], a[48:51]
ds_read_b64_tr_b16 a[214:215], v15 offset:9152
v_mfma_f32_16x16x32_bf16 a[80:83], a[192:195], a[176:179], a[80:83]
v_mfma_f32_16x16x32_bf16 a[80:83], a[196:199], a[180:183], a[80:83]
v_mfma_f32_16x16x32_bf16 a[112:115], a[192:195], a[184:187], a[112:115]
v_mfma_f32_16x16x32_bf16 a[112:115], a[196:199], a[188:191], a[112:115]
s_waitcnt lgkmcnt(4)
v_mfma_f32_16x16x32_bf16 a[20:23], a[200:203], a[160:163], a[20:23]
ds_read_b64_tr_b16 a[216:217], v15 offset:200
v_mfma_f32_16x16x32_bf16 a[20:23], a[204:207], a[164:167], a[20:23]
ds_read_b64_tr_b16 a[218:219], v15 offset:456
v_mfma_f32_16x16x32_bf16 a[52:55], a[200:203], a[168:171], a[52:55]
ds_read_b64_tr_b16 a[220:221], v15 offset:8904
v_mfma_f32_16x16x32_bf16 a[52:55], a[204:207], a[172:175], a[52:55]
ds_read_b64_tr_b16 a[222:223], v15 offset:9160
v_mfma_f32_16x16x32_bf16 a[84:87], a[200:203], a[176:179], a[84:87]
v_mfma_f32_16x16x32_bf16 a[84:87], a[204:207], a[180:183], a[84:87]
v_mfma_f32_16x16x32_bf16 a[116:119], a[200:203], a[184:187], a[116:119]
v_mfma_f32_16x16x32_bf16 a[116:119], a[204:207], a[188:191], a[116:119]
s_waitcnt vmcnt(8) lgkmcnt(0)
s_barrier
v_add_u32 v15, s36, v14
v_mfma_f32_16x16x32_bf16 a[24:27], a[208:211], a[160:163], a[24:27]
ds_read_b64_tr_b16 a[192:193], v15 offset:0
v_mfma_f32_16x16x32_bf16 a[24:27], a[212:215], a[164:167], a[24:27]
s_add_u32 s29, s28, s33
ds_read_b64_tr_b16 a[194:195], v15 offset:256
v_mfma_f32_16x16x32_bf16 a[56:59], a[208:211], a[168:171], a[56:59]
s_mov_b32 s28, s36
ds_read_b64_tr_b16 a[196:197], v15 offset:8704
v_mfma_f32_16x16x32_bf16 a[56:59], a[212:215], a[172:175], a[56:59]
ds_read_b64_tr_b16 a[198:199], v15 offset:8960
v_mfma_f32_16x16x32_bf16 a[88:91], a[208:211], a[176:179], a[88:91]
v_mfma_f32_16x16x32_bf16 a[88:91], a[212:215], a[180:183], a[88:91]
v_mfma_f32_16x16x32_bf16 a[120:123], a[208:211], a[184:187], a[120:123]
v_mfma_f32_16x16x32_bf16 a[120:123], a[212:215], a[188:191], a[120:123]
v_mfma_f32_16x16x32_bf16 a[28:31], a[216:219], a[160:163], a[28:31]
ds_read_b64_tr_b16 a[200:201], v15 offset:8
v_mfma_f32_16x16x32_bf16 a[28:31], a[220:223], a[164:167], a[28:31]
ds_read_b64_tr_b16 a[202:203], v15 offset:264
v_mfma_f32_16x16x32_bf16 a[60:63], a[216:219], a[168:171], a[60:63]
ds_read_b64_tr_b16 a[204:205], v15 offset:8712
v_mfma_f32_16x16x32_bf16 a[60:63], a[220:223], a[172:175], a[60:63]
ds_read_b64_tr_b16 a[206:207], v15 offset:8968
v_mfma_f32_16x16x32_bf16 a[92:95], a[216:219], a[176:179], a[92:95]
v_mfma_f32_16x16x32_bf16 a[92:95], a[220:223], a[180:183], a[92:95]
v_mfma_f32_16x16x32_bf16 a[124:127], a[216:219], a[184:187], a[124:127]
v_mfma_f32_16x16x32_bf16 a[124:127], a[220:223], a[188:191], a[124:127]
s_waitcnt lgkmcnt(4)
v_mfma_f32_16x16x32_bf16 v[128:131], a[192:195], a[128:131], v[128:131]
ds_read_b64_tr_b16 a[208:209], v15 offset:64
s_add_u32 m0, s38, 0
v_mfma_f32_16x16x32_bf16 v[128:131], a[196:199], a[132:135], v[128:131]
buffer_load_dwordx4 v24, s[16:19], s39 offen offset:0 nt lds
ds_read_b64_tr_b16 a[210:211], v15 offset:320
v_accvgpr_read_b32 v72, a120
v_accvgpr_read_b32 v73, a121
v_accvgpr_read_b32 v74, a122
v_accvgpr_read_b32 v75, a123
v_mfma_f32_16x16x32_bf16 v[160:163], a[192:195], a[136:139], v[160:163]
ds_read_b64_tr_b16 a[212:213], v15 offset:8768
v_accvgpr_read_b32 v76, a124
v_accvgpr_read_b32 v77, a125
v_accvgpr_read_b32 v78, a126
v_accvgpr_read_b32 v79, a127
v_mul_f32 v72, s48, v72
v_mfma_f32_16x16x32_bf16 v[160:163], a[196:199], a[140:143], v[160:163]
ds_read_b64_tr_b16 a[214:215], v15 offset:9024
v_mul_f32 v73, s48, v73
v_mul_f32 v74, s48, v74
v_mul_f32 v75, s48, v75
v_mul_f32 v76, s48, v76
v_mul_f32 v77, s48, v77
v_mfma_f32_16x16x32_bf16 v[192:195], a[192:195], a[144:147], v[192:195]
s_add_u32 m0, s38, 8704
v_mul_f32 v78, s48, v78
v_mul_f32 v79, s48, v79
v_cvt_pk_bf16_f32 v72, v72, v73
v_cvt_pk_bf16_f32 v73, v74, v75
v_cvt_pk_bf16_f32 v74, v76, v77
v_mfma_f32_16x16x32_bf16 v[192:195], a[196:199], a[148:151], v[192:195]
buffer_load_dwordx4 v25, s[20:23], s39 offen offset:0 nt lds
v_cvt_pk_bf16_f32 v75, v78, v79
v_accvgpr_write_b32 a124, v72
v_accvgpr_write_b32 a125, v73
v_accvgpr_write_b32 a126, v74
v_accvgpr_write_b32 a127, v75
v_mfma_f32_16x16x32_bf16 v[224:227], a[192:195], a[152:155], v[224:227]
v_accvgpr_read_b32 v64, a112
v_accvgpr_read_b32 v65, a113
v_accvgpr_read_b32 v66, a114
v_accvgpr_read_b32 v67, a115
v_accvgpr_read_b32 v68, a116
v_mfma_f32_16x16x32_bf16 v[224:227], a[196:199], a[156:159], v[224:227]
s_waitcnt lgkmcnt(4)
v_accvgpr_read_b32 v69, a117
v_accvgpr_read_b32 v70, a118
v_accvgpr_read_b32 v71, a119
v_mul_f32 v64, s48, v64
v_mul_f32 v65, s48, v65
v_mfma_f32_16x16x32_bf16 v[132:135], a[200:203], a[128:131], v[132:135]
ds_read_b64_tr_b16 a[216:217], v15 offset:72
s_add_u32 m0, s38, 64
v_mul_f32 v66, s48, v66
v_mul_f32 v67, s48, v67
v_mul_f32 v68, s48, v68
v_mul_f32 v69, s48, v69
v_mfma_f32_16x16x32_bf16 v[132:135], a[204:207], a[132:135], v[132:135]
buffer_load_dwordx4 v24, s[16:19], s39 offen offset:1024 nt lds
ds_read_b64_tr_b16 a[218:219], v15 offset:328
v_mul_f32 v70, s48, v70
v_mul_f32 v71, s48, v71
v_cvt_pk_bf16_f32 v64, v64, v65
v_cvt_pk_bf16_f32 v65, v66, v67
v_cvt_pk_bf16_f32 v66, v68, v69
v_mfma_f32_16x16x32_bf16 v[164:167], a[200:203], a[136:139], v[164:167]
ds_read_b64_tr_b16 a[220:221], v15 offset:8776
v_cvt_pk_bf16_f32 v67, v70, v71
v_accvgpr_write_b32 a120, v64
v_accvgpr_write_b32 a121, v65
v_accvgpr_write_b32 a122, v66
v_accvgpr_write_b32 a123, v67
v_mfma_f32_16x16x32_bf16 v[164:167], a[204:207], a[140:143], v[164:167]
ds_read_b64_tr_b16 a[222:223], v15 offset:9032
v_accvgpr_read_b32 v72, a104
v_accvgpr_read_b32 v73, a105
v_accvgpr_read_b32 v74, a106
v_accvgpr_read_b32 v75, a107
v_accvgpr_read_b32 v76, a108
v_mfma_f32_16x16x32_bf16 v[196:199], a[200:203], a[144:147], v[196:199]
s_add_u32 m0, s38, 9536
v_accvgpr_read_b32 v77, a109
v_accvgpr_read_b32 v78, a110
v_accvgpr_read_b32 v79, a111
v_mul_f32 v72, s48, v72
v_mul_f32 v73, s48, v73
v_mfma_f32_16x16x32_bf16 v[196:199], a[204:207], a[148:151], v[196:199]
buffer_load_dwordx4 v25, s[20:23], s39 offen offset:256 nt lds
v_mul_f32 v74, s48, v74
v_mul_f32 v75, s48, v75
v_mul_f32 v76, s48, v76
v_mul_f32 v77, s48, v77
v_mul_f32 v78, s48, v78
v_mfma_f32_16x16x32_bf16 v[228:231], a[200:203], a[152:155], v[228:231]
s_add_u32 s101, s101, 8192
s_add_u32 s100, s100, s92
s_and_b32 s39, s100, 0xf800
s_and_b32 s93, s101, 0x40000
s_or_b32 s39, s39, s93
s_add_u32 s38, s38, 17408
s_cmp_eq_u32 s38, s71
s_cselect_b32 s38, s70, s38
v_mul_f32 v79, s48, v79
v_cvt_pk_bf16_f32 v72, v72, v73
v_cvt_pk_bf16_f32 v73, v74, v75
v_cvt_pk_bf16_f32 v74, v76, v77
v_cvt_pk_bf16_f32 v75, v78, v79
v_mfma_f32_16x16x32_bf16 v[228:231], a[204:207], a[156:159], v[228:231]
s_waitcnt lgkmcnt(4)
v_accvgpr_write_b32 a116, v72
v_accvgpr_write_b32 a117, v73
v_accvgpr_write_b32 a118, v74
v_accvgpr_write_b32 a119, v75
v_mfma_f32_16x16x32_bf16 v[136:139], a[208:211], a[128:131], v[136:139]
ds_read_b64_tr_b16 a[192:193], v15 offset:128
v_accvgpr_read_b32 v64, a96
v_accvgpr_read_b32 v65, a97
v_accvgpr_read_b32 v66, a98
v_accvgpr_read_b32 v67, a99
v_accvgpr_read_b32 v68, a100
v_mfma_f32_16x16x32_bf16 v[136:139], a[212:215], a[132:135], v[136:139]
ds_read_b64_tr_b16 a[194:195], v15 offset:384
v_accvgpr_read_b32 v69, a101
v_accvgpr_read_b32 v70, a102
v_accvgpr_read_b32 v71, a103
v_mul_f32 v64, s48, v64
v_mul_f32 v65, s48, v65
v_mfma_f32_16x16x32_bf16 v[168:171], a[208:211], a[136:139], v[168:171]
ds_read_b64_tr_b16 a[196:197], v15 offset:8832
v_mul_f32 v66, s48, v66
v_mul_f32 v67, s48, v67
v_mul_f32 v68, s48, v68
v_mul_f32 v69, s48, v69
v_mul_f32 v70, s48, v70
v_mfma_f32_16x16x32_bf16 v[168:171], a[212:215], a[140:143], v[168:171]
ds_read_b64_tr_b16 a[198:199], v15 offset:9088
v_mul_f32 v71, s48, v71
v_cvt_pk_bf16_f32 v64, v64, v65
v_cvt_pk_bf16_f32 v65, v66, v67
v_cvt_pk_bf16_f32 v66, v68, v69
v_cvt_pk_bf16_f32 v67, v70, v71
v_mfma_f32_16x16x32_bf16 v[200:203], a[208:211], a[144:147], v[200:203]
v_accvgpr_write_b32 a112, v64
v_accvgpr_write_b32 a113, v65
v_accvgpr_write_b32 a114, v66
v_accvgpr_write_b32 a115, v67
v_accvgpr_read_b32 v72, a88
v_mfma_f32_16x16x32_bf16 v[200:203], a[212:215], a[148:151], v[200:203]
v_accvgpr_read_b32 v73, a89
v_accvgpr_read_b32 v74, a90
v_accvgpr_read_b32 v75, a91
v_accvgpr_read_b32 v76, a92
v_accvgpr_read_b32 v77, a93
v_mfma_f32_16x16x32_bf16 v[232:235], a[208:211], a[152:155], v[232:235]
v_accvgpr_read_b32 v78, a94
v_accvgpr_read_b32 v79, a95
v_mul_f32 v72, s48, v72
v_mul_f32 v73, s48, v73
v_mfma_f32_16x16x32_bf16 v[232:235], a[212:215], a[156:159], v[232:235]
s_waitcnt lgkmcnt(4)
v_mul_f32 v74, s48, v74
v_mul_f32 v75, s48, v75
v_mul_f32 v76, s48, v76
v_mul_f32 v77, s48, v77
v_mul_f32 v78, s48, v78
v_mfma_f32_16x16x32_bf16 v[140:143], a[216:219], a[128:131], v[140:143]
ds_read_b64_tr_b16 a[200:201], v15 offset:136
s_add_u32 m0, s38, 0
v_mul_f32 v79, s48, v79
v_cvt_pk_bf16_f32 v72, v72, v73
v_cvt_pk_bf16_f32 v73, v74, v75
v_cvt_pk_bf16_f32 v74, v76, v77
v_cvt_pk_bf16_f32 v75, v78, v79
v_mfma_f32_16x16x32_bf16 v[140:143], a[220:223], a[132:135], v[140:143]
buffer_load_dwordx4 v24, s[16:19], s39 offen offset:0 nt lds
ds_read_b64_tr_b16 a[202:203], v15 offset:392
v_accvgpr_write_b32 a108, v72
v_accvgpr_write_b32 a109, v73
v_accvgpr_write_b32 a110, v74
v_accvgpr_write_b32 a111, v75
v_accvgpr_read_b32 v64, a80
v_mfma_f32_16x16x32_bf16 v[172:175], a[216:219], a[136:139], v[172:175]
ds_read_b64_tr_b16 a[204:205], v15 offset:8840
v_accvgpr_read_b32 v65, a81
v_accvgpr_read_b32 v66, a82
v_accvgpr_read_b32 v67, a83
v_accvgpr_read_b32 v68, a84
v_accvgpr_read_b32 v69, a85
v_mfma_f32_16x16x32_bf16 v[172:175], a[220:223], a[140:143], v[172:175]
ds_read_b64_tr_b16 a[206:207], v15 offset:9096
v_accvgpr_read_b32 v70, a86
v_accvgpr_read_b32 v71, a87
v_mul_f32 v64, s48, v64
v_mul_f32 v65, s48, v65
v_mul_f32 v66, s48, v66
v_mfma_f32_16x16x32_bf16 v[204:207], a[216:219], a[144:147], v[204:207]
s_add_u32 m0, s38, 8704
v_mul_f32 v67, s48, v67
v_mul_f32 v68, s48, v68
v_mul_f32 v69, s48, v69
v_mul_f32 v70, s48, v70
v_mul_f32 v71, s48, v71
v_mfma_f32_16x16x32_bf16 v[204:207], a[220:223], a[148:151], v[204:207]
buffer_load_dwordx4 v25, s[20:23], s39 offen offset:0 nt lds
v_cvt_pk_bf16_f32 v64, v64, v65
v_cvt_pk_bf16_f32 v65, v66, v67
v_cvt_pk_bf16_f32 v66, v68, v69
v_cvt_pk_bf16_f32 v67, v70, v71
v_mfma_f32_16x16x32_bf16 v[236:239], a[216:219], a[152:155], v[236:239]
v_accvgpr_write_b32 a104, v64
v_accvgpr_write_b32 a105, v65
v_accvgpr_write_b32 a106, v66
v_accvgpr_write_b32 a107, v67
v_accvgpr_read_b32 v72, a72
v_mfma_f32_16x16x32_bf16 v[236:239], a[220:223], a[156:159], v[236:239]
s_waitcnt lgkmcnt(4)
v_accvgpr_read_b32 v73, a73
v_accvgpr_read_b32 v74, a74
v_accvgpr_read_b32 v75, a75
v_accvgpr_read_b32 v76, a76
v_accvgpr_read_b32 v77, a77
v_mfma_f32_16x16x32_bf16 v[144:147], a[192:195], a[128:131], v[144:147]
s_add_u32 s37, s28, 17408
ds_read_b64_tr_b16 a[208:209], v15 offset:192
s_add_u32 m0, s38, 64
v_accvgpr_read_b32 v78, a78
v_accvgpr_read_b32 v79, a79
v_mul_f32 v72, s48, v72
v_mul_f32 v73, s48, v73
v_mul_f32 v74, s48, v74
v_mfma_f32_16x16x32_bf16 v[144:147], a[196:199], a[132:135], v[144:147]
buffer_load_dwordx4 v24, s[16:19], s39 offen offset:1024 nt lds
s_cmp_eq_u32 s37, 139264
ds_read_b64_tr_b16 a[210:211], v15 offset:448
v_mul_f32 v75, s48, v75
v_mul_f32 v76, s48, v76
v_mul_f32 v77, s48, v77
v_mul_f32 v78, s48, v78
v_mul_f32 v79, s48, v79
v_mfma_f32_16x16x32_bf16 v[176:179], a[192:195], a[136:139], v[176:179]
s_cselect_b32 s36, 52224, s37
ds_read_b64_tr_b16 a[212:213], v15 offset:8896
v_cvt_pk_bf16_f32 v72, v72, v73
v_cvt_pk_bf16_f32 v73, v74, v75
v_cvt_pk_bf16_f32 v74, v76, v77
v_cvt_pk_bf16_f32 v75, v78, v79
v_accvgpr_write_b32 a100, v72
v_mfma_f32_16x16x32_bf16 v[176:179], a[196:199], a[140:143], v[176:179]
ds_read_b64_tr_b16 a[214:215], v15 offset:9152
v_accvgpr_write_b32 a101, v73
v_accvgpr_write_b32 a102, v74
v_accvgpr_write_b32 a103, v75
v_accvgpr_read_b32 v64, a64
v_accvgpr_read_b32 v65, a65
v_mfma_f32_16x16x32_bf16 v[208:211], a[192:195], a[144:147], v[208:211]
s_add_u32 m0, s38, 9536
v_accvgpr_read_b32 v66, a66
v_accvgpr_read_b32 v67, a67
v_accvgpr_read_b32 v68, a68
v_accvgpr_read_b32 v69, a69
v_mfma_f32_16x16x32_bf16 v[208:211], a[196:199], a[148:151], v[208:211]
buffer_load_dwordx4 v25, s[20:23], s39 offen offset:256 nt lds
v_accvgpr_read_b32 v70, a70
v_accvgpr_read_b32 v71, a71
v_mul_f32 v64, s48, v64
v_mul_f32 v65, s48, v65
v_mul_f32 v66, s48, v66
v_mfma_f32_16x16x32_bf16 v[240:243], a[192:195], a[152:155], v[240:243]
s_add_u32 s101, s101, 8192
s_add_u32 s100, s100, s92
s_and_b32 s39, s100, 0xf800
s_and_b32 s93, s101, 0x40000
s_or_b32 s39, s39, s93
s_add_u32 s38, s38, 17408
s_cmp_eq_u32 s38, s71
s_cselect_b32 s38, s70, s38
v_mul_f32 v67, s48, v67
v_mul_f32 v68, s48, v68
v_mul_f32 v69, s48, v69
v_mul_f32 v70, s48, v70
v_mul_f32 v71, s48, v71
v_mfma_f32_16x16x32_bf16 v[240:243], a[196:199], a[156:159], v[240:243]
s_waitcnt lgkmcnt(4)
v_cvt_pk_bf16_f32 v64, v64, v65
v_cvt_pk_bf16_f32 v65, v66, v67
v_cvt_pk_bf16_f32 v66, v68, v69
v_cvt_pk_bf16_f32 v67, v70, v71
v_accvgpr_write_b32 a96, v64
v_mfma_f32_16x16x32_bf16 v[148:151], a[200:203], a[128:131], v[148:151]
ds_read_b64_tr_b16 a[216:217], v15 offset:200
v_accvgpr_write_b32 a97, v65
v_accvgpr_write_b32 a98, v66
v_accvgpr_write_b32 a99, v67
v_accvgpr_read_b32 v72, a56
v_accvgpr_read_b32 v73, a57
v_mfma_f32_16x16x32_bf16 v[148:151], a[204:207], a[132:135], v[148:151]
ds_read_b64_tr_b16 a[218:219], v15 offset:456
v_accvgpr_read_b32 v74, a58
v_accvgpr_read_b32 v75, a59
v_accvgpr_read_b32 v76, a60
v_accvgpr_read_b32 v77, a61
v_accvgpr_read_b32 v78, a62
v_mfma_f32_16x16x32_bf16 v[180:183], a[200:203], a[136:139], v[180:183]
ds_read_b64_tr_b16 a[220:221], v15 offset:8904
v_accvgpr_read_b32 v79, a63
v_mul_f32 v72, s48, v72
v_mul_f32 v73, s48, v73
v_mul_f32 v74, s48, v74
v_mul_f32 v75, s48, v75
v_mfma_f32_16x16x32_bf16 v[180:183], a[204:207], a[140:143], v[180:183]
ds_read_b64_tr_b16 a[222:223], v15 offset:9160
v_mul_f32 v76, s48, v76
v_mul_f32 v77, s48, v77
v_mul_f32 v78, s48, v78
v_mul_f32 v79, s48, v79
v_mfma_f32_16x16x32_bf16 v[212:215], a[200:203], a[144:147], v[212:215]
v_cvt_pk_bf16_f32 v72, v72, v73
v_cvt_pk_bf16_f32 v73, v74, v75
v_cvt_pk_bf16_f32 v74, v76, v77
v_cvt_pk_bf16_f32 v75, v78, v79
v_accvgpr_write_b32 a92, v72
v_mfma_f32_16x16x32_bf16 v[212:215], a[204:207], a[148:151], v[212:215]
v_accvgpr_write_b32 a93, v73
v_accvgpr_write_b32 a94, v74
v_accvgpr_write_b32 a95, v75
v_accvgpr_read_b32 v64, a48
v_accvgpr_read_b32 v65, a49
v_mfma_f32_16x16x32_bf16 v[244:247], a[200:203], a[152:155], v[244:247]
v_accvgpr_read_b32 v66, a50
v_accvgpr_read_b32 v67, a51
v_accvgpr_read_b32 v68, a52
v_accvgpr_read_b32 v69, a53
v_accvgpr_read_b32 v70, a54
v_mfma_f32_16x16x32_bf16 v[244:247], a[204:207], a[156:159], v[244:247]
s_waitcnt vmcnt(11) lgkmcnt(0)
s_barrier
v_add_u32 v15, s36, v14
v_accvgpr_read_b32 v71, a55
v_mul_f32 v64, s48, v64
v_mul_f32 v65, s48, v65
v_mul_f32 v66, s48, v66
v_mul_f32 v67, s48, v67
v_mfma_f32_16x16x32_bf16 v[152:155], a[208:211], a[128:131], v[152:155]
ds_read_b64_tr_b16 a[192:193], v15 offset:0
s_add_u32 m0, s38, 0
v_mul_f32 v68, s48, v68
v_mul_f32 v69, s48, v69
v_mul_f32 v70, s48, v70
v_mul_f32 v71, s48, v71
v_cvt_pk_bf16_f32 v64, v64, v65
v_mfma_f32_16x16x32_bf16 v[152:155], a[212:215], a[132:135], v[152:155]
buffer_load_dwordx4 v24, s[16:19], s39 offen offset:0 nt lds
s_add_u32 s29, s28, s33
ds_read_b64_tr_b16 a[194:195], v15 offset:256
v_cvt_pk_bf16_f32 v65, v66, v67
v_cvt_pk_bf16_f32 v66, v68, v69
v_cvt_pk_bf16_f32 v67, v70, v71
v_accvgpr_write_b32 a88, v64
v_accvgpr_write_b32 a89, v65
v_mfma_f32_16x16x32_bf16 v[184:187], a[208:211], a[136:139], v[184:187]
s_mov_b32 s28, s36
ds_read_b64_tr_b16 a[196:197], v15 offset:8704
buffer_load_dword v127, v126, s[52:55], s69 offen
v_accvgpr_write_b32 a90, v66
v_accvgpr_write_b32 a91, v67
v_accvgpr_read_b32 v72, a40
v_accvgpr_read_b32 v73, a41
v_mfma_f32_16x16x32_bf16 v[184:187], a[212:215], a[140:143], v[184:187]
ds_read_b64_tr_b16 a[198:199], v15 offset:8960
v_accvgpr_read_b32 v74, a42
v_accvgpr_read_b32 v75, a43
v_accvgpr_read_b32 v76, a44
v_accvgpr_read_b32 v77, a45
v_accvgpr_read_b32 v78, a46
v_mfma_f32_16x16x32_bf16 v[216:219], a[208:211], a[144:147], v[216:219]
s_add_u32 m0, s38, 8704
v_accvgpr_read_b32 v79, a47
v_mul_f32 v72, s48, v72
v_mul_f32 v73, s48, v73
v_mul_f32 v74, s48, v74
v_mul_f32 v75, s48, v75
v_mfma_f32_16x16x32_bf16 v[216:219], a[212:215], a[148:151], v[216:219]
buffer_load_dwordx4 v25, s[20:23], s39 offen offset:0 nt lds
v_mul_f32 v76, s48, v76
v_mul_f32 v77, s48, v77
v_mul_f32 v78, s48, v78
v_mul_f32 v79, s48, v79
v_cvt_pk_bf16_f32 v72, v72, v73
v_mfma_f32_16x16x32_bf16 v[248:251], a[208:211], a[152:155], v[248:251]
v_cvt_pk_bf16_f32 v73, v74, v75
v_cvt_pk_bf16_f32 v74, v76, v77
v_cvt_pk_bf16_f32 v75, v78, v79
v_accvgpr_write_b32 a84, v72
v_accvgpr_write_b32 a85, v73
v_mfma_f32_16x16x32_bf16 v[248:251], a[212:215], a[156:159], v[248:251]
v_accvgpr_write_b32 a86, v74
v_accvgpr_write_b32 a87, v75
v_accvgpr_read_b32 v64, a32
v_accvgpr_read_b32 v65, a33
v_accvgpr_read_b32 v66, a34
v_mfma_f32_16x16x32_bf16 v[156:159], a[216:219], a[128:131], v[156:159]
ds_read_b64_tr_b16 a[200:201], v15 offset:8
s_add_u32 m0, s38, 64
v_accvgpr_read_b32 v67, a35
v_accvgpr_read_b32 v68, a36
v_accvgpr_read_b32 v69, a37
v_accvgpr_read_b32 v70, a38
v_accvgpr_read_b32 v71, a39
v_mfma_f32_16x16x32_bf16 v[156:159], a[220:223], a[132:135], v[156:159]
buffer_load_dwordx4 v24, s[16:19], s39 offen offset:1024 nt lds
s_add_u32 s69, s69, 4096
ds_read_b64_tr_b16 a[202:203], v15 offset:264
v_mul_f32 v64, s48, v64
v_mul_f32 v65, s48, v65
v_mul_f32 v66, s48, v66
v_mul_f32 v67, s48, v67
v_mfma_f32_16x16x32_bf16 v[188:191], a[216:219], a[136:139], v[188:191]
ds_read_b64_tr_b16 a[204:205], v15 offset:8712
v_mul_f32 v68, s48, v68
v_mul_f32 v69, s48, v69
v_mul_f32 v70, s48, v70
v_mul_f32 v71, s48, v71
v_cvt_pk_bf16_f32 v64, v64, v65
v_mfma_f32_16x16x32_bf16 v[188:191], a[220:223], a[140:143], v[188:191]
ds_read_b64_tr_b16 a[206:207], v15 offset:8968
v_cvt_pk_bf16_f32 v65, v66, v67
v_cvt_pk_bf16_f32 v66, v68, v69
v_cvt_pk_bf16_f32 v67, v70, v71
v_accvgpr_write_b32 a80, v64
v_accvgpr_write_b32 a81, v65
v_mfma_f32_16x16x32_bf16 v[220:223], a[216:219], a[144:147], v[220:223]
s_add_u32 m0, s38, 9536
v_accvgpr_write_b32 a82, v66
v_accvgpr_write_b32 a83, v67
v_accvgpr_read_b32 v72, a24
v_accvgpr_read_b32 v73, a25
v_accvgpr_read_b32 v74, a26
v_mfma_f32_16x16x32_bf16 v[220:223], a[220:223], a[148:151], v[220:223]
buffer_load_dwordx4 v25, s[20:23], s39 offen offset:256 nt lds
v_accvgpr_read_b32 v75, a27
v_accvgpr_read_b32 v76, a28
v_accvgpr_read_b32 v77, a29
v_accvgpr_read_b32 v78, a30
v_accvgpr_read_b32 v79, a31
v_mfma_f32_16x16x32_bf16 v[252:255], a[216:219], a[152:155], v[252:255]
s_add_u32 s101, s101, 8192
s_add_u32 s100, s100, s92
s_and_b32 s39, s100, 0xf800
s_and_b32 s93, s101, 0x40000
s_or_b32 s39, s39, s93
s_add_u32 s38, s38, 17408
s_cmp_eq_u32 s38, s71
s_cselect_b32 s38, s70, s38
v_mul_f32 v72, s48, v72
v_mul_f32 v73, s48, v73
v_mul_f32 v74, s48, v74
v_mul_f32 v75, s48, v75
v_mul_f32 v76, s48, v76
v_mfma_f32_16x16x32_bf16 v[252:255], a[220:223], a[156:159], v[252:255]
s_waitcnt lgkmcnt(4)
v_mul_f32 v77, s48, v77
v_mul_f32 v78, s48, v78
v_mul_f32 v79, s48, v79
v_cvt_pk_bf16_f32 v72, v72, v73
v_cvt_pk_bf16_f32 v73, v74, v75
v_mfma_f32_16x16x32_bf16 v[128:131], a[192:195], a[160:163], v[128:131]
ds_read_b64_tr_b16 a[208:209], v15 offset:64
v_cvt_pk_bf16_f32 v74, v76, v77
v_cvt_pk_bf16_f32 v75, v78, v79
v_accvgpr_write_b32 a76, v72
v_accvgpr_write_b32 a77, v73
v_mfma_f32_16x16x32_bf16 v[128:131], a[196:199], a[164:167], v[128:131]
ds_read_b64_tr_b16 a[210:211], v15 offset:320
v_accvgpr_write_b32 a78, v74
v_accvgpr_write_b32 a79, v75
v_accvgpr_read_b32 v64, a16
v_accvgpr_read_b32 v65, a17
v_accvgpr_read_b32 v66, a18
v_mfma_f32_16x16x32_bf16 v[160:163], a[192:195], a[168:171], v[160:163]
ds_read_b64_tr_b16 a[212:213], v15 offset:8768
v_accvgpr_read_b32 v67, a19
v_accvgpr_read_b32 v68, a20
v_accvgpr_read_b32 v69, a21
v_accvgpr_read_b32 v70, a22
v_accvgpr_read_b32 v71, a23
v_mfma_f32_16x16x32_bf16 v[160:163], a[196:199], a[172:175], v[160:163]
ds_read_b64_tr_b16 a[214:215], v15 offset:9024
v_mul_f32 v64, s48, v64
v_mul_f32 v65, s48, v65
v_mul_f32 v66, s48, v66
v_mul_f32 v67, s48, v67
v_mul_f32 v68, s48, v68
v_mfma_f32_16x16x32_bf16 v[192:195], a[192:195], a[176:179], v[192:195]
v_mul_f32 v69, s48, v69
v_mul_f32 v70, s48, v70
v_mul_f32 v71, s48, v71
v_cvt_pk_bf16_f32 v64, v64, v65
v_cvt_pk_bf16_f32 v65, v66, v67
v_mfma_f32_16x16x32_bf16 v[192:195], a[196:199], a[180:183], v[192:195]
v_cvt_pk_bf16_f32 v66, v68, v69
v_cvt_pk_bf16_f32 v67, v70, v71
v_accvgpr_write_b32 a72, v64
v_accvgpr_write_b32 a73, v65
v_accvgpr_write_b32 a74, v66
v_mfma_f32_16x16x32_bf16 v[224:227], a[192:195], a[184:187], v[224:227]
v_accvgpr_write_b32 a75, v67
v_accvgpr_read_b32 v72, a8
v_accvgpr_read_b32 v73, a9
v_accvgpr_read_b32 v74, a10
v_accvgpr_read_b32 v75, a11
v_mfma_f32_16x16x32_bf16 v[224:227], a[196:199], a[188:191], v[224:227]
s_waitcnt lgkmcnt(4)
v_accvgpr_read_b32 v76, a12
v_accvgpr_read_b32 v77, a13
v_accvgpr_read_b32 v78, a14
v_accvgpr_read_b32 v79, a15
v_mul_f32 v72, s48, v72
v_mfma_f32_16x16x32_bf16 v[132:135], a[200:203], a[160:163], v[132:135]
ds_read_b64_tr_b16 a[216:217], v15 offset:72
s_add_u32 m0, s38, 0
v_mul_f32 v73, s48, v73
v_mul_f32 v74, s48, v74
v_mul_f32 v75, s48, v75
v_mul_f32 v76, s48, v76
v_mfma_f32_16x16x32_bf16 v[132:135], a[204:207], a[164:167], v[132:135]
buffer_load_dwordx4 v24, s[16:19], s39 offen offset:0 nt lds
ds_read_b64_tr_b16 a[218:219], v15 offset:328
v_mul_f32 v77, s48, v77
v_mul_f32 v78, s48, v78
v_mul_f32 v79, s48, v79
v_cvt_pk_bf16_f32 v72, v72, v73
v_cvt_pk_bf16_f32 v73, v74, v75
v_mfma_f32_16x16x32_bf16 v[164:167], a[200:203], a[168:171], v[164:167]
ds_read_b64_tr_b16 a[220:221], v15 offset:8776
v_cvt_pk_bf16_f32 v74, v76, v77
v_cvt_pk_bf16_f32 v75, v78, v79
v_accvgpr_write_b32 a68, v72
v_accvgpr_write_b32 a69, v73
v_accvgpr_write_b32 a70, v74
v_mfma_f32_16x16x32_bf16 v[164:167], a[204:207], a[172:175], v[164:167]
ds_read_b64_tr_b16 a[222:223], v15 offset:9032
v_accvgpr_write_b32 a71, v75
v_accvgpr_read_b32 v64, a0
v_accvgpr_read_b32 v65, a1
v_accvgpr_read_b32 v66, a2
v_accvgpr_read_b32 v67, a3
v_mfma_f32_16x16x32_bf16 v[196:199], a[200:203], a[176:179], v[196:199]
s_add_u32 m0, s38, 8704
v_accvgpr_read_b32 v68, a4
v_accvgpr_read_b32 v69, a5
v_accvgpr_read_b32 v70, a6
v_accvgpr_read_b32 v71, a7
v_mul_f32 v64, s48, v64
v_mfma_f32_16x16x32_bf16 v[196:199], a[204:207], a[180:183], v[196:199]
buffer_load_dwordx4 v25, s[20:23], s39 offen offset:0 nt lds
v_mul_f32 v65, s48, v65
v_mul_f32 v66, s48, v66
v_mul_f32 v67, s48, v67
v_mul_f32 v68, s48, v68
v_mul_f32 v69, s48, v69
v_mfma_f32_16x16x32_bf16 v[228:231], a[200:203], a[184:187], v[228:231]
v_mul_f32 v70, s48, v70
v_mul_f32 v71, s48, v71
v_cvt_pk_bf16_f32 v64, v64, v65
v_cvt_pk_bf16_f32 v65, v66, v67
v_cvt_pk_bf16_f32 v66, v68, v69
v_mfma_f32_16x16x32_bf16 v[228:231], a[204:207], a[188:191], v[228:231]
s_waitcnt lgkmcnt(4)
v_cvt_pk_bf16_f32 v67, v70, v71
v_accvgpr_write_b32 a64, v64
v_accvgpr_write_b32 a65, v65
v_accvgpr_write_b32 a66, v66
v_accvgpr_write_b32 a67, v67
v_mfma_f32_16x16x32_bf16 v[136:139], a[208:211], a[160:163], v[136:139]
ds_read_b64_tr_b16 a[192:193], v15 offset:128
s_add_u32 m0, s38, 64
v_mfma_f32_16x16x32_bf16 v[136:139], a[212:215], a[164:167], v[136:139]
buffer_load_dwordx4 v24, s[16:19], s39 offen offset:1024 nt lds
ds_read_b64_tr_b16 a[194:195], v15 offset:384
v_mul_f32 v64, s48, v128
v_mul_f32 v65, s48, v129
v_mul_f32 v66, s48, v130
v_mul_f32 v67, s48, v131
v_mfma_f32_16x16x32_bf16 v[168:171], a[208:211], a[168:171], v[168:171]
ds_read_b64_tr_b16 a[196:197], v15 offset:8832
v_mul_f32 v68, s48, v132
v_mul_f32 v69, s48, v133
v_mul_f32 v70, s48, v134
v_mul_f32 v71, s48, v135
v_mfma_f32_16x16x32_bf16 v[168:171], a[212:215], a[172:175], v[168:171]
ds_read_b64_tr_b16 a[198:199], v15 offset:9088
v_cvt_pk_bf16_f32 v64, v64, v65
v_cvt_pk_bf16_f32 v65, v66, v67
v_cvt_pk_bf16_f32 v66, v68, v69
v_cvt_pk_bf16_f32 v67, v70, v71
v_mfma_f32_16x16x32_bf16 v[200:203], a[208:211], a[176:179], v[200:203]
s_add_u32 m0, s38, 9536
v_accvgpr_write_b32 a0, v64
v_accvgpr_write_b32 a1, v65
v_accvgpr_write_b32 a2, v66
v_accvgpr_write_b32 a3, v67
v_mul_f32 v64, s48, v160
v_mfma_f32_16x16x32_bf16 v[200:203], a[212:215], a[180:183], v[200:203]
buffer_load_dwordx4 v25, s[20:23], s39 offen offset:256 nt lds
v_mul_f32 v65, s48, v161
v_mul_f32 v66, s48, v162
v_mul_f32 v67, s48, v163
v_mul_f32 v68, s48, v164
v_mfma_f32_16x16x32_bf16 v[232:235], a[208:211], a[184:187], v[232:235]
s_add_u32 s101, s101, 8192
s_add_u32 s100, s100, s92
s_and_b32 s39, s100, 0xf800
s_and_b32 s93, s101, 0x40000
s_or_b32 s39, s39, s93
s_add_u32 s38, s38, 17408
s_cmp_eq_u32 s38, s71
s_cselect_b32 s38, s70, s38
v_mul_f32 v69, s48, v165
v_mul_f32 v70, s48, v166
v_mul_f32 v71, s48, v167
v_cvt_pk_bf16_f32 v64, v64, v65
v_mfma_f32_16x16x32_bf16 v[232:235], a[212:215], a[188:191], v[232:235]
s_waitcnt lgkmcnt(4)
v_cvt_pk_bf16_f32 v65, v66, v67
v_cvt_pk_bf16_f32 v66, v68, v69
v_cvt_pk_bf16_f32 v67, v70, v71
v_accvgpr_write_b32 a16, v64
v_mfma_f32_16x16x32_bf16 v[140:143], a[216:219], a[160:163], v[140:143]
ds_read_b64_tr_b16 a[200:201], v15 offset:136
v_accvgpr_write_b32 a17, v65
v_accvgpr_write_b32 a18, v66
v_accvgpr_write_b32 a19, v67
v_mul_f32 v64, s48, v192
v_mul_f32 v65, s48, v193
v_mfma_f32_16x16x32_bf16 v[140:143], a[220:223], a[164:167], v[140:143]
ds_read_b64_tr_b16 a[202:203], v15 offset:392
v_mul_f32 v66, s48, v194
v_mul_f32 v67, s48, v195
v_mul_f32 v68, s48, v196
v_mul_f32 v69, s48, v197
v_mfma_f32_16x16x32_bf16 v[172:175], a[216:219], a[168:171], v[172:175]
ds_read_b64_tr_b16 a[204:205], v15 offset:8840
v_mul_f32 v70, s48, v198
v_mul_f32 v71, s48, v199
v_cvt_pk_bf16_f32 v64, v64, v65
v_cvt_pk_bf16_f32 v65, v66, v67
v_mfma_f32_16x16x32_bf16 v[172:175], a[220:223], a[172:175], v[172:175]
ds_read_b64_tr_b16 a[206:207], v15 offset:9096
v_cvt_pk_bf16_f32 v66, v68, v69
v_cvt_pk_bf16_f32 v67, v70, v71
v_accvgpr_write_b32 a32, v64
v_accvgpr_write_b32 a33, v65
v_mfma_f32_16x16x32_bf16 v[204:207], a[216:219], a[176:179], v[204:207]
v_accvgpr_write_b32 a34, v66
v_accvgpr_write_b32 a35, v67
v_mul_f32 v64, s48, v224
v_mul_f32 v65, s48, v225
v_mul_f32 v66, s48, v226
v_mfma_f32_16x16x32_bf16 v[204:207], a[220:223], a[180:183], v[204:207]
v_mul_f32 v67, s48, v227
v_mul_f32 v68, s48, v228
v_mul_f32 v69, s48, v229
v_mul_f32 v70, s48, v230
v_mfma_f32_16x16x32_bf16 v[236:239], a[216:219], a[184:187], v[236:239]
v_mul_f32 v71, s48, v231
v_cvt_pk_bf16_f32 v64, v64, v65
v_cvt_pk_bf16_f32 v65, v66, v67
v_cvt_pk_bf16_f32 v66, v68, v69
v_mfma_f32_16x16x32_bf16 v[236:239], a[220:223], a[188:191], v[236:239]
s_waitcnt lgkmcnt(4)
v_cvt_pk_bf16_f32 v67, v70, v71
v_accvgpr_write_b32 a48, v64
v_accvgpr_write_b32 a49, v65
v_accvgpr_write_b32 a50, v66
v_accvgpr_write_b32 a51, v67
v_mfma_f32_16x16x32_bf16 v[144:147], a[192:195], a[160:163], v[144:147]
ds_read_b64_tr_b16 a[208:209], v15 offset:192
s_add_u32 m0, s38, 0
v_mfma_f32_16x16x32_bf16 v[144:147], a[196:199], a[164:167], v[144:147]
buffer_load_dwordx4 v24, s[16:19], s39 offen offset:0 nt lds
ds_read_b64_tr_b16 a[210:211], v15 offset:448
v_mul_f32 v72, s48, v136
v_mul_f32 v73, s48, v137
v_mul_f32 v74, s48, v138
v_mul_f32 v75, s48, v139
v_mfma_f32_16x16x32_bf16 v[176:179], a[192:195], a[168:171], v[176:179]
ds_read_b64_tr_b16 a[212:213], v15 offset:8896
v_mul_f32 v76, s48, v140
v_mul_f32 v77, s48, v141
v_mul_f32 v78, s48, v142
v_mul_f32 v79, s48, v143
v_mfma_f32_16x16x32_bf16 v[176:179], a[196:199], a[172:175], v[176:179]
ds_read_b64_tr_b16 a[214:215], v15 offset:9152
v_cvt_pk_bf16_f32 v72, v72, v73
v_cvt_pk_bf16_f32 v73, v74, v75
v_cvt_pk_bf16_f32 v74, v76, v77
v_cvt_pk_bf16_f32 v75, v78, v79
v_mfma_f32_16x16x32_bf16 v[208:211], a[192:195], a[176:179], v[208:211]
s_add_u32 m0, s38, 8704
v_accvgpr_write_b32 a4, v72
v_accvgpr_write_b32 a5, v73
v_accvgpr_write_b32 a6, v74
v_accvgpr_write_b32 a7, v75
v_mul_f32 v72, s48, v168
v_mfma_f32_16x16x32_bf16 v[208:211], a[196:199], a[180:183], v[208:211]
buffer_load_dwordx4 v25, s[20:23], s39 offen offset:0 nt lds
v_mul_f32 v73, s48, v169
v_mul_f32 v74, s48, v170
v_mul_f32 v75, s48, v171
v_mul_f32 v76, s48, v172
v_mfma_f32_16x16x32_bf16 v[240:243], a[192:195], a[184:187], v[240:243]
v_mul_f32 v77, s48, v173
v_mul_f32 v78, s48, v174
v_mul_f32 v79, s48, v175
v_cvt_pk_bf16_f32 v72, v72, v73
v_mfma_f32_16x16x32_bf16 v[240:243], a[196:199], a[188:191], v[240:243]
s_waitcnt lgkmcnt(4)
v_cvt_pk_bf16_f32 v73, v74, v75
v_cvt_pk_bf16_f32 v74, v76, v77
v_cvt_pk_bf16_f32 v75, v78, v79
v_accvgpr_write_b32 a20, v72
v_mfma_f32_16x16x32_bf16 v[148:151], a[200:203], a[160:163], v[148:151]
ds_read_b64_tr_b16 a[216:217], v15 offset:200
s_add_u32 m0, s38, 64
v_accvgpr_write_b32 a21, v73
v_accvgpr_write_b32 a22, v74
v_accvgpr_write_b32 a23, v75
v_mul_f32 v72, s48, v200
v_mul_f32 v73, s48, v201
v_mfma_f32_16x16x32_bf16 v[148:151], a[204:207], a[164:167], v[148:151]
buffer_load_dwordx4 v24, s[16:19], s39 offen offset:1024 nt lds
ds_read_b64_tr_b16 a[218:219], v15 offset:456
v_mul_f32 v74, s48, v202
v_mul_f32 v75, s48, v203
v_mul_f32 v76, s48, v204
v_mul_f32 v77, s48, v205
v_mfma_f32_16x16x32_bf16 v[180:183], a[200:203], a[168:171], v[180:183]
ds_read_b64_tr_b16 a[220:221], v15 offset:8904
v_mul_f32 v78, s48, v206
v_mul_f32 v79, s48, v207
v_cvt_pk_bf16_f32 v72, v72, v73
v_cvt_pk_bf16_f32 v73, v74, v75
v_mfma_f32_16x16x32_bf16 v[180:183], a[204:207], a[172:175], v[180:183]
ds_read_b64_tr_b16 a[222:223], v15 offset:9160
v_cvt_pk_bf16_f32 v74, v76, v77
v_cvt_pk_bf16_f32 v75, v78, v79
v_accvgpr_write_b32 a36, v72
v_accvgpr_write_b32 a37, v73
v_mfma_f32_16x16x32_bf16 v[212:215], a[200:203], a[176:179], v[212:215]
s_add_u32 m0, s38, 9536
v_accvgpr_write_b32 a38, v74
v_accvgpr_write_b32 a39, v75
v_mul_f32 v72, s48, v232
v_mul_f32 v73, s48, v233
v_mul_f32 v74, s48, v234
v_mfma_f32_16x16x32_bf16 v[212:215], a[204:207], a[180:183], v[212:215]
buffer_load_dwordx4 v25, s[20:23], s39 offen offset:256 nt lds
v_mul_f32 v75, s48, v235
v_mul_f32 v76, s48, v236
v_mul_f32 v77, s48, v237
v_mul_f32 v78, s48, v238
v_mfma_f32_16x16x32_bf16 v[244:247], a[200:203], a[184:187], v[244:247]
s_add_u32 s101, s101, 8192
s_add_u32 s100, s100, s92
s_and_b32 s39, s100, 0xf800
s_and_b32 s93, s101, 0x40000
s_or_b32 s39, s39, s93
s_add_u32 s38, s38, 17408
s_cmp_eq_u32 s38, s71
s_cselect_b32 s38, s70, s38
v_mul_f32 v79, s48, v239
v_cvt_pk_bf16_f32 v72, v72, v73
v_cvt_pk_bf16_f32 v73, v74, v75
v_cvt_pk_bf16_f32 v74, v76, v77
v_mfma_f32_16x16x32_bf16 v[244:247], a[204:207], a[188:191], v[244:247]
s_waitcnt lgkmcnt(4)
v_cvt_pk_bf16_f32 v75, v78, v79
v_accvgpr_write_b32 a52, v72
v_accvgpr_write_b32 a53, v73
v_accvgpr_write_b32 a54, v74
v_accvgpr_write_b32 a55, v75
v_mfma_f32_16x16x32_bf16 v[152:155], a[208:211], a[160:163], v[152:155]
v_mfma_f32_16x16x32_bf16 v[152:155], a[212:215], a[164:167], v[152:155]
v_mul_f32 v64, s48, v144
v_mul_f32 v65, s48, v145
v_mul_f32 v66, s48, v146
v_mul_f32 v67, s48, v147
v_mfma_f32_16x16x32_bf16 v[184:187], a[208:211], a[168:171], v[184:187]
buffer_load_dword v127, v126, s[52:55], s69 offen
v_mul_f32 v68, s48, v148
v_mul_f32 v69, s48, v149
v_mul_f32 v70, s48, v150
v_mul_f32 v71, s48, v151
v_mfma_f32_16x16x32_bf16 v[184:187], a[212:215], a[172:175], v[184:187]
v_cvt_pk_bf16_f32 v64, v64, v65
v_cvt_pk_bf16_f32 v65, v66, v67
v_cvt_pk_bf16_f32 v66, v68, v69
v_cvt_pk_bf16_f32 v67, v70, v71
v_mfma_f32_16x16x32_bf16 v[216:219], a[208:211], a[176:179], v[216:219]
v_accvgpr_write_b32 a8, v64
v_accvgpr_write_b32 a9, v65
v_accvgpr_write_b32 a10, v66
v_accvgpr_write_b32 a11, v67
v_mul_f32 v64, s48, v176
v_mfma_f32_16x16x32_bf16 v[216:219], a[212:215], a[180:183], v[216:219]
v_mul_f32 v65, s48, v177
v_mul_f32 v66, s48, v178
v_mul_f32 v67, s48, v179
v_mul_f32 v68, s48, v180
v_mfma_f32_16x16x32_bf16 v[248:251], a[208:211], a[184:187], v[248:251]
v_mul_f32 v69, s48, v181
v_mul_f32 v70, s48, v182
v_mul_f32 v71, s48, v183
v_cvt_pk_bf16_f32 v64, v64, v65
v_mfma_f32_16x16x32_bf16 v[248:251], a[212:215], a[188:191], v[248:251]
s_waitcnt lgkmcnt(0)
v_cvt_pk_bf16_f32 v65, v66, v67
v_cvt_pk_bf16_f32 v66, v68, v69
v_cvt_pk_bf16_f32 v67, v70, v71
v_accvgpr_write_b32 a24, v64
v_mfma_f32_16x16x32_bf16 v[156:159], a[216:219], a[160:163], v[156:159]
v_accvgpr_write_b32 a25, v65
v_accvgpr_write_b32 a26, v66
v_accvgpr_write_b32 a27, v67
v_mul_f32 v64, s48, v208
v_mul_f32 v65, s48, v209
v_mfma_f32_16x16x32_bf16 v[156:159], a[220:223], a[164:167], v[156:159]
s_add_u32 s69, s69, 4096
v_mul_f32 v66, s48, v210
v_mul_f32 v67, s48, v211
v_mul_f32 v68, s48, v212
v_mul_f32 v69, s48, v213
v_mfma_f32_16x16x32_bf16 v[188:191], a[216:219], a[168:171], v[188:191]
v_mul_f32 v70, s48, v214
v_mul_f32 v71, s48, v215
v_cvt_pk_bf16_f32 v64, v64, v65
v_cvt_pk_bf16_f32 v65, v66, v67
v_mfma_f32_16x16x32_bf16 v[188:191], a[220:223], a[172:175], v[188:191]
v_cvt_pk_bf16_f32 v66, v68, v69
v_cvt_pk_bf16_f32 v67, v70, v71
v_accvgpr_write_b32 a40, v64
v_accvgpr_write_b32 a41, v65
v_mfma_f32_16x16x32_bf16 v[220:223], a[216:219], a[176:179], v[220:223]
v_accvgpr_write_b32 a42, v66
v_accvgpr_write_b32 a43, v67
v_mul_f32 v64, s48, v240
v_mul_f32 v65, s48, v241
v_mul_f32 v66, s48, v242
v_mfma_f32_16x16x32_bf16 v[220:223], a[220:223], a[180:183], v[220:223]
v_mul_f32 v67, s48, v243
v_mul_f32 v68, s48, v244
v_mul_f32 v69, s48, v245
v_mul_f32 v70, s48, v246
v_mfma_f32_16x16x32_bf16 v[252:255], a[216:219], a[184:187], v[252:255]
v_mul_f32 v71, s48, v247
v_cvt_pk_bf16_f32 v64, v64, v65
v_cvt_pk_bf16_f32 v65, v66, v67
v_cvt_pk_bf16_f32 v66, v68, v69
v_mfma_f32_16x16x32_bf16 v[252:255], a[220:223], a[188:191], v[252:255]
v_cvt_pk_bf16_f32 v67, v70, v71
v_accvgpr_write_b32 a56, v64
v_accvgpr_write_b32 a57, v65
v_accvgpr_write_b32 a58, v66
v_accvgpr_write_b32 a59, v67
s_add_u32 m0, s38, 0
s_nop 0
buffer_load_dwordx4 v24, s[16:19], s39 offen offset:0 nt lds
s_add_u32 m0, s38, 8704
s_nop 0
buffer_load_dwordx4 v25, s[20:23], s39 offen offset:0 nt lds
s_add_u32 m0, s38, 64
s_nop 0
buffer_load_dwordx4 v24, s[16:19], s39 offen offset:1024 nt lds
s_add_u32 m0, s38, 9536
s_nop 0
buffer_load_dwordx4 v25, s[20:23], s39 offen offset:256 nt lds
s_add_u32 s101, s101, 8192
s_add_u32 s100, s100, s92
s_and_b32 s39, s100, 0xf800
s_and_b32 s93, s101, 0x40000
s_or_b32 s39, s39, s93
s_add_u32 s38, s38, 17408
s_cmp_eq_u32 s38, s71
s_cselect_b32 s38, s70, s38
v_mfma_f32_16x16x32_bf16 v[80:83], v[48:51], a[64:67], 0
v_mul_f32 v72, s48, v152
v_mul_f32 v73, s48, v153
v_mul_f32 v74, s48, v154
v_mul_f32 v75, s48, v155
v_mfma_f32_16x16x32_bf16 v[84:87], v[48:51], a[80:83], 0
v_mul_f32 v76, s48, v156
v_mul_f32 v77, s48, v157
v_mul_f32 v78, s48, v158
v_mul_f32 v79, s48, v159
v_mfma_f32_16x16x32_bf16 v[88:91], v[48:51], a[96:99], 0
v_cvt_pk_bf16_f32 v72, v72, v73
v_cvt_pk_bf16_f32 v73, v74, v75
v_cvt_pk_bf16_f32 v74, v76, v77
v_cvt_pk_bf16_f32 v75, v78, v79
v_mfma_f32_16x16x32_bf16 v[92:95], v[48:51], a[112:115], 0
v_accvgpr_write_b32 a12, v72
v_accvgpr_write_b32 a13, v73
v_accvgpr_write_b32 a14, v74
v_accvgpr_write_b32 a15, v75
v_mfma_f32_16x16x32_bf16 v[80:83], v[52:55], a[68:71], v[80:83]
v_mul_f32 v72, s48, v184
v_mul_f32 v73, s48, v185
v_mul_f32 v74, s48, v186
v_mul_f32 v75, s48, v187
v_mfma_f32_16x16x32_bf16 v[84:87], v[52:55], a[84:87], v[84:87]
v_mul_f32 v76, s48, v188
v_mul_f32 v77, s48, v189
v_mul_f32 v78, s48, v190
v_mul_f32 v79, s48, v191
v_mfma_f32_16x16x32_bf16 v[88:91], v[52:55], a[100:103], v[88:91]
v_cvt_pk_bf16_f32 v72, v72, v73
v_cvt_pk_bf16_f32 v73, v74, v75
v_cvt_pk_bf16_f32 v74, v76, v77
v_cvt_pk_bf16_f32 v75, v78, v79
v_mfma_f32_16x16x32_bf16 v[92:95], v[52:55], a[116:119], v[92:95]
v_accvgpr_write_b32 a28, v72
v_accvgpr_write_b32 a29, v73
v_accvgpr_write_b32 a30, v74
v_accvgpr_write_b32 a31, v75
v_mfma_f32_16x16x32_bf16 v[80:83], v[56:59], a[72:75], v[80:83]
v_mul_f32 v72, s48, v216
v_mul_f32 v73, s48, v217
v_mul_f32 v74, s48, v218
v_mul_f32 v75, s48, v219
v_mfma_f32_16x16x32_bf16 v[84:87], v[56:59], a[88:91], v[84:87]
v_mul_f32 v76, s48, v220
v_mul_f32 v77, s48, v221
v_mul_f32 v78, s48, v222
v_mul_f32 v79, s48, v223
v_mfma_f32_16x16x32_bf16 v[88:91], v[56:59], a[104:107], v[88:91]
v_cvt_pk_bf16_f32 v72, v72, v73
v_cvt_pk_bf16_f32 v73, v74, v75
v_cvt_pk_bf16_f32 v74, v76, v77
v_cvt_pk_bf16_f32 v75, v78, v79
v_mfma_f32_16x16x32_bf16 v[92:95], v[56:59], a[120:123], v[92:95]
v_accvgpr_write_b32 a44, v72
v_accvgpr_write_b32 a45, v73
v_accvgpr_write_b32 a46, v74
v_accvgpr_write_b32 a47, v75
v_mfma_f32_16x16x32_bf16 v[80:83], v[60:63], a[76:79], v[80:83]
v_mul_f32 v72, s48, v248
v_mul_f32 v73, s48, v249
v_mul_f32 v74, s48, v250
v_mul_f32 v75, s48, v251
v_mfma_f32_16x16x32_bf16 v[84:87], v[60:63], a[92:95], v[84:87]
v_mul_f32 v76, s48, v252
v_mul_f32 v77, s48, v253
v_mul_f32 v78, s48, v254
v_mul_f32 v79, s48, v255
v_mfma_f32_16x16x32_bf16 v[88:91], v[60:63], a[108:111], v[88:91]
v_cvt_pk_bf16_f32 v72, v72, v73
v_cvt_pk_bf16_f32 v73, v74, v75
v_cvt_pk_bf16_f32 v74, v76, v77
v_cvt_pk_bf16_f32 v75, v78, v79
v_mfma_f32_16x16x32_bf16 v[92:95], v[60:63], a[124:127], v[92:95]
v_accvgpr_write_b32 a60, v72
v_accvgpr_write_b32 a61, v73
v_accvgpr_write_b32 a62, v74
v_accvgpr_write_b32 a63, v75
v_mfma_f32_16x16x32_bf16 v[128:131], v[32:35], a[0:3], 0
v_mfma_f32_16x16x32_bf16 v[132:135], v[32:35], a[16:19], 0
v_mfma_f32_16x16x32_bf16 v[136:139], v[32:35], a[32:35], 0
v_max3_f32 v80, v80, v81, v82
v_max3_f32 v84, v84, v85, v86
v_mfma_f32_16x16x32_bf16 v[140:143], v[32:35], a[48:51], 0
v_max3_f32 v88, v88, v89, v90
v_max3_f32 v92, v92, v93, v94
v_max_f32 v80, v80, v83
v_mfma_f32_16x16x32_bf16 v[128:131], v[36:39], a[4:7], v[128:131]
v_max_f32 v84, v84, v87
v_max_f32 v88, v88, v91
v_max_f32 v92, v92, v95
v_mfma_f32_16x16x32_bf16 v[132:135], v[36:39], a[20:23], v[132:135]
v_mov_b32 v81, v80
v_mov_b32 v85, v84
v_mov_b32 v89, v88
v_mfma_f32_16x16x32_bf16 v[136:139], v[36:39], a[36:39], v[136:139]
v_mov_b32 v93, v92
s_nop 1
v_permlane32_swap_b32 v80, v81
v_mfma_f32_16x16x32_bf16 v[140:143], v[36:39], a[52:55], v[140:143]
v_permlane32_swap_b32 v84, v85
v_permlane32_swap_b32 v88, v89
v_permlane32_swap_b32 v92, v93
v_mfma_f32_16x16x32_bf16 v[128:131], v[40:43], a[8:11], v[128:131]
s_nop 1
v_max_f32 v80, v80, v81
v_max_f32 v84, v84, v85
v_mfma_f32_16x16x32_bf16 v[132:135], v[40:43], a[24:27], v[132:135]
v_max_f32 v88, v88, v89
v_max_f32 v92, v92, v93
v_mfma_f32_16x16x32_bf16 v[136:139], v[40:43], a[40:43], v[136:139]
v_mov_b32 v81, v80
v_mov_b32 v85, v84
v_mov_b32 v89, v88
v_mfma_f32_16x16x32_bf16 v[140:143], v[40:43], a[56:59], v[140:143]
v_mov_b32 v93, v92
s_nop 1
v_permlane16_swap_b32 v80, v81
v_mfma_f32_16x16x32_bf16 v[128:131], v[44:47], a[12:15], v[128:131]
v_permlane16_swap_b32 v84, v85
v_permlane16_swap_b32 v88, v89
v_permlane16_swap_b32 v92, v93
v_mfma_f32_16x16x32_bf16 v[132:135], v[44:47], a[28:31], v[132:135]
s_nop 1
v_max_f32 v80, v80, v81
v_max_f32 v84, v84, v85
v_mfma_f32_16x16x32_bf16 v[136:139], v[44:47], a[44:47], v[136:139]
v_max_f32 v88, v88, v89
v_max_f32 v92, v92, v93
v_sub_f32 v112, 0, v80
v_mfma_f32_16x16x32_bf16 v[140:143], v[44:47], a[60:63], v[140:143]
v_sub_f32 v113, 0, v84
v_sub_f32 v114, 0, v88
v_sub_f32 v115, 0, v92
s_nop 7
v_max3_f32 v128, v128, v129, v130
v_max3_f32 v132, v132, v133, v134
v_max3_f32 v136, v136, v137, v138
v_max3_f32 v140, v140, v141, v142
v_max_f32 v128, v128, v131
v_max_f32 v132, v132, v135
v_max_f32 v136, v136, v139
v_max_f32 v140, v140, v143
v_mov_b32 v129, v128
v_mov_b32 v133, v132
v_mov_b32 v137, v136
v_mov_b32 v141, v140
s_nop 1
v_permlane32_swap_b32 v128, v129
v_permlane32_swap_b32 v132, v133
v_permlane32_swap_b32 v136, v137
v_permlane32_swap_b32 v140, v141
s_nop 1
v_max_f32 v128, v128, v129
v_max_f32 v132, v132, v133
v_max_f32 v136, v136, v137
v_max_f32 v140, v140, v141
v_mov_b32 v129, v128
v_mov_b32 v133, v132
v_mov_b32 v137, v136
v_mov_b32 v141, v140
s_nop 1
v_permlane16_swap_b32 v128, v129
v_permlane16_swap_b32 v132, v133
v_permlane16_swap_b32 v136, v137
v_permlane16_swap_b32 v140, v141
s_nop 1
v_max_f32 v128, v128, v129
v_max_f32 v132, v132, v133
v_max_f32 v136, v136, v137
v_max_f32 v140, v140, v141
v_sub_f32 v96, 0, v128
v_sub_f32 v97, 0, v128
v_sub_f32 v98, 0, v128
v_sub_f32 v99, 0, v128
v_sub_f32 v100, 0, v132
v_sub_f32 v101, 0, v132
v_sub_f32 v102, 0, v132
v_sub_f32 v103, 0, v132
v_sub_f32 v104, 0, v136
v_sub_f32 v105, 0, v136
v_sub_f32 v106, 0, v136
v_sub_f32 v107, 0, v136
v_sub_f32 v108, 0, v140
v_sub_f32 v109, 0, v140
v_sub_f32 v110, 0, v140
v_sub_f32 v111, 0, v140
s_cmp_lg_u32 s42, 0
s_cbranch_scc1 L_tm
L_attn:
v_mov_b32 v88, 0
v_mov_b32 v89, 0
v_mov_b32 v90, 0
v_mov_b32 v91, 0
v_mov_b32 v92, 0
v_mov_b32 v93, 0
v_mov_b32 v94, 0
v_mov_b32 v95, 0
s_mov_b32 s41, 104448
v_add_u32 v21, 104448, v18
v_add_u32 v22, 104448, v19
v_add_u32 v23, 104448, v20
s_mov_b32 s40, 0
s_waitcnt vmcnt(22)
s_barrier
ds_read_b128 a[128:131], v21 offset:0
ds_read_b128 a[132:135], v21 offset:64
ds_read_b128 a[136:139], v21 offset:128
ds_read_b128 a[140:143], v21 offset:192
ds_read_b128 a[144:147], v21 offset:4352
ds_read_b128 a[148:151], v21 offset:4416
ds_read_b128 a[152:155], v21 offset:4480
ds_read_b128 a[156:159], v21 offset:4544
s_add_u32 m0, s38, 0
s_nop 0
buffer_load_dwordx4 v24, s[16:19], s39 offen offset:0 nt lds
s_add_u32 m0, s38, 8704
s_nop 0
buffer_load_dwordx4 v25, s[20:23], s39 offen offset:0 nt lds
s_add_u32 m0, s38, 64
s_nop 0
buffer_load_dwordx4 v24, s[16:19], s39 offen offset:1024 nt lds
s_add_u32 m0, s38, 9536
s_nop 0
buffer_load_dwordx4 v25, s[20:23], s39 offen offset:256 nt lds
s_waitcnt lgkmcnt(4)
v_mfma_f32_16x16x32_bf16 v[64:67], a[128:131], a[0:3], v[96:99]
ds_read_b64_tr_b16 a[192:193], v22 offset:8704
v_mfma_f32_16x16x32_bf16 v[64:67], a[132:135], a[4:7], v[64:67]
ds_read_b64_tr_b16 a[194:195], v22 offset:13056
v_mfma_f32_16x16x32_bf16 v[64:67], a[136:139], a[8:11], v[64:67]
ds_read_b64_tr_b16 a[196:197], v23 offset:8736
v_mfma_f32_16x16x32_bf16 v[64:67], a[140:143], a[12:15], v[64:67]
s_waitcnt lgkmcnt(3)
ds_read_b64_tr_b16 a[198:199], v23 offset:13088
ds_read_b64_tr_b16 a[200:201], v22 offset:8768
v_mfma_f32_16x16x32_bf16 v[68:71], a[144:147], a[0:3], v[96:99]
ds_read_b64_tr_b16 a[202:203], v22 offset:13120
v_mfma_f32_16x16x32_bf16 v[68:71], a[148:151], a[4:7], v[68:71]
v_mfma_f32_16x16x32_bf16 v[68:71], a[152:155], a[8:11], v[68:71]
ds_read_b64_tr_b16 a[204:205], v23 offset:8800
v_mfma_f32_16x16x32_bf16 v[68:71], a[156:159], a[12:15], v[68:71]
ds_read_b64_tr_b16 a[206:207], v23 offset:13152
s_waitcnt lgkmcnt(6)
v_mfma_f32_16x16x32_bf16 v[72:75], a[128:131], a[16:19], v[100:103]
ds_read_b64_tr_b16 a[208:209], v22 offset:8832
v_exp_f32 v64, v64
v_mfma_f32_16x16x32_bf16 v[72:75], a[132:135], a[20:23], v[72:75]
ds_read_b64_tr_b16 a[210:211], v22 offset:13184
v_exp_f32 v65, v65
v_mfma_f32_16x16x32_bf16 v[72:75], a[136:139], a[24:27], v[72:75]
ds_read_b64_tr_b16 a[212:213], v23 offset:8864
v_cvt_pk_bf16_f32 v80, v64, v65
v_mfma_f32_16x16x32_bf16 v[72:75], a[140:143], a[28:31], v[72:75]
v_exp_f32 v66, v66
ds_read_b64_tr_b16 a[214:215], v23 offset:13216
v_add_f32 v88, v88, v64
v_add_f32 v89, v89, v65
v_exp_f32 v67, v67
ds_read_b64_tr_b16 a[216:217], v22 offset:8896
v_cvt_pk_bf16_f32 v81, v66, v67
v_exp_f32 v68, v68
v_mfma_f32_16x16x32_bf16 v[76:79], a[144:147], a[16:19], v[100:103]
ds_read_b64_tr_b16 a[218:219], v22 offset:13248
v_add_f32 v88, v88, v66
v_add_f32 v89, v89, v67
v_mfma_f32_16x16x32_bf16 v[76:79], a[148:151], a[20:23], v[76:79]
v_exp_f32 v69, v69
v_mfma_f32_16x16x32_bf16 v[76:79], a[152:155], a[24:27], v[76:79]
ds_read_b64_tr_b16 a[220:221], v23 offset:8928
v_cvt_pk_bf16_f32 v82, v68, v69
v_mfma_f32_16x16x32_bf16 v[76:79], a[156:159], a[28:31], v[76:79]
v_exp_f32 v70, v70
v_add_f32 v88, v88, v68
v_add_f32 v89, v89, v69
v_exp_f32 v71, v71
ds_read_b64_tr_b16 a[222:223], v23 offset:13280
v_cvt_pk_bf16_f32 v83, v70, v71
s_waitcnt lgkmcnt(6)
s_add_u32 s101, s101, 8192
s_add_u32 s100, s100, s92
s_and_b32 s39, s100, 0xf800
s_and_b32 s93, s101, 0x40000
s_or_b32 s39, s39, s93
s_add_u32 s38, s38, 17408
s_cmp_eq_u32 s38, s71
s_cselect_b32 s38, s70, s38
v_add_f32 v88, v88, v70
v_add_f32 v89, v89, v71
s_waitcnt vmcnt(22)
s_barrier
v_mfma_f32_16x16x32_bf16 v[64:67], a[128:131], a[32:35], v[104:107]
ds_read_b128 a[160:163], v21 offset:17408
v_exp_f32 v72, v72
v_mfma_f32_16x16x32_bf16 v[64:67], a[132:135], a[36:39], v[64:67]
ds_read_b128 a[164:167], v21 offset:17472
v_exp_f32 v73, v73
v_mfma_f32_16x16x32_bf16 v[64:67], a[136:139], a[40:43], v[64:67]
ds_read_b128 a[168:171], v21 offset:17536
v_cvt_pk_bf16_f32 v84, v72, v73
v_mfma_f32_16x16x32_bf16 v[64:67], a[140:143], a[44:47], v[64:67]
v_exp_f32 v74, v74
v_mfma_f32_16x16x32_bf16 v[128:131], a[192:195], v[80:83], 0
s_add_u32 m0, s38, 0
v_add_f32 v90, v90, v72
v_add_f32 v91, v91, v73
v_mfma_f32_16x16x32_bf16 v[132:135], a[196:199], v[80:83], 0
buffer_load_dwordx4 v24, s[16:19], s39 offen offset:0 nt lds
v_exp_f32 v75, v75
v_mfma_f32_16x16x32_bf16 v[136:139], a[200:203], v[80:83], 0
ds_read_b128 a[172:175], v21 offset:17600
v_cvt_pk_bf16_f32 v85, v74, v75
v_mfma_f32_16x16x32_bf16 v[140:143], a[204:207], v[80:83], 0
v_exp_f32 v76, v76
v_mfma_f32_16x16x32_bf16 v[68:71], a[144:147], a[32:35], v[104:107]
v_add_f32 v90, v90, v74
v_add_f32 v91, v91, v75
v_mfma_f32_16x16x32_bf16 v[68:71], a[148:151], a[36:39], v[68:71]
v_exp_f32 v77, v77
v_mfma_f32_16x16x32_bf16 v[68:71], a[152:155], a[40:43], v[68:71]
ds_read_b128 a[176:179], v21 offset:21760
v_cvt_pk_bf16_f32 v86, v76, v77
v_mfma_f32_16x16x32_bf16 v[68:71], a[156:159], a[44:47], v[68:71]
s_waitcnt lgkmcnt(5)
v_exp_f32 v78, v78
v_mfma_f32_16x16x32_bf16 v[144:147], a[208:211], v[80:83], 0
v_add_f32 v90, v90, v76
v_add_f32 v91, v91, v77
v_mfma_f32_16x16x32_bf16 v[148:151], a[212:215], v[80:83], 0
v_exp_f32 v79, v79
v_mfma_f32_16x16x32_bf16 v[152:155], a[216:219], v[80:83], 0
ds_read_b128 a[180:183], v21 offset:21824
v_cvt_pk_bf16_f32 v87, v78, v79
v_mfma_f32_16x16x32_bf16 v[156:159], a[220:223], v[80:83], 0
v_add_f32 v90, v90, v78
v_add_f32 v91, v91, v79
v_mfma_f32_16x16x32_bf16 v[72:75], a[128:131], a[48:51], v[108:111]
ds_read_b128 a[184:187], v21 offset:21888
v_exp_f32 v64, v64
v_mfma_f32_16x16x32_bf16 v[72:75], a[132:135], a[52:55], v[72:75]
ds_read_b128 a[188:191], v21 offset:21952
v_exp_f32 v65, v65
v_mfma_f32_16x16x32_bf16 v[72:75], a[136:139], a[56:59], v[72:75]
ds_read_b64_tr_b16 a[224:225], v22 offset:26112
v_cvt_pk_bf16_f32 v80, v64, v65
v_mfma_f32_16x16x32_bf16 v[72:75], a[140:143], a[60:63], v[72:75]
v_exp_f32 v66, v66
v_mfma_f32_16x16x32_bf16 v[160:163], a[192:195], v[84:87], 0
s_add_u32 m0, s38, 8704
v_add_f32 v92, v92, v64
v_add_f32 v93, v93, v65
v_mfma_f32_16x16x32_bf16 v[164:167], a[196:199], v[84:87], 0
buffer_load_dwordx4 v25, s[20:23], s39 offen offset:0 nt lds
v_exp_f32 v67, v67
v_mfma_f32_16x16x32_bf16 v[168:171], a[200:203], v[84:87], 0
ds_read_b64_tr_b16 a[226:227], v22 offset:30464
v_cvt_pk_bf16_f32 v81, v66, v67
v_mfma_f32_16x16x32_bf16 v[172:175], a[204:207], v[84:87], 0
v_exp_f32 v68, v68
v_mfma_f32_16x16x32_bf16 v[76:79], a[144:147], a[48:51], v[108:111]
v_add_f32 v92, v92, v66
v_add_f32 v93, v93, v67
v_mfma_f32_16x16x32_bf16 v[76:79], a[148:151], a[52:55], v[76:79]
v_exp_f32 v69, v69
v_mfma_f32_16x16x32_bf16 v[76:79], a[152:155], a[56:59], v[76:79]
ds_read_b64_tr_b16 a[228:229], v23 offset:26144
v_cvt_pk_bf16_f32 v82, v68, v69
v_mfma_f32_16x16x32_bf16 v[76:79], a[156:159], a[60:63], v[76:79]
v_exp_f32 v70, v70
v_mfma_f32_16x16x32_bf16 v[176:179], a[208:211], v[84:87], 0
v_add_f32 v92, v92, v68
v_add_f32 v93, v93, v69
v_mfma_f32_16x16x32_bf16 v[180:183], a[212:215], v[84:87], 0
v_exp_f32 v71, v71
v_mfma_f32_16x16x32_bf16 v[184:187], a[216:219], v[84:87], 0
ds_read_b64_tr_b16 a[230:231], v23 offset:30496
v_cvt_pk_bf16_f32 v83, v70, v71
v_mfma_f32_16x16x32_bf16 v[188:191], a[220:223], v[84:87], 0
s_waitcnt lgkmcnt(6)
v_add_f32 v92, v92, v70
v_add_f32 v93, v93, v71
v_mfma_f32_16x16x32_bf16 v[64:67], a[160:163], a[0:3], v[96:99]
ds_read_b64_tr_b16 a[232:233], v22 offset:26176
v_exp_f32 v72, v72
v_mfma_f32_16x16x32_bf16 v[64:67], a[164:167], a[4:7], v[64:67]
ds_read_b64_tr_b16 a[234:235], v22 offset:30528
v_exp_f32 v73, v73
v_mfma_f32_16x16x32_bf16 v[64:67], a[168:171], a[8:11], v[64:67]
ds_read_b64_tr_b16 a[236:237], v23 offset:26208
v_cvt_pk_bf16_f32 v84, v72, v73
v_mfma_f32_16x16x32_bf16 v[64:67], a[172:175], a[12:15], v[64:67]
v_exp_f32 v74, v74
v_mfma_f32_16x16x32_bf16 v[192:195], a[192:195], v[80:83], 0
s_add_u32 m0, s38, 64
v_add_f32 v94, v94, v72
v_add_f32 v95, v95, v73
v_mfma_f32_16x16x32_bf16 v[196:199], a[196:199], v[80:83], 0
buffer_load_dwordx4 v24, s[16:19], s39 offen offset:1024 nt lds
v_exp_f32 v75, v75
v_mfma_f32_16x16x32_bf16 v[200:203], a[200:203], v[80:83], 0
ds_read_b64_tr_b16 a[238:239], v23 offset:30560
v_cvt_pk_bf16_f32 v85, v74, v75
v_mfma_f32_16x16x32_bf16 v[204:207], a[204:207], v[80:83], 0
s_waitcnt lgkmcnt(8)
v_exp_f32 v76, v76
v_mfma_f32_16x16x32_bf16 v[68:71], a[176:179], a[0:3], v[96:99]
v_add_f32 v94, v94, v74
v_add_f32 v95, v95, v75
v_mfma_f32_16x16x32_bf16 v[68:71], a[180:183], a[4:7], v[68:71]
v_exp_f32 v77, v77
v_mfma_f32_16x16x32_bf16 v[68:71], a[184:187], a[8:11], v[68:71]
ds_read_b64_tr_b16 a[240:241], v22 offset:26240
v_cvt_pk_bf16_f32 v86, v76, v77
v_mfma_f32_16x16x32_bf16 v[68:71], a[188:191], a[12:15], v[68:71]
v_exp_f32 v78, v78
v_mfma_f32_16x16x32_bf16 v[208:211], a[208:211], v[80:83], 0
v_add_f32 v94, v94, v76
v_add_f32 v95, v95, v77
v_mfma_f32_16x16x32_bf16 v[212:215], a[212:215], v[80:83], 0
v_exp_f32 v79, v79
v_mfma_f32_16x16x32_bf16 v[216:219], a[216:219], v[80:83], 0
ds_read_b64_tr_b16 a[242:243], v22 offset:30592
v_cvt_pk_bf16_f32 v87, v78, v79
v_mfma_f32_16x16x32_bf16 v[220:223], a[220:223], v[80:83], 0
s_waitcnt lgkmcnt(6)
v_add_f32 v94, v94, v78
v_add_f32 v95, v95, v79
v_mfma_f32_16x16x32_bf16 v[72:75], a[160:163], a[16:19], v[100:103]
ds_read_b64_tr_b16 a[244:245], v23 offset:26272
v_exp_f32 v64, v64
v_mfma_f32_16x16x32_bf16 v[72:75], a[164:167], a[20:23], v[72:75]
ds_read_b64_tr_b16 a[246:247], v23 offset:30624
v_exp_f32 v65, v65
v_mfma_f32_16x16x32_bf16 v[72:75], a[168:171], a[24:27], v[72:75]
ds_read_b64_tr_b16 a[248:249], v22 offset:26304
v_cvt_pk_bf16_f32 v80, v64, v65
v_mfma_f32_16x16x32_bf16 v[72:75], a[172:175], a[28:31], v[72:75]
s_add_u32 s41, s41, 34816
v_exp_f32 v66, v66
v_mfma_f32_16x16x32_bf16 v[224:227], a[192:195], v[84:87], 0
s_add_u32 m0, s38, 9536
v_add_f32 v88, v88, v64
v_add_f32 v89, v89, v65
v_mfma_f32_16x16x32_bf16 v[228:231], a[196:199], v[84:87], 0
s_cmp_eq_u32 s41, 139264
buffer_load_dwordx4 v25, s[20:23], s39 offen offset:256 nt lds
v_exp_f32 v67, v67
v_mfma_f32_16x16x32_bf16 v[232:235], a[200:203], v[84:87], 0
ds_read_b64_tr_b16 a[250:251], v22 offset:30656
v_cvt_pk_bf16_f32 v81, v66, v67
v_mfma_f32_16x16x32_bf16 v[236:239], a[204:207], v[84:87], 0
s_cselect_b32 s41, 0, s41
v_exp_f32 v68, v68
v_mfma_f32_16x16x32_bf16 v[76:79], a[176:179], a[16:19], v[100:103]
v_add_f32 v88, v88, v66
v_add_f32 v89, v89, v67
v_mfma_f32_16x16x32_bf16 v[76:79], a[180:183], a[20:23], v[76:79]
v_exp_f32 v69, v69
v_mfma_f32_16x16x32_bf16 v[76:79], a[184:187], a[24:27], v[76:79]
ds_read_b64_tr_b16 a[252:253], v23 offset:26336
v_cvt_pk_bf16_f32 v82, v68, v69
v_mfma_f32_16x16x32_bf16 v[76:79], a[188:191], a[28:31], v[76:79]
v_exp_f32 v70, v70
v_mfma_f32_16x16x32_bf16 v[240:243], a[208:211], v[84:87], 0
v_add_f32 v88, v88, v68
v_add_f32 v89, v89, v69
v_mfma_f32_16x16x32_bf16 v[244:247], a[212:215], v[84:87], 0
v_exp_f32 v71, v71
v_mfma_f32_16x16x32_bf16 v[248:251], a[216:219], v[84:87], 0
ds_read_b64_tr_b16 a[254:255], v23 offset:30688
v_cvt_pk_bf16_f32 v83, v70, v71
v_mfma_f32_16x16x32_bf16 v[252:255], a[220:223], v[84:87], 0
s_waitcnt lgkmcnt(6)
v_add_u32 v21, s41, v18
v_add_u32 v22, s41, v19
v_add_u32 v23, s41, v20
s_add_u32 s101, s101, 8192
s_add_u32 s100, s100, s92
s_and_b32 s39, s100, 0xf800
s_and_b32 s93, s101, 0x40000
s_or_b32 s39, s39, s93
s_add_u32 s38, s38, 17408
s_cmp_eq_u32 s38, s71
s_cselect_b32 s38, s70, s38
v_add_f32 v88, v88, v70
v_add_f32 v89, v89, v71
s_waitcnt vmcnt(21)
s_barrier
v_mfma_f32_16x16x32_bf16 v[64:67], a[160:163], a[32:35], v[104:107]
ds_read_b128 a[128:131], v21 offset:0
v_exp_f32 v72, v72
v_mfma_f32_16x16x32_bf16 v[64:67], a[164:167], a[36:39], v[64:67]
ds_read_b128 a[132:135], v21 offset:64
v_exp_f32 v73, v73
v_mfma_f32_16x16x32_bf16 v[64:67], a[168:171], a[40:43], v[64:67]
ds_read_b128 a[136:139], v21 offset:128
v_cvt_pk_bf16_f32 v84, v72, v73
v_mfma_f32_16x16x32_bf16 v[64:67], a[172:175], a[44:47], v[64:67]
v_exp_f32 v74, v74
v_mfma_f32_16x16x32_bf16 v[128:131], a[224:227], v[80:83], v[128:131]
s_add_u32 m0, s38, 0
v_add_f32 v90, v90, v72
v_add_f32 v91, v91, v73
v_mfma_f32_16x16x32_bf16 v[132:135], a[228:231], v[80:83], v[132:135]
buffer_load_dwordx4 v24, s[16:19], s39 offen offset:0 nt lds
v_exp_f32 v75, v75
v_mfma_f32_16x16x32_bf16 v[136:139], a[232:235], v[80:83], v[136:139]
ds_read_b128 a[140:143], v21 offset:192
v_cvt_pk_bf16_f32 v85, v74, v75
v_mfma_f32_16x16x32_bf16 v[140:143], a[236:239], v[80:83], v[140:143]
v_exp_f32 v76, v76
v_mfma_f32_16x16x32_bf16 v[68:71], a[176:179], a[32:35], v[104:107]
v_add_f32 v90, v90, v74
v_add_f32 v91, v91, v75
v_mfma_f32_16x16x32_bf16 v[68:71], a[180:183], a[36:39], v[68:71]
v_exp_f32 v77, v77
v_mfma_f32_16x16x32_bf16 v[68:71], a[184:187], a[40:43], v[68:71]
ds_read_b128 a[144:147], v21 offset:4352
v_cvt_pk_bf16_f32 v86, v76, v77
v_mfma_f32_16x16x32_bf16 v[68:71], a[188:191], a[44:47], v[68:71]
s_waitcnt lgkmcnt(5)
v_exp_f32 v78, v78
v_mfma_f32_16x16x32_bf16 v[144:147], a[240:243], v[80:83], v[144:147]
v_add_f32 v90, v90, v76
v_add_f32 v91, v91, v77
v_mfma_f32_16x16x32_bf16 v[148:151], a[244:247], v[80:83], v[148:151]
v_exp_f32 v79, v79
v_mfma_f32_16x16x32_bf16 v[152:155], a[248:251], v[80:83], v[152:155]
ds_read_b128 a[148:151], v21 offset:4416
v_cvt_pk_bf16_f32 v87, v78, v79
v_mfma_f32_16x16x32_bf16 v[156:159], a[252:255], v[80:83], v[156:159]
v_add_f32 v90, v90, v78
v_add_f32 v91, v91, v79
v_mfma_f32_16x16x32_bf16 v[72:75], a[160:163], a[48:51], v[108:111]
ds_read_b128 a[152:155], v21 offset:4480
v_exp_f32 v64, v64
v_mfma_f32_16x16x32_bf16 v[72:75], a[164:167], a[52:55], v[72:75]
ds_read_b128 a[156:159], v21 offset:4544
v_exp_f32 v65, v65
v_mfma_f32_16x16x32_bf16 v[72:75], a[168:171], a[56:59], v[72:75]
ds_read_b64_tr_b16 a[192:193], v22 offset:8704
v_cvt_pk_bf16_f32 v80, v64, v65
v_mfma_f32_16x16x32_bf16 v[72:75], a[172:175], a[60:63], v[72:75]
v_exp_f32 v66, v66
v_mfma_f32_16x16x32_bf16 v[160:163], a[224:227], v[84:87], v[160:163]
s_add_u32 m0, s38, 8704
v_add_f32 v92, v92, v64
v_add_f32 v93, v93, v65
v_mfma_f32_16x16x32_bf16 v[164:167], a[228:231], v[84:87], v[164:167]
buffer_load_dwordx4 v25, s[20:23], s39 offen offset:0 nt lds
v_exp_f32 v67, v67
v_mfma_f32_16x16x32_bf16 v[168:171], a[232:235], v[84:87], v[168:171]
ds_read_b64_tr_b16 a[194:195], v22 offset:13056
v_cvt_pk_bf16_f32 v81, v66, v67
v_mfma_f32_16x16x32_bf16 v[172:175], a[236:239], v[84:87], v[172:175]
v_exp_f32 v68, v68
v_mfma_f32_16x16x32_bf16 v[76:79], a[176:179], a[48:51], v[108:111]
v_add_f32 v92, v92, v66
v_add_f32 v93, v93, v67
v_mfma_f32_16x16x32_bf16 v[76:79], a[180:183], a[52:55], v[76:79]
v_exp_f32 v69, v69
v_mfma_f32_16x16x32_bf16 v[76:79], a[184:187], a[56:59], v[76:79]
ds_read_b64_tr_b16 a[196:197], v23 offset:8736
v_cvt_pk_bf16_f32 v82, v68, v69
v_mfma_f32_16x16x32_bf16 v[76:79], a[188:191], a[60:63], v[76:79]
v_exp_f32 v70, v70
v_mfma_f32_16x16x32_bf16 v[176:179], a[240:243], v[84:87], v[176:179]
v_add_f32 v92, v92, v68
v_add_f32 v93, v93, v69
v_mfma_f32_16x16x32_bf16 v[180:183], a[244:247], v[84:87], v[180:183]
v_exp_f32 v71, v71
v_mfma_f32_16x16x32_bf16 v[184:187], a[248:251], v[84:87], v[184:187]
ds_read_b64_tr_b16 a[198:199], v23 offset:13088
v_cvt_pk_bf16_f32 v83, v70, v71
v_mfma_f32_16x16x32_bf16 v[188:191], a[252:255], v[84:87], v[188:191]
s_waitcnt lgkmcnt(6)
v_add_f32 v92, v92, v70
v_add_f32 v93, v93, v71
v_mfma_f32_16x16x32_bf16 v[64:67], a[128:131], a[0:3], v[96:99]
ds_read_b64_tr_b16 a[200:201], v22 offset:8768
v_exp_f32 v72, v72
v_mfma_f32_16x16x32_bf16 v[64:67], a[132:135], a[4:7], v[64:67]
ds_read_b64_tr_b16 a[202:203], v22 offset:13120
v_exp_f32 v73, v73
v_mfma_f32_16x16x32_bf16 v[64:67], a[136:139], a[8:11], v[64:67]
ds_read_b64_tr_b16 a[204:205], v23 offset:8800
v_cvt_pk_bf16_f32 v84, v72, v73
v_mfma_f32_16x16x32_bf16 v[64:67], a[140:143], a[12:15], v[64:67]
v_exp_f32 v74, v74
v_mfma_f32_16x16x32_bf16 v[192:195], a[224:227], v[80:83], v[192:195]
s_add_u32 m0, s38, 64
v_add_f32 v94, v94, v72
v_add_f32 v95, v95, v73
v_mfma_f32_16x16x32_bf16 v[196:199], a[228:231], v[80:83], v[196:199]
buffer_load_dwordx4 v24, s[16:19], s39 offen offset:1024 nt lds
v_exp_f32 v75, v75
v_mfma_f32_16x16x32_bf16 v[200:203], a[232:235], v[80:83], v[200:203]
ds_read_b64_tr_b16 a[206:207], v23 offset:13152
v_cvt_pk_bf16_f32 v85, v74, v75
v_mfma_f32_16x16x32_bf16 v[204:207], a[236:239], v[80:83], v[204:207]
s_waitcnt lgkmcnt(8)
v_exp_f32 v76, v76
v_mfma_f32_16x16x32_bf16 v[68:71], a[144:147], a[0:3], v[96:99]
v_add_f32 v94, v94, v74
v_add_f32 v95, v95, v75
v_mfma_f32_16x16x32_bf16 v[68:71], a[148:151], a[4:7], v[68:71]
v_exp_f32 v77, v77
v_mfma_f32_16x16x32_bf16 v[68:71], a[152:155], a[8:11], v[68:71]
ds_read_b64_tr_b16 a[208:209], v22 offset:8832
v_cvt_pk_bf16_f32 v86, v76, v77
v_mfma_f32_16x16x32_bf16 v[68:71], a[156:159], a[12:15], v[68:71]
v_exp_f32 v78, v78
v_mfma_f32_16x16x32_bf16 v[208:211], a[240:243], v[80:83], v[208:211]
v_add_f32 v94, v94, v76
v_add_f32 v95, v95, v77
v_mfma_f32_16x16x32_bf16 v[212:215], a[244:247], v[80:83], v[212:215]
v_exp_f32 v79, v79
v_mfma_f32_16x16x32_bf16 v[216:219], a[248:251], v[80:83], v[216:219]
ds_read_b64_tr_b16 a[210:211], v22 offset:13184
v_cvt_pk_bf16_f32 v87, v78, v79
v_mfma_f32_16x16x32_bf16 v[220:223], a[252:255], v[80:83], v[220:223]
s_waitcnt lgkmcnt(6)
v_add_f32 v94, v94, v78
v_add_f32 v95, v95, v79
v_mfma_f32_16x16x32_bf16 v[72:75], a[128:131], a[16:19], v[100:103]
ds_read_b64_tr_b16 a[212:213], v23 offset:8864
v_exp_f32 v64, v64
v_mfma_f32_16x16x32_bf16 v[72:75], a[132:135], a[20:23], v[72:75]
ds_read_b64_tr_b16 a[214:215], v23 offset:13216
v_exp_f32 v65, v65
v_mfma_f32_16x16x32_bf16 v[72:75], a[136:139], a[24:27], v[72:75]
ds_read_b64_tr_b16 a[216:217], v22 offset:8896
v_cvt_pk_bf16_f32 v80, v64, v65
v_mfma_f32_16x16x32_bf16 v[72:75], a[140:143], a[28:31], v[72:75]
v_exp_f32 v66, v66
v_mfma_f32_16x16x32_bf16 v[224:227], a[224:227], v[84:87], v[224:227]
s_add_u32 m0, s38, 9536
v_add_f32 v88, v88, v64
v_add_f32 v89, v89, v65
v_mfma_f32_16x16x32_bf16 v[228:231], a[228:231], v[84:87], v[228:231]
buffer_load_dwordx4 v25, s[20:23], s39 offen offset:256 nt lds
v_exp_f32 v67, v67
v_mfma_f32_16x16x32_bf16 v[232:235], a[232:235], v[84:87], v[232:235]
ds_read_b64_tr_b16 a[218:219], v22 offset:13248
v_cvt_pk_bf16_f32 v81, v66, v67
v_mfma_f32_16x16x32_bf16 v[236:239], a[236:239], v[84:87], v[236:239]
v_exp_f32 v68, v68
v_mfma_f32_16x16x32_bf16 v[76:79], a[144:147], a[16:19], v[100:103]
v_add_f32 v88, v88, v66
v_add_f32 v89, v89, v67
v_mfma_f32_16x16x32_bf16 v[76:79], a[148:151], a[20:23], v[76:79]
v_exp_f32 v69, v69
v_mfma_f32_16x16x32_bf16 v[76:79], a[152:155], a[24:27], v[76:79]
ds_read_b64_tr_b16 a[220:221], v23 offset:8928
v_cvt_pk_bf16_f32 v82, v68, v69
v_mfma_f32_16x16x32_bf16 v[76:79], a[156:159], a[28:31], v[76:79]
v_exp_f32 v70, v70
v_mfma_f32_16x16x32_bf16 v[240:243], a[240:243], v[84:87], v[240:243]
v_add_f32 v88, v88, v68
v_add_f32 v89, v89, v69
v_mfma_f32_16x16x32_bf16 v[244:247], a[244:247], v[84:87], v[244:247]
v_exp_f32 v71, v71
v_mfma_f32_16x16x32_bf16 v[248:251], a[248:251], v[84:87], v[248:251]
ds_read_b64_tr_b16 a[222:223], v23 offset:13280
v_cvt_pk_bf16_f32 v83, v70, v71
v_mfma_f32_16x16x32_bf16 v[252:255], a[252:255], v[84:87], v[252:255]
s_waitcnt lgkmcnt(6)
s_add_u32 s101, s101, 8192
s_add_u32 s100, s100, s92
s_and_b32 s39, s100, 0xf800
s_and_b32 s93, s101, 0x40000
s_or_b32 s39, s39, s93
s_add_u32 s38, s38, 17408
s_cmp_eq_u32 s38, s71
s_cselect_b32 s38, s70, s38
v_add_f32 v88, v88, v70
v_add_f32 v89, v89, v71
s_waitcnt vmcnt(21)
s_barrier
v_mfma_f32_16x16x32_bf16 v[64:67], a[128:131], a[32:35], v[104:107]
ds_read_b128 a[160:163], v21 offset:17408
v_exp_f32 v72, v72
v_mfma_f32_16x16x32_bf16 v[64:67], a[132:135], a[36:39], v[64:67]
ds_read_b128 a[164:167], v21 offset:17472
v_exp_f32 v73, v73
v_mfma_f32_16x16x32_bf16 v[64:67], a[136:139], a[40:43], v[64:67]
ds_read_b128 a[168:171], v21 offset:17536
v_cvt_pk_bf16_f32 v84, v72, v73
v_mfma_f32_16x16x32_bf16 v[64:67], a[140:143], a[44:47], v[64:67]
v_exp_f32 v74, v74
v_mfma_f32_16x16x32_bf16 v[128:131], a[192:195], v[80:83], v[128:131]
s_add_u32 m0, s38, 0
v_add_f32 v90, v90, v72
v_add_f32 v91, v91, v73
v_mfma_f32_16x16x32_bf16 v[132:135], a[196:199], v[80:83], v[132:135]
buffer_load_dwordx4 v24, s[16:19], s39 offen offset:0 nt lds
v_exp_f32 v75, v75
v_mfma_f32_16x16x32_bf16 v[136:139], a[200:203], v[80:83], v[136:139]
ds_read_b128 a[172:175], v21 offset:17600
v_cvt_pk_bf16_f32 v85, v74, v75
v_mfma_f32_16x16x32_bf16 v[140:143], a[204:207], v[80:83], v[140:143]
v_exp_f32 v76, v76
v_mfma_f32_16x16x32_bf16 v[68:71], a[144:147], a[32:35], v[104:107]
v_add_f32 v90, v90, v74
v_add_f32 v91, v91, v75
v_mfma_f32_16x16x32_bf16 v[68:71], a[148:151], a[36:39], v[68:71]
v_exp_f32 v77, v77
v_mfma_f32_16x16x32_bf16 v[68:71], a[152:155], a[40:43], v[68:71]
ds_read_b128 a[176:179], v21 offset:21760
v_cvt_pk_bf16_f32 v86, v76, v77
v_mfma_f32_16x16x32_bf16 v[68:71], a[156:159], a[44:47], v[68:71]
s_waitcnt lgkmcnt(5)
v_exp_f32 v78, v78
v_mfma_f32_16x16x32_bf16 v[144:147], a[208:211], v[80:83], v[144:147]
v_add_f32 v90, v90, v76
v_add_f32 v91, v91, v77
v_mfma_f32_16x16x32_bf16 v[148:151], a[212:215], v[80:83], v[148:151]
v_exp_f32 v79, v79
v_mfma_f32_16x16x32_bf16 v[152:155], a[216:219], v[80:83], v[152:155]
ds_read_b128 a[180:183], v21 offset:21824
v_cvt_pk_bf16_f32 v87, v78, v79
v_mfma_f32_16x16x32_bf16 v[156:159], a[220:223], v[80:83], v[156:159]
v_add_f32 v90, v90, v78
v_add_f32 v91, v91, v79
v_mfma_f32_16x16x32_bf16 v[72:75], a[128:131], a[48:51], v[108:111]
ds_read_b128 a[184:187], v21 offset:21888
v_exp_f32 v64, v64
v_mfma_f32_16x16x32_bf16 v[72:75], a[132:135], a[52:55], v[72:75]
ds_read_b128 a[188:191], v21 offset:21952
v_exp_f32 v65, v65
v_mfma_f32_16x16x32_bf16 v[72:75], a[136:139], a[56:59], v[72:75]
ds_read_b64_tr_b16 a[224:225], v22 offset:26112
v_cvt_pk_bf16_f32 v80, v64, v65
v_mfma_f32_16x16x32_bf16 v[72:75], a[140:143], a[60:63], v[72:75]
v_exp_f32 v66, v66
v_mfma_f32_16x16x32_bf16 v[160:163], a[192:195], v[84:87], v[160:163]
s_add_u32 m0, s38, 8704
v_add_f32 v92, v92, v64
v_add_f32 v93, v93, v65
v_mfma_f32_16x16x32_bf16 v[164:167], a[196:199], v[84:87], v[164:167]
buffer_load_dwordx4 v25, s[20:23], s39 offen offset:0 nt lds
v_exp_f32 v67, v67
v_mfma_f32_16x16x32_bf16 v[168:171], a[200:203], v[84:87], v[168:171]
ds_read_b64_tr_b16 a[226:227], v22 offset:30464
v_cvt_pk_bf16_f32 v81, v66, v67
v_mfma_f32_16x16x32_bf16 v[172:175], a[204:207], v[84:87], v[172:175]
v_exp_f32 v68, v68
v_mfma_f32_16x16x32_bf16 v[76:79], a[144:147], a[48:51], v[108:111]
v_add_f32 v92, v92, v66
v_add_f32 v93, v93, v67
v_mfma_f32_16x16x32_bf16 v[76:79], a[148:151], a[52:55], v[76:79]
v_exp_f32 v69, v69
v_mfma_f32_16x16x32_bf16 v[76:79], a[152:155], a[56:59], v[76:79]
ds_read_b64_tr_b16 a[228:229], v23 offset:26144
v_cvt_pk_bf16_f32 v82, v68, v69
v_mfma_f32_16x16x32_bf16 v[76:79], a[156:159], a[60:63], v[76:79]
v_exp_f32 v70, v70
v_mfma_f32_16x16x32_bf16 v[176:179], a[208:211], v[84:87], v[176:179]
v_add_f32 v92, v92, v68
v_add_f32 v93, v93, v69
v_mfma_f32_16x16x32_bf16 v[180:183], a[212:215], v[84:87], v[180:183]
v_exp_f32 v71, v71
v_mfma_f32_16x16x32_bf16 v[184:187], a[216:219], v[84:87], v[184:187]
ds_read_b64_tr_b16 a[230:231], v23 offset:30496
v_cvt_pk_bf16_f32 v83, v70, v71
v_mfma_f32_16x16x32_bf16 v[188:191], a[220:223], v[84:87], v[188:191]
s_waitcnt lgkmcnt(6)
v_add_f32 v92, v92, v70
v_add_f32 v93, v93, v71
v_mfma_f32_16x16x32_bf16 v[64:67], a[160:163], a[0:3], v[96:99]
ds_read_b64_tr_b16 a[232:233], v22 offset:26176
v_exp_f32 v72, v72
v_mfma_f32_16x16x32_bf16 v[64:67], a[164:167], a[4:7], v[64:67]
ds_read_b64_tr_b16 a[234:235], v22 offset:30528
v_exp_f32 v73, v73
v_mfma_f32_16x16x32_bf16 v[64:67], a[168:171], a[8:11], v[64:67]
ds_read_b64_tr_b16 a[236:237], v23 offset:26208
v_cvt_pk_bf16_f32 v84, v72, v73
v_mfma_f32_16x16x32_bf16 v[64:67], a[172:175], a[12:15], v[64:67]
v_exp_f32 v74, v74
v_mfma_f32_16x16x32_bf16 v[192:195], a[192:195], v[80:83], v[192:195]
s_add_u32 m0, s38, 64
v_add_f32 v94, v94, v72
v_add_f32 v95, v95, v73
v_mfma_f32_16x16x32_bf16 v[196:199], a[196:199], v[80:83], v[196:199]
buffer_load_dwordx4 v24, s[16:19], s39 offen offset:1024 nt lds
v_exp_f32 v75, v75
v_mfma_f32_16x16x32_bf16 v[200:203], a[200:203], v[80:83], v[200:203]
ds_read_b64_tr_b16 a[238:239], v23 offset:30560
v_cvt_pk_bf16_f32 v85, v74, v75
v_mfma_f32_16x16x32_bf16 v[204:207], a[204:207], v[80:83], v[204:207]
s_waitcnt lgkmcnt(8)
v_exp_f32 v76, v76
v_mfma_f32_16x16x32_bf16 v[68:71], a[176:179], a[0:3], v[96:99]
v_add_f32 v94, v94, v74
v_add_f32 v95, v95, v75
v_mfma_f32_16x16x32_bf16 v[68:71], a[180:183], a[4:7], v[68:71]
v_exp_f32 v77, v77
v_mfma_f32_16x16x32_bf16 v[68:71], a[184:187], a[8:11], v[68:71]
ds_read_b64_tr_b16 a[240:241], v22 offset:26240
v_cvt_pk_bf16_f32 v86, v76, v77
v_mfma_f32_16x16x32_bf16 v[68:71], a[188:191], a[12:15], v[68:71]
v_exp_f32 v78, v78
v_mfma_f32_16x16x32_bf16 v[208:211], a[208:211], v[80:83], v[208:211]
v_add_f32 v94, v94, v76
v_add_f32 v95, v95, v77
v_mfma_f32_16x16x32_bf16 v[212:215], a[212:215], v[80:83], v[212:215]
v_exp_f32 v79, v79
v_mfma_f32_16x16x32_bf16 v[216:219], a[216:219], v[80:83], v[216:219]
ds_read_b64_tr_b16 a[242:243], v22 offset:30592
v_cvt_pk_bf16_f32 v87, v78, v79
v_mfma_f32_16x16x32_bf16 v[220:223], a[220:223], v[80:83], v[220:223]
s_waitcnt lgkmcnt(6)
v_add_f32 v94, v94, v78
v_add_f32 v95, v95, v79
v_mfma_f32_16x16x32_bf16 v[72:75], a[160:163], a[16:19], v[100:103]
ds_read_b64_tr_b16 a[244:245], v23 offset:26272
v_exp_f32 v64, v64
v_mfma_f32_16x16x32_bf16 v[72:75], a[164:167], a[20:23], v[72:75]
ds_read_b64_tr_b16 a[246:247], v23 offset:30624
v_exp_f32 v65, v65
v_mfma_f32_16x16x32_bf16 v[72:75], a[168:171], a[24:27], v[72:75]
ds_read_b64_tr_b16 a[248:249], v22 offset:26304
v_cvt_pk_bf16_f32 v80, v64, v65
v_mfma_f32_16x16x32_bf16 v[72:75], a[172:175], a[28:31], v[72:75]
s_add_u32 s41, s41, 34816
v_exp_f32 v66, v66
v_mfma_f32_16x16x32_bf16 v[224:227], a[192:195], v[84:87], v[224:227]
s_add_u32 m0, s38, 9536
v_add_f32 v88, v88, v64
v_add_f32 v89, v89, v65
v_mfma_f32_16x16x32_bf16 v[228:231], a[196:199], v[84:87], v[228:231]
s_cmp_eq_u32 s41, 139264
buffer_load_dwordx4 v25, s[20:23], s39 offen offset:256 nt lds
v_exp_f32 v67, v67
v_mfma_f32_16x16x32_bf16 v[232:235], a[200:203], v[84:87], v[232:235]
ds_read_b64_tr_b16 a[250:251], v22 offset:30656
v_cvt_pk_bf16_f32 v81, v66, v67
v_mfma_f32_16x16x32_bf16 v[236:239], a[204:207], v[84:87], v[236:239]
s_cselect_b32 s41, 0, s41
v_exp_f32 v68, v68
v_mfma_f32_16x16x32_bf16 v[76:79], a[176:179], a[16:19], v[100:103]
v_add_f32 v88, v88, v66
v_add_f32 v89, v89, v67
v_mfma_f32_16x16x32_bf16 v[76:79], a[180:183], a[20:23], v[76:79]
v_exp_f32 v69, v69
v_mfma_f32_16x16x32_bf16 v[76:79], a[184:187], a[24:27], v[76:79]
ds_read_b64_tr_b16 a[252:253], v23 offset:26336
v_cvt_pk_bf16_f32 v82, v68, v69
v_mfma_f32_16x16x32_bf16 v[76:79], a[188:191], a[28:31], v[76:79]
v_exp_f32 v70, v70
v_mfma_f32_16x16x32_bf16 v[240:243], a[208:211], v[84:87], v[240:243]
v_add_f32 v88, v88, v68
v_add_f32 v89, v89, v69
v_mfma_f32_16x16x32_bf16 v[244:247], a[212:215], v[84:87], v[244:247]
v_exp_f32 v71, v71
v_mfma_f32_16x16x32_bf16 v[248:251], a[216:219], v[84:87], v[248:251]
ds_read_b64_tr_b16 a[254:255], v23 offset:30688
v_cvt_pk_bf16_f32 v83, v70, v71
v_mfma_f32_16x16x32_bf16 v[252:255], a[220:223], v[84:87], v[252:255]
s_waitcnt lgkmcnt(6)
v_add_u32 v21, s41, v18
v_add_u32 v22, s41, v19
v_add_u32 v23, s41, v20
s_add_u32 s101, s101, 8192
s_add_u32 s100, s100, s92
s_and_b32 s39, s100, 0xf800
s_and_b32 s93, s101, 0x40000
s_or_b32 s39, s39, s93
s_add_u32 s38, s38, 17408
s_cmp_eq_u32 s38, s71
s_cselect_b32 s38, s70, s38
s_sub_u32 s32, s32, 1
s_cmp_lg_u32 s32, 0
v_add_f32 v88, v88, v70
v_add_f32 v89, v89, v71
s_waitcnt vmcnt(21)
s_barrier
v_mfma_f32_16x16x32_bf16 v[64:67], a[160:163], a[32:35], v[104:107]
ds_read_b128 a[128:131], v21 offset:0
v_exp_f32 v72, v72
v_mfma_f32_16x16x32_bf16 v[64:67], a[164:167], a[36:39], v[64:67]
ds_read_b128 a[132:135], v21 offset:64
v_exp_f32 v73, v73
v_mfma_f32_16x16x32_bf16 v[64:67], a[168:171], a[40:43], v[64:67]
ds_read_b128 a[136:139], v21 offset:128
v_cvt_pk_bf16_f32 v84, v72, v73
v_mfma_f32_16x16x32_bf16 v[64:67], a[172:175], a[44:47], v[64:67]
v_exp_f32 v74, v74
v_mfma_f32_16x16x32_bf16 v[128:131], a[224:227], v[80:83], v[128:131]
s_add_u32 m0, s38, 0
v_add_f32 v90, v90, v72
v_add_f32 v91, v91, v73
v_mfma_f32_16x16x32_bf16 v[132:135], a[228:231], v[80:83], v[132:135]
buffer_load_dwordx4 v24, s[16:19], s39 offen offset:0 nt lds
v_exp_f32 v75, v75
v_mfma_f32_16x16x32_bf16 v[136:139], a[232:235], v[80:83], v[136:139]
ds_read_b128 a[140:143], v21 offset:192
v_cvt_pk_bf16_f32 v85, v74, v75
v_mfma_f32_16x16x32_bf16 v[140:143], a[236:239], v[80:83], v[140:143]
v_exp_f32 v76, v76
v_mfma_f32_16x16x32_bf16 v[68:71], a[176:179], a[32:35], v[104:107]
v_add_f32 v90, v90, v74
v_add_f32 v91, v91, v75
v_mfma_f32_16x16x32_bf16 v[68:71], a[180:183], a[36:39], v[68:71]
v_exp_f32 v77, v77
v_mfma_f32_16x16x32_bf16 v[68:71], a[184:187], a[40:43], v[68:71]
ds_read_b128 a[144:147], v21 offset:4352
v_cvt_pk_bf16_f32 v86, v76, v77
v_mfma_f32_16x16x32_bf16 v[68:71], a[188:191], a[44:47], v[68:71]
s_waitcnt lgkmcnt(5)
v_exp_f32 v78, v78
v_mfma_f32_16x16x32_bf16 v[144:147], a[240:243], v[80:83], v[144:147]
v_add_f32 v90, v90, v76
v_add_f32 v91, v91, v77
v_mfma_f32_16x16x32_bf16 v[148:151], a[244:247], v[80:83], v[148:151]
v_exp_f32 v79, v79
v_mfma_f32_16x16x32_bf16 v[152:155], a[248:251], v[80:83], v[152:155]
ds_read_b128 a[148:151], v21 offset:4416
v_cvt_pk_bf16_f32 v87, v78, v79
v_mfma_f32_16x16x32_bf16 v[156:159], a[252:255], v[80:83], v[156:159]
v_add_f32 v90, v90, v78
v_add_f32 v91, v91, v79
v_mfma_f32_16x16x32_bf16 v[72:75], a[160:163], a[48:51], v[108:111]
ds_read_b128 a[152:155], v21 offset:4480
v_exp_f32 v64, v64
v_mfma_f32_16x16x32_bf16 v[72:75], a[164:167], a[52:55], v[72:75]
ds_read_b128 a[156:159], v21 offset:4544
v_exp_f32 v65, v65
v_mfma_f32_16x16x32_bf16 v[72:75], a[168:171], a[56:59], v[72:75]
ds_read_b64_tr_b16 a[192:193], v22 offset:8704
v_cvt_pk_bf16_f32 v80, v64, v65
v_mfma_f32_16x16x32_bf16 v[72:75], a[172:175], a[60:63], v[72:75]
v_exp_f32 v66, v66
v_mfma_f32_16x16x32_bf16 v[160:163], a[224:227], v[84:87], v[160:163]
s_add_u32 m0, s38, 8704
v_add_f32 v92, v92, v64
v_add_f32 v93, v93, v65
v_mfma_f32_16x16x32_bf16 v[164:167], a[228:231], v[84:87], v[164:167]
buffer_load_dwordx4 v25, s[20:23], s39 offen offset:0 nt lds
v_exp_f32 v67, v67
v_mfma_f32_16x16x32_bf16 v[168:171], a[232:235], v[84:87], v[168:171]
ds_read_b64_tr_b16 a[194:195], v22 offset:13056
v_cvt_pk_bf16_f32 v81, v66, v67
v_mfma_f32_16x16x32_bf16 v[172:175], a[236:239], v[84:87], v[172:175]
v_exp_f32 v68, v68
v_mfma_f32_16x16x32_bf16 v[76:79], a[176:179], a[48:51], v[108:111]
v_add_f32 v92, v92, v66
v_add_f32 v93, v93, v67
v_mfma_f32_16x16x32_bf16 v[76:79], a[180:183], a[52:55], v[76:79]
v_exp_f32 v69, v69
v_mfma_f32_16x16x32_bf16 v[76:79], a[184:187], a[56:59], v[76:79]
ds_read_b64_tr_b16 a[196:197], v23 offset:8736
v_cvt_pk_bf16_f32 v82, v68, v69
v_mfma_f32_16x16x32_bf16 v[76:79], a[188:191], a[60:63], v[76:79]
v_exp_f32 v70, v70
v_mfma_f32_16x16x32_bf16 v[176:179], a[240:243], v[84:87], v[176:179]
v_add_f32 v92, v92, v68
v_add_f32 v93, v93, v69
v_mfma_f32_16x16x32_bf16 v[180:183], a[244:247], v[84:87], v[180:183]
v_exp_f32 v71, v71
v_mfma_f32_16x16x32_bf16 v[184:187], a[248:251], v[84:87], v[184:187]
ds_read_b64_tr_b16 a[198:199], v23 offset:13088
v_cvt_pk_bf16_f32 v83, v70, v71
v_mfma_f32_16x16x32_bf16 v[188:191], a[252:255], v[84:87], v[188:191]
s_waitcnt lgkmcnt(6)
v_add_f32 v92, v92, v70
v_add_f32 v93, v93, v71
v_mfma_f32_16x16x32_bf16 v[64:67], a[128:131], a[0:3], v[96:99]
ds_read_b64_tr_b16 a[200:201], v22 offset:8768
v_exp_f32 v72, v72
v_mfma_f32_16x16x32_bf16 v[64:67], a[132:135], a[4:7], v[64:67]
ds_read_b64_tr_b16 a[202:203], v22 offset:13120
v_exp_f32 v73, v73
v_mfma_f32_16x16x32_bf16 v[64:67], a[136:139], a[8:11], v[64:67]
ds_read_b64_tr_b16 a[204:205], v23 offset:8800
v_cvt_pk_bf16_f32 v84, v72, v73
v_mfma_f32_16x16x32_bf16 v[64:67], a[140:143], a[12:15], v[64:67]
v_exp_f32 v74, v74
v_mfma_f32_16x16x32_bf16 v[192:195], a[224:227], v[80:83], v[192:195]
s_add_u32 m0, s38, 64
v_add_f32 v94, v94, v72
v_add_f32 v95, v95, v73
v_mfma_f32_16x16x32_bf16 v[196:199], a[228:231], v[80:83], v[196:199]
buffer_load_dwordx4 v24, s[16:19], s39 offen offset:1024 nt lds
v_exp_f32 v75, v75
v_mfma_f32_16x16x32_bf16 v[200:203], a[232:235], v[80:83], v[200:203]
ds_read_b64_tr_b16 a[206:207], v23 offset:13152
v_cvt_pk_bf16_f32 v85, v74, v75
v_mfma_f32_16x16x32_bf16 v[204:207], a[236:239], v[80:83], v[204:207]
s_waitcnt lgkmcnt(8)
v_exp_f32 v76, v76
v_mfma_f32_16x16x32_bf16 v[68:71], a[144:147], a[0:3], v[96:99]
v_add_f32 v94, v94, v74
v_add_f32 v95, v95, v75
v_mfma_f32_16x16x32_bf16 v[68:71], a[148:151], a[4:7], v[68:71]
v_exp_f32 v77, v77
v_mfma_f32_16x16x32_bf16 v[68:71], a[152:155], a[8:11], v[68:71]
ds_read_b64_tr_b16 a[208:209], v22 offset:8832
v_cvt_pk_bf16_f32 v86, v76, v77
v_mfma_f32_16x16x32_bf16 v[68:71], a[156:159], a[12:15], v[68:71]
v_exp_f32 v78, v78
v_mfma_f32_16x16x32_bf16 v[208:211], a[240:243], v[80:83], v[208:211]
v_add_f32 v94, v94, v76
v_add_f32 v95, v95, v77
v_mfma_f32_16x16x32_bf16 v[212:215], a[244:247], v[80:83], v[212:215]
v_exp_f32 v79, v79
v_mfma_f32_16x16x32_bf16 v[216:219], a[248:251], v[80:83], v[216:219]
ds_read_b64_tr_b16 a[210:211], v22 offset:13184
v_cvt_pk_bf16_f32 v87, v78, v79
v_mfma_f32_16x16x32_bf16 v[220:223], a[252:255], v[80:83], v[220:223]
s_waitcnt lgkmcnt(6)
v_add_f32 v94, v94, v78
v_add_f32 v95, v95, v79
v_mfma_f32_16x16x32_bf16 v[72:75], a[128:131], a[16:19], v[100:103]
ds_read_b64_tr_b16 a[212:213], v23 offset:8864
v_exp_f32 v64, v64
v_mfma_f32_16x16x32_bf16 v[72:75], a[132:135], a[20:23], v[72:75]
ds_read_b64_tr_b16 a[214:215], v23 offset:13216
v_exp_f32 v65, v65
v_mfma_f32_16x16x32_bf16 v[72:75], a[136:139], a[24:27], v[72:75]
ds_read_b64_tr_b16 a[216:217], v22 offset:8896
v_cvt_pk_bf16_f32 v80, v64, v65
v_mfma_f32_16x16x32_bf16 v[72:75], a[140:143], a[28:31], v[72:75]
v_exp_f32 v66, v66
v_mfma_f32_16x16x32_bf16 v[224:227], a[224:227], v[84:87], v[224:227]
s_add_u32 m0, s38, 9536
v_add_f32 v88, v88, v64
v_add_f32 v89, v89, v65
v_mfma_f32_16x16x32_bf16 v[228:231], a[228:231], v[84:87], v[228:231]
buffer_load_dwordx4 v25, s[20:23], s39 offen offset:256 nt lds
v_exp_f32 v67, v67
v_mfma_f32_16x16x32_bf16 v[232:235], a[232:235], v[84:87], v[232:235]
ds_read_b64_tr_b16 a[218:219], v22 offset:13248
v_cvt_pk_bf16_f32 v81, v66, v67
v_mfma_f32_16x16x32_bf16 v[236:239], a[236:239], v[84:87], v[236:239]
v_exp_f32 v68, v68
v_mfma_f32_16x16x32_bf16 v[76:79], a[144:147], a[16:19], v[100:103]
v_add_f32 v88, v88, v66
v_add_f32 v89, v89, v67
v_mfma_f32_16x16x32_bf16 v[76:79], a[148:151], a[20:23], v[76:79]
v_exp_f32 v69, v69
v_mfma_f32_16x16x32_bf16 v[76:79], a[152:155], a[24:27], v[76:79]
ds_read_b64_tr_b16 a[220:221], v23 offset:8928
v_cvt_pk_bf16_f32 v82, v68, v69
v_mfma_f32_16x16x32_bf16 v[76:79], a[156:159], a[28:31], v[76:79]
v_exp_f32 v70, v70
v_mfma_f32_16x16x32_bf16 v[240:243], a[240:243], v[84:87], v[240:243]
v_add_f32 v88, v88, v68
v_add_f32 v89, v89, v69
v_mfma_f32_16x16x32_bf16 v[244:247], a[244:247], v[84:87], v[244:247]
v_exp_f32 v71, v71
v_mfma_f32_16x16x32_bf16 v[248:251], a[248:251], v[84:87], v[248:251]
ds_read_b64_tr_b16 a[222:223], v23 offset:13280
v_cvt_pk_bf16_f32 v83, v70, v71
v_mfma_f32_16x16x32_bf16 v[252:255], a[252:255], v[84:87], v[252:255]
s_waitcnt lgkmcnt(6)
s_add_u32 s101, s101, 8192
s_add_u32 s100, s100, s92
s_and_b32 s39, s100, 0xf800
s_and_b32 s93, s101, 0x40000
s_or_b32 s39, s39, s93
s_add_u32 s38, s38, 17408
s_cmp_eq_u32 s38, s71
s_cselect_b32 s38, s70, s38
v_add_f32 v88, v88, v70
v_add_f32 v89, v89, v71
s_waitcnt vmcnt(20)
s_barrier
v_mfma_f32_16x16x32_bf16 v[64:67], a[128:131], a[32:35], v[104:107]
ds_read_b128 a[160:163], v21 offset:17408
v_exp_f32 v72, v72
v_mfma_f32_16x16x32_bf16 v[64:67], a[132:135], a[36:39], v[64:67]
ds_read_b128 a[164:167], v21 offset:17472
v_exp_f32 v73, v73
v_mfma_f32_16x16x32_bf16 v[64:67], a[136:139], a[40:43], v[64:67]
ds_read_b128 a[168:171], v21 offset:17536
v_cvt_pk_bf16_f32 v84, v72, v73
v_mfma_f32_16x16x32_bf16 v[64:67], a[140:143], a[44:47], v[64:67]
v_exp_f32 v74, v74
v_mfma_f32_16x16x32_bf16 v[128:131], a[192:195], v[80:83], v[128:131]
s_add_u32 m0, s38, 0
v_add_f32 v90, v90, v72
v_add_f32 v91, v91, v73
v_mfma_f32_16x16x32_bf16 v[132:135], a[196:199], v[80:83], v[132:135]
buffer_load_dwordx4 v24, s[16:19], s39 offen offset:0 nt lds
v_exp_f32 v75, v75
v_mfma_f32_16x16x32_bf16 v[136:139], a[200:203], v[80:83], v[136:139]
ds_read_b128 a[172:175], v21 offset:17600
v_cvt_pk_bf16_f32 v85, v74, v75
v_mfma_f32_16x16x32_bf16 v[140:143], a[204:207], v[80:83], v[140:143]
v_exp_f32 v76, v76
v_mfma_f32_16x16x32_bf16 v[68:71], a[144:147], a[32:35], v[104:107]
v_add_f32 v90, v90, v74
v_add_f32 v91, v91, v75
v_mfma_f32_16x16x32_bf16 v[68:71], a[148:151], a[36:39], v[68:71]
v_exp_f32 v77, v77
v_mfma_f32_16x16x32_bf16 v[68:71], a[152:155], a[40:43], v[68:71]
ds_read_b128 a[176:179], v21 offset:21760
v_cvt_pk_bf16_f32 v86, v76, v77
v_mfma_f32_16x16x32_bf16 v[68:71], a[156:159], a[44:47], v[68:71]
s_waitcnt lgkmcnt(5)
v_exp_f32 v78, v78
v_mfma_f32_16x16x32_bf16 v[144:147], a[208:211], v[80:83], v[144:147]
v_add_f32 v90, v90, v76
v_add_f32 v91, v91, v77
v_mfma_f32_16x16x32_bf16 v[148:151], a[212:215], v[80:83], v[148:151]
v_exp_f32 v79, v79
v_mfma_f32_16x16x32_bf16 v[152:155], a[216:219], v[80:83], v[152:155]
ds_read_b128 a[180:183], v21 offset:21824
v_cvt_pk_bf16_f32 v87, v78, v79
v_mfma_f32_16x16x32_bf16 v[156:159], a[220:223], v[80:83], v[156:159]
v_add_f32 v90, v90, v78
v_add_f32 v91, v91, v79
v_mfma_f32_16x16x32_bf16 v[72:75], a[128:131], a[48:51], v[108:111]
ds_read_b128 a[184:187], v21 offset:21888
v_exp_f32 v64, v64
v_mfma_f32_16x16x32_bf16 v[72:75], a[132:135], a[52:55], v[72:75]
ds_read_b128 a[188:191], v21 offset:21952
v_exp_f32 v65, v65
v_mfma_f32_16x16x32_bf16 v[72:75], a[136:139], a[56:59], v[72:75]
ds_read_b64_tr_b16 a[224:225], v22 offset:26112
v_cvt_pk_bf16_f32 v80, v64, v65
v_mfma_f32_16x16x32_bf16 v[72:75], a[140:143], a[60:63], v[72:75]
v_exp_f32 v66, v66
v_mfma_f32_16x16x32_bf16 v[160:163], a[192:195], v[84:87], v[160:163]
s_add_u32 m0, s38, 8704
v_add_f32 v92, v92, v64
v_add_f32 v93, v93, v65
v_mfma_f32_16x16x32_bf16 v[164:167], a[196:199], v[84:87], v[164:167]
buffer_load_dwordx4 v25, s[20:23], s39 offen offset:0 nt lds
v_exp_f32 v67, v67
v_mfma_f32_16x16x32_bf16 v[168:171], a[200:203], v[84:87], v[168:171]
ds_read_b64_tr_b16 a[226:227], v22 offset:30464
v_cvt_pk_bf16_f32 v81, v66, v67
v_mfma_f32_16x16x32_bf16 v[172:175], a[204:207], v[84:87], v[172:175]
v_exp_f32 v68, v68
v_mfma_f32_16x16x32_bf16 v[76:79], a[144:147], a[48:51], v[108:111]
v_add_f32 v92, v92, v66
v_add_f32 v93, v93, v67
v_mfma_f32_16x16x32_bf16 v[76:79], a[148:151], a[52:55], v[76:79]
v_exp_f32 v69, v69
v_mfma_f32_16x16x32_bf16 v[76:79], a[152:155], a[56:59], v[76:79]
ds_read_b64_tr_b16 a[228:229], v23 offset:26144
v_cvt_pk_bf16_f32 v82, v68, v69
v_mfma_f32_16x16x32_bf16 v[76:79], a[156:159], a[60:63], v[76:79]
v_exp_f32 v70, v70
v_mfma_f32_16x16x32_bf16 v[176:179], a[208:211], v[84:87], v[176:179]
v_add_f32 v92, v92, v68
v_add_f32 v93, v93, v69
v_mfma_f32_16x16x32_bf16 v[180:183], a[212:215], v[84:87], v[180:183]
v_exp_f32 v71, v71
v_mfma_f32_16x16x32_bf16 v[184:187], a[216:219], v[84:87], v[184:187]
ds_read_b64_tr_b16 a[230:231], v23 offset:30496
v_cvt_pk_bf16_f32 v83, v70, v71
v_mfma_f32_16x16x32_bf16 v[188:191], a[220:223], v[84:87], v[188:191]
s_waitcnt lgkmcnt(6)
v_add_f32 v92, v92, v70
v_add_f32 v93, v93, v71
v_mfma_f32_16x16x32_bf16 v[64:67], a[160:163], a[0:3], v[96:99]
ds_read_b64_tr_b16 a[232:233], v22 offset:26176
v_exp_f32 v72, v72
v_mfma_f32_16x16x32_bf16 v[64:67], a[164:167], a[4:7], v[64:67]
ds_read_b64_tr_b16 a[234:235], v22 offset:30528
v_exp_f32 v73, v73
v_mfma_f32_16x16x32_bf16 v[64:67], a[168:171], a[8:11], v[64:67]
ds_read_b64_tr_b16 a[236:237], v23 offset:26208
v_cvt_pk_bf16_f32 v84, v72, v73
v_mfma_f32_16x16x32_bf16 v[64:67], a[172:175], a[12:15], v[64:67]
v_exp_f32 v74, v74
v_mfma_f32_16x16x32_bf16 v[192:195], a[192:195], v[80:83], v[192:195]
s_add_u32 m0, s38, 64
v_add_f32 v94, v94, v72
v_add_f32 v95, v95, v73
v_mfma_f32_16x16x32_bf16 v[196:199], a[196:199], v[80:83], v[196:199]
buffer_load_dwordx4 v24, s[16:19], s39 offen offset:1024 nt lds
v_exp_f32 v75, v75
v_mfma_f32_16x16x32_bf16 v[200:203], a[200:203], v[80:83], v[200:203]
ds_read_b64_tr_b16 a[238:239], v23 offset:30560
v_cvt_pk_bf16_f32 v85, v74, v75
v_mfma_f32_16x16x32_bf16 v[204:207], a[204:207], v[80:83], v[204:207]
s_waitcnt lgkmcnt(8)
v_exp_f32 v76, v76
v_mfma_f32_16x16x32_bf16 v[68:71], a[176:179], a[0:3], v[96:99]
v_add_f32 v94, v94, v74
v_add_f32 v95, v95, v75
v_mfma_f32_16x16x32_bf16 v[68:71], a[180:183], a[4:7], v[68:71]
v_exp_f32 v77, v77
v_mfma_f32_16x16x32_bf16 v[68:71], a[184:187], a[8:11], v[68:71]
ds_read_b64_tr_b16 a[240:241], v22 offset:26240
v_cvt_pk_bf16_f32 v86, v76, v77
v_mfma_f32_16x16x32_bf16 v[68:71], a[188:191], a[12:15], v[68:71]
v_exp_f32 v78, v78
v_mfma_f32_16x16x32_bf16 v[208:211], a[208:211], v[80:83], v[208:211]
v_add_f32 v94, v94, v76
v_add_f32 v95, v95, v77
v_mfma_f32_16x16x32_bf16 v[212:215], a[212:215], v[80:83], v[212:215]
v_exp_f32 v79, v79
v_mfma_f32_16x16x32_bf16 v[216:219], a[216:219], v[80:83], v[216:219]
ds_read_b64_tr_b16 a[242:243], v22 offset:30592
v_cvt_pk_bf16_f32 v87, v78, v79
v_mfma_f32_16x16x32_bf16 v[220:223], a[220:223], v[80:83], v[220:223]
s_waitcnt lgkmcnt(6)
v_add_f32 v94, v94, v78
v_add_f32 v95, v95, v79
v_mfma_f32_16x16x32_bf16 v[72:75], a[160:163], a[16:19], v[100:103]
ds_read_b64_tr_b16 a[244:245], v23 offset:26272
v_exp_f32 v64, v64
v_mfma_f32_16x16x32_bf16 v[72:75], a[164:167], a[20:23], v[72:75]
ds_read_b64_tr_b16 a[246:247], v23 offset:30624
v_exp_f32 v65, v65
v_mfma_f32_16x16x32_bf16 v[72:75], a[168:171], a[24:27], v[72:75]
ds_read_b64_tr_b16 a[248:249], v22 offset:26304
v_cvt_pk_bf16_f32 v80, v64, v65
v_mfma_f32_16x16x32_bf16 v[72:75], a[172:175], a[28:31], v[72:75]
s_add_u32 s41, s41, 34816
v_exp_f32 v66, v66
v_mfma_f32_16x16x32_bf16 v[224:227], a[192:195], v[84:87], v[224:227]
s_add_u32 m0, s38, 9536
v_add_f32 v88, v88, v64
v_add_f32 v89, v89, v65
v_mfma_f32_16x16x32_bf16 v[228:231], a[196:199], v[84:87], v[228:231]
s_cmp_eq_u32 s41, 139264
buffer_load_dwordx4 v25, s[20:23], s39 offen offset:256 nt lds
v_exp_f32 v67, v67
v_mfma_f32_16x16x32_bf16 v[232:235], a[200:203], v[84:87], v[232:235]
ds_read_b64_tr_b16 a[250:251], v22 offset:30656
v_cvt_pk_bf16_f32 v81, v66, v67
v_mfma_f32_16x16x32_bf16 v[236:239], a[204:207], v[84:87], v[236:239]
s_cselect_b32 s41, 0, s41
v_exp_f32 v68, v68
v_mfma_f32_16x16x32_bf16 v[76:79], a[176:179], a[16:19], v[100:103]
v_add_f32 v88, v88, v66
v_add_f32 v89, v89, v67
v_mfma_f32_16x16x32_bf16 v[76:79], a[180:183], a[20:23], v[76:79]
v_exp_f32 v69, v69
v_mfma_f32_16x16x32_bf16 v[76:79], a[184:187], a[24:27], v[76:79]
ds_read_b64_tr_b16 a[252:253], v23 offset:26336
v_cvt_pk_bf16_f32 v82, v68, v69
v_mfma_f32_16x16x32_bf16 v[76:79], a[188:191], a[28:31], v[76:79]
v_exp_f32 v70, v70
v_mfma_f32_16x16x32_bf16 v[240:243], a[208:211], v[84:87], v[240:243]
v_add_f32 v88, v88, v68
v_add_f32 v89, v89, v69
v_mfma_f32_16x16x32_bf16 v[244:247], a[212:215], v[84:87], v[244:247]
v_exp_f32 v71, v71
v_mfma_f32_16x16x32_bf16 v[248:251], a[216:219], v[84:87], v[248:251]
ds_read_b64_tr_b16 a[254:255], v23 offset:30688
v_cvt_pk_bf16_f32 v83, v70, v71
v_mfma_f32_16x16x32_bf16 v[252:255], a[220:223], v[84:87], v[252:255]
s_waitcnt lgkmcnt(6)
v_add_u32 v21, s41, v18
v_add_u32 v22, s41, v19
v_add_u32 v23, s41, v20
s_add_u32 s101, s101, 8192
s_add_u32 s100, s100, s92
s_and_b32 s39, s100, 0xf800
s_and_b32 s93, s101, 0x40000
s_or_b32 s39, s39, s93
s_add_u32 s38, s38, 17408
s_cmp_eq_u32 s38, s71
s_cselect_b32 s38, s70, s38
s_sub_u32 s32, s32, 1
s_cmp_lg_u32 s32, 0
v_add_f32 v88, v88, v70
v_add_f32 v89, v89, v71
s_mov_b32 s32, 13
L_at_1:
s_waitcnt vmcnt(20)
s_barrier
v_mfma_f32_16x16x32_bf16 v[64:67], a[160:163], a[32:35], v[104:107]
ds_read_b128 a[128:131], v21 offset:0
v_exp_f32 v72, v72
v_mfma_f32_16x16x32_bf16 v[64:67], a[164:167], a[36:39], v[64:67]
ds_read_b128 a[132:135], v21 offset:64
v_exp_f32 v73, v73
v_mfma_f32_16x16x32_bf16 v[64:67], a[168:171], a[40:43], v[64:67]
ds_read_b128 a[136:139], v21 offset:128
v_cvt_pk_bf16_f32 v84, v72, v73
v_mfma_f32_16x16x32_bf16 v[64:67], a[172:175], a[44:47], v[64:67]
v_exp_f32 v74, v74
v_mfma_f32_16x16x32_bf16 v[128:131], a[224:227], v[80:83], v[128:131]
s_add_u32 m0, s38, 0
v_add_f32 v90, v90, v72
v_add_f32 v91, v91, v73
v_mfma_f32_16x16x32_bf16 v[132:135], a[228:231], v[80:83], v[132:135]
buffer_load_dwordx4 v24, s[16:19], s39 offen offset:0 nt lds
v_exp_f32 v75, v75
v_mfma_f32_16x16x32_bf16 v[136:139], a[232:235], v[80:83], v[136:139]
ds_read_b128 a[140:143], v21 offset:192
v_cvt_pk_bf16_f32 v85, v74, v75
v_mfma_f32_16x16x32_bf16 v[140:143], a[236:239], v[80:83], v[140:143]
v_exp_f32 v76, v76
v_mfma_f32_16x16x32_bf16 v[68:71], a[176:179], a[32:35], v[104:107]
v_add_f32 v90, v90, v74
v_add_f32 v91, v91, v75
v_mfma_f32_16x16x32_bf16 v[68:71], a[180:183], a[36:39], v[68:71]
v_exp_f32 v77, v77
v_mfma_f32_16x16x32_bf16 v[68:71], a[184:187], a[40:43], v[68:71]
ds_read_b128 a[144:147], v21 offset:4352
v_cvt_pk_bf16_f32 v86, v76, v77
v_mfma_f32_16x16x32_bf16 v[68:71], a[188:191], a[44:47], v[68:71]
s_waitcnt lgkmcnt(5)
v_exp_f32 v78, v78
v_mfma_f32_16x16x32_bf16 v[144:147], a[240:243], v[80:83], v[144:147]
v_add_f32 v90, v90, v76
v_add_f32 v91, v91, v77
v_mfma_f32_16x16x32_bf16 v[148:151], a[244:247], v[80:83], v[148:151]
v_exp_f32 v79, v79
v_mfma_f32_16x16x32_bf16 v[152:155], a[248:251], v[80:83], v[152:155]
ds_read_b128 a[148:151], v21 offset:4416
v_cvt_pk_bf16_f32 v87, v78, v79
v_mfma_f32_16x16x32_bf16 v[156:159], a[252:255], v[80:83], v[156:159]
v_add_f32 v90, v90, v78
v_add_f32 v91, v91, v79
v_mfma_f32_16x16x32_bf16 v[72:75], a[160:163], a[48:51], v[108:111]
ds_read_b128 a[152:155], v21 offset:4480
v_exp_f32 v64, v64
v_mfma_f32_16x16x32_bf16 v[72:75], a[164:167], a[52:55], v[72:75]
ds_read_b128 a[156:159], v21 offset:4544
v_exp_f32 v65, v65
v_mfma_f32_16x16x32_bf16 v[72:75], a[168:171], a[56:59], v[72:75]
ds_read_b64_tr_b16 a[192:193], v22 offset:8704
v_cvt_pk_bf16_f32 v80, v64, v65
v_mfma_f32_16x16x32_bf16 v[72:75], a[172:175], a[60:63], v[72:75]
v_exp_f32 v66, v66
v_mfma_f32_16x16x32_bf16 v[160:163], a[224:227], v[84:87], v[160:163]
s_add_u32 m0, s38, 8704
v_add_f32 v92, v92, v64
v_add_f32 v93, v93, v65
v_mfma_f32_16x16x32_bf16 v[164:167], a[228:231], v[84:87], v[164:167]
buffer_load_dwordx4 v25, s[20:23], s39 offen offset:0 nt lds
v_exp_f32 v67, v67
v_mfma_f32_16x16x32_bf16 v[168:171], a[232:235], v[84:87], v[168:171]
ds_read_b64_tr_b16 a[194:195], v22 offset:13056
v_cvt_pk_bf16_f32 v81, v66, v67
v_mfma_f32_16x16x32_bf16 v[172:175], a[236:239], v[84:87], v[172:175]
v_exp_f32 v68, v68
v_mfma_f32_16x16x32_bf16 v[76:79], a[176:179], a[48:51], v[108:111]
v_add_f32 v92, v92, v66
v_add_f32 v93, v93, v67
v_mfma_f32_16x16x32_bf16 v[76:79], a[180:183], a[52:55], v[76:79]
v_exp_f32 v69, v69
v_mfma_f32_16x16x32_bf16 v[76:79], a[184:187], a[56:59], v[76:79]
ds_read_b64_tr_b16 a[196:197], v23 offset:8736
v_cvt_pk_bf16_f32 v82, v68, v69
v_mfma_f32_16x16x32_bf16 v[76:79], a[188:191], a[60:63], v[76:79]
v_exp_f32 v70, v70
v_mfma_f32_16x16x32_bf16 v[176:179], a[240:243], v[84:87], v[176:179]
v_add_f32 v92, v92, v68
v_add_f32 v93, v93, v69
v_mfma_f32_16x16x32_bf16 v[180:183], a[244:247], v[84:87], v[180:183]
v_exp_f32 v71, v71
v_mfma_f32_16x16x32_bf16 v[184:187], a[248:251], v[84:87], v[184:187]
ds_read_b64_tr_b16 a[198:199], v23 offset:13088
v_cvt_pk_bf16_f32 v83, v70, v71
v_mfma_f32_16x16x32_bf16 v[188:191], a[252:255], v[84:87], v[188:191]
s_waitcnt lgkmcnt(6)
v_add_f32 v92, v92, v70
v_add_f32 v93, v93, v71
v_mfma_f32_16x16x32_bf16 v[64:67], a[128:131], a[0:3], v[96:99]
ds_read_b64_tr_b16 a[200:201], v22 offset:8768
v_exp_f32 v72, v72
v_mfma_f32_16x16x32_bf16 v[64:67], a[132:135], a[4:7], v[64:67]
ds_read_b64_tr_b16 a[202:203], v22 offset:13120
v_exp_f32 v73, v73
v_mfma_f32_16x16x32_bf16 v[64:67], a[136:139], a[8:11], v[64:67]
ds_read_b64_tr_b16 a[204:205], v23 offset:8800
v_cvt_pk_bf16_f32 v84, v72, v73
v_mfma_f32_16x16x32_bf16 v[64:67], a[140:143], a[12:15], v[64:67]
v_exp_f32 v74, v74
v_mfma_f32_16x16x32_bf16 v[192:195], a[224:227], v[80:83], v[192:195]
s_add_u32 m0, s38, 64
v_add_f32 v94, v94, v72
v_add_f32 v95, v95, v73
v_mfma_f32_16x16x32_bf16 v[196:199], a[228:231], v[80:83], v[196:199]
buffer_load_dwordx4 v24, s[16:19], s39 offen offset:1024 nt lds
v_exp_f32 v75, v75
v_mfma_f32_16x16x32_bf16 v[200:203], a[232:235], v[80:83], v[200:203]
ds_read_b64_tr_b16 a[206:207], v23 offset:13152
v_cvt_pk_bf16_f32 v85, v74, v75
v_mfma_f32_16x16x32_bf16 v[204:207], a[236:239], v[80:83], v[204:207]
s_waitcnt lgkmcnt(8)
v_exp_f32 v76, v76
v_mfma_f32_16x16x32_bf16 v[68:71], a[144:147], a[0:3], v[96:99]
v_add_f32 v94, v94, v74
v_add_f32 v95, v95, v75
v_mfma_f32_16x16x32_bf16 v[68:71], a[148:151], a[4:7], v[68:71]
v_exp_f32 v77, v77
v_mfma_f32_16x16x32_bf16 v[68:71], a[152:155], a[8:11], v[68:71]
ds_read_b64_tr_b16 a[208:209], v22 offset:8832
v_cvt_pk_bf16_f32 v86, v76, v77
v_mfma_f32_16x16x32_bf16 v[68:71], a[156:159], a[12:15], v[68:71]
v_exp_f32 v78, v78
v_mfma_f32_16x16x32_bf16 v[208:211], a[240:243], v[80:83], v[208:211]
v_add_f32 v94, v94, v76
v_add_f32 v95, v95, v77
v_mfma_f32_16x16x32_bf16 v[212:215], a[244:247], v[80:83], v[212:215]
v_exp_f32 v79, v79
v_mfma_f32_16x16x32_bf16 v[216:219], a[248:251], v[80:83], v[216:219]
ds_read_b64_tr_b16 a[210:211], v22 offset:13184
v_cvt_pk_bf16_f32 v87, v78, v79
v_mfma_f32_16x16x32_bf16 v[220:223], a[252:255], v[80:83], v[220:223]
s_waitcnt lgkmcnt(6)
v_add_f32 v94, v94, v78
v_add_f32 v95, v95, v79
v_mfma_f32_16x16x32_bf16 v[72:75], a[128:131], a[16:19], v[100:103]
ds_read_b64_tr_b16 a[212:213], v23 offset:8864
v_exp_f32 v64, v64
v_mfma_f32_16x16x32_bf16 v[72:75], a[132:135], a[20:23], v[72:75]
ds_read_b64_tr_b16 a[214:215], v23 offset:13216
v_exp_f32 v65, v65
v_mfma_f32_16x16x32_bf16 v[72:75], a[136:139], a[24:27], v[72:75]
ds_read_b64_tr_b16 a[216:217], v22 offset:8896
v_cvt_pk_bf16_f32 v80, v64, v65
v_mfma_f32_16x16x32_bf16 v[72:75], a[140:143], a[28:31], v[72:75]
v_exp_f32 v66, v66
v_mfma_f32_16x16x32_bf16 v[224:227], a[224:227], v[84:87], v[224:227]
s_add_u32 m0, s38, 9536
v_add_f32 v88, v88, v64
v_add_f32 v89, v89, v65
v_mfma_f32_16x16x32_bf16 v[228:231], a[228:231], v[84:87], v[228:231]
buffer_load_dwordx4 v25, s[20:23], s39 offen offset:256 nt lds
v_exp_f32 v67, v67
v_mfma_f32_16x16x32_bf16 v[232:235], a[232:235], v[84:87], v[232:235]
ds_read_b64_tr_b16 a[218:219], v22 offset:13248
v_cvt_pk_bf16_f32 v81, v66, v67
v_mfma_f32_16x16x32_bf16 v[236:239], a[236:239], v[84:87], v[236:239]
v_exp_f32 v68, v68
v_mfma_f32_16x16x32_bf16 v[76:79], a[144:147], a[16:19], v[100:103]
v_add_f32 v88, v88, v66
v_add_f32 v89, v89, v67
v_mfma_f32_16x16x32_bf16 v[76:79], a[148:151], a[20:23], v[76:79]
v_exp_f32 v69, v69
v_mfma_f32_16x16x32_bf16 v[76:79], a[152:155], a[24:27], v[76:79]
ds_read_b64_tr_b16 a[220:221], v23 offset:8928
v_cvt_pk_bf16_f32 v82, v68, v69
v_mfma_f32_16x16x32_bf16 v[76:79], a[156:159], a[28:31], v[76:79]
v_exp_f32 v70, v70
v_mfma_f32_16x16x32_bf16 v[240:243], a[240:243], v[84:87], v[240:243]
v_add_f32 v88, v88, v68
v_add_f32 v89, v89, v69
v_mfma_f32_16x16x32_bf16 v[244:247], a[244:247], v[84:87], v[244:247]
v_exp_f32 v71, v71
v_mfma_f32_16x16x32_bf16 v[248:251], a[248:251], v[84:87], v[248:251]
ds_read_b64_tr_b16 a[222:223], v23 offset:13280
v_cvt_pk_bf16_f32 v83, v70, v71
v_mfma_f32_16x16x32_bf16 v[252:255], a[252:255], v[84:87], v[252:255]
s_waitcnt lgkmcnt(6)
s_add_u32 s101, s101, 8192
s_add_u32 s100, s100, s92
s_and_b32 s39, s100, 0xf800
s_and_b32 s93, s101, 0x40000
s_or_b32 s39, s39, s93
s_add_u32 s38, s38, 17408
s_cmp_eq_u32 s38, s71
s_cselect_b32 s38, s70, s38
v_add_f32 v88, v88, v70
v_add_f32 v89, v89, v71
s_waitcnt vmcnt(20)
s_barrier
v_mfma_f32_16x16x32_bf16 v[64:67], a[128:131], a[32:35], v[104:107]
ds_read_b128 a[160:163], v21 offset:17408
v_exp_f32 v72, v72
v_mfma_f32_16x16x32_bf16 v[64:67], a[132:135], a[36:39], v[64:67]
ds_read_b128 a[164:167], v21 offset:17472
v_exp_f32 v73, v73
v_mfma_f32_16x16x32_bf16 v[64:67], a[136:139], a[40:43], v[64:67]
ds_read_b128 a[168:171], v21 offset:17536
v_cvt_pk_bf16_f32 v84, v72, v73
v_mfma_f32_16x16x32_bf16 v[64:67], a[140:143], a[44:47], v[64:67]
v_exp_f32 v74, v74
v_mfma_f32_16x16x32_bf16 v[128:131], a[192:195], v[80:83], v[128:131]
s_add_u32 m0, s38, 0
v_add_f32 v90, v90, v72
v_add_f32 v91, v91, v73
v_mfma_f32_16x16x32_bf16 v[132:135], a[196:199], v[80:83], v[132:135]
buffer_load_dwordx4 v24, s[16:19], s39 offen offset:0 nt lds
v_exp_f32 v75, v75
v_mfma_f32_16x16x32_bf16 v[136:139], a[200:203], v[80:83], v[136:139]
ds_read_b128 a[172:175], v21 offset:17600
v_cvt_pk_bf16_f32 v85, v74, v75
v_mfma_f32_16x16x32_bf16 v[140:143], a[204:207], v[80:83], v[140:143]
v_exp_f32 v76, v76
v_mfma_f32_16x16x32_bf16 v[68:71], a[144:147], a[32:35], v[104:107]
v_add_f32 v90, v90, v74
v_add_f32 v91, v91, v75
v_mfma_f32_16x16x32_bf16 v[68:71], a[148:151], a[36:39], v[68:71]
v_exp_f32 v77, v77
v_mfma_f32_16x16x32_bf16 v[68:71], a[152:155], a[40:43], v[68:71]
ds_read_b128 a[176:179], v21 offset:21760
v_cvt_pk_bf16_f32 v86, v76, v77
v_mfma_f32_16x16x32_bf16 v[68:71], a[156:159], a[44:47], v[68:71]
s_waitcnt lgkmcnt(5)
v_exp_f32 v78, v78
v_mfma_f32_16x16x32_bf16 v[144:147], a[208:211], v[80:83], v[144:147]
v_add_f32 v90, v90, v76
v_add_f32 v91, v91, v77
v_mfma_f32_16x16x32_bf16 v[148:151], a[212:215], v[80:83], v[148:151]
v_exp_f32 v79, v79
v_mfma_f32_16x16x32_bf16 v[152:155], a[216:219], v[80:83], v[152:155]
ds_read_b128 a[180:183], v21 offset:21824
v_cvt_pk_bf16_f32 v87, v78, v79
v_mfma_f32_16x16x32_bf16 v[156:159], a[220:223], v[80:83], v[156:159]
v_add_f32 v90, v90, v78
v_add_f32 v91, v91, v79
v_mfma_f32_16x16x32_bf16 v[72:75], a[128:131], a[48:51], v[108:111]
ds_read_b128 a[184:187], v21 offset:21888
v_exp_f32 v64, v64
v_mfma_f32_16x16x32_bf16 v[72:75], a[132:135], a[52:55], v[72:75]
ds_read_b128 a[188:191], v21 offset:21952
v_exp_f32 v65, v65
v_mfma_f32_16x16x32_bf16 v[72:75], a[136:139], a[56:59], v[72:75]
ds_read_b64_tr_b16 a[224:225], v22 offset:26112
v_cvt_pk_bf16_f32 v80, v64, v65
v_mfma_f32_16x16x32_bf16 v[72:75], a[140:143], a[60:63], v[72:75]
v_exp_f32 v66, v66
v_mfma_f32_16x16x32_bf16 v[160:163], a[192:195], v[84:87], v[160:163]
s_add_u32 m0, s38, 8704
v_add_f32 v92, v92, v64
v_add_f32 v93, v93, v65
v_mfma_f32_16x16x32_bf16 v[164:167], a[196:199], v[84:87], v[164:167]
buffer_load_dwordx4 v25, s[20:23], s39 offen offset:0 nt lds
v_exp_f32 v67, v67
v_mfma_f32_16x16x32_bf16 v[168:171], a[200:203], v[84:87], v[168:171]
ds_read_b64_tr_b16 a[226:227], v22 offset:30464
v_cvt_pk_bf16_f32 v81, v66, v67
v_mfma_f32_16x16x32_bf16 v[172:175], a[204:207], v[84:87], v[172:175]
v_exp_f32 v68, v68
v_mfma_f32_16x16x32_bf16 v[76:79], a[144:147], a[48:51], v[108:111]
v_add_f32 v92, v92, v66
v_add_f32 v93, v93, v67
v_mfma_f32_16x16x32_bf16 v[76:79], a[148:151], a[52:55], v[76:79]
v_exp_f32 v69, v69
v_mfma_f32_16x16x32_bf16 v[76:79], a[152:155], a[56:59], v[76:79]
ds_read_b64_tr_b16 a[228:229], v23 offset:26144
v_cvt_pk_bf16_f32 v82, v68, v69
v_mfma_f32_16x16x32_bf16 v[76:79], a[156:159], a[60:63], v[76:79]
v_exp_f32 v70, v70
v_mfma_f32_16x16x32_bf16 v[176:179], a[208:211], v[84:87], v[176:179]
v_add_f32 v92, v92, v68
v_add_f32 v93, v93, v69
v_mfma_f32_16x16x32_bf16 v[180:183], a[212:215], v[84:87], v[180:183]
v_exp_f32 v71, v71
v_mfma_f32_16x16x32_bf16 v[184:187], a[216:219], v[84:87], v[184:187]
ds_read_b64_tr_b16 a[230:231], v23 offset:30496
v_cvt_pk_bf16_f32 v83, v70, v71
v_mfma_f32_16x16x32_bf16 v[188:191], a[220:223], v[84:87], v[188:191]
s_waitcnt lgkmcnt(6)
v_add_f32 v92, v92, v70
v_add_f32 v93, v93, v71
v_mfma_f32_16x16x32_bf16 v[64:67], a[160:163], a[0:3], v[96:99]
ds_read_b64_tr_b16 a[232:233], v22 offset:26176
v_exp_f32 v72, v72
v_mfma_f32_16x16x32_bf16 v[64:67], a[164:167], a[4:7], v[64:67]
ds_read_b64_tr_b16 a[234:235], v22 offset:30528
v_exp_f32 v73, v73
v_mfma_f32_16x16x32_bf16 v[64:67], a[168:171], a[8:11], v[64:67]
ds_read_b64_tr_b16 a[236:237], v23 offset:26208
v_cvt_pk_bf16_f32 v84, v72, v73
v_mfma_f32_16x16x32_bf16 v[64:67], a[172:175], a[12:15], v[64:67]
v_exp_f32 v74, v74
v_mfma_f32_16x16x32_bf16 v[192:195], a[192:195], v[80:83], v[192:195]
s_add_u32 m0, s38, 64
v_add_f32 v94, v94, v72
v_add_f32 v95, v95, v73
v_mfma_f32_16x16x32_bf16 v[196:199], a[196:199], v[80:83], v[196:199]
buffer_load_dwordx4 v24, s[16:19], s39 offen offset:1024 nt lds
v_exp_f32 v75, v75
v_mfma_f32_16x16x32_bf16 v[200:203], a[200:203], v[80:83], v[200:203]
ds_read_b64_tr_b16 a[238:239], v23 offset:30560
v_cvt_pk_bf16_f32 v85, v74, v75
v_mfma_f32_16x16x32_bf16 v[204:207], a[204:207], v[80:83], v[204:207]
s_waitcnt lgkmcnt(8)
v_exp_f32 v76, v76
v_mfma_f32_16x16x32_bf16 v[68:71], a[176:179], a[0:3], v[96:99]
v_add_f32 v94, v94, v74
v_add_f32 v95, v95, v75
v_mfma_f32_16x16x32_bf16 v[68:71], a[180:183], a[4:7], v[68:71]
v_exp_f32 v77, v77
v_mfma_f32_16x16x32_bf16 v[68:71], a[184:187], a[8:11], v[68:71]
ds_read_b64_tr_b16 a[240:241], v22 offset:26240
v_cvt_pk_bf16_f32 v86, v76, v77
v_mfma_f32_16x16x32_bf16 v[68:71], a[188:191], a[12:15], v[68:71]
v_exp_f32 v78, v78
v_mfma_f32_16x16x32_bf16 v[208:211], a[208:211], v[80:83], v[208:211]
v_add_f32 v94, v94, v76
v_add_f32 v95, v95, v77
v_mfma_f32_16x16x32_bf16 v[212:215], a[212:215], v[80:83], v[212:215]
v_exp_f32 v79, v79
v_mfma_f32_16x16x32_bf16 v[216:219], a[216:219], v[80:83], v[216:219]
ds_read_b64_tr_b16 a[242:243], v22 offset:30592
v_cvt_pk_bf16_f32 v87, v78, v79
v_mfma_f32_16x16x32_bf16 v[220:223], a[220:223], v[80:83], v[220:223]
s_waitcnt lgkmcnt(6)
v_add_f32 v94, v94, v78
v_add_f32 v95, v95, v79
v_mfma_f32_16x16x32_bf16 v[72:75], a[160:163], a[16:19], v[100:103]
ds_read_b64_tr_b16 a[244:245], v23 offset:26272
v_exp_f32 v64, v64
v_mfma_f32_16x16x32_bf16 v[72:75], a[164:167], a[20:23], v[72:75]
ds_read_b64_tr_b16 a[246:247], v23 offset:30624
v_exp_f32 v65, v65
v_mfma_f32_16x16x32_bf16 v[72:75], a[168:171], a[24:27], v[72:75]
ds_read_b64_tr_b16 a[248:249], v22 offset:26304
v_cvt_pk_bf16_f32 v80, v64, v65
v_mfma_f32_16x16x32_bf16 v[72:75], a[172:175], a[28:31], v[72:75]
s_add_u32 s41, s41, 34816
v_exp_f32 v66, v66
v_mfma_f32_16x16x32_bf16 v[224:227], a[192:195], v[84:87], v[224:227]
s_add_u32 m0, s38, 9536
v_add_f32 v88, v88, v64
v_add_f32 v89, v89, v65
v_mfma_f32_16x16x32_bf16 v[228:231], a[196:199], v[84:87], v[228:231]
s_cmp_eq_u32 s41, 139264
buffer_load_dwordx4 v25, s[20:23], s39 offen offset:256 nt lds
v_exp_f32 v67, v67
v_mfma_f32_16x16x32_bf16 v[232:235], a[200:203], v[84:87], v[232:235]
ds_read_b64_tr_b16 a[250:251], v22 offset:30656
v_cvt_pk_bf16_f32 v81, v66, v67
v_mfma_f32_16x16x32_bf16 v[236:239], a[204:207], v[84:87], v[236:239]
s_cselect_b32 s41, 0, s41
v_exp_f32 v68, v68
v_mfma_f32_16x16x32_bf16 v[76:79], a[176:179], a[16:19], v[100:103]
v_add_f32 v88, v88, v66
v_add_f32 v89, v89, v67
v_mfma_f32_16x16x32_bf16 v[76:79], a[180:183], a[20:23], v[76:79]
v_exp_f32 v69, v69
v_mfma_f32_16x16x32_bf16 v[76:79], a[184:187], a[24:27], v[76:79]
ds_read_b64_tr_b16 a[252:253], v23 offset:26336
v_cvt_pk_bf16_f32 v82, v68, v69
v_mfma_f32_16x16x32_bf16 v[76:79], a[188:191], a[28:31], v[76:79]
v_exp_f32 v70, v70
v_mfma_f32_16x16x32_bf16 v[240:243], a[208:211], v[84:87], v[240:243]
v_add_f32 v88, v88, v68
v_add_f32 v89, v89, v69
v_mfma_f32_16x16x32_bf16 v[244:247], a[212:215], v[84:87], v[244:247]
v_exp_f32 v71, v71
v_mfma_f32_16x16x32_bf16 v[248:251], a[216:219], v[84:87], v[248:251]
ds_read_b64_tr_b16 a[254:255], v23 offset:30688
v_cvt_pk_bf16_f32 v83, v70, v71
v_mfma_f32_16x16x32_bf16 v[252:255], a[220:223], v[84:87], v[252:255]
s_waitcnt lgkmcnt(6)
v_add_u32 v21, s41, v18
v_add_u32 v22, s41, v19
v_add_u32 v23, s41, v20
s_add_u32 s101, s101, 8192
s_add_u32 s100, s100, s92
s_and_b32 s39, s100, 0xf800
s_and_b32 s93, s101, 0x40000
s_or_b32 s39, s39, s93
s_add_u32 s38, s38, 17408
s_cmp_eq_u32 s38, s71
s_cselect_b32 s38, s70, s38
s_sub_u32 s32, s32, 1
s_cmp_lg_u32 s32, 0
v_add_f32 v88, v88, v70
v_add_f32 v89, v89, v71
s_cbranch_scc1 L_at_1
L_tr:
s_waitcnt vmcnt(20)
s_barrier
v_mfma_f32_16x16x32_bf16 v[64:67], a[160:163], a[32:35], v[104:107]
ds_read_b128 a[128:131], v21 offset:0
v_exp_f32 v72, v72
v_mov_b32 v96, v112
v_mov_b32 v97, v112
v_mfma_f32_16x16x32_bf16 v[64:67], a[164:167], a[36:39], v[64:67]
ds_read_b128 a[132:135], v21 offset:64
v_exp_f32 v73, v73
v_mov_b32 v98, v112
v_mov_b32 v99, v112
v_mfma_f32_16x16x32_bf16 v[64:67], a[168:171], a[40:43], v[64:67]
ds_read_b128 a[136:139], v21 offset:128
v_cvt_pk_bf16_f32 v84, v72, v73
v_add_f32 v116, v88, v89
v_mov_b32 v88, 0
v_mfma_f32_16x16x32_bf16 v[64:67], a[172:175], a[44:47], v[64:67]
v_exp_f32 v74, v74
v_mov_b32 v89, 0
v_mov_b32 v27, v116
v_mfma_f32_16x16x32_bf16 v[128:131], a[224:227], v[80:83], v[128:131]
s_add_u32 m0, s38, 0
v_add_f32 v90, v90, v72
v_add_f32 v91, v91, v73
s_nop 1
v_permlane32_swap_b32 v116, v27
v_mfma_f32_16x16x32_bf16 v[132:135], a[228:231], v[80:83], v[132:135]
buffer_load_dwordx4 v24, s[16:19], s39 offen offset:0 nt lds
v_exp_f32 v75, v75
s_nop 1
v_add_f32 v116, v116, v27
v_mfma_f32_16x16x32_bf16 v[136:139], a[232:235], v[80:83], v[136:139]
ds_read_b128 a[140:143], v21 offset:192
v_cvt_pk_bf16_f32 v85, v74, v75
v_mov_b32 v27, v116
s_nop 1
v_mfma_f32_16x16x32_bf16 v[140:143], a[236:239], v[80:83], v[140:143]
v_exp_f32 v76, v76
v_permlane16_swap_b32 v116, v27
s_nop 1
v_mfma_f32_16x16x32_bf16 v[68:71], a[176:179], a[32:35], v[104:107]
v_add_f32 v90, v90, v74
v_add_f32 v91, v91, v75
v_add_f32 v116, v116, v27
v_cmp_nge_f32 vcc, 0x4e800000, v116
v_mfma_f32_16x16x32_bf16 v[68:71], a[180:183], a[36:39], v[68:71]
v_exp_f32 v77, v77
v_rcp_f32 v116, v116
s_nop 1
v_mfma_f32_16x16x32_bf16 v[68:71], a[184:187], a[40:43], v[68:71]
ds_read_b128 a[144:147], v21 offset:4352
v_cvt_pk_bf16_f32 v86, v76, v77
s_or_b64 s[46:47], s[46:47], vcc
v_mfma_f32_16x16x32_bf16 v[68:71], a[188:191], a[44:47], v[68:71]
s_waitcnt lgkmcnt(5)
v_exp_f32 v78, v78
v_mfma_f32_16x16x32_bf16 v[144:147], a[240:243], v[80:83], v[144:147]
v_add_f32 v90, v90, v76
v_add_f32 v91, v91, v77
v_mfma_f32_16x16x32_bf16 v[148:151], a[244:247], v[80:83], v[148:151]
v_exp_f32 v79, v79
v_mfma_f32_16x16x32_bf16 v[152:155], a[248:251], v[80:83], v[152:155]
ds_read_b128 a[148:151], v21 offset:4416
v_cvt_pk_bf16_f32 v87, v78, v79
v_mfma_f32_16x16x32_bf16 v[156:159], a[252:255], v[80:83], v[156:159]
v_add_f32 v90, v90, v78
v_add_f32 v91, v91, v79
v_mfma_f32_16x16x32_bf16 v[72:75], a[160:163], a[48:51], v[108:111]
ds_read_b128 a[152:155], v21 offset:4480
v_exp_f32 v64, v64
s_mov_b32 s43, 0
v_mul_f32 v128, v128, v116
v_mul_f32 v129, v129, v116
v_mfma_f32_16x16x32_bf16 v[72:75], a[164:167], a[52:55], v[72:75]
ds_read_b128 a[156:159], v21 offset:4544
v_exp_f32 v65, v65
v_mul_f32 v130, v130, v116
v_mul_f32 v131, v131, v116
v_mul_f32 v132, v132, v116
v_mfma_f32_16x16x32_bf16 v[72:75], a[168:171], a[56:59], v[72:75]
ds_read_b64_tr_b16 a[192:193], v22 offset:8704
v_cvt_pk_bf16_f32 v80, v64, v65
v_mul_f32 v133, v133, v116
v_mul_f32 v134, v134, v116
v_mul_f32 v135, v135, v116
v_mfma_f32_16x16x32_bf16 v[72:75], a[172:175], a[60:63], v[72:75]
v_exp_f32 v66, v66
v_cvt_pk_bf16_f32 v120, v128, v129
v_cvt_pk_bf16_f32 v121, v130, v131
v_cvt_pk_bf16_f32 v122, v132, v133
v_mfma_f32_16x16x32_bf16 v[160:163], a[224:227], v[84:87], v[160:163]
s_add_u32 m0, s38, 8704
v_add_f32 v92, v92, v64
v_add_f32 v93, v93, v65
v_cvt_pk_bf16_f32 v123, v134, v135
buffer_store_dwordx4 v[120:123], v26, s[24:27], s43 offen offset:0 sc1
v_mul_f32 v136, v136, v116
v_mfma_f32_16x16x32_bf16 v[164:167], a[228:231], v[84:87], v[164:167]
buffer_load_dwordx4 v25, s[20:23], s39 offen offset:0 nt lds
v_exp_f32 v67, v67
v_mul_f32 v137, v137, v116
v_mul_f32 v138, v138, v116
v_mul_f32 v139, v139, v116
v_mfma_f32_16x16x32_bf16 v[168:171], a[232:235], v[84:87], v[168:171]
ds_read_b64_tr_b16 a[194:195], v22 offset:13056
v_cvt_pk_bf16_f32 v81, v66, v67
v_mul_f32 v140, v140, v116
v_mul_f32 v141, v141, v116
v_mul_f32 v142, v142, v116
v_mfma_f32_16x16x32_bf16 v[172:175], a[236:239], v[84:87], v[172:175]
v_exp_f32 v68, v68
v_mul_f32 v143, v143, v116
v_cvt_pk_bf16_f32 v124, v136, v137
v_cvt_pk_bf16_f32 v125, v138, v139
v_mfma_f32_16x16x32_bf16 v[76:79], a[176:179], a[48:51], v[108:111]
v_add_f32 v92, v92, v66
v_add_f32 v93, v93, v67
v_cvt_pk_bf16_f32 v126, v140, v141
v_cvt_pk_bf16_f32 v127, v142, v143
buffer_store_dwordx4 v[124:127], v26, s[24:27], s43 offen offset:1024 sc1
v_mfma_f32_16x16x32_bf16 v[76:79], a[180:183], a[52:55], v[76:79]
v_exp_f32 v69, v69
v_mov_b32 v100, v113
v_mov_b32 v101, v113
v_mov_b32 v102, v113
v_mfma_f32_16x16x32_bf16 v[76:79], a[184:187], a[56:59], v[76:79]
ds_read_b64_tr_b16 a[196:197], v23 offset:8736
v_cvt_pk_bf16_f32 v82, v68, v69
v_mov_b32 v103, v113
v_add_f32 v117, v90, v91
v_mov_b32 v90, 0
v_mfma_f32_16x16x32_bf16 v[76:79], a[188:191], a[60:63], v[76:79]
v_exp_f32 v70, v70
v_mov_b32 v91, 0
v_mov_b32 v27, v117
s_nop 1
v_mfma_f32_16x16x32_bf16 v[176:179], a[240:243], v[84:87], v[176:179]
v_add_f32 v92, v92, v68
v_add_f32 v93, v93, v69
v_permlane32_swap_b32 v117, v27
s_nop 1
v_add_f32 v117, v117, v27
v_mfma_f32_16x16x32_bf16 v[180:183], a[244:247], v[84:87], v[180:183]
v_exp_f32 v71, v71
v_mov_b32 v27, v117
s_nop 1
v_permlane16_swap_b32 v117, v27
v_mfma_f32_16x16x32_bf16 v[184:187], a[248:251], v[84:87], v[184:187]
ds_read_b64_tr_b16 a[198:199], v23 offset:13088
v_cvt_pk_bf16_f32 v83, v70, v71
s_nop 1
v_add_f32 v117, v117, v27
v_cmp_nge_f32 vcc, 0x4e800000, v117
v_mfma_f32_16x16x32_bf16 v[188:191], a[252:255], v[84:87], v[188:191]
s_waitcnt lgkmcnt(6)
v_add_f32 v92, v92, v70
v_add_f32 v93, v93, v71
v_rcp_f32 v117, v117
s_nop 1
s_or_b64 s[46:47], s[46:47], vcc
v_mfma_f32_16x16x32_bf16 v[64:67], a[128:131], a[64:67], v[96:99]
ds_read_b64_tr_b16 a[200:201], v22 offset:8768
v_exp_f32 v72, v72
s_mov_b32 s43, 32768
v_mul_f32 v144, v144, v116
v_mul_f32 v145, v145, v116
v_mul_f32 v146, v146, v116
v_mul_f32 v147, v147, v116
v_mfma_f32_16x16x32_bf16 v[64:67], a[132:135], a[68:71], v[64:67]
ds_read_b64_tr_b16 a[202:203], v22 offset:13120
v_exp_f32 v73, v73
v_mul_f32 v148, v148, v116
v_mul_f32 v149, v149, v116
v_mul_f32 v150, v150, v116
v_mul_f32 v151, v151, v116
v_cvt_pk_bf16_f32 v120, v144, v145
v_mfma_f32_16x16x32_bf16 v[64:67], a[136:139], a[72:75], v[64:67]
ds_read_b64_tr_b16 a[204:205], v23 offset:8800
v_cvt_pk_bf16_f32 v84, v72, v73
v_cvt_pk_bf16_f32 v121, v146, v147
v_cvt_pk_bf16_f32 v122, v148, v149
v_cvt_pk_bf16_f32 v123, v150, v151
buffer_store_dwordx4 v[120:123], v26, s[24:27], s43 offen offset:0 sc1
v_mul_f32 v152, v152, v116
v_mfma_f32_16x16x32_bf16 v[64:67], a[140:143], a[76:79], v[64:67]
v_exp_f32 v74, v74
v_mul_f32 v153, v153, v116
v_mul_f32 v154, v154, v116
v_mul_f32 v155, v155, v116
v_mul_f32 v156, v156, v116
v_mul_f32 v157, v157, v116
v_mfma_f32_16x16x32_bf16 v[192:195], a[224:227], v[80:83], v[192:195]
s_add_u32 m0, s38, 64
v_add_f32 v94, v94, v72
v_add_f32 v95, v95, v73
v_mul_f32 v158, v158, v116
v_mul_f32 v159, v159, v116
v_cvt_pk_bf16_f32 v124, v152, v153
v_cvt_pk_bf16_f32 v125, v154, v155
v_cvt_pk_bf16_f32 v126, v156, v157
v_mfma_f32_16x16x32_bf16 v[196:199], a[228:231], v[80:83], v[196:199]
buffer_load_dwordx4 v24, s[16:19], s39 offen offset:1024 nt lds
v_exp_f32 v75, v75
v_cvt_pk_bf16_f32 v127, v158, v159
buffer_store_dwordx4 v[124:127], v26, s[24:27], s43 offen offset:1024 sc1
s_mov_b32 s43, 131072
v_mul_f32 v160, v160, v117
v_mul_f32 v161, v161, v117
v_mfma_f32_16x16x32_bf16 v[200:203], a[232:235], v[80:83], v[200:203]
ds_read_b64_tr_b16 a[206:207], v23 offset:13152
v_cvt_pk_bf16_f32 v85, v74, v75
v_mul_f32 v162, v162, v117
v_mul_f32 v163, v163, v117
v_mul_f32 v164, v164, v117
v_mul_f32 v165, v165, v117
v_mul_f32 v166, v166, v117
v_mfma_f32_16x16x32_bf16 v[204:207], a[236:239], v[80:83], v[204:207]
s_waitcnt lgkmcnt(8)
v_exp_f32 v76, v76
v_mul_f32 v167, v167, v117
v_cvt_pk_bf16_f32 v120, v160, v161
v_cvt_pk_bf16_f32 v121, v162, v163
v_cvt_pk_bf16_f32 v122, v164, v165
v_cvt_pk_bf16_f32 v123, v166, v167
v_mfma_f32_16x16x32_bf16 v[68:71], a[144:147], a[64:67], v[96:99]
v_add_f32 v94, v94, v74
v_add_f32 v95, v95, v75
buffer_store_dwordx4 v[120:123], v26, s[24:27], s43 offen offset:0 sc1
v_mul_f32 v168, v168, v117
v_mul_f32 v169, v169, v117
v_mul_f32 v170, v170, v117
v_mul_f32 v171, v171, v117
v_mfma_f32_16x16x32_bf16 v[68:71], a[148:151], a[68:71], v[68:71]
v_exp_f32 v77, v77
v_mul_f32 v172, v172, v117
v_mul_f32 v173, v173, v117
v_mul_f32 v174, v174, v117
v_mul_f32 v175, v175, v117
v_cvt_pk_bf16_f32 v124, v168, v169
v_mfma_f32_16x16x32_bf16 v[68:71], a[152:155], a[72:75], v[68:71]
ds_read_b64_tr_b16 a[208:209], v22 offset:8832
v_cvt_pk_bf16_f32 v86, v76, v77
v_cvt_pk_bf16_f32 v125, v170, v171
v_cvt_pk_bf16_f32 v126, v172, v173
v_cvt_pk_bf16_f32 v127, v174, v175
buffer_store_dwordx4 v[124:127], v26, s[24:27], s43 offen offset:1024 sc1
v_mov_b32 v104, v114
v_mfma_f32_16x16x32_bf16 v[68:71], a[156:159], a[76:79], v[68:71]
v_exp_f32 v78, v78
v_mov_b32 v105, v114
v_mov_b32 v106, v114
v_mov_b32 v107, v114
v_add_f32 v118, v92, v93
v_mov_b32 v92, 0
v_mfma_f32_16x16x32_bf16 v[208:211], a[240:243], v[80:83], v[208:211]
v_add_f32 v94, v94, v76
v_add_f32 v95, v95, v77
v_mov_b32 v93, 0
v_mov_b32 v27, v118
s_nop 1
v_permlane32_swap_b32 v118, v27
s_nop 1
v_mfma_f32_16x16x32_bf16 v[212:215], a[244:247], v[80:83], v[212:215]
v_exp_f32 v79, v79
v_add_f32 v118, v118, v27
v_mov_b32 v27, v118
s_nop 1
v_permlane16_swap_b32 v118, v27
s_nop 1
v_mfma_f32_16x16x32_bf16 v[216:219], a[248:251], v[80:83], v[216:219]
ds_read_b64_tr_b16 a[210:211], v22 offset:13184
v_cvt_pk_bf16_f32 v87, v78, v79
v_add_f32 v118, v118, v27
v_cmp_nge_f32 vcc, 0x4e800000, v118
v_rcp_f32 v118, v118
s_nop 1
s_nop 0
s_or_b64 s[46:47], s[46:47], vcc
v_mfma_f32_16x16x32_bf16 v[220:223], a[252:255], v[80:83], v[220:223]
s_waitcnt lgkmcnt(6)
v_add_f32 v94, v94, v78
v_add_f32 v95, v95, v79
v_mfma_f32_16x16x32_bf16 v[72:75], a[128:131], a[80:83], v[100:103]
ds_read_b64_tr_b16 a[212:213], v23 offset:8864
v_exp_f32 v64, v64
s_mov_b32 s43, 163840
v_mul_f32 v176, v176, v117
v_mul_f32 v177, v177, v117
v_mul_f32 v178, v178, v117
v_mul_f32 v179, v179, v117
v_mfma_f32_16x16x32_bf16 v[72:75], a[132:135], a[84:87], v[72:75]
ds_read_b64_tr_b16 a[214:215], v23 offset:13216
v_exp_f32 v65, v65
v_mul_f32 v180, v180, v117
v_mul_f32 v181, v181, v117
v_mul_f32 v182, v182, v117
v_mul_f32 v183, v183, v117
v_cvt_pk_bf16_f32 v120, v176, v177
v_mfma_f32_16x16x32_bf16 v[72:75], a[136:139], a[88:91], v[72:75]
ds_read_b64_tr_b16 a[216:217], v22 offset:8896
v_cvt_pk_bf16_f32 v80, v64, v65
v_cvt_pk_bf16_f32 v121, v178, v179
v_cvt_pk_bf16_f32 v122, v180, v181
v_cvt_pk_bf16_f32 v123, v182, v183
buffer_store_dwordx4 v[120:123], v26, s[24:27], s43 offen offset:0 sc1
v_mul_f32 v184, v184, v117
v_mfma_f32_16x16x32_bf16 v[72:75], a[140:143], a[92:95], v[72:75]
v_exp_f32 v66, v66
v_mul_f32 v185, v185, v117
v_mul_f32 v186, v186, v117
v_mul_f32 v187, v187, v117
v_mul_f32 v188, v188, v117
v_mul_f32 v189, v189, v117
v_mfma_f32_16x16x32_bf16 v[224:227], a[224:227], v[84:87], v[224:227]
s_add_u32 m0, s38, 9536
v_add_f32 v88, v88, v64
v_add_f32 v89, v89, v65
v_mul_f32 v190, v190, v117
v_mul_f32 v191, v191, v117
v_cvt_pk_bf16_f32 v124, v184, v185
v_cvt_pk_bf16_f32 v125, v186, v187
v_cvt_pk_bf16_f32 v126, v188, v189
v_mfma_f32_16x16x32_bf16 v[228:231], a[228:231], v[84:87], v[228:231]
buffer_load_dwordx4 v25, s[20:23], s39 offen offset:256 nt lds
v_exp_f32 v67, v67
v_cvt_pk_bf16_f32 v127, v190, v191
buffer_store_dwordx4 v[124:127], v26, s[24:27], s43 offen offset:1024 sc1
s_mov_b32 s43, 262144
v_mul_f32 v192, v192, v118
v_mul_f32 v193, v193, v118
v_mfma_f32_16x16x32_bf16 v[232:235], a[232:235], v[84:87], v[232:235]
ds_read_b64_tr_b16 a[218:219], v22 offset:13248
v_cvt_pk_bf16_f32 v81, v66, v67
v_mul_f32 v194, v194, v118
v_mul_f32 v195, v195, v118
v_mul_f32 v196, v196, v118
v_mul_f32 v197, v197, v118
v_mul_f32 v198, v198, v118
v_mfma_f32_16x16x32_bf16 v[236:239], a[236:239], v[84:87], v[236:239]
v_exp_f32 v68, v68
v_mul_f32 v199, v199, v118
v_cvt_pk_bf16_f32 v120, v192, v193
v_cvt_pk_bf16_f32 v121, v194, v195
v_cvt_pk_bf16_f32 v122, v196, v197
v_cvt_pk_bf16_f32 v123, v198, v199
v_mfma_f32_16x16x32_bf16 v[76:79], a[144:147], a[80:83], v[100:103]
v_add_f32 v88, v88, v66
v_add_f32 v89, v89, v67
buffer_store_dwordx4 v[120:123], v26, s[24:27], s43 offen offset:0 sc1
v_mul_f32 v200, v200, v118
v_mul_f32 v201, v201, v118
v_mul_f32 v202, v202, v118
v_mul_f32 v203, v203, v118
v_mfma_f32_16x16x32_bf16 v[76:79], a[148:151], a[84:87], v[76:79]
v_exp_f32 v69, v69
v_mul_f32 v204, v204, v118
v_mul_f32 v205, v205, v118
v_mul_f32 v206, v206, v118
v_mul_f32 v207, v207, v118
v_cvt_pk_bf16_f32 v124, v200, v201
v_mfma_f32_16x16x32_bf16 v[76:79], a[152:155], a[88:91], v[76:79]
ds_read_b64_tr_b16 a[220:221], v23 offset:8928
v_cvt_pk_bf16_f32 v82, v68, v69
v_cvt_pk_bf16_f32 v125, v202, v203
v_cvt_pk_bf16_f32 v126, v204, v205
v_cvt_pk_bf16_f32 v127, v206, v207
buffer_store_dwordx4 v[124:127], v26, s[24:27], s43 offen offset:1024 sc1
v_mov_b32 v108, v115
v_mfma_f32_16x16x32_bf16 v[76:79], a[156:159], a[92:95], v[76:79]
v_exp_f32 v70, v70
v_mov_b32 v109, v115
v_mov_b32 v110, v115
v_mov_b32 v111, v115
v_add_f32 v119, v94, v95
v_mov_b32 v94, 0
v_mfma_f32_16x16x32_bf16 v[240:243], a[240:243], v[84:87], v[240:243]
v_add_f32 v88, v88, v68
v_add_f32 v89, v89, v69
v_mov_b32 v95, 0
v_mov_b32 v27, v119
s_nop 1
v_permlane32_swap_b32 v119, v27
s_nop 1
v_mfma_f32_16x16x32_bf16 v[244:247], a[244:247], v[84:87], v[244:247]
v_exp_f32 v71, v71
v_add_f32 v119, v119, v27
v_mov_b32 v27, v119
s_nop 1
v_permlane16_swap_b32 v119, v27
s_nop 1
v_mfma_f32_16x16x32_bf16 v[248:251], a[248:251], v[84:87], v[248:251]
ds_read_b64_tr_b16 a[222:223], v23 offset:13280
v_cvt_pk_bf16_f32 v83, v70, v71
v_add_f32 v119, v119, v27
v_cmp_nge_f32 vcc, 0x4e800000, v119
v_rcp_f32 v119, v119
s_nop 1
s_nop 0
s_or_b64 s[46:47], s[46:47], vcc
v_mfma_f32_16x16x32_bf16 v[252:255], a[252:255], v[84:87], v[252:255]
s_waitcnt lgkmcnt(6)
s_add_u32 s101, s101, 8192
s_add_u32 s100, s100, s92
s_and_b32 s39, s100, 0xf800
s_and_b32 s93, s101, 0x40000
s_or_b32 s39, s39, s93
s_add_u32 s38, s38, 17408
s_cmp_eq_u32 s38, s71
s_cselect_b32 s38, s70, s38
v_add_f32 v88, v88, v70
v_add_f32 v89, v89, v71
s_waitcnt vmcnt(30)
s_barrier
v_mfma_f32_16x16x32_bf16 v[64:67], a[128:131], a[96:99], v[104:107]
ds_read_b128 a[160:163], v21 offset:17408
v_exp_f32 v72, v72
s_mov_b32 s43, 294912
v_mul_f32 v208, v208, v118
v_mul_f32 v209, v209, v118
v_mul_f32 v210, v210, v118
v_mfma_f32_16x16x32_bf16 v[64:67], a[132:135], a[100:103], v[64:67]
ds_read_b128 a[164:167], v21 offset:17472
v_exp_f32 v73, v73
v_mul_f32 v211, v211, v118
v_mul_f32 v212, v212, v118
v_mul_f32 v213, v213, v118
v_mul_f32 v214, v214, v118
v_mfma_f32_16x16x32_bf16 v[64:67], a[136:139], a[104:107], v[64:67]
ds_read_b128 a[168:171], v21 offset:17536
v_cvt_pk_bf16_f32 v84, v72, v73
v_mul_f32 v215, v215, v118
v_cvt_pk_bf16_f32 v120, v208, v209
v_cvt_pk_bf16_f32 v121, v210, v211
v_cvt_pk_bf16_f32 v122, v212, v213
v_mfma_f32_16x16x32_bf16 v[64:67], a[140:143], a[108:111], v[64:67]
v_exp_f32 v74, v74
v_cvt_pk_bf16_f32 v123, v214, v215
buffer_store_dwordx4 v[120:123], v26, s[24:27], s43 offen offset:0 sc1
v_mul_f32 v216, v216, v118
v_mul_f32 v217, v217, v118
v_mfma_f32_16x16x32_bf16 v[128:131], a[192:195], v[80:83], 0
s_add_u32 m0, s38, 0
v_add_f32 v90, v90, v72
v_add_f32 v91, v91, v73
v_mul_f32 v218, v218, v118
v_mul_f32 v219, v219, v118
v_mul_f32 v220, v220, v118
v_mul_f32 v221, v221, v118
v_mfma_f32_16x16x32_bf16 v[132:135], a[196:199], v[80:83], 0
buffer_load_dwordx4 v24, s[16:19], s39 offen offset:0 nt lds
v_exp_f32 v75, v75
v_mul_f32 v222, v222, v118
v_mul_f32 v223, v223, v118
v_cvt_pk_bf16_f32 v124, v216, v217
v_cvt_pk_bf16_f32 v125, v218, v219
v_mfma_f32_16x16x32_bf16 v[136:139], a[200:203], v[80:83], 0
ds_read_b128 a[172:175], v21 offset:17600
v_cvt_pk_bf16_f32 v85, v74, v75
v_cvt_pk_bf16_f32 v126, v220, v221
v_cvt_pk_bf16_f32 v127, v222, v223
buffer_store_dwordx4 v[124:127], v26, s[24:27], s43 offen offset:1024 sc1
s_mov_b32 s43, 393216
v_mfma_f32_16x16x32_bf16 v[140:143], a[204:207], v[80:83], 0
v_exp_f32 v76, v76
v_mul_f32 v224, v224, v119
v_mul_f32 v225, v225, v119
v_mul_f32 v226, v226, v119
v_mul_f32 v227, v227, v119
v_mfma_f32_16x16x32_bf16 v[68:71], a[144:147], a[96:99], v[104:107]
v_add_f32 v90, v90, v74
v_add_f32 v91, v91, v75
v_mul_f32 v228, v228, v119
v_mul_f32 v229, v229, v119
v_mul_f32 v230, v230, v119
v_mul_f32 v231, v231, v119
v_mfma_f32_16x16x32_bf16 v[68:71], a[148:151], a[100:103], v[68:71]
v_exp_f32 v77, v77
v_cvt_pk_bf16_f32 v120, v224, v225
v_cvt_pk_bf16_f32 v121, v226, v227
v_cvt_pk_bf16_f32 v122, v228, v229
v_cvt_pk_bf16_f32 v123, v230, v231
v_mfma_f32_16x16x32_bf16 v[68:71], a[152:155], a[104:107], v[68:71]
ds_read_b128 a[176:179], v21 offset:21760
v_cvt_pk_bf16_f32 v86, v76, v77
buffer_store_dwordx4 v[120:123], v26, s[24:27], s43 offen offset:0 sc1
v_mul_f32 v232, v232, v119
v_mul_f32 v233, v233, v119
v_mul_f32 v234, v234, v119
v_mfma_f32_16x16x32_bf16 v[68:71], a[156:159], a[108:111], v[68:71]
s_waitcnt lgkmcnt(5)
v_exp_f32 v78, v78
v_mul_f32 v235, v235, v119
v_mul_f32 v236, v236, v119
v_mul_f32 v237, v237, v119
v_mul_f32 v238, v238, v119
v_mfma_f32_16x16x32_bf16 v[144:147], a[208:211], v[80:83], 0
v_add_f32 v90, v90, v76
v_add_f32 v91, v91, v77
v_mul_f32 v239, v239, v119
v_cvt_pk_bf16_f32 v124, v232, v233
v_cvt_pk_bf16_f32 v125, v234, v235
v_cvt_pk_bf16_f32 v126, v236, v237
v_mfma_f32_16x16x32_bf16 v[148:151], a[212:215], v[80:83], 0
v_exp_f32 v79, v79
v_cvt_pk_bf16_f32 v127, v238, v239
buffer_store_dwordx4 v[124:127], v26, s[24:27], s43 offen offset:1024 sc1
v_mfma_f32_16x16x32_bf16 v[152:155], a[216:219], v[80:83], 0
ds_read_b128 a[180:183], v21 offset:21824
v_cvt_pk_bf16_f32 v87, v78, v79
v_mfma_f32_16x16x32_bf16 v[156:159], a[220:223], v[80:83], 0
v_add_f32 v90, v90, v78
v_add_f32 v91, v91, v79
v_mfma_f32_16x16x32_bf16 v[72:75], a[128:131], a[112:115], v[108:111]
ds_read_b128 a[184:187], v21 offset:21888
v_exp_f32 v64, v64
s_mov_b32 s43, 425984
v_mul_f32 v240, v240, v119
v_mfma_f32_16x16x32_bf16 v[72:75], a[132:135], a[116:119], v[72:75]
ds_read_b128 a[188:191], v21 offset:21952
v_exp_f32 v65, v65
v_mul_f32 v241, v241, v119
v_mul_f32 v242, v242, v119
v_mfma_f32_16x16x32_bf16 v[72:75], a[136:139], a[120:123], v[72:75]
ds_read_b64_tr_b16 a[224:225], v22 offset:26112
v_cvt_pk_bf16_f32 v80, v64, v65
v_mul_f32 v243, v243, v119
v_mul_f32 v244, v244, v119
v_mfma_f32_16x16x32_bf16 v[72:75], a[140:143], a[124:127], v[72:75]
v_exp_f32 v66, v66
v_mul_f32 v245, v245, v119
v_mul_f32 v246, v246, v119
v_mfma_f32_16x16x32_bf16 v[160:163], a[192:195], v[84:87], 0
s_add_u32 m0, s38, 8704
v_add_f32 v92, v92, v64
v_add_f32 v93, v93, v65
v_mul_f32 v247, v247, v119
v_cvt_pk_bf16_f32 v120, v240, v241
v_mfma_f32_16x16x32_bf16 v[164:167], a[196:199], v[84:87], 0
buffer_load_dwordx4 v25, s[20:23], s39 offen offset:0 nt lds
v_exp_f32 v67, v67
v_cvt_pk_bf16_f32 v121, v242, v243
v_cvt_pk_bf16_f32 v122, v244, v245
v_mfma_f32_16x16x32_bf16 v[168:171], a[200:203], v[84:87], 0
ds_read_b64_tr_b16 a[226:227], v22 offset:30464
v_cvt_pk_bf16_f32 v81, v66, v67
v_cvt_pk_bf16_f32 v123, v246, v247
buffer_store_dwordx4 v[120:123], v26, s[24:27], s43 offen offset:0 sc1
v_mfma_f32_16x16x32_bf16 v[172:175], a[204:207], v[84:87], 0
v_exp_f32 v68, v68
v_mul_f32 v248, v248, v119
v_mul_f32 v249, v249, v119
v_mfma_f32_16x16x32_bf16 v[76:79], a[144:147], a[112:115], v[108:111]
v_add_f32 v92, v92, v66
v_add_f32 v93, v93, v67
v_mul_f32 v250, v250, v119
v_mul_f32 v251, v251, v119
v_mfma_f32_16x16x32_bf16 v[76:79], a[148:151], a[116:119], v[76:79]
v_exp_f32 v69, v69
v_mul_f32 v252, v252, v119
v_mul_f32 v253, v253, v119
v_mfma_f32_16x16x32_bf16 v[76:79], a[152:155], a[120:123], v[76:79]
ds_read_b64_tr_b16 a[228:229], v23 offset:26144
v_cvt_pk_bf16_f32 v82, v68, v69
v_mul_f32 v254, v254, v119
v_mul_f32 v255, v255, v119
v_mfma_f32_16x16x32_bf16 v[76:79], a[156:159], a[124:127], v[76:79]
v_exp_f32 v70, v70
v_cvt_pk_bf16_f32 v124, v248, v249
v_cvt_pk_bf16_f32 v125, v250, v251
v_mfma_f32_16x16x32_bf16 v[176:179], a[208:211], v[84:87], 0
v_add_f32 v92, v92, v68
v_add_f32 v93, v93, v69
v_cvt_pk_bf16_f32 v126, v252, v253
v_cvt_pk_bf16_f32 v127, v254, v255
v_mfma_f32_16x16x32_bf16 v[180:183], a[212:215], v[84:87], 0
v_exp_f32 v71, v71
buffer_store_dwordx4 v[124:127], v26, s[24:27], s43 offen offset:1024 sc1
v_mfma_f32_16x16x32_bf16 v[184:187], a[216:219], v[84:87], 0
ds_read_b64_tr_b16 a[230:231], v23 offset:30496
v_cvt_pk_bf16_f32 v83, v70, v71
v_mfma_f32_16x16x32_bf16 v[188:191], a[220:223], v[84:87], 0
s_waitcnt lgkmcnt(6)
v_add_f32 v92, v92, v70
v_add_f32 v93, v93, v71
v_mfma_f32_16x16x32_bf16 v[64:67], a[160:163], a[64:67], v[96:99]
ds_read_b64_tr_b16 a[232:233], v22 offset:26176
v_exp_f32 v72, v72
v_mfma_f32_16x16x32_bf16 v[64:67], a[164:167], a[68:71], v[64:67]
ds_read_b64_tr_b16 a[234:235], v22 offset:30528
v_exp_f32 v73, v73
v_mfma_f32_16x16x32_bf16 v[64:67], a[168:171], a[72:75], v[64:67]
ds_read_b64_tr_b16 a[236:237], v23 offset:26208
v_cvt_pk_bf16_f32 v84, v72, v73
v_mfma_f32_16x16x32_bf16 v[64:67], a[172:175], a[76:79], v[64:67]
v_exp_f32 v74, v74
v_mfma_f32_16x16x32_bf16 v[192:195], a[192:195], v[80:83], 0
s_add_u32 m0, s38, 64
v_add_f32 v94, v94, v72
v_add_f32 v95, v95, v73
v_mfma_f32_16x16x32_bf16 v[196:199], a[196:199], v[80:83], 0
buffer_load_dwordx4 v24, s[16:19], s39 offen offset:1024 nt lds
v_exp_f32 v75, v75
v_mfma_f32_16x16x32_bf16 v[200:203], a[200:203], v[80:83], 0
ds_read_b64_tr_b16 a[238:239], v23 offset:30560
v_cvt_pk_bf16_f32 v85, v74, v75
v_mfma_f32_16x16x32_bf16 v[204:207], a[204:207], v[80:83], 0
s_waitcnt lgkmcnt(8)
v_exp_f32 v76, v76
v_mfma_f32_16x16x32_bf16 v[68:71], a[176:179], a[64:67], v[96:99]
v_add_f32 v94, v94, v74
v_add_f32 v95, v95, v75
v_mfma_f32_16x16x32_bf16 v[68:71], a[180:183], a[68:71], v[68:71]
v_exp_f32 v77, v77
v_mfma_f32_16x16x32_bf16 v[68:71], a[184:187], a[72:75], v[68:71]
ds_read_b64_tr_b16 a[240:241], v22 offset:26240
v_cvt_pk_bf16_f32 v86, v76, v77
v_mfma_f32_16x16x32_bf16 v[68:71], a[188:191], a[76:79], v[68:71]
v_exp_f32 v78, v78
v_mfma_f32_16x16x32_bf16 v[208:211], a[208:211], v[80:83], 0
v_add_f32 v94, v94, v76
v_add_f32 v95, v95, v77
v_mfma_f32_16x16x32_bf16 v[212:215], a[212:215], v[80:83], 0
v_exp_f32 v79, v79
v_mfma_f32_16x16x32_bf16 v[216:219], a[216:219], v[80:83], 0
ds_read_b64_tr_b16 a[242:243], v22 offset:30592
v_cvt_pk_bf16_f32 v87, v78, v79
v_mfma_f32_16x16x32_bf16 v[220:223], a[220:223], v[80:83], 0
s_waitcnt lgkmcnt(6)
v_add_f32 v94, v94, v78
v_add_f32 v95, v95, v79
v_mfma_f32_16x16x32_bf16 v[72:75], a[160:163], a[80:83], v[100:103]
ds_read_b64_tr_b16 a[244:245], v23 offset:26272
v_exp_f32 v64, v64
v_mfma_f32_16x16x32_bf16 v[72:75], a[164:167], a[84:87], v[72:75]
ds_read_b64_tr_b16 a[246:247], v23 offset:30624
v_exp_f32 v65, v65
v_mfma_f32_16x16x32_bf16 v[72:75], a[168:171], a[88:91], v[72:75]
ds_read_b64_tr_b16 a[248:249], v22 offset:26304
v_cvt_pk_bf16_f32 v80, v64, v65
v_mfma_f32_16x16x32_bf16 v[72:75], a[172:175], a[92:95], v[72:75]
s_add_u32 s41, s41, 34816
v_exp_f32 v66, v66
v_mfma_f32_16x16x32_bf16 v[224:227], a[192:195], v[84:87], 0
s_add_u32 m0, s38, 9536
v_add_f32 v88, v88, v64
v_add_f32 v89, v89, v65
v_mfma_f32_16x16x32_bf16 v[228:231], a[196:199], v[84:87], 0
s_cmp_eq_u32 s41, 139264
buffer_load_dwordx4 v25, s[20:23], s39 offen offset:256 nt lds
v_exp_f32 v67, v67
v_mfma_f32_16x16x32_bf16 v[232:235], a[200:203], v[84:87], 0
ds_read_b64_tr_b16 a[250:251], v22 offset:30656
v_cvt_pk_bf16_f32 v81, v66, v67
v_mfma_f32_16x16x32_bf16 v[236:239], a[204:207], v[84:87], 0
s_cselect_b32 s41, 0, s41
v_exp_f32 v68, v68
v_mfma_f32_16x16x32_bf16 v[76:79], a[176:179], a[80:83], v[100:103]
v_add_f32 v88, v88, v66
v_add_f32 v89, v89, v67
v_mfma_f32_16x16x32_bf16 v[76:79], a[180:183], a[84:87], v[76:79]
v_exp_f32 v69, v69
v_mfma_f32_16x16x32_bf16 v[76:79], a[184:187], a[88:91], v[76:79]
ds_read_b64_tr_b16 a[252:253], v23 offset:26336
v_cvt_pk_bf16_f32 v82, v68, v69
v_mfma_f32_16x16x32_bf16 v[76:79], a[188:191], a[92:95], v[76:79]
v_exp_f32 v70, v70
v_mfma_f32_16x16x32_bf16 v[240:243], a[208:211], v[84:87], 0
v_add_f32 v88, v88, v68
v_add_f32 v89, v89, v69
v_mfma_f32_16x16x32_bf16 v[244:247], a[212:215], v[84:87], 0
v_exp_f32 v71, v71
v_mfma_f32_16x16x32_bf16 v[248:251], a[216:219], v[84:87], 0
ds_read_b64_tr_b16 a[254:255], v23 offset:30688
v_cvt_pk_bf16_f32 v83, v70, v71
v_mfma_f32_16x16x32_bf16 v[252:255], a[220:223], v[84:87], 0
s_waitcnt lgkmcnt(6)
v_add_u32 v21, s41, v18
v_add_u32 v22, s41, v19
v_add_u32 v23, s41, v20
s_add_u32 s101, s101, 8192
s_add_u32 s100, s100, s92
s_and_b32 s39, s100, 0xf800
s_and_b32 s93, s101, 0x40000
s_or_b32 s39, s39, s93
s_add_u32 s38, s38, 17408
s_cmp_eq_u32 s38, s71
s_cselect_b32 s38, s70, s38
v_add_f32 v88, v88, v70
v_add_f32 v89, v89, v71
s_waitcnt vmcnt(36)
s_barrier
s_cmp_eq_u32 s42, 1
s_cbranch_scc1 L_nbw
s_cmp_eq_u64 s[46:47], 0
s_cbranch_scc1 L_nbw
v_mov_b32 v27, 1
v_mov_b32 v28, 163832
ds_write_b32 v28, v27
L_nbw:
v_mfma_f32_16x16x32_bf16 v[64:67], a[160:163], a[96:99], v[104:107]
ds_read_b128 a[128:131], v21 offset:0
v_exp_f32 v72, v72
v_mfma_f32_16x16x32_bf16 v[64:67], a[164:167], a[100:103], v[64:67]
ds_read_b128 a[132:135], v21 offset:64
v_exp_f32 v73, v73
v_mfma_f32_16x16x32_bf16 v[64:67], a[168:171], a[104:107], v[64:67]
ds_read_b128 a[136:139], v21 offset:128
v_cvt_pk_bf16_f32 v84, v72, v73
v_mfma_f32_16x16x32_bf16 v[64:67], a[172:175], a[108:111], v[64:67]
v_exp_f32 v74, v74
v_mfma_f32_16x16x32_bf16 v[128:131], a[224:227], v[80:83], v[128:131]
s_add_u32 m0, s38, 0
v_add_f32 v90, v90, v72
v_add_f32 v91, v91, v73
v_mfma_f32_16x16x32_bf16 v[132:135], a[228:231], v[80:83], v[132:135]
buffer_load_dwordx4 v24, s[16:19], s39 offen offset:0 nt lds
v_exp_f32 v75, v75
v_mfma_f32_16x16x32_bf16 v[136:139], a[232:235], v[80:83], v[136:139]
ds_read_b128 a[140:143], v21 offset:192
v_cvt_pk_bf16_f32 v85, v74, v75
v_mfma_f32_16x16x32_bf16 v[140:143], a[236:239], v[80:83], v[140:143]
v_exp_f32 v76, v76
v_mfma_f32_16x16x32_bf16 v[68:71], a[176:179], a[96:99], v[104:107]
v_add_f32 v90, v90, v74
v_add_f32 v91, v91, v75
v_mfma_f32_16x16x32_bf16 v[68:71], a[180:183], a[100:103], v[68:71]
v_exp_f32 v77, v77
v_mfma_f32_16x16x32_bf16 v[68:71], a[184:187], a[104:107], v[68:71]
ds_read_b128 a[144:147], v21 offset:4352
v_cvt_pk_bf16_f32 v86, v76, v77
v_mfma_f32_16x16x32_bf16 v[68:71], a[188:191], a[108:111], v[68:71]
s_waitcnt lgkmcnt(5)
v_exp_f32 v78, v78
v_mfma_f32_16x16x32_bf16 v[144:147], a[240:243], v[80:83], v[144:147]
v_add_f32 v90, v90, v76
v_add_f32 v91, v91, v77
v_mfma_f32_16x16x32_bf16 v[148:151], a[244:247], v[80:83], v[148:151]
v_exp_f32 v79, v79
v_mfma_f32_16x16x32_bf16 v[152:155], a[248:251], v[80:83], v[152:155]
ds_read_b128 a[148:151], v21 offset:4416
v_cvt_pk_bf16_f32 v87, v78, v79
v_mfma_f32_16x16x32_bf16 v[156:159], a[252:255], v[80:83], v[156:159]
v_add_f32 v90, v90, v78
v_add_f32 v91, v91, v79
v_mfma_f32_16x16x32_bf16 v[72:75], a[160:163], a[112:115], v[108:111]
ds_read_b128 a[152:155], v21 offset:4480
v_exp_f32 v64, v64
v_mfma_f32_16x16x32_bf16 v[72:75], a[164:167], a[116:119], v[72:75]
ds_read_b128 a[156:159], v21 offset:4544
v_exp_f32 v65, v65
v_mfma_f32_16x16x32_bf16 v[72:75], a[168:171], a[120:123], v[72:75]
ds_read_b64_tr_b16 a[192:193], v22 offset:8704
v_cvt_pk_bf16_f32 v80, v64, v65
v_mfma_f32_16x16x32_bf16 v[72:75], a[172:175], a[124:127], v[72:75]
v_exp_f32 v66, v66
v_mfma_f32_16x16x32_bf16 v[160:163], a[224:227], v[84:87], v[160:163]
s_add_u32 m0, s38, 8704
v_add_f32 v92, v92, v64
v_add_f32 v93, v93, v65
v_mfma_f32_16x16x32_bf16 v[164:167], a[228:231], v[84:87], v[164:167]
buffer_load_dwordx4 v25, s[20:23], s39 offen offset:0 nt lds
v_exp_f32 v67, v67
v_mfma_f32_16x16x32_bf16 v[168:171], a[232:235], v[84:87], v[168:171]
ds_read_b64_tr_b16 a[194:195], v22 offset:13056
v_cvt_pk_bf16_f32 v81, v66, v67
v_mfma_f32_16x16x32_bf16 v[172:175], a[236:239], v[84:87], v[172:175]
v_exp_f32 v68, v68
v_mfma_f32_16x16x32_bf16 v[76:79], a[176:179], a[112:115], v[108:111]
v_add_f32 v92, v92, v66
v_add_f32 v93, v93, v67
v_mfma_f32_16x16x32_bf16 v[76:79], a[180:183], a[116:119], v[76:79]
v_exp_f32 v69, v69
v_mfma_f32_16x16x32_bf16 v[76:79], a[184:187], a[120:123], v[76:79]
ds_read_b64_tr_b16 a[196:197], v23 offset:8736
v_cvt_pk_bf16_f32 v82, v68, v69
v_mfma_f32_16x16x32_bf16 v[76:79], a[188:191], a[124:127], v[76:79]
v_exp_f32 v70, v70
v_mfma_f32_16x16x32_bf16 v[176:179], a[240:243], v[84:87], v[176:179]
v_add_f32 v92, v92, v68
v_add_f32 v93, v93, v69
v_mfma_f32_16x16x32_bf16 v[180:183], a[244:247], v[84:87], v[180:183]
v_exp_f32 v71, v71
v_mfma_f32_16x16x32_bf16 v[184:187], a[248:251], v[84:87], v[184:187]
ds_read_b64_tr_b16 a[198:199], v23 offset:13088
v_cvt_pk_bf16_f32 v83, v70, v71
v_mfma_f32_16x16x32_bf16 v[188:191], a[252:255], v[84:87], v[188:191]
s_waitcnt lgkmcnt(6)
v_add_f32 v92, v92, v70
v_add_f32 v93, v93, v71
v_mfma_f32_16x16x32_bf16 v[64:67], a[128:131], a[64:67], v[96:99]
ds_read_b64_tr_b16 a[200:201], v22 offset:8768
v_exp_f32 v72, v72
v_mfma_f32_16x16x32_bf16 v[64:67], a[132:135], a[68:71], v[64:67]
ds_read_b64_tr_b16 a[202:203], v22 offset:13120
v_exp_f32 v73, v73
v_mfma_f32_16x16x32_bf16 v[64:67], a[136:139], a[72:75], v[64:67]
ds_read_b64_tr_b16 a[204:205], v23 offset:8800
v_cvt_pk_bf16_f32 v84, v72, v73
v_mfma_f32_16x16x32_bf16 v[64:67], a[140:143], a[76:79], v[64:67]
v_exp_f32 v74, v74
v_mfma_f32_16x16x32_bf16 v[192:195], a[224:227], v[80:83], v[192:195]
s_add_u32 m0, s38, 64
v_add_f32 v94, v94, v72
v_add_f32 v95, v95, v73
v_mfma_f32_16x16x32_bf16 v[196:199], a[228:231], v[80:83], v[196:199]
buffer_load_dwordx4 v24, s[16:19], s39 offen offset:1024 nt lds
v_exp_f32 v75, v75
v_mfma_f32_16x16x32_bf16 v[200:203], a[232:235], v[80:83], v[200:203]
ds_read_b64_tr_b16 a[206:207], v23 offset:13152
v_cvt_pk_bf16_f32 v85, v74, v75
v_mfma_f32_16x16x32_bf16 v[204:207], a[236:239], v[80:83], v[204:207]
s_waitcnt lgkmcnt(8)
v_exp_f32 v76, v76
v_mfma_f32_16x16x32_bf16 v[68:71], a[144:147], a[64:67], v[96:99]
v_add_f32 v94, v94, v74
v_add_f32 v95, v95, v75
v_mfma_f32_16x16x32_bf16 v[68:71], a[148:151], a[68:71], v[68:71]
v_exp_f32 v77, v77
v_mfma_f32_16x16x32_bf16 v[68:71], a[152:155], a[72:75], v[68:71]
ds_read_b64_tr_b16 a[208:209], v22 offset:8832
v_cvt_pk_bf16_f32 v86, v76, v77
v_mfma_f32_16x16x32_bf16 v[68:71], a[156:159], a[76:79], v[68:71]
v_exp_f32 v78, v78
v_mfma_f32_16x16x32_bf16 v[208:211], a[240:243], v[80:83], v[208:211]
v_add_f32 v94, v94, v76
v_add_f32 v95, v95, v77
v_mfma_f32_16x16x32_bf16 v[212:215], a[244:247], v[80:83], v[212:215]
v_exp_f32 v79, v79
v_mfma_f32_16x16x32_bf16 v[216:219], a[248:251], v[80:83], v[216:219]
ds_read_b64_tr_b16 a[210:211], v22 offset:13184
v_cvt_pk_bf16_f32 v87, v78, v79
v_mfma_f32_16x16x32_bf16 v[220:223], a[252:255], v[80:83], v[220:223]
s_waitcnt lgkmcnt(6)
v_add_f32 v94, v94, v78
v_add_f32 v95, v95, v79
v_mfma_f32_16x16x32_bf16 v[72:75], a[128:131], a[80:83], v[100:103]
ds_read_b64_tr_b16 a[212:213], v23 offset:8864
v_exp_f32 v64, v64
v_mfma_f32_16x16x32_bf16 v[72:75], a[132:135], a[84:87], v[72:75]
ds_read_b64_tr_b16 a[214:215], v23 offset:13216
v_exp_f32 v65, v65
v_mfma_f32_16x16x32_bf16 v[72:75], a[136:139], a[88:91], v[72:75]
ds_read_b64_tr_b16 a[216:217], v22 offset:8896
v_cvt_pk_bf16_f32 v80, v64, v65
v_mfma_f32_16x16x32_bf16 v[72:75], a[140:143], a[92:95], v[72:75]
v_exp_f32 v66, v66
v_mfma_f32_16x16x32_bf16 v[224:227], a[224:227], v[84:87], v[224:227]
s_add_u32 m0, s38, 9536
v_add_f32 v88, v88, v64
v_add_f32 v89, v89, v65
v_mfma_f32_16x16x32_bf16 v[228:231], a[228:231], v[84:87], v[228:231]
buffer_load_dwordx4 v25, s[20:23], s39 offen offset:256 nt lds
v_exp_f32 v67, v67
v_mfma_f32_16x16x32_bf16 v[232:235], a[232:235], v[84:87], v[232:235]
ds_read_b64_tr_b16 a[218:219], v22 offset:13248
v_cvt_pk_bf16_f32 v81, v66, v67
v_mfma_f32_16x16x32_bf16 v[236:239], a[236:239], v[84:87], v[236:239]
v_exp_f32 v68, v68
v_mfma_f32_16x16x32_bf16 v[76:79], a[144:147], a[80:83], v[100:103]
v_add_f32 v88, v88, v66
v_add_f32 v89, v89, v67
v_mfma_f32_16x16x32_bf16 v[76:79], a[148:151], a[84:87], v[76:79]
v_exp_f32 v69, v69
v_mfma_f32_16x16x32_bf16 v[76:79], a[152:155], a[88:91], v[76:79]
ds_read_b64_tr_b16 a[220:221], v23 offset:8928
v_cvt_pk_bf16_f32 v82, v68, v69
v_mfma_f32_16x16x32_bf16 v[76:79], a[156:159], a[92:95], v[76:79]
v_exp_f32 v70, v70
v_mfma_f32_16x16x32_bf16 v[240:243], a[240:243], v[84:87], v[240:243]
v_add_f32 v88, v88, v68
v_add_f32 v89, v89, v69
v_mfma_f32_16x16x32_bf16 v[244:247], a[244:247], v[84:87], v[244:247]
v_exp_f32 v71, v71
v_mfma_f32_16x16x32_bf16 v[248:251], a[248:251], v[84:87], v[248:251]
ds_read_b64_tr_b16 a[222:223], v23 offset:13280
v_cvt_pk_bf16_f32 v83, v70, v71
v_mfma_f32_16x16x32_bf16 v[252:255], a[252:255], v[84:87], v[252:255]
s_waitcnt lgkmcnt(6)
s_add_u32 s101, s101, 8192
s_add_u32 s100, s100, s92
s_and_b32 s39, s100, 0xf800
s_and_b32 s93, s101, 0x40000
s_or_b32 s39, s39, s93
s_add_u32 s38, s38, 17408
s_cmp_eq_u32 s38, s71
s_cselect_b32 s38, s70, s38
v_add_f32 v88, v88, v70
v_add_f32 v89, v89, v71
s_waitcnt vmcnt(36)
s_barrier
v_mfma_f32_16x16x32_bf16 v[64:67], a[128:131], a[96:99], v[104:107]
ds_read_b128 a[160:163], v21 offset:17408
v_exp_f32 v72, v72
v_mfma_f32_16x16x32_bf16 v[64:67], a[132:135], a[100:103], v[64:67]
ds_read_b128 a[164:167], v21 offset:17472
v_exp_f32 v73, v73
v_mfma_f32_16x16x32_bf16 v[64:67], a[136:139], a[104:107], v[64:67]
ds_read_b128 a[168:171], v21 offset:17536
v_cvt_pk_bf16_f32 v84, v72, v73
v_mfma_f32_16x16x32_bf16 v[64:67], a[140:143], a[108:111], v[64:67]
v_exp_f32 v74, v74
v_mfma_f32_16x16x32_bf16 v[128:131], a[192:195], v[80:83], v[128:131]
s_add_u32 m0, s38, 0
v_add_f32 v90, v90, v72
v_add_f32 v91, v91, v73
v_mfma_f32_16x16x32_bf16 v[132:135], a[196:199], v[80:83], v[132:135]
buffer_load_dwordx4 v24, s[16:19], s39 offen offset:0 nt lds
v_exp_f32 v75, v75
v_mfma_f32_16x16x32_bf16 v[136:139], a[200:203], v[80:83], v[136:139]
ds_read_b128 a[172:175], v21 offset:17600
v_cvt_pk_bf16_f32 v85, v74, v75
v_mfma_f32_16x16x32_bf16 v[140:143], a[204:207], v[80:83], v[140:143]
v_exp_f32 v76, v76
v_mfma_f32_16x16x32_bf16 v[68:71], a[144:147], a[96:99], v[104:107]
v_add_f32 v90, v90, v74
v_add_f32 v91, v91, v75
v_mfma_f32_16x16x32_bf16 v[68:71], a[148:151], a[100:103], v[68:71]
v_exp_f32 v77, v77
v_mfma_f32_16x16x32_bf16 v[68:71], a[152:155], a[104:107], v[68:71]
ds_read_b128 a[176:179], v21 offset:21760
v_cvt_pk_bf16_f32 v86, v76, v77
v_mfma_f32_16x16x32_bf16 v[68:71], a[156:159], a[108:111], v[68:71]
s_waitcnt lgkmcnt(5)
v_exp_f32 v78, v78
v_mfma_f32_16x16x32_bf16 v[144:147], a[208:211], v[80:83], v[144:147]
v_add_f32 v90, v90, v76
v_add_f32 v91, v91, v77
v_mfma_f32_16x16x32_bf16 v[148:151], a[212:215], v[80:83], v[148:151]
v_exp_f32 v79, v79
v_mfma_f32_16x16x32_bf16 v[152:155], a[216:219], v[80:83], v[152:155]
ds_read_b128 a[180:183], v21 offset:21824
v_cvt_pk_bf16_f32 v87, v78, v79
v_mfma_f32_16x16x32_bf16 v[156:159], a[220:223], v[80:83], v[156:159]
v_add_f32 v90, v90, v78
v_add_f32 v91, v91, v79
v_mfma_f32_16x16x32_bf16 v[72:75], a[128:131], a[112:115], v[108:111]
ds_read_b128 a[184:187], v21 offset:21888
v_exp_f32 v64, v64
v_mfma_f32_16x16x32_bf16 v[72:75], a[132:135], a[116:119], v[72:75]
ds_read_b128 a[188:191], v21 offset:21952
v_exp_f32 v65, v65
v_mfma_f32_16x16x32_bf16 v[72:75], a[136:139], a[120:123], v[72:75]
ds_read_b64_tr_b16 a[224:225], v22 offset:26112
v_cvt_pk_bf16_f32 v80, v64, v65
v_mfma_f32_16x16x32_bf16 v[72:75], a[140:143], a[124:127], v[72:75]
v_exp_f32 v66, v66
v_mfma_f32_16x16x32_bf16 v[160:163], a[192:195], v[84:87], v[160:163]
s_add_u32 m0, s38, 8704
v_add_f32 v92, v92, v64
v_add_f32 v93, v93, v65
v_mfma_f32_16x16x32_bf16 v[164:167], a[196:199], v[84:87], v[164:167]
buffer_load_dwordx4 v25, s[20:23], s39 offen offset:0 nt lds
v_exp_f32 v67, v67
v_mfma_f32_16x16x32_bf16 v[168:171], a[200:203], v[84:87], v[168:171]
ds_read_b64_tr_b16 a[226:227], v22 offset:30464
v_cvt_pk_bf16_f32 v81, v66, v67
v_mfma_f32_16x16x32_bf16 v[172:175], a[204:207], v[84:87], v[172:175]
v_exp_f32 v68, v68
v_mfma_f32_16x16x32_bf16 v[76:79], a[144:147], a[112:115], v[108:111]
v_add_f32 v92, v92, v66
v_add_f32 v93, v93, v67
v_mfma_f32_16x16x32_bf16 v[76:79], a[148:151], a[116:119], v[76:79]
v_exp_f32 v69, v69
v_mfma_f32_16x16x32_bf16 v[76:79], a[152:155], a[120:123], v[76:79]
ds_read_b64_tr_b16 a[228:229], v23 offset:26144
v_cvt_pk_bf16_f32 v82, v68, v69
v_mfma_f32_16x16x32_bf16 v[76:79], a[156:159], a[124:127], v[76:79]
v_exp_f32 v70, v70
v_mfma_f32_16x16x32_bf16 v[176:179], a[208:211], v[84:87], v[176:179]
v_add_f32 v92, v92, v68
v_add_f32 v93, v93, v69
v_mfma_f32_16x16x32_bf16 v[180:183], a[212:215], v[84:87], v[180:183]
v_exp_f32 v71, v71
v_mfma_f32_16x16x32_bf16 v[184:187], a[216:219], v[84:87], v[184:187]
ds_read_b64_tr_b16 a[230:231], v23 offset:30496
v_cvt_pk_bf16_f32 v83, v70, v71
v_mfma_f32_16x16x32_bf16 v[188:191], a[220:223], v[84:87], v[188:191]
s_waitcnt lgkmcnt(6)
v_add_f32 v92, v92, v70
v_add_f32 v93, v93, v71
v_mfma_f32_16x16x32_bf16 v[64:67], a[160:163], a[64:67], v[96:99]
ds_read_b64_tr_b16 a[232:233], v22 offset:26176
v_exp_f32 v72, v72
v_mfma_f32_16x16x32_bf16 v[64:67], a[164:167], a[68:71], v[64:67]
ds_read_b64_tr_b16 a[234:235], v22 offset:30528
v_exp_f32 v73, v73
v_mfma_f32_16x16x32_bf16 v[64:67], a[168:171], a[72:75], v[64:67]
ds_read_b64_tr_b16 a[236:237], v23 offset:26208
v_cvt_pk_bf16_f32 v84, v72, v73
v_mfma_f32_16x16x32_bf16 v[64:67], a[172:175], a[76:79], v[64:67]
v_exp_f32 v74, v74
v_mfma_f32_16x16x32_bf16 v[192:195], a[192:195], v[80:83], v[192:195]
s_add_u32 m0, s38, 64
v_add_f32 v94, v94, v72
v_add_f32 v95, v95, v73
v_mfma_f32_16x16x32_bf16 v[196:199], a[196:199], v[80:83], v[196:199]
buffer_load_dwordx4 v24, s[16:19], s39 offen offset:1024 nt lds
v_exp_f32 v75, v75
v_mfma_f32_16x16x32_bf16 v[200:203], a[200:203], v[80:83], v[200:203]
ds_read_b64_tr_b16 a[238:239], v23 offset:30560
v_cvt_pk_bf16_f32 v85, v74, v75
v_mfma_f32_16x16x32_bf16 v[204:207], a[204:207], v[80:83], v[204:207]
s_waitcnt lgkmcnt(8)
v_exp_f32 v76, v76
v_mfma_f32_16x16x32_bf16 v[68:71], a[176:179], a[64:67], v[96:99]
v_add_f32 v94, v94, v74
v_add_f32 v95, v95, v75
v_mfma_f32_16x16x32_bf16 v[68:71], a[180:183], a[68:71], v[68:71]
v_exp_f32 v77, v77
v_mfma_f32_16x16x32_bf16 v[68:71], a[184:187], a[72:75], v[68:71]
ds_read_b64_tr_b16 a[240:241], v22 offset:26240
v_cvt_pk_bf16_f32 v86, v76, v77
v_mfma_f32_16x16x32_bf16 v[68:71], a[188:191], a[76:79], v[68:71]
v_exp_f32 v78, v78
v_mfma_f32_16x16x32_bf16 v[208:211], a[208:211], v[80:83], v[208:211]
v_add_f32 v94, v94, v76
v_add_f32 v95, v95, v77
v_mfma_f32_16x16x32_bf16 v[212:215], a[212:215], v[80:83], v[212:215]
v_exp_f32 v79, v79
v_mfma_f32_16x16x32_bf16 v[216:219], a[216:219], v[80:83], v[216:219]
ds_read_b64_tr_b16 a[242:243], v22 offset:30592
v_cvt_pk_bf16_f32 v87, v78, v79
v_mfma_f32_16x16x32_bf16 v[220:223], a[220:223], v[80:83], v[220:223]
s_waitcnt lgkmcnt(6)
v_add_f32 v94, v94, v78
v_add_f32 v95, v95, v79
v_mfma_f32_16x16x32_bf16 v[72:75], a[160:163], a[80:83], v[100:103]
ds_read_b64_tr_b16 a[244:245], v23 offset:26272
v_exp_f32 v64, v64
v_mfma_f32_16x16x32_bf16 v[72:75], a[164:167], a[84:87], v[72:75]
ds_read_b64_tr_b16 a[246:247], v23 offset:30624
v_exp_f32 v65, v65
v_mfma_f32_16x16x32_bf16 v[72:75], a[168:171], a[88:91], v[72:75]
ds_read_b64_tr_b16 a[248:249], v22 offset:26304
v_cvt_pk_bf16_f32 v80, v64, v65
v_mfma_f32_16x16x32_bf16 v[72:75], a[172:175], a[92:95], v[72:75]
s_add_u32 s41, s41, 34816
v_exp_f32 v66, v66
v_mfma_f32_16x16x32_bf16 v[224:227], a[192:195], v[84:87], v[224:227]
s_add_u32 m0, s38, 9536
v_add_f32 v88, v88, v64
v_add_f32 v89, v89, v65
v_mfma_f32_16x16x32_bf16 v[228:231], a[196:199], v[84:87], v[228:231]
s_cmp_eq_u32 s41, 139264
buffer_load_dwordx4 v25, s[20:23], s39 offen offset:256 nt lds
v_exp_f32 v67, v67
v_mfma_f32_16x16x32_bf16 v[232:235], a[200:203], v[84:87], v[232:235]
ds_read_b64_tr_b16 a[250:251], v22 offset:30656
v_cvt_pk_bf16_f32 v81, v66, v67
v_mfma_f32_16x16x32_bf16 v[236:239], a[204:207], v[84:87], v[236:239]
s_cselect_b32 s41, 0, s41
v_exp_f32 v68, v68
v_mfma_f32_16x16x32_bf16 v[76:79], a[176:179], a[80:83], v[100:103]
v_add_f32 v88, v88, v66
v_add_f32 v89, v89, v67
v_mfma_f32_16x16x32_bf16 v[76:79], a[180:183], a[84:87], v[76:79]
v_exp_f32 v69, v69
v_mfma_f32_16x16x32_bf16 v[76:79], a[184:187], a[88:91], v[76:79]
ds_read_b64_tr_b16 a[252:253], v23 offset:26336
v_cvt_pk_bf16_f32 v82, v68, v69
v_mfma_f32_16x16x32_bf16 v[76:79], a[188:191], a[92:95], v[76:79]
v_exp_f32 v70, v70
v_mfma_f32_16x16x32_bf16 v[240:243], a[208:211], v[84:87], v[240:243]
v_add_f32 v88, v88, v68
v_add_f32 v89, v89, v69
v_mfma_f32_16x16x32_bf16 v[244:247], a[212:215], v[84:87], v[244:247]
v_exp_f32 v71, v71
v_mfma_f32_16x16x32_bf16 v[248:251], a[216:219], v[84:87], v[248:251]
ds_read_b64_tr_b16 a[254:255], v23 offset:30688
v_cvt_pk_bf16_f32 v83, v70, v71
v_mfma_f32_16x16x32_bf16 v[252:255], a[220:223], v[84:87], v[252:255]
s_waitcnt lgkmcnt(6)
v_add_u32 v21, s41, v18
v_add_u32 v22, s41, v19
v_add_u32 v23, s41, v20
s_add_u32 s101, s101, 8192
s_add_u32 s100, s100, s92
s_and_b32 s39, s100, 0xf800
s_and_b32 s93, s101, 0x40000
s_or_b32 s39, s39, s93
s_add_u32 s38, s38, 17408
s_cmp_eq_u32 s38, s71
s_cselect_b32 s38, s70, s38
s_sub_u32 s32, s32, 1
s_cmp_lg_u32 s32, 0
v_add_f32 v88, v88, v70
v_add_f32 v89, v89, v71
s_waitcnt vmcnt(36)
s_barrier
v_mfma_f32_16x16x32_bf16 v[64:67], a[160:163], a[96:99], v[104:107]
ds_read_b128 a[128:131], v21 offset:0
v_exp_f32 v72, v72
v_mfma_f32_16x16x32_bf16 v[64:67], a[164:167], a[100:103], v[64:67]
ds_read_b128 a[132:135], v21 offset:64
v_exp_f32 v73, v73
v_mfma_f32_16x16x32_bf16 v[64:67], a[168:171], a[104:107], v[64:67]
ds_read_b128 a[136:139], v21 offset:128
v_cvt_pk_bf16_f32 v84, v72, v73
v_mfma_f32_16x16x32_bf16 v[64:67], a[172:175], a[108:111], v[64:67]
v_exp_f32 v74, v74
v_mfma_f32_16x16x32_bf16 v[128:131], a[224:227], v[80:83], v[128:131]
s_add_u32 m0, s38, 0
v_add_f32 v90, v90, v72
v_add_f32 v91, v91, v73
v_mfma_f32_16x16x32_bf16 v[132:135], a[228:231], v[80:83], v[132:135]
buffer_load_dwordx4 v24, s[16:19], s39 offen offset:0 nt lds
v_exp_f32 v75, v75
v_mfma_f32_16x16x32_bf16 v[136:139], a[232:235], v[80:83], v[136:139]
ds_read_b128 a[140:143], v21 offset:192
v_cvt_pk_bf16_f32 v85, v74, v75
v_mfma_f32_16x16x32_bf16 v[140:143], a[236:239], v[80:83], v[140:143]
v_exp_f32 v76, v76
v_mfma_f32_16x16x32_bf16 v[68:71], a[176:179], a[96:99], v[104:107]
v_add_f32 v90, v90, v74
v_add_f32 v91, v91, v75
v_mfma_f32_16x16x32_bf16 v[68:71], a[180:183], a[100:103], v[68:71]
v_exp_f32 v77, v77
v_mfma_f32_16x16x32_bf16 v[68:71], a[184:187], a[104:107], v[68:71]
ds_read_b128 a[144:147], v21 offset:4352
v_cvt_pk_bf16_f32 v86, v76, v77
v_mfma_f32_16x16x32_bf16 v[68:71], a[188:191], a[108:111], v[68:71]
s_waitcnt lgkmcnt(5)
v_exp_f32 v78, v78
v_mfma_f32_16x16x32_bf16 v[144:147], a[240:243], v[80:83], v[144:147]
v_add_f32 v90, v90, v76
v_add_f32 v91, v91, v77
v_mfma_f32_16x16x32_bf16 v[148:151], a[244:247], v[80:83], v[148:151]
v_exp_f32 v79, v79
v_mfma_f32_16x16x32_bf16 v[152:155], a[248:251], v[80:83], v[152:155]
ds_read_b128 a[148:151], v21 offset:4416
v_cvt_pk_bf16_f32 v87, v78, v79
v_mfma_f32_16x16x32_bf16 v[156:159], a[252:255], v[80:83], v[156:159]
v_add_f32 v90, v90, v78
v_add_f32 v91, v91, v79
v_mfma_f32_16x16x32_bf16 v[72:75], a[160:163], a[112:115], v[108:111]
ds_read_b128 a[152:155], v21 offset:4480
v_exp_f32 v64, v64
v_mfma_f32_16x16x32_bf16 v[72:75], a[164:167], a[116:119], v[72:75]
ds_read_b128 a[156:159], v21 offset:4544
v_exp_f32 v65, v65
v_mfma_f32_16x16x32_bf16 v[72:75], a[168:171], a[120:123], v[72:75]
ds_read_b64_tr_b16 a[192:193], v22 offset:8704
v_cvt_pk_bf16_f32 v80, v64, v65
v_mfma_f32_16x16x32_bf16 v[72:75], a[172:175], a[124:127], v[72:75]
v_exp_f32 v66, v66
v_mfma_f32_16x16x32_bf16 v[160:163], a[224:227], v[84:87], v[160:163]
s_add_u32 m0, s38, 8704
v_add_f32 v92, v92, v64
v_add_f32 v93, v93, v65
v_mfma_f32_16x16x32_bf16 v[164:167], a[228:231], v[84:87], v[164:167]
buffer_load_dwordx4 v25, s[20:23], s39 offen offset:0 nt lds
v_exp_f32 v67, v67
v_mfma_f32_16x16x32_bf16 v[168:171], a[232:235], v[84:87], v[168:171]
ds_read_b64_tr_b16 a[194:195], v22 offset:13056
v_cvt_pk_bf16_f32 v81, v66, v67
v_mfma_f32_16x16x32_bf16 v[172:175], a[236:239], v[84:87], v[172:175]
v_exp_f32 v68, v68
v_mfma_f32_16x16x32_bf16 v[76:79], a[176:179], a[112:115], v[108:111]
v_add_f32 v92, v92, v66
v_add_f32 v93, v93, v67
v_mfma_f32_16x16x32_bf16 v[76:79], a[180:183], a[116:119], v[76:79]
v_exp_f32 v69, v69
v_mfma_f32_16x16x32_bf16 v[76:79], a[184:187], a[120:123], v[76:79]
ds_read_b64_tr_b16 a[196:197], v23 offset:8736
v_cvt_pk_bf16_f32 v82, v68, v69
v_mfma_f32_16x16x32_bf16 v[76:79], a[188:191], a[124:127], v[76:79]
v_exp_f32 v70, v70
v_mfma_f32_16x16x32_bf16 v[176:179], a[240:243], v[84:87], v[176:179]
v_add_f32 v92, v92, v68
v_add_f32 v93, v93, v69
v_mfma_f32_16x16x32_bf16 v[180:183], a[244:247], v[84:87], v[180:183]
v_exp_f32 v71, v71
v_mfma_f32_16x16x32_bf16 v[184:187], a[248:251], v[84:87], v[184:187]
ds_read_b64_tr_b16 a[198:199], v23 offset:13088
v_cvt_pk_bf16_f32 v83, v70, v71
v_mfma_f32_16x16x32_bf16 v[188:191], a[252:255], v[84:87], v[188:191]
s_waitcnt lgkmcnt(6)
v_add_f32 v92, v92, v70
v_add_f32 v93, v93, v71
v_mfma_f32_16x16x32_bf16 v[64:67], a[128:131], a[64:67], v[96:99]
ds_read_b64_tr_b16 a[200:201], v22 offset:8768
v_exp_f32 v72, v72
v_mfma_f32_16x16x32_bf16 v[64:67], a[132:135], a[68:71], v[64:67]
ds_read_b64_tr_b16 a[202:203], v22 offset:13120
v_exp_f32 v73, v73
v_mfma_f32_16x16x32_bf16 v[64:67], a[136:139], a[72:75], v[64:67]
ds_read_b64_tr_b16 a[204:205], v23 offset:8800
v_cvt_pk_bf16_f32 v84, v72, v73
v_mfma_f32_16x16x32_bf16 v[64:67], a[140:143], a[76:79], v[64:67]
v_exp_f32 v74, v74
v_mfma_f32_16x16x32_bf16 v[192:195], a[224:227], v[80:83], v[192:195]
s_add_u32 m0, s38, 64
v_add_f32 v94, v94, v72
v_add_f32 v95, v95, v73
v_mfma_f32_16x16x32_bf16 v[196:199], a[228:231], v[80:83], v[196:199]
buffer_load_dwordx4 v24, s[16:19], s39 offen offset:1024 nt lds
v_exp_f32 v75, v75
v_mfma_f32_16x16x32_bf16 v[200:203], a[232:235], v[80:83], v[200:203]
ds_read_b64_tr_b16 a[206:207], v23 offset:13152
v_cvt_pk_bf16_f32 v85, v74, v75
v_mfma_f32_16x16x32_bf16 v[204:207], a[236:239], v[80:83], v[204:207]
s_waitcnt lgkmcnt(8)
v_exp_f32 v76, v76
v_mfma_f32_16x16x32_bf16 v[68:71], a[144:147], a[64:67], v[96:99]
v_add_f32 v94, v94, v74
v_add_f32 v95, v95, v75
v_mfma_f32_16x16x32_bf16 v[68:71], a[148:151], a[68:71], v[68:71]
v_exp_f32 v77, v77
v_mfma_f32_16x16x32_bf16 v[68:71], a[152:155], a[72:75], v[68:71]
ds_read_b64_tr_b16 a[208:209], v22 offset:8832
v_cvt_pk_bf16_f32 v86, v76, v77
v_mfma_f32_16x16x32_bf16 v[68:71], a[156:159], a[76:79], v[68:71]
v_exp_f32 v78, v78
v_mfma_f32_16x16x32_bf16 v[208:211], a[240:243], v[80:83], v[208:211]
v_add_f32 v94, v94, v76
v_add_f32 v95, v95, v77
v_mfma_f32_16x16x32_bf16 v[212:215], a[244:247], v[80:83], v[212:215]
v_exp_f32 v79, v79
v_mfma_f32_16x16x32_bf16 v[216:219], a[248:251], v[80:83], v[216:219]
ds_read_b64_tr_b16 a[210:211], v22 offset:13184
v_cvt_pk_bf16_f32 v87, v78, v79
v_mfma_f32_16x16x32_bf16 v[220:223], a[252:255], v[80:83], v[220:223]
s_waitcnt lgkmcnt(6)
v_add_f32 v94, v94, v78
v_add_f32 v95, v95, v79
v_mfma_f32_16x16x32_bf16 v[72:75], a[128:131], a[80:83], v[100:103]
ds_read_b64_tr_b16 a[212:213], v23 offset:8864
v_exp_f32 v64, v64
v_mfma_f32_16x16x32_bf16 v[72:75], a[132:135], a[84:87], v[72:75]
ds_read_b64_tr_b16 a[214:215], v23 offset:13216
v_exp_f32 v65, v65
v_mfma_f32_16x16x32_bf16 v[72:75], a[136:139], a[88:91], v[72:75]
ds_read_b64_tr_b16 a[216:217], v22 offset:8896
v_cvt_pk_bf16_f32 v80, v64, v65
v_mfma_f32_16x16x32_bf16 v[72:75], a[140:143], a[92:95], v[72:75]
v_exp_f32 v66, v66
v_mfma_f32_16x16x32_bf16 v[224:227], a[224:227], v[84:87], v[224:227]
s_add_u32 m0, s38, 9536
v_add_f32 v88, v88, v64
v_add_f32 v89, v89, v65
v_mfma_f32_16x16x32_bf16 v[228:231], a[228:231], v[84:87], v[228:231]
buffer_load_dwordx4 v25, s[20:23], s39 offen offset:256 nt lds
v_exp_f32 v67, v67
v_mfma_f32_16x16x32_bf16 v[232:235], a[232:235], v[84:87], v[232:235]
ds_read_b64_tr_b16 a[218:219], v22 offset:13248
v_cvt_pk_bf16_f32 v81, v66, v67
v_mfma_f32_16x16x32_bf16 v[236:239], a[236:239], v[84:87], v[236:239]
v_exp_f32 v68, v68
v_mfma_f32_16x16x32_bf16 v[76:79], a[144:147], a[80:83], v[100:103]
v_add_f32 v88, v88, v66
v_add_f32 v89, v89, v67
v_mfma_f32_16x16x32_bf16 v[76:79], a[148:151], a[84:87], v[76:79]
v_exp_f32 v69, v69
v_mfma_f32_16x16x32_bf16 v[76:79], a[152:155], a[88:91], v[76:79]
ds_read_b64_tr_b16 a[220:221], v23 offset:8928
v_cvt_pk_bf16_f32 v82, v68, v69
v_mfma_f32_16x16x32_bf16 v[76:79], a[156:159], a[92:95], v[76:79]
v_exp_f32 v70, v70
v_mfma_f32_16x16x32_bf16 v[240:243], a[240:243], v[84:87], v[240:243]
v_add_f32 v88, v88, v68
v_add_f32 v89, v89, v69
v_mfma_f32_16x16x32_bf16 v[244:247], a[244:247], v[84:87], v[244:247]
v_exp_f32 v71, v71
v_mfma_f32_16x16x32_bf16 v[248:251], a[248:251], v[84:87], v[248:251]
ds_read_b64_tr_b16 a[222:223], v23 offset:13280
v_cvt_pk_bf16_f32 v83, v70, v71
v_mfma_f32_16x16x32_bf16 v[252:255], a[252:255], v[84:87], v[252:255]
s_waitcnt lgkmcnt(6)
s_add_u32 s101, s101, 8192
s_add_u32 s100, s100, s92
s_and_b32 s39, s100, 0xf800
s_and_b32 s93, s101, 0x40000
s_or_b32 s39, s39, s93
s_add_u32 s38, s38, 17408
s_cmp_eq_u32 s38, s71
s_cselect_b32 s38, s70, s38
v_add_f32 v88, v88, v70
v_add_f32 v89, v89, v71
s_waitcnt vmcnt(36)
s_barrier
v_mov_b32 v28, 163832
ds_read_b32 v29, v28
v_mfma_f32_16x16x32_bf16 v[64:67], a[128:131], a[96:99], v[104:107]
ds_read_b128 a[160:163], v21 offset:17408
v_exp_f32 v72, v72
v_mfma_f32_16x16x32_bf16 v[64:67], a[132:135], a[100:103], v[64:67]
ds_read_b128 a[164:167], v21 offset:17472
v_exp_f32 v73, v73
v_mfma_f32_16x16x32_bf16 v[64:67], a[136:139], a[104:107], v[64:67]
ds_read_b128 a[168:171], v21 offset:17536
v_cvt_pk_bf16_f32 v84, v72, v73
v_mfma_f32_16x16x32_bf16 v[64:67], a[140:143], a[108:111], v[64:67]
v_exp_f32 v74, v74
v_mfma_f32_16x16x32_bf16 v[128:131], a[192:195], v[80:83], v[128:131]
s_add_u32 m0, s38, 0
v_add_f32 v90, v90, v72
v_add_f32 v91, v91, v73
v_mfma_f32_16x16x32_bf16 v[132:135], a[196:199], v[80:83], v[132:135]
buffer_load_dwordx4 v24, s[16:19], s39 offen offset:0 nt lds
v_exp_f32 v75, v75
v_mfma_f32_16x16x32_bf16 v[136:139], a[200:203], v[80:83], v[136:139]
ds_read_b128 a[172:175], v21 offset:17600
v_cvt_pk_bf16_f32 v85, v74, v75
v_mfma_f32_16x16x32_bf16 v[140:143], a[204:207], v[80:83], v[140:143]
v_exp_f32 v76, v76
v_mfma_f32_16x16x32_bf16 v[68:71], a[144:147], a[96:99], v[104:107]
v_add_f32 v90, v90, v74
v_add_f32 v91, v91, v75
v_mfma_f32_16x16x32_bf16 v[68:71], a[148:151], a[100:103], v[68:71]
v_exp_f32 v77, v77
v_mfma_f32_16x16x32_bf16 v[68:71], a[152:155], a[104:107], v[68:71]
ds_read_b128 a[176:179], v21 offset:21760
v_cvt_pk_bf16_f32 v86, v76, v77
v_mfma_f32_16x16x32_bf16 v[68:71], a[156:159], a[108:111], v[68:71]
s_waitcnt lgkmcnt(6)
v_exp_f32 v78, v78
v_mfma_f32_16x16x32_bf16 v[144:147], a[208:211], v[80:83], v[144:147]
v_add_f32 v90, v90, v76
v_add_f32 v91, v91, v77
v_mfma_f32_16x16x32_bf16 v[148:151], a[212:215], v[80:83], v[148:151]
v_exp_f32 v79, v79
v_mfma_f32_16x16x32_bf16 v[152:155], a[216:219], v[80:83], v[152:155]
ds_read_b128 a[180:183], v21 offset:21824
v_cvt_pk_bf16_f32 v87, v78, v79
v_mfma_f32_16x16x32_bf16 v[156:159], a[220:223], v[80:83], v[156:159]
s_waitcnt lgkmcnt(6)
v_add_f32 v90, v90, v78
v_add_f32 v91, v91, v79
v_mfma_f32_16x16x32_bf16 v[72:75], a[128:131], a[112:115], v[108:111]
ds_read_b128 a[184:187], v21 offset:21888
v_exp_f32 v64, v64
v_mfma_f32_16x16x32_bf16 v[72:75], a[132:135], a[116:119], v[72:75]
ds_read_b128 a[188:191], v21 offset:21952
v_exp_f32 v65, v65
v_mfma_f32_16x16x32_bf16 v[72:75], a[136:139], a[120:123], v[72:75]
ds_read_b64_tr_b16 a[224:225], v22 offset:26112
v_cvt_pk_bf16_f32 v80, v64, v65
v_mfma_f32_16x16x32_bf16 v[72:75], a[140:143], a[124:127], v[72:75]
v_exp_f32 v66, v66
v_mfma_f32_16x16x32_bf16 v[160:163], a[192:195], v[84:87], v[160:163]
s_add_u32 m0, s38, 8704
v_add_f32 v92, v92, v64
v_add_f32 v93, v93, v65
v_mfma_f32_16x16x32_bf16 v[164:167], a[196:199], v[84:87], v[164:167]
buffer_load_dwordx4 v25, s[20:23], s39 offen offset:0 nt lds
v_exp_f32 v67, v67
v_mfma_f32_16x16x32_bf16 v[168:171], a[200:203], v[84:87], v[168:171]
ds_read_b64_tr_b16 a[226:227], v22 offset:30464
v_cvt_pk_bf16_f32 v81, v66, v67
v_mfma_f32_16x16x32_bf16 v[172:175], a[204:207], v[84:87], v[172:175]
v_exp_f32 v68, v68
v_mfma_f32_16x16x32_bf16 v[76:79], a[144:147], a[112:115], v[108:111]
v_add_f32 v92, v92, v66
v_add_f32 v93, v93, v67
v_mfma_f32_16x16x32_bf16 v[76:79], a[148:151], a[116:119], v[76:79]
v_exp_f32 v69, v69
v_mfma_f32_16x16x32_bf16 v[76:79], a[152:155], a[120:123], v[76:79]
ds_read_b64_tr_b16 a[228:229], v23 offset:26144
v_cvt_pk_bf16_f32 v82, v68, v69
v_mfma_f32_16x16x32_bf16 v[76:79], a[156:159], a[124:127], v[76:79]
v_exp_f32 v70, v70
v_mfma_f32_16x16x32_bf16 v[176:179], a[208:211], v[84:87], v[176:179]
v_add_f32 v92, v92, v68
v_add_f32 v93, v93, v69
v_mfma_f32_16x16x32_bf16 v[180:183], a[212:215], v[84:87], v[180:183]
v_exp_f32 v71, v71
v_mfma_f32_16x16x32_bf16 v[184:187], a[216:219], v[84:87], v[184:187]
ds_read_b64_tr_b16 a[230:231], v23 offset:30496
v_cvt_pk_bf16_f32 v83, v70, v71
v_mfma_f32_16x16x32_bf16 v[188:191], a[220:223], v[84:87], v[188:191]
s_waitcnt lgkmcnt(6)
v_add_f32 v92, v92, v70
v_add_f32 v93, v93, v71
v_mfma_f32_16x16x32_bf16 v[64:67], a[160:163], a[64:67], v[96:99]
ds_read_b64_tr_b16 a[232:233], v22 offset:26176
v_exp_f32 v72, v72
v_mfma_f32_16x16x32_bf16 v[64:67], a[164:167], a[68:71], v[64:67]
ds_read_b64_tr_b16 a[234:235], v22 offset:30528
v_exp_f32 v73, v73
v_mfma_f32_16x16x32_bf16 v[64:67], a[168:171], a[72:75], v[64:67]
ds_read_b64_tr_b16 a[236:237], v23 offset:26208
v_cvt_pk_bf16_f32 v84, v72, v73
v_mfma_f32_16x16x32_bf16 v[64:67], a[172:175], a[76:79], v[64:67]
v_exp_f32 v74, v74
v_mfma_f32_16x16x32_bf16 v[192:195], a[192:195], v[80:83], v[192:195]
s_add_u32 m0, s38, 64
v_add_f32 v94, v94, v72
v_add_f32 v95, v95, v73
v_mfma_f32_16x16x32_bf16 v[196:199], a[196:199], v[80:83], v[196:199]
buffer_load_dwordx4 v24, s[16:19], s39 offen offset:1024 nt lds
v_exp_f32 v75, v75
v_mfma_f32_16x16x32_bf16 v[200:203], a[200:203], v[80:83], v[200:203]
ds_read_b64_tr_b16 a[238:239], v23 offset:30560
v_cvt_pk_bf16_f32 v85, v74, v75
v_mfma_f32_16x16x32_bf16 v[204:207], a[204:207], v[80:83], v[204:207]
s_waitcnt lgkmcnt(8)
v_exp_f32 v76, v76
v_mfma_f32_16x16x32_bf16 v[68:71], a[176:179], a[64:67], v[96:99]
v_add_f32 v94, v94, v74
v_add_f32 v95, v95, v75
v_mfma_f32_16x16x32_bf16 v[68:71], a[180:183], a[68:71], v[68:71]
v_exp_f32 v77, v77
v_mfma_f32_16x16x32_bf16 v[68:71], a[184:187], a[72:75], v[68:71]
ds_read_b64_tr_b16 a[240:241], v22 offset:26240
v_cvt_pk_bf16_f32 v86, v76, v77
v_mfma_f32_16x16x32_bf16 v[68:71], a[188:191], a[76:79], v[68:71]
v_exp_f32 v78, v78
v_mfma_f32_16x16x32_bf16 v[208:211], a[208:211], v[80:83], v[208:211]
v_add_f32 v94, v94, v76
v_add_f32 v95, v95, v77
v_mfma_f32_16x16x32_bf16 v[212:215], a[212:215], v[80:83], v[212:215]
v_exp_f32 v79, v79
v_mfma_f32_16x16x32_bf16 v[216:219], a[216:219], v[80:83], v[216:219]
ds_read_b64_tr_b16 a[242:243], v22 offset:30592
v_cvt_pk_bf16_f32 v87, v78, v79
v_mfma_f32_16x16x32_bf16 v[220:223], a[220:223], v[80:83], v[220:223]
s_waitcnt lgkmcnt(6)
v_add_f32 v94, v94, v78
v_add_f32 v95, v95, v79
v_mfma_f32_16x16x32_bf16 v[72:75], a[160:163], a[80:83], v[100:103]
ds_read_b64_tr_b16 a[244:245], v23 offset:26272
v_exp_f32 v64, v64
v_mfma_f32_16x16x32_bf16 v[72:75], a[164:167], a[84:87], v[72:75]
ds_read_b64_tr_b16 a[246:247], v23 offset:30624
v_exp_f32 v65, v65
v_mfma_f32_16x16x32_bf16 v[72:75], a[168:171], a[88:91], v[72:75]
ds_read_b64_tr_b16 a[248:249], v22 offset:26304
v_cvt_pk_bf16_f32 v80, v64, v65
v_mfma_f32_16x16x32_bf16 v[72:75], a[172:175], a[92:95], v[72:75]
s_add_u32 s41, s41, 34816
v_exp_f32 v66, v66
v_mfma_f32_16x16x32_bf16 v[224:227], a[192:195], v[84:87], v[224:227]
s_add_u32 m0, s38, 9536
v_add_f32 v88, v88, v64
v_add_f32 v89, v89, v65
v_mfma_f32_16x16x32_bf16 v[228:231], a[196:199], v[84:87], v[228:231]
s_cmp_eq_u32 s41, 139264
buffer_load_dwordx4 v25, s[20:23], s39 offen offset:256 nt lds
v_exp_f32 v67, v67
v_mfma_f32_16x16x32_bf16 v[232:235], a[200:203], v[84:87], v[232:235]
ds_read_b64_tr_b16 a[250:251], v22 offset:30656
v_cvt_pk_bf16_f32 v81, v66, v67
v_mfma_f32_16x16x32_bf16 v[236:239], a[204:207], v[84:87], v[236:239]
s_cselect_b32 s41, 0, s41
v_exp_f32 v68, v68
v_mfma_f32_16x16x32_bf16 v[76:79], a[176:179], a[80:83], v[100:103]
v_add_f32 v88, v88, v66
v_add_f32 v89, v89, v67
v_mfma_f32_16x16x32_bf16 v[76:79], a[180:183], a[84:87], v[76:79]
v_exp_f32 v69, v69
v_mfma_f32_16x16x32_bf16 v[76:79], a[184:187], a[88:91], v[76:79]
ds_read_b64_tr_b16 a[252:253], v23 offset:26336
v_cvt_pk_bf16_f32 v82, v68, v69
v_mfma_f32_16x16x32_bf16 v[76:79], a[188:191], a[92:95], v[76:79]
v_exp_f32 v70, v70
v_mfma_f32_16x16x32_bf16 v[240:243], a[208:211], v[84:87], v[240:243]
v_add_f32 v88, v88, v68
v_add_f32 v89, v89, v69
v_mfma_f32_16x16x32_bf16 v[244:247], a[212:215], v[84:87], v[244:247]
v_exp_f32 v71, v71
v_mfma_f32_16x16x32_bf16 v[248:251], a[216:219], v[84:87], v[248:251]
ds_read_b64_tr_b16 a[254:255], v23 offset:30688
v_cvt_pk_bf16_f32 v83, v70, v71
v_mfma_f32_16x16x32_bf16 v[252:255], a[220:223], v[84:87], v[252:255]
s_waitcnt lgkmcnt(6)
v_add_u32 v21, s41, v18
v_add_u32 v22, s41, v19
v_add_u32 v23, s41, v20
s_add_u32 s101, s101, 8192
s_add_u32 s100, s100, s92
s_and_b32 s39, s100, 0xf800
s_and_b32 s93, s101, 0x40000
s_or_b32 s39, s39, s93
s_add_u32 s38, s38, 17408
s_cmp_eq_u32 s38, s71
s_cselect_b32 s38, s70, s38
s_sub_u32 s32, s32, 1
s_cmp_lg_u32 s32, 0
v_add_f32 v88, v88, v70
v_add_f32 v89, v89, v71
s_waitcnt vmcnt(29)
s_barrier
v_readfirstlane_b32 s66, v29
v_mfma_f32_16x16x32_bf16 v[64:67], a[160:163], a[96:99], v[104:107]
ds_read_b128 a[128:131], v21 offset:0
v_exp_f32 v72, v72
v_mfma_f32_16x16x32_bf16 v[64:67], a[164:167], a[100:103], v[64:67]
ds_read_b128 a[132:135], v21 offset:64
v_exp_f32 v73, v73
v_mfma_f32_16x16x32_bf16 v[64:67], a[168:171], a[104:107], v[64:67]
ds_read_b128 a[136:139], v21 offset:128
v_cvt_pk_bf16_f32 v84, v72, v73
v_mfma_f32_16x16x32_bf16 v[64:67], a[172:175], a[108:111], v[64:67]
v_exp_f32 v74, v74
v_mfma_f32_16x16x32_bf16 v[128:131], a[224:227], v[80:83], v[128:131]
s_add_u32 m0, s38, 0
v_add_f32 v90, v90, v72
v_add_f32 v91, v91, v73
v_mfma_f32_16x16x32_bf16 v[132:135], a[228:231], v[80:83], v[132:135]
buffer_load_dwordx4 v24, s[16:19], s39 offen offset:0 nt lds
v_exp_f32 v75, v75
v_mfma_f32_16x16x32_bf16 v[136:139], a[232:235], v[80:83], v[136:139]
ds_read_b128 a[140:143], v21 offset:192
v_cvt_pk_bf16_f32 v85, v74, v75
v_mfma_f32_16x16x32_bf16 v[140:143], a[236:239], v[80:83], v[140:143]
v_exp_f32 v76, v76
v_mfma_f32_16x16x32_bf16 v[68:71], a[176:179], a[96:99], v[104:107]
v_add_f32 v90, v90, v74
v_add_f32 v91, v91, v75
v_mfma_f32_16x16x32_bf16 v[68:71], a[180:183], a[100:103], v[68:71]
v_exp_f32 v77, v77
v_mfma_f32_16x16x32_bf16 v[68:71], a[184:187], a[104:107], v[68:71]
ds_read_b128 a[144:147], v21 offset:4352
v_cvt_pk_bf16_f32 v86, v76, v77
v_mfma_f32_16x16x32_bf16 v[68:71], a[188:191], a[108:111], v[68:71]
s_waitcnt lgkmcnt(5)
v_exp_f32 v78, v78
v_mfma_f32_16x16x32_bf16 v[144:147], a[240:243], v[80:83], v[144:147]
v_add_f32 v90, v90, v76
v_add_f32 v91, v91, v77
v_mfma_f32_16x16x32_bf16 v[148:151], a[244:247], v[80:83], v[148:151]
v_exp_f32 v79, v79
v_mfma_f32_16x16x32_bf16 v[152:155], a[248:251], v[80:83], v[152:155]
ds_read_b128 a[148:151], v21 offset:4416
v_cvt_pk_bf16_f32 v87, v78, v79
v_mfma_f32_16x16x32_bf16 v[156:159], a[252:255], v[80:83], v[156:159]
v_add_f32 v90, v90, v78
v_add_f32 v91, v91, v79
v_mfma_f32_16x16x32_bf16 v[72:75], a[160:163], a[112:115], v[108:111]
ds_read_b128 a[152:155], v21 offset:4480
v_exp_f32 v64, v64
v_mfma_f32_16x16x32_bf16 v[72:75], a[164:167], a[116:119], v[72:75]
ds_read_b128 a[156:159], v21 offset:4544
v_exp_f32 v65, v65
v_mfma_f32_16x16x32_bf16 v[72:75], a[168:171], a[120:123], v[72:75]
ds_read_b64_tr_b16 a[192:193], v22 offset:8704
v_cvt_pk_bf16_f32 v80, v64, v65
v_mfma_f32_16x16x32_bf16 v[72:75], a[172:175], a[124:127], v[72:75]
v_exp_f32 v66, v66
v_mfma_f32_16x16x32_bf16 v[160:163], a[224:227], v[84:87], v[160:163]
s_add_u32 m0, s38, 8704
v_add_f32 v92, v92, v64
v_add_f32 v93, v93, v65
v_mfma_f32_16x16x32_bf16 v[164:167], a[228:231], v[84:87], v[164:167]
buffer_load_dwordx4 v25, s[20:23], s39 offen offset:0 nt lds
v_exp_f32 v67, v67
v_mfma_f32_16x16x32_bf16 v[168:171], a[232:235], v[84:87], v[168:171]
ds_read_b64_tr_b16 a[194:195], v22 offset:13056
v_cvt_pk_bf16_f32 v81, v66, v67
v_mfma_f32_16x16x32_bf16 v[172:175], a[236:239], v[84:87], v[172:175]
v_exp_f32 v68, v68
v_mfma_f32_16x16x32_bf16 v[76:79], a[176:179], a[112:115], v[108:111]
v_add_f32 v92, v92, v66
v_add_f32 v93, v93, v67
v_mfma_f32_16x16x32_bf16 v[76:79], a[180:183], a[116:119], v[76:79]
v_exp_f32 v69, v69
v_mfma_f32_16x16x32_bf16 v[76:79], a[184:187], a[120:123], v[76:79]
ds_read_b64_tr_b16 a[196:197], v23 offset:8736
v_cvt_pk_bf16_f32 v82, v68, v69
v_mfma_f32_16x16x32_bf16 v[76:79], a[188:191], a[124:127], v[76:79]
v_exp_f32 v70, v70
v_mfma_f32_16x16x32_bf16 v[176:179], a[240:243], v[84:87], v[176:179]
v_add_f32 v92, v92, v68
v_add_f32 v93, v93, v69
v_mfma_f32_16x16x32_bf16 v[180:183], a[244:247], v[84:87], v[180:183]
v_exp_f32 v71, v71
v_mfma_f32_16x16x32_bf16 v[184:187], a[248:251], v[84:87], v[184:187]
ds_read_b64_tr_b16 a[198:199], v23 offset:13088
v_cvt_pk_bf16_f32 v83, v70, v71
v_mfma_f32_16x16x32_bf16 v[188:191], a[252:255], v[84:87], v[188:191]
s_waitcnt lgkmcnt(6)
v_add_f32 v92, v92, v70
v_add_f32 v93, v93, v71
v_mfma_f32_16x16x32_bf16 v[64:67], a[128:131], a[64:67], v[96:99]
ds_read_b64_tr_b16 a[200:201], v22 offset:8768
v_exp_f32 v72, v72
v_mfma_f32_16x16x32_bf16 v[64:67], a[132:135], a[68:71], v[64:67]
ds_read_b64_tr_b16 a[202:203], v22 offset:13120
v_exp_f32 v73, v73
v_mfma_f32_16x16x32_bf16 v[64:67], a[136:139], a[72:75], v[64:67]
ds_read_b64_tr_b16 a[204:205], v23 offset:8800
v_cvt_pk_bf16_f32 v84, v72, v73
v_mfma_f32_16x16x32_bf16 v[64:67], a[140:143], a[76:79], v[64:67]
v_exp_f32 v74, v74
v_mfma_f32_16x16x32_bf16 v[192:195], a[224:227], v[80:83], v[192:195]
s_add_u32 m0, s38, 64
v_add_f32 v94, v94, v72
v_add_f32 v95, v95, v73
v_mfma_f32_16x16x32_bf16 v[196:199], a[228:231], v[80:83], v[196:199]
buffer_load_dwordx4 v24, s[16:19], s39 offen offset:1024 nt lds
v_exp_f32 v75, v75
v_mfma_f32_16x16x32_bf16 v[200:203], a[232:235], v[80:83], v[200:203]
ds_read_b64_tr_b16 a[206:207], v23 offset:13152
v_cvt_pk_bf16_f32 v85, v74, v75
v_mfma_f32_16x16x32_bf16 v[204:207], a[236:239], v[80:83], v[204:207]
s_waitcnt lgkmcnt(8)
v_exp_f32 v76, v76
v_mfma_f32_16x16x32_bf16 v[68:71], a[144:147], a[64:67], v[96:99]
v_add_f32 v94, v94, v74
v_add_f32 v95, v95, v75
v_mfma_f32_16x16x32_bf16 v[68:71], a[148:151], a[68:71], v[68:71]
v_exp_f32 v77, v77
v_mfma_f32_16x16x32_bf16 v[68:71], a[152:155], a[72:75], v[68:71]
ds_read_b64_tr_b16 a[208:209], v22 offset:8832
v_cvt_pk_bf16_f32 v86, v76, v77
v_mfma_f32_16x16x32_bf16 v[68:71], a[156:159], a[76:79], v[68:71]
v_exp_f32 v78, v78
v_mfma_f32_16x16x32_bf16 v[208:211], a[240:243], v[80:83], v[208:211]
v_add_f32 v94, v94, v76
v_add_f32 v95, v95, v77
v_mfma_f32_16x16x32_bf16 v[212:215], a[244:247], v[80:83], v[212:215]
v_exp_f32 v79, v79
v_mfma_f32_16x16x32_bf16 v[216:219], a[248:251], v[80:83], v[216:219]
ds_read_b64_tr_b16 a[210:211], v22 offset:13184
v_cvt_pk_bf16_f32 v87, v78, v79
v_mfma_f32_16x16x32_bf16 v[220:223], a[252:255], v[80:83], v[220:223]
s_waitcnt lgkmcnt(6)
v_add_f32 v94, v94, v78
v_add_f32 v95, v95, v79
v_mfma_f32_16x16x32_bf16 v[72:75], a[128:131], a[80:83], v[100:103]
ds_read_b64_tr_b16 a[212:213], v23 offset:8864
v_exp_f32 v64, v64
v_mfma_f32_16x16x32_bf16 v[72:75], a[132:135], a[84:87], v[72:75]
ds_read_b64_tr_b16 a[214:215], v23 offset:13216
v_exp_f32 v65, v65
v_mfma_f32_16x16x32_bf16 v[72:75], a[136:139], a[88:91], v[72:75]
ds_read_b64_tr_b16 a[216:217], v22 offset:8896
v_cvt_pk_bf16_f32 v80, v64, v65
v_mfma_f32_16x16x32_bf16 v[72:75], a[140:143], a[92:95], v[72:75]
v_exp_f32 v66, v66
v_mfma_f32_16x16x32_bf16 v[224:227], a[224:227], v[84:87], v[224:227]
s_add_u32 m0, s38, 9536
v_add_f32 v88, v88, v64
v_add_f32 v89, v89, v65
v_mfma_f32_16x16x32_bf16 v[228:231], a[228:231], v[84:87], v[228:231]
buffer_load_dwordx4 v25, s[20:23], s39 offen offset:256 nt lds
v_exp_f32 v67, v67
v_mfma_f32_16x16x32_bf16 v[232:235], a[232:235], v[84:87], v[232:235]
ds_read_b64_tr_b16 a[218:219], v22 offset:13248
v_cvt_pk_bf16_f32 v81, v66, v67
v_mfma_f32_16x16x32_bf16 v[236:239], a[236:239], v[84:87], v[236:239]
v_exp_f32 v68, v68
v_mfma_f32_16x16x32_bf16 v[76:79], a[144:147], a[80:83], v[100:103]
v_add_f32 v88, v88, v66
v_add_f32 v89, v89, v67
v_mfma_f32_16x16x32_bf16 v[76:79], a[148:151], a[84:87], v[76:79]
v_exp_f32 v69, v69
v_mfma_f32_16x16x32_bf16 v[76:79], a[152:155], a[88:91], v[76:79]
ds_read_b64_tr_b16 a[220:221], v23 offset:8928
v_cvt_pk_bf16_f32 v82, v68, v69
v_mfma_f32_16x16x32_bf16 v[76:79], a[156:159], a[92:95], v[76:79]
v_exp_f32 v70, v70
v_mfma_f32_16x16x32_bf16 v[240:243], a[240:243], v[84:87], v[240:243]
v_add_f32 v88, v88, v68
v_add_f32 v89, v89, v69
v_mfma_f32_16x16x32_bf16 v[244:247], a[244:247], v[84:87], v[244:247]
v_exp_f32 v71, v71
v_mfma_f32_16x16x32_bf16 v[248:251], a[248:251], v[84:87], v[248:251]
ds_read_b64_tr_b16 a[222:223], v23 offset:13280
v_cvt_pk_bf16_f32 v83, v70, v71
v_mfma_f32_16x16x32_bf16 v[252:255], a[252:255], v[84:87], v[252:255]
s_waitcnt lgkmcnt(6)
s_add_u32 s101, s101, 8192
s_add_u32 s100, s100, s92
s_and_b32 s39, s100, 0xf800
s_and_b32 s93, s101, 0x40000
s_or_b32 s39, s39, s93
s_add_u32 s38, s38, 17408
s_cmp_eq_u32 s38, s71
s_cselect_b32 s38, s70, s38
v_add_f32 v88, v88, v70
v_add_f32 v89, v89, v71
s_waitcnt vmcnt(20)
s_barrier
s_lshl_b32 s48, 1, s68
s_lshl_b32 s49, s6, 3
s_add_u32 s49, s49, s7
s_mul_i32 s49, s49, 16
v_mov_b32 v29, s48
v_mov_b32 v30, s49
s_cmp_lg_u32 s66, 0
s_cbranch_scc1 L_nosig0
s_cmp_lg_u32 s3, 0
s_cbranch_scc1 L_nosig0
s_mov_b64 exec, 1
buffer_atomic_or v29, v30, s[60:63], 0 offen
s_mov_b64 exec, -1
L_nosig0:
v_mfma_f32_16x16x32_bf16 v[64:67], a[128:131], a[96:99], v[104:107]
ds_read_b128 a[160:163], v21 offset:17408
v_exp_f32 v72, v72
v_mfma_f32_16x16x32_bf16 v[64:67], a[132:135], a[100:103], v[64:67]
ds_read_b128 a[164:167], v21 offset:17472
v_exp_f32 v73, v73
v_mfma_f32_16x16x32_bf16 v[64:67], a[136:139], a[104:107], v[64:67]
ds_read_b128 a[168:171], v21 offset:17536
v_cvt_pk_bf16_f32 v84, v72, v73
v_mfma_f32_16x16x32_bf16 v[64:67], a[140:143], a[108:111], v[64:67]
v_exp_f32 v74, v74
v_mfma_f32_16x16x32_bf16 v[128:131], a[192:195], v[80:83], v[128:131]
s_add_u32 m0, s38, 0
v_add_f32 v90, v90, v72
v_add_f32 v91, v91, v73
v_mfma_f32_16x16x32_bf16 v[132:135], a[196:199], v[80:83], v[132:135]
buffer_load_dwordx4 v24, s[16:19], s39 offen offset:0 nt lds
v_exp_f32 v75, v75
v_mfma_f32_16x16x32_bf16 v[136:139], a[200:203], v[80:83], v[136:139]
ds_read_b128 a[172:175], v21 offset:17600
v_cvt_pk_bf16_f32 v85, v74, v75
v_mfma_f32_16x16x32_bf16 v[140:143], a[204:207], v[80:83], v[140:143]
v_exp_f32 v76, v76
v_mfma_f32_16x16x32_bf16 v[68:71], a[144:147], a[96:99], v[104:107]
v_add_f32 v90, v90, v74
v_add_f32 v91, v91, v75
v_mfma_f32_16x16x32_bf16 v[68:71], a[148:151], a[100:103], v[68:71]
v_exp_f32 v77, v77
v_mfma_f32_16x16x32_bf16 v[68:71], a[152:155], a[104:107], v[68:71]
ds_read_b128 a[176:179], v21 offset:21760
v_cvt_pk_bf16_f32 v86, v76, v77
v_mfma_f32_16x16x32_bf16 v[68:71], a[156:159], a[108:111], v[68:71]
s_waitcnt lgkmcnt(5)
v_exp_f32 v78, v78
v_mfma_f32_16x16x32_bf16 v[144:147], a[208:211], v[80:83], v[144:147]
v_add_f32 v90, v90, v76
v_add_f32 v91, v91, v77
v_mfma_f32_16x16x32_bf16 v[148:151], a[212:215], v[80:83], v[148:151]
v_exp_f32 v79, v79
v_mfma_f32_16x16x32_bf16 v[152:155], a[216:219], v[80:83], v[152:155]
ds_read_b128 a[180:183], v21 offset:21824
v_cvt_pk_bf16_f32 v87, v78, v79
v_mfma_f32_16x16x32_bf16 v[156:159], a[220:223], v[80:83], v[156:159]
v_add_f32 v90, v90, v78
v_add_f32 v91, v91, v79
v_mfma_f32_16x16x32_bf16 v[72:75], a[128:131], a[112:115], v[108:111]
ds_read_b128 a[184:187], v21 offset:21888
v_exp_f32 v64, v64
v_mfma_f32_16x16x32_bf16 v[72:75], a[132:135], a[116:119], v[72:75]
ds_read_b128 a[188:191], v21 offset:21952
v_exp_f32 v65, v65
v_mfma_f32_16x16x32_bf16 v[72:75], a[136:139], a[120:123], v[72:75]
ds_read_b64_tr_b16 a[224:225], v22 offset:26112
v_cvt_pk_bf16_f32 v80, v64, v65
v_mfma_f32_16x16x32_bf16 v[72:75], a[140:143], a[124:127], v[72:75]
v_exp_f32 v66, v66
v_mfma_f32_16x16x32_bf16 v[160:163], a[192:195], v[84:87], v[160:163]
s_add_u32 m0, s38, 8704
v_add_f32 v92, v92, v64
v_add_f32 v93, v93, v65
v_mfma_f32_16x16x32_bf16 v[164:167], a[196:199], v[84:87], v[164:167]
buffer_load_dwordx4 v25, s[20:23], s39 offen offset:0 nt lds
v_exp_f32 v67, v67
v_mfma_f32_16x16x32_bf16 v[168:171], a[200:203], v[84:87], v[168:171]
ds_read_b64_tr_b16 a[226:227], v22 offset:30464
v_cvt_pk_bf16_f32 v81, v66, v67
v_mfma_f32_16x16x32_bf16 v[172:175], a[204:207], v[84:87], v[172:175]
v_exp_f32 v68, v68
v_mfma_f32_16x16x32_bf16 v[76:79], a[144:147], a[112:115], v[108:111]
v_add_f32 v92, v92, v66
v_add_f32 v93, v93, v67
v_mfma_f32_16x16x32_bf16 v[76:79], a[148:151], a[116:119], v[76:79]
v_exp_f32 v69, v69
v_mfma_f32_16x16x32_bf16 v[76:79], a[152:155], a[120:123], v[76:79]
ds_read_b64_tr_b16 a[228:229], v23 offset:26144
v_cvt_pk_bf16_f32 v82, v68, v69
v_mfma_f32_16x16x32_bf16 v[76:79], a[156:159], a[124:127], v[76:79]
v_exp_f32 v70, v70
v_mfma_f32_16x16x32_bf16 v[176:179], a[208:211], v[84:87], v[176:179]
v_add_f32 v92, v92, v68
v_add_f32 v93, v93, v69
v_mfma_f32_16x16x32_bf16 v[180:183], a[212:215], v[84:87], v[180:183]
v_exp_f32 v71, v71
v_mfma_f32_16x16x32_bf16 v[184:187], a[216:219], v[84:87], v[184:187]
ds_read_b64_tr_b16 a[230:231], v23 offset:30496
v_cvt_pk_bf16_f32 v83, v70, v71
v_mfma_f32_16x16x32_bf16 v[188:191], a[220:223], v[84:87], v[188:191]
s_waitcnt lgkmcnt(6)
v_add_f32 v92, v92, v70
v_add_f32 v93, v93, v71
v_mfma_f32_16x16x32_bf16 v[64:67], a[160:163], a[64:67], v[96:99]
ds_read_b64_tr_b16 a[232:233], v22 offset:26176
v_exp_f32 v72, v72
v_mfma_f32_16x16x32_bf16 v[64:67], a[164:167], a[68:71], v[64:67]
ds_read_b64_tr_b16 a[234:235], v22 offset:30528
v_exp_f32 v73, v73
v_mfma_f32_16x16x32_bf16 v[64:67], a[168:171], a[72:75], v[64:67]
ds_read_b64_tr_b16 a[236:237], v23 offset:26208
v_cvt_pk_bf16_f32 v84, v72, v73
v_mfma_f32_16x16x32_bf16 v[64:67], a[172:175], a[76:79], v[64:67]
v_exp_f32 v74, v74
v_mfma_f32_16x16x32_bf16 v[192:195], a[192:195], v[80:83], v[192:195]
s_add_u32 m0, s38, 64
v_add_f32 v94, v94, v72
v_add_f32 v95, v95, v73
v_mfma_f32_16x16x32_bf16 v[196:199], a[196:199], v[80:83], v[196:199]
buffer_load_dwordx4 v24, s[16:19], s39 offen offset:1024 nt lds
v_exp_f32 v75, v75
v_mfma_f32_16x16x32_bf16 v[200:203], a[200:203], v[80:83], v[200:203]
ds_read_b64_tr_b16 a[238:239], v23 offset:30560
v_cvt_pk_bf16_f32 v85, v74, v75
v_mfma_f32_16x16x32_bf16 v[204:207], a[204:207], v[80:83], v[204:207]
s_waitcnt lgkmcnt(8)
v_exp_f32 v76, v76
v_mfma_f32_16x16x32_bf16 v[68:71], a[176:179], a[64:67], v[96:99]
v_add_f32 v94, v94, v74
v_add_f32 v95, v95, v75
v_mfma_f32_16x16x32_bf16 v[68:71], a[180:183], a[68:71], v[68:71]
v_exp_f32 v77, v77
v_mfma_f32_16x16x32_bf16 v[68:71], a[184:187], a[72:75], v[68:71]
ds_read_b64_tr_b16 a[240:241], v22 offset:26240
v_cvt_pk_bf16_f32 v86, v76, v77
v_mfma_f32_16x16x32_bf16 v[68:71], a[188:191], a[76:79], v[68:71]
v_exp_f32 v78, v78
v_mfma_f32_16x16x32_bf16 v[208:211], a[208:211], v[80:83], v[208:211]
v_add_f32 v94, v94, v76
v_add_f32 v95, v95, v77
v_mfma_f32_16x16x32_bf16 v[212:215], a[212:215], v[80:83], v[212:215]
v_exp_f32 v79, v79
v_mfma_f32_16x16x32_bf16 v[216:219], a[216:219], v[80:83], v[216:219]
ds_read_b64_tr_b16 a[242:243], v22 offset:30592
v_cvt_pk_bf16_f32 v87, v78, v79
v_mfma_f32_16x16x32_bf16 v[220:223], a[220:223], v[80:83], v[220:223]
s_waitcnt lgkmcnt(6)
v_add_f32 v94, v94, v78
v_add_f32 v95, v95, v79
v_mfma_f32_16x16x32_bf16 v[72:75], a[160:163], a[80:83], v[100:103]
ds_read_b64_tr_b16 a[244:245], v23 offset:26272
v_exp_f32 v64, v64
v_mfma_f32_16x16x32_bf16 v[72:75], a[164:167], a[84:87], v[72:75]
ds_read_b64_tr_b16 a[246:247], v23 offset:30624
v_exp_f32 v65, v65
v_mfma_f32_16x16x32_bf16 v[72:75], a[168:171], a[88:91], v[72:75]
ds_read_b64_tr_b16 a[248:249], v22 offset:26304
v_cvt_pk_bf16_f32 v80, v64, v65
v_mfma_f32_16x16x32_bf16 v[72:75], a[172:175], a[92:95], v[72:75]
s_add_u32 s41, s41, 34816
v_exp_f32 v66, v66
v_mfma_f32_16x16x32_bf16 v[224:227], a[192:195], v[84:87], v[224:227]
s_add_u32 m0, s38, 9536
v_add_f32 v88, v88, v64
v_add_f32 v89, v89, v65
v_mfma_f32_16x16x32_bf16 v[228:231], a[196:199], v[84:87], v[228:231]
s_cmp_eq_u32 s41, 139264
buffer_load_dwordx4 v25, s[20:23], s39 offen offset:256 nt lds
v_exp_f32 v67, v67
v_mfma_f32_16x16x32_bf16 v[232:235], a[200:203], v[84:87], v[232:235]
ds_read_b64_tr_b16 a[250:251], v22 offset:30656
v_cvt_pk_bf16_f32 v81, v66, v67
v_mfma_f32_16x16x32_bf16 v[236:239], a[204:207], v[84:87], v[236:239]
s_cselect_b32 s41, 0, s41
v_exp_f32 v68, v68
v_mfma_f32_16x16x32_bf16 v[76:79], a[176:179], a[80:83], v[100:103]
v_add_f32 v88, v88, v66
v_add_f32 v89, v89, v67
v_mfma_f32_16x16x32_bf16 v[76:79], a[180:183], a[84:87], v[76:79]
v_exp_f32 v69, v69
v_mfma_f32_16x16x32_bf16 v[76:79], a[184:187], a[88:91], v[76:79]
ds_read_b64_tr_b16 a[252:253], v23 offset:26336
v_cvt_pk_bf16_f32 v82, v68, v69
v_mfma_f32_16x16x32_bf16 v[76:79], a[188:191], a[92:95], v[76:79]
v_exp_f32 v70, v70
v_mfma_f32_16x16x32_bf16 v[240:243], a[208:211], v[84:87], v[240:243]
v_add_f32 v88, v88, v68
v_add_f32 v89, v89, v69
v_mfma_f32_16x16x32_bf16 v[244:247], a[212:215], v[84:87], v[244:247]
v_exp_f32 v71, v71
v_mfma_f32_16x16x32_bf16 v[248:251], a[216:219], v[84:87], v[248:251]
ds_read_b64_tr_b16 a[254:255], v23 offset:30688
v_cvt_pk_bf16_f32 v83, v70, v71
v_mfma_f32_16x16x32_bf16 v[252:255], a[220:223], v[84:87], v[252:255]
s_waitcnt lgkmcnt(6)
v_add_u32 v21, s41, v18
v_add_u32 v22, s41, v19
v_add_u32 v23, s41, v20
s_add_u32 s101, s101, 8192
s_add_u32 s100, s100, s92
s_and_b32 s39, s100, 0xf800
s_and_b32 s93, s101, 0x40000
s_or_b32 s39, s39, s93
s_add_u32 s38, s38, 17408
s_cmp_eq_u32 s38, s71
s_cselect_b32 s38, s70, s38
s_sub_u32 s32, s32, 1
s_cmp_lg_u32 s32, 0
v_add_f32 v88, v88, v70
v_add_f32 v89, v89, v71
s_mov_b32 s32, 9
L_at_33:
s_waitcnt vmcnt(20)
s_barrier
v_mfma_f32_16x16x32_bf16 v[64:67], a[160:163], a[96:99], v[104:107]
ds_read_b128 a[128:131], v21 offset:0
v_exp_f32 v72, v72
v_mfma_f32_16x16x32_bf16 v[64:67], a[164:167], a[100:103], v[64:67]
ds_read_b128 a[132:135], v21 offset:64
v_exp_f32 v73, v73
v_mfma_f32_16x16x32_bf16 v[64:67], a[168:171], a[104:107], v[64:67]
ds_read_b128 a[136:139], v21 offset:128
v_cvt_pk_bf16_f32 v84, v72, v73
v_mfma_f32_16x16x32_bf16 v[64:67], a[172:175], a[108:111], v[64:67]
v_exp_f32 v74, v74
v_mfma_f32_16x16x32_bf16 v[128:131], a[224:227], v[80:83], v[128:131]
s_add_u32 m0, s38, 0
v_add_f32 v90, v90, v72
v_add_f32 v91, v91, v73
v_mfma_f32_16x16x32_bf16 v[132:135], a[228:231], v[80:83], v[132:135]
buffer_load_dwordx4 v24, s[16:19], s39 offen offset:0 nt lds
v_exp_f32 v75, v75
v_mfma_f32_16x16x32_bf16 v[136:139], a[232:235], v[80:83], v[136:139]
ds_read_b128 a[140:143], v21 offset:192
v_cvt_pk_bf16_f32 v85, v74, v75
v_mfma_f32_16x16x32_bf16 v[140:143], a[236:239], v[80:83], v[140:143]
v_exp_f32 v76, v76
v_mfma_f32_16x16x32_bf16 v[68:71], a[176:179], a[96:99], v[104:107]
v_add_f32 v90, v90, v74
v_add_f32 v91, v91, v75
v_mfma_f32_16x16x32_bf16 v[68:71], a[180:183], a[100:103], v[68:71]
v_exp_f32 v77, v77
v_mfma_f32_16x16x32_bf16 v[68:71], a[184:187], a[104:107], v[68:71]
ds_read_b128 a[144:147], v21 offset:4352
v_cvt_pk_bf16_f32 v86, v76, v77
v_mfma_f32_16x16x32_bf16 v[68:71], a[188:191], a[108:111], v[68:71]
s_waitcnt lgkmcnt(5)
v_exp_f32 v78, v78
v_mfma_f32_16x16x32_bf16 v[144:147], a[240:243], v[80:83], v[144:147]
v_add_f32 v90, v90, v76
v_add_f32 v91, v91, v77
v_mfma_f32_16x16x32_bf16 v[148:151], a[244:247], v[80:83], v[148:151]
v_exp_f32 v79, v79
v_mfma_f32_16x16x32_bf16 v[152:155], a[248:251], v[80:83], v[152:155]
ds_read_b128 a[148:151], v21 offset:4416
v_cvt_pk_bf16_f32 v87, v78, v79
v_mfma_f32_16x16x32_bf16 v[156:159], a[252:255], v[80:83], v[156:159]
v_add_f32 v90, v90, v78
v_add_f32 v91, v91, v79
v_mfma_f32_16x16x32_bf16 v[72:75], a[160:163], a[112:115], v[108:111]
ds_read_b128 a[152:155], v21 offset:4480
v_exp_f32 v64, v64
v_mfma_f32_16x16x32_bf16 v[72:75], a[164:167], a[116:119], v[72:75]
ds_read_b128 a[156:159], v21 offset:4544
v_exp_f32 v65, v65
v_mfma_f32_16x16x32_bf16 v[72:75], a[168:171], a[120:123], v[72:75]
ds_read_b64_tr_b16 a[192:193], v22 offset:8704
v_cvt_pk_bf16_f32 v80, v64, v65
v_mfma_f32_16x16x32_bf16 v[72:75], a[172:175], a[124:127], v[72:75]
v_exp_f32 v66, v66
v_mfma_f32_16x16x32_bf16 v[160:163], a[224:227], v[84:87], v[160:163]
s_add_u32 m0, s38, 8704
v_add_f32 v92, v92, v64
v_add_f32 v93, v93, v65
v_mfma_f32_16x16x32_bf16 v[164:167], a[228:231], v[84:87], v[164:167]
buffer_load_dwordx4 v25, s[20:23], s39 offen offset:0 nt lds
v_exp_f32 v67, v67
v_mfma_f32_16x16x32_bf16 v[168:171], a[232:235], v[84:87], v[168:171]
ds_read_b64_tr_b16 a[194:195], v22 offset:13056
v_cvt_pk_bf16_f32 v81, v66, v67
v_mfma_f32_16x16x32_bf16 v[172:175], a[236:239], v[84:87], v[172:175]
v_exp_f32 v68, v68
v_mfma_f32_16x16x32_bf16 v[76:79], a[176:179], a[112:115], v[108:111]
v_add_f32 v92, v92, v66
v_add_f32 v93, v93, v67
v_mfma_f32_16x16x32_bf16 v[76:79], a[180:183], a[116:119], v[76:79]
v_exp_f32 v69, v69
v_mfma_f32_16x16x32_bf16 v[76:79], a[184:187], a[120:123], v[76:79]
ds_read_b64_tr_b16 a[196:197], v23 offset:8736
v_cvt_pk_bf16_f32 v82, v68, v69
v_mfma_f32_16x16x32_bf16 v[76:79], a[188:191], a[124:127], v[76:79]
v_exp_f32 v70, v70
v_mfma_f32_16x16x32_bf16 v[176:179], a[240:243], v[84:87], v[176:179]
v_add_f32 v92, v92, v68
v_add_f32 v93, v93, v69
v_mfma_f32_16x16x32_bf16 v[180:183], a[244:247], v[84:87], v[180:183]
v_exp_f32 v71, v71
v_mfma_f32_16x16x32_bf16 v[184:187], a[248:251], v[84:87], v[184:187]
ds_read_b64_tr_b16 a[198:199], v23 offset:13088
v_cvt_pk_bf16_f32 v83, v70, v71
v_mfma_f32_16x16x32_bf16 v[188:191], a[252:255], v[84:87], v[188:191]
s_waitcnt lgkmcnt(6)
v_add_f32 v92, v92, v70
v_add_f32 v93, v93, v71
v_mfma_f32_16x16x32_bf16 v[64:67], a[128:131], a[64:67], v[96:99]
ds_read_b64_tr_b16 a[200:201], v22 offset:8768
v_exp_f32 v72, v72
v_mfma_f32_16x16x32_bf16 v[64:67], a[132:135], a[68:71], v[64:67]
ds_read_b64_tr_b16 a[202:203], v22 offset:13120
v_exp_f32 v73, v73
v_mfma_f32_16x16x32_bf16 v[64:67], a[136:139], a[72:75], v[64:67]
ds_read_b64_tr_b16 a[204:205], v23 offset:8800
v_cvt_pk_bf16_f32 v84, v72, v73
v_mfma_f32_16x16x32_bf16 v[64:67], a[140:143], a[76:79], v[64:67]
v_exp_f32 v74, v74
v_mfma_f32_16x16x32_bf16 v[192:195], a[224:227], v[80:83], v[192:195]
s_add_u32 m0, s38, 64
v_add_f32 v94, v94, v72
v_add_f32 v95, v95, v73
v_mfma_f32_16x16x32_bf16 v[196:199], a[228:231], v[80:83], v[196:199]
buffer_load_dwordx4 v24, s[16:19], s39 offen offset:1024 nt lds
v_exp_f32 v75, v75
v_mfma_f32_16x16x32_bf16 v[200:203], a[232:235], v[80:83], v[200:203]
ds_read_b64_tr_b16 a[206:207], v23 offset:13152
v_cvt_pk_bf16_f32 v85, v74, v75
v_mfma_f32_16x16x32_bf16 v[204:207], a[236:239], v[80:83], v[204:207]
s_waitcnt lgkmcnt(8)
v_exp_f32 v76, v76
v_mfma_f32_16x16x32_bf16 v[68:71], a[144:147], a[64:67], v[96:99]
v_add_f32 v94, v94, v74
v_add_f32 v95, v95, v75
v_mfma_f32_16x16x32_bf16 v[68:71], a[148:151], a[68:71], v[68:71]
v_exp_f32 v77, v77
v_mfma_f32_16x16x32_bf16 v[68:71], a[152:155], a[72:75], v[68:71]
ds_read_b64_tr_b16 a[208:209], v22 offset:8832
v_cvt_pk_bf16_f32 v86, v76, v77
v_mfma_f32_16x16x32_bf16 v[68:71], a[156:159], a[76:79], v[68:71]
v_exp_f32 v78, v78
v_mfma_f32_16x16x32_bf16 v[208:211], a[240:243], v[80:83], v[208:211]
v_add_f32 v94, v94, v76
v_add_f32 v95, v95, v77
v_mfma_f32_16x16x32_bf16 v[212:215], a[244:247], v[80:83], v[212:215]
v_exp_f32 v79, v79
v_mfma_f32_16x16x32_bf16 v[216:219], a[248:251], v[80:83], v[216:219]
ds_read_b64_tr_b16 a[210:211], v22 offset:13184
v_cvt_pk_bf16_f32 v87, v78, v79
v_mfma_f32_16x16x32_bf16 v[220:223], a[252:255], v[80:83], v[220:223]
s_waitcnt lgkmcnt(6)
v_add_f32 v94, v94, v78
v_add_f32 v95, v95, v79
v_mfma_f32_16x16x32_bf16 v[72:75], a[128:131], a[80:83], v[100:103]
ds_read_b64_tr_b16 a[212:213], v23 offset:8864
v_exp_f32 v64, v64
v_mfma_f32_16x16x32_bf16 v[72:75], a[132:135], a[84:87], v[72:75]
ds_read_b64_tr_b16 a[214:215], v23 offset:13216
v_exp_f32 v65, v65
v_mfma_f32_16x16x32_bf16 v[72:75], a[136:139], a[88:91], v[72:75]
ds_read_b64_tr_b16 a[216:217], v22 offset:8896
v_cvt_pk_bf16_f32 v80, v64, v65
v_mfma_f32_16x16x32_bf16 v[72:75], a[140:143], a[92:95], v[72:75]
v_exp_f32 v66, v66
v_mfma_f32_16x16x32_bf16 v[224:227], a[224:227], v[84:87], v[224:227]
s_add_u32 m0, s38, 9536
v_add_f32 v88, v88, v64
v_add_f32 v89, v89, v65
v_mfma_f32_16x16x32_bf16 v[228:231], a[228:231], v[84:87], v[228:231]
buffer_load_dwordx4 v25, s[20:23], s39 offen offset:256 nt lds
v_exp_f32 v67, v67
v_mfma_f32_16x16x32_bf16 v[232:235], a[232:235], v[84:87], v[232:235]
ds_read_b64_tr_b16 a[218:219], v22 offset:13248
v_cvt_pk_bf16_f32 v81, v66, v67
v_mfma_f32_16x16x32_bf16 v[236:239], a[236:239], v[84:87], v[236:239]
v_exp_f32 v68, v68
v_mfma_f32_16x16x32_bf16 v[76:79], a[144:147], a[80:83], v[100:103]
v_add_f32 v88, v88, v66
v_add_f32 v89, v89, v67
v_mfma_f32_16x16x32_bf16 v[76:79], a[148:151], a[84:87], v[76:79]
v_exp_f32 v69, v69
v_mfma_f32_16x16x32_bf16 v[76:79], a[152:155], a[88:91], v[76:79]
ds_read_b64_tr_b16 a[220:221], v23 offset:8928
v_cvt_pk_bf16_f32 v82, v68, v69
v_mfma_f32_16x16x32_bf16 v[76:79], a[156:159], a[92:95], v[76:79]
v_exp_f32 v70, v70
v_mfma_f32_16x16x32_bf16 v[240:243], a[240:243], v[84:87], v[240:243]
v_add_f32 v88, v88, v68
v_add_f32 v89, v89, v69
v_mfma_f32_16x16x32_bf16 v[244:247], a[244:247], v[84:87], v[244:247]
v_exp_f32 v71, v71
v_mfma_f32_16x16x32_bf16 v[248:251], a[248:251], v[84:87], v[248:251]
ds_read_b64_tr_b16 a[222:223], v23 offset:13280
v_cvt_pk_bf16_f32 v83, v70, v71
v_mfma_f32_16x16x32_bf16 v[252:255], a[252:255], v[84:87], v[252:255]
s_waitcnt lgkmcnt(6)
s_add_u32 s101, s101, 8192
s_add_u32 s100, s100, s92
s_and_b32 s39, s100, 0xf800
s_and_b32 s93, s101, 0x40000
s_or_b32 s39, s39, s93
s_add_u32 s38, s38, 17408
s_cmp_eq_u32 s38, s71
s_cselect_b32 s38, s70, s38
v_add_f32 v88, v88, v70
v_add_f32 v89, v89, v71
s_waitcnt vmcnt(20)
s_barrier
v_mfma_f32_16x16x32_bf16 v[64:67], a[128:131], a[96:99], v[104:107]
ds_read_b128 a[160:163], v21 offset:17408
v_exp_f32 v72, v72
v_mfma_f32_16x16x32_bf16 v[64:67], a[132:135], a[100:103], v[64:67]
ds_read_b128 a[164:167], v21 offset:17472
v_exp_f32 v73, v73
v_mfma_f32_16x16x32_bf16 v[64:67], a[136:139], a[104:107], v[64:67]
ds_read_b128 a[168:171], v21 offset:17536
v_cvt_pk_bf16_f32 v84, v72, v73
v_mfma_f32_16x16x32_bf16 v[64:67], a[140:143], a[108:111], v[64:67]
v_exp_f32 v74, v74
v_mfma_f32_16x16x32_bf16 v[128:131], a[192:195], v[80:83], v[128:131]
s_add_u32 m0, s38, 0
v_add_f32 v90, v90, v72
v_add_f32 v91, v91, v73
v_mfma_f32_16x16x32_bf16 v[132:135], a[196:199], v[80:83], v[132:135]
buffer_load_dwordx4 v24, s[16:19], s39 offen offset:0 nt lds
v_exp_f32 v75, v75
v_mfma_f32_16x16x32_bf16 v[136:139], a[200:203], v[80:83], v[136:139]
ds_read_b128 a[172:175], v21 offset:17600
v_cvt_pk_bf16_f32 v85, v74, v75
v_mfma_f32_16x16x32_bf16 v[140:143], a[204:207], v[80:83], v[140:143]
v_exp_f32 v76, v76
v_mfma_f32_16x16x32_bf16 v[68:71], a[144:147], a[96:99], v[104:107]
v_add_f32 v90, v90, v74
v_add_f32 v91, v91, v75
v_mfma_f32_16x16x32_bf16 v[68:71], a[148:151], a[100:103], v[68:71]
v_exp_f32 v77, v77
v_mfma_f32_16x16x32_bf16 v[68:71], a[152:155], a[104:107], v[68:71]
ds_read_b128 a[176:179], v21 offset:21760
v_cvt_pk_bf16_f32 v86, v76, v77
v_mfma_f32_16x16x32_bf16 v[68:71], a[156:159], a[108:111], v[68:71]
s_waitcnt lgkmcnt(5)
v_exp_f32 v78, v78
v_mfma_f32_16x16x32_bf16 v[144:147], a[208:211], v[80:83], v[144:147]
v_add_f32 v90, v90, v76
v_add_f32 v91, v91, v77
v_mfma_f32_16x16x32_bf16 v[148:151], a[212:215], v[80:83], v[148:151]
v_exp_f32 v79, v79
v_mfma_f32_16x16x32_bf16 v[152:155], a[216:219], v[80:83], v[152:155]
ds_read_b128 a[180:183], v21 offset:21824
v_cvt_pk_bf16_f32 v87, v78, v79
v_mfma_f32_16x16x32_bf16 v[156:159], a[220:223], v[80:83], v[156:159]
v_add_f32 v90, v90, v78
v_add_f32 v91, v91, v79
v_mfma_f32_16x16x32_bf16 v[72:75], a[128:131], a[112:115], v[108:111]
ds_read_b128 a[184:187], v21 offset:21888
v_exp_f32 v64, v64
v_mfma_f32_16x16x32_bf16 v[72:75], a[132:135], a[116:119], v[72:75]
ds_read_b128 a[188:191], v21 offset:21952
v_exp_f32 v65, v65
v_mfma_f32_16x16x32_bf16 v[72:75], a[136:139], a[120:123], v[72:75]
ds_read_b64_tr_b16 a[224:225], v22 offset:26112
v_cvt_pk_bf16_f32 v80, v64, v65
v_mfma_f32_16x16x32_bf16 v[72:75], a[140:143], a[124:127], v[72:75]
v_exp_f32 v66, v66
v_mfma_f32_16x16x32_bf16 v[160:163], a[192:195], v[84:87], v[160:163]
s_add_u32 m0, s38, 8704
v_add_f32 v92, v92, v64
v_add_f32 v93, v93, v65
v_mfma_f32_16x16x32_bf16 v[164:167], a[196:199], v[84:87], v[164:167]
buffer_load_dwordx4 v25, s[20:23], s39 offen offset:0 nt lds
v_exp_f32 v67, v67
v_mfma_f32_16x16x32_bf16 v[168:171], a[200:203], v[84:87], v[168:171]
ds_read_b64_tr_b16 a[226:227], v22 offset:30464
v_cvt_pk_bf16_f32 v81, v66, v67
v_mfma_f32_16x16x32_bf16 v[172:175], a[204:207], v[84:87], v[172:175]
v_exp_f32 v68, v68
v_mfma_f32_16x16x32_bf16 v[76:79], a[144:147], a[112:115], v[108:111]
v_add_f32 v92, v92, v66
v_add_f32 v93, v93, v67
v_mfma_f32_16x16x32_bf16 v[76:79], a[148:151], a[116:119], v[76:79]
v_exp_f32 v69, v69
v_mfma_f32_16x16x32_bf16 v[76:79], a[152:155], a[120:123], v[76:79]
ds_read_b64_tr_b16 a[228:229], v23 offset:26144
v_cvt_pk_bf16_f32 v82, v68, v69
v_mfma_f32_16x16x32_bf16 v[76:79], a[156:159], a[124:127], v[76:79]
v_exp_f32 v70, v70
v_mfma_f32_16x16x32_bf16 v[176:179], a[208:211], v[84:87], v[176:179]
v_add_f32 v92, v92, v68
v_add_f32 v93, v93, v69
v_mfma_f32_16x16x32_bf16 v[180:183], a[212:215], v[84:87], v[180:183]
v_exp_f32 v71, v71
v_mfma_f32_16x16x32_bf16 v[184:187], a[216:219], v[84:87], v[184:187]
ds_read_b64_tr_b16 a[230:231], v23 offset:30496
v_cvt_pk_bf16_f32 v83, v70, v71
v_mfma_f32_16x16x32_bf16 v[188:191], a[220:223], v[84:87], v[188:191]
s_waitcnt lgkmcnt(6)
v_add_f32 v92, v92, v70
v_add_f32 v93, v93, v71
v_mfma_f32_16x16x32_bf16 v[64:67], a[160:163], a[64:67], v[96:99]
ds_read_b64_tr_b16 a[232:233], v22 offset:26176
v_exp_f32 v72, v72
v_mfma_f32_16x16x32_bf16 v[64:67], a[164:167], a[68:71], v[64:67]
ds_read_b64_tr_b16 a[234:235], v22 offset:30528
v_exp_f32 v73, v73
v_mfma_f32_16x16x32_bf16 v[64:67], a[168:171], a[72:75], v[64:67]
ds_read_b64_tr_b16 a[236:237], v23 offset:26208
v_cvt_pk_bf16_f32 v84, v72, v73
v_mfma_f32_16x16x32_bf16 v[64:67], a[172:175], a[76:79], v[64:67]
v_exp_f32 v74, v74
v_mfma_f32_16x16x32_bf16 v[192:195], a[192:195], v[80:83], v[192:195]
s_add_u32 m0, s38, 64
v_add_f32 v94, v94, v72
v_add_f32 v95, v95, v73
v_mfma_f32_16x16x32_bf16 v[196:199], a[196:199], v[80:83], v[196:199]
buffer_load_dwordx4 v24, s[16:19], s39 offen offset:1024 nt lds
v_exp_f32 v75, v75
v_mfma_f32_16x16x32_bf16 v[200:203], a[200:203], v[80:83], v[200:203]
ds_read_b64_tr_b16 a[238:239], v23 offset:30560
v_cvt_pk_bf16_f32 v85, v74, v75
v_mfma_f32_16x16x32_bf16 v[204:207], a[204:207], v[80:83], v[204:207]
s_waitcnt lgkmcnt(8)
v_exp_f32 v76, v76
v_mfma_f32_16x16x32_bf16 v[68:71], a[176:179], a[64:67], v[96:99]
v_add_f32 v94, v94, v74
v_add_f32 v95, v95, v75
v_mfma_f32_16x16x32_bf16 v[68:71], a[180:183], a[68:71], v[68:71]
v_exp_f32 v77, v77
v_mfma_f32_16x16x32_bf16 v[68:71], a[184:187], a[72:75], v[68:71]
ds_read_b64_tr_b16 a[240:241], v22 offset:26240
v_cvt_pk_bf16_f32 v86, v76, v77
v_mfma_f32_16x16x32_bf16 v[68:71], a[188:191], a[76:79], v[68:71]
v_exp_f32 v78, v78
v_mfma_f32_16x16x32_bf16 v[208:211], a[208:211], v[80:83], v[208:211]
v_add_f32 v94, v94, v76
v_add_f32 v95, v95, v77
v_mfma_f32_16x16x32_bf16 v[212:215], a[212:215], v[80:83], v[212:215]
v_exp_f32 v79, v79
v_mfma_f32_16x16x32_bf16 v[216:219], a[216:219], v[80:83], v[216:219]
ds_read_b64_tr_b16 a[242:243], v22 offset:30592
v_cvt_pk_bf16_f32 v87, v78, v79
v_mfma_f32_16x16x32_bf16 v[220:223], a[220:223], v[80:83], v[220:223]
s_waitcnt lgkmcnt(6)
v_add_f32 v94, v94, v78
v_add_f32 v95, v95, v79
v_mfma_f32_16x16x32_bf16 v[72:75], a[160:163], a[80:83], v[100:103]
ds_read_b64_tr_b16 a[244:245], v23 offset:26272
v_exp_f32 v64, v64
v_mfma_f32_16x16x32_bf16 v[72:75], a[164:167], a[84:87], v[72:75]
ds_read_b64_tr_b16 a[246:247], v23 offset:30624
v_exp_f32 v65, v65
v_mfma_f32_16x16x32_bf16 v[72:75], a[168:171], a[88:91], v[72:75]
ds_read_b64_tr_b16 a[248:249], v22 offset:26304
v_cvt_pk_bf16_f32 v80, v64, v65
v_mfma_f32_16x16x32_bf16 v[72:75], a[172:175], a[92:95], v[72:75]
s_add_u32 s41, s41, 34816
v_exp_f32 v66, v66
v_mfma_f32_16x16x32_bf16 v[224:227], a[192:195], v[84:87], v[224:227]
s_add_u32 m0, s38, 9536
v_add_f32 v88, v88, v64
v_add_f32 v89, v89, v65
v_mfma_f32_16x16x32_bf16 v[228:231], a[196:199], v[84:87], v[228:231]
s_cmp_eq_u32 s41, 139264
buffer_load_dwordx4 v25, s[20:23], s39 offen offset:256 nt lds
v_exp_f32 v67, v67
v_mfma_f32_16x16x32_bf16 v[232:235], a[200:203], v[84:87], v[232:235]
ds_read_b64_tr_b16 a[250:251], v22 offset:30656
v_cvt_pk_bf16_f32 v81, v66, v67
v_mfma_f32_16x16x32_bf16 v[236:239], a[204:207], v[84:87], v[236:239]
s_cselect_b32 s41, 0, s41
v_exp_f32 v68, v68
v_mfma_f32_16x16x32_bf16 v[76:79], a[176:179], a[80:83], v[100:103]
v_add_f32 v88, v88, v66
v_add_f32 v89, v89, v67
v_mfma_f32_16x16x32_bf16 v[76:79], a[180:183], a[84:87], v[76:79]
v_exp_f32 v69, v69
v_mfma_f32_16x16x32_bf16 v[76:79], a[184:187], a[88:91], v[76:79]
ds_read_b64_tr_b16 a[252:253], v23 offset:26336
v_cvt_pk_bf16_f32 v82, v68, v69
v_mfma_f32_16x16x32_bf16 v[76:79], a[188:191], a[92:95], v[76:79]
v_exp_f32 v70, v70
v_mfma_f32_16x16x32_bf16 v[240:243], a[208:211], v[84:87], v[240:243]
v_add_f32 v88, v88, v68
v_add_f32 v89, v89, v69
v_mfma_f32_16x16x32_bf16 v[244:247], a[212:215], v[84:87], v[244:247]
v_exp_f32 v71, v71
v_mfma_f32_16x16x32_bf16 v[248:251], a[216:219], v[84:87], v[248:251]
ds_read_b64_tr_b16 a[254:255], v23 offset:30688
v_cvt_pk_bf16_f32 v83, v70, v71
v_mfma_f32_16x16x32_bf16 v[252:255], a[220:223], v[84:87], v[252:255]
s_waitcnt lgkmcnt(6)
v_add_u32 v21, s41, v18
v_add_u32 v22, s41, v19
v_add_u32 v23, s41, v20
s_add_u32 s101, s101, 8192
s_add_u32 s100, s100, s92
s_and_b32 s39, s100, 0xf800
s_and_b32 s93, s101, 0x40000
s_or_b32 s39, s39, s93
s_add_u32 s38, s38, 17408
s_cmp_eq_u32 s38, s71
s_cselect_b32 s38, s70, s38
s_sub_u32 s32, s32, 1
s_cmp_lg_u32 s32, 0
v_add_f32 v88, v88, v70
v_add_f32 v89, v89, v71
s_cbranch_scc1 L_at_33
s_waitcnt vmcnt(20)
s_barrier
v_mfma_f32_16x16x32_bf16 v[64:67], a[160:163], a[96:99], v[104:107]
ds_read_b128 a[128:131], v21 offset:0
v_exp_f32 v72, v72
s_bfe_u32 s22, s4, 0x10001
s_mul_i32 s22, s22, 30
s_add_u32 s22, s22, s5
s_lshr_b32 s20, s22, 2
v_mfma_f32_16x16x32_bf16 v[64:67], a[164:167], a[100:103], v[64:67]
ds_read_b128 a[132:135], v21 offset:64
v_exp_f32 v73, v73
s_and_b32 s21, s22, 3
s_lshl_b32 s21, s21, 1
s_and_b32 s22, s4, 1
s_xor_b32 s22, s22, 1
v_mfma_f32_16x16x32_bf16 v[64:67], a[168:171], a[104:107], v[64:67]
ds_read_b128 a[136:139], v21 offset:128
v_cvt_pk_bf16_f32 v84, v72, v73
s_add_u32 s21, s21, s22
s_cmp_lt_u32 s5, 30
s_cselect_b32 s33, 1, 0
s_lshl_b32 s22, s21, 8
s_add_u32 s12, s56, s22
s_addc_u32 s13, s57, 0
v_mfma_f32_16x16x32_bf16 v[64:67], a[172:175], a[108:111], v[64:67]
v_exp_f32 v74, v74
s_sub_u32 s14, 8388608, s22
s_cmp_lg_u32 s33, 0
s_cselect_b32 s14, s14, 0
s_cselect_b32 s10, 0x100000, 0
s_mov_b32 s15, 0x20000
s_cselect_b32 s34, 0xffff, 0
s_cmp_eq_u32 s66, 0
s_cselect_b32 s34, s34, 0
s_cmp_eq_u32 s3, 0
s_cselect_b32 s34, s34, 0
v_mfma_f32_16x16x32_bf16 v[128:131], a[224:227], v[80:83], v[128:131]
v_add_f32 v90, v90, v72
v_add_f32 v91, v91, v73
s_mov_b32 s35, 0
s_lshl_b32 s32, s3, 12
s_mov_b32 s28, 524288
s_mov_b32 s29, 0
v_mfma_f32_16x16x32_bf16 v[132:135], a[228:231], v[80:83], v[132:135]
v_exp_f32 v75, v75
s_mul_i32 s22, s6, 120
s_lshl_b32 s23, s20, 3
s_add_u32 s22, s22, s23
s_lshl_b32 s22, s22, 17
v_mfma_f32_16x16x32_bf16 v[136:139], a[232:235], v[80:83], v[136:139]
ds_read_b128 a[140:143], v21 offset:192
v_cvt_pk_bf16_f32 v85, v74, v75
s_add_u32 s8, s64, s22
s_addc_u32 s9, s65, 0
s_mov_b32 s11, 0x20000
s_add_u32 s22, s23, 7
s_mul_i32 s23, s23, 4370
v_mfma_f32_16x16x32_bf16 v[140:143], a[236:239], v[80:83], v[140:143]
v_exp_f32 v76, v76
s_mul_i32 s22, s22, 4370
s_lshr_b32 s22, s22, 16
s_lshr_b32 s23, s23, 16
s_lshl_b32 s31, s6, 3
v_mfma_f32_16x16x32_bf16 v[68:71], a[176:179], a[96:99], v[104:107]
v_add_f32 v90, v90, v74
v_add_f32 v91, v91, v75
s_add_u32 s22, s22, s31
s_add_u32 s23, s23, s31
s_mul_i32 s22, s22, 16
s_mul_i32 s23, s23, 16
v_mfma_f32_16x16x32_bf16 v[68:71], a[180:183], a[100:103], v[68:71]
v_exp_f32 v77, v77
s_cmp_eq_u32 s3, 0
s_cselect_b32 s22, s22, 0x40000000
s_cselect_b32 s23, s23, 0x40000000
v_lshrrev_b32 v48, 4, v1
v_and_b32 v49, 15, v1
v_lshlrev_b32 v52, 1, v48
v_mfma_f32_16x16x32_bf16 v[68:71], a[184:187], a[104:107], v[68:71]
ds_read_b128 a[144:147], v21 offset:4352
v_cvt_pk_bf16_f32 v86, v76, v77
v_xor_b32 v52, v49, v52
v_xor_b32 v53, 8, v52
s_lshl_b32 s31, s3, 15
v_lshlrev_b32 v54, 11, v48
v_mfma_f32_16x16x32_bf16 v[68:71], a[188:191], a[108:111], v[68:71]
s_waitcnt lgkmcnt(5)
v_exp_f32 v78, v78
v_add_u32 v54, s31, v54
v_lshl_add_u32 v2, v52, 4, v54
v_lshl_add_u32 v3, v53, 4, v54
v_add_u32 v3, 8192, v3
v_mfma_f32_16x16x32_bf16 v[144:147], a[240:243], v[80:83], v[144:147]
v_add_f32 v90, v90, v76
v_add_f32 v91, v91, v77
v_lshl_add_u32 v4, v52, 4, v54
v_add_u32 v4, 16384, v4
v_lshl_add_u32 v5, v53, 4, v54
v_add_u32 v5, 24576, v5
v_mfma_f32_16x16x32_bf16 v[148:151], a[244:247], v[80:83], v[148:151]
v_exp_f32 v79, v79
v_and_b32 v54, 1, v1
v_mov_b32 v8, s22
v_mov_b32 v52, s23
v_cmp_eq_u32 vcc, 1, v54
v_mfma_f32_16x16x32_bf16 v[152:155], a[248:251], v[80:83], v[152:155]
ds_read_b128 a[148:151], v21 offset:4416
v_cvt_pk_bf16_f32 v87, v78, v79
s_lshl_b32 s31, s3, 18
v_lshlrev_b32 v6, 4, v1
v_cndmask_b32 v8, v8, v52, vcc
v_add_u32 v6, s31, v6
v_add_u32 v7, 131072, v6
v_mfma_f32_16x16x32_bf16 v[156:159], a[252:255], v[80:83], v[156:159]
v_add_f32 v90, v90, v78
v_add_f32 v91, v91, v79
v_mfma_f32_16x16x32_bf16 v[72:75], a[160:163], a[112:115], v[108:111]
ds_read_b128 a[152:155], v21 offset:4480
v_exp_f32 v64, v64
v_mfma_f32_16x16x32_bf16 v[72:75], a[164:167], a[116:119], v[72:75]
ds_read_b128 a[156:159], v21 offset:4544
v_exp_f32 v65, v65
v_mfma_f32_16x16x32_bf16 v[72:75], a[168:171], a[120:123], v[72:75]
ds_read_b64_tr_b16 a[192:193], v22 offset:8704
v_cvt_pk_bf16_f32 v80, v64, v65
s_cmp_eq_u32 s34, 0
s_cbranch_scc1 L_nsp
s_load_dword s48, s[60:61], s22 glc
s_load_dword s49, s[60:61], s23 glc
L_nsp:
v_mfma_f32_16x16x32_bf16 v[72:75], a[172:175], a[124:127], v[72:75]
v_exp_f32 v66, v66
v_mfma_f32_16x16x32_bf16 v[160:163], a[224:227], v[84:87], v[160:163]
s_add_u32 m0, s32, 104448
v_add_f32 v92, v92, v64
v_add_f32 v93, v93, v65
v_mfma_f32_16x16x32_bf16 v[164:167], a[228:231], v[84:87], v[164:167]
buffer_load_dwordx4 v2, s[12:15], s28 offen  lds
v_exp_f32 v67, v67
v_mfma_f32_16x16x32_bf16 v[168:171], a[232:235], v[84:87], v[168:171]
ds_read_b64_tr_b16 a[194:195], v22 offset:13056
v_cvt_pk_bf16_f32 v81, v66, v67
v_mfma_f32_16x16x32_bf16 v[172:175], a[236:239], v[84:87], v[172:175]
v_exp_f32 v68, v68
v_mfma_f32_16x16x32_bf16 v[76:79], a[176:179], a[112:115], v[108:111]
v_add_f32 v92, v92, v66
v_add_f32 v93, v93, v67
v_mfma_f32_16x16x32_bf16 v[76:79], a[180:183], a[116:119], v[76:79]
v_exp_f32 v69, v69
v_mfma_f32_16x16x32_bf16 v[76:79], a[184:187], a[120:123], v[76:79]
ds_read_b64_tr_b16 a[196:197], v23 offset:8736
v_cvt_pk_bf16_f32 v82, v68, v69
v_mfma_f32_16x16x32_bf16 v[76:79], a[188:191], a[124:127], v[76:79]
v_exp_f32 v70, v70
v_mfma_f32_16x16x32_bf16 v[176:179], a[240:243], v[84:87], v[176:179]
v_add_f32 v92, v92, v68
v_add_f32 v93, v93, v69
v_mfma_f32_16x16x32_bf16 v[180:183], a[244:247], v[84:87], v[180:183]
v_exp_f32 v71, v71
v_mfma_f32_16x16x32_bf16 v[184:187], a[248:251], v[84:87], v[184:187]
ds_read_b64_tr_b16 a[198:199], v23 offset:13088
v_cvt_pk_bf16_f32 v83, v70, v71
v_mfma_f32_16x16x32_bf16 v[188:191], a[252:255], v[84:87], v[188:191]
s_waitcnt lgkmcnt(6)
v_add_f32 v92, v92, v70
v_add_f32 v93, v93, v71
v_mfma_f32_16x16x32_bf16 v[64:67], a[128:131], a[64:67], v[96:99]
ds_read_b64_tr_b16 a[200:201], v22 offset:8768
v_exp_f32 v72, v72
v_mfma_f32_16x16x32_bf16 v[64:67], a[132:135], a[68:71], v[64:67]
ds_read_b64_tr_b16 a[202:203], v22 offset:13120
v_exp_f32 v73, v73
v_mfma_f32_16x16x32_bf16 v[64:67], a[136:139], a[72:75], v[64:67]
ds_read_b64_tr_b16 a[204:205], v23 offset:8800
v_cvt_pk_bf16_f32 v84, v72, v73
v_mfma_f32_16x16x32_bf16 v[64:67], a[140:143], a[76:79], v[64:67]
v_exp_f32 v74, v74
v_mfma_f32_16x16x32_bf16 v[192:195], a[224:227], v[80:83], v[192:195]
s_add_u32 m0, s32, 105472
v_add_f32 v94, v94, v72
v_add_f32 v95, v95, v73
v_mfma_f32_16x16x32_bf16 v[196:199], a[228:231], v[80:83], v[196:199]
buffer_load_dwordx4 v3, s[12:15], s28 offen  lds
v_exp_f32 v75, v75
v_mfma_f32_16x16x32_bf16 v[200:203], a[232:235], v[80:83], v[200:203]
ds_read_b64_tr_b16 a[206:207], v23 offset:13152
v_cvt_pk_bf16_f32 v85, v74, v75
v_mfma_f32_16x16x32_bf16 v[204:207], a[236:239], v[80:83], v[204:207]
s_waitcnt lgkmcnt(8)
v_exp_f32 v76, v76
v_mfma_f32_16x16x32_bf16 v[68:71], a[144:147], a[64:67], v[96:99]
v_add_f32 v94, v94, v74
v_add_f32 v95, v95, v75
v_mfma_f32_16x16x32_bf16 v[68:71], a[148:151], a[68:71], v[68:71]
v_exp_f32 v77, v77
v_mfma_f32_16x16x32_bf16 v[68:71], a[152:155], a[72:75], v[68:71]
ds_read_b64_tr_b16 a[208:209], v22 offset:8832
v_cvt_pk_bf16_f32 v86, v76, v77
v_mfma_f32_16x16x32_bf16 v[68:71], a[156:159], a[76:79], v[68:71]
v_exp_f32 v78, v78
v_mfma_f32_16x16x32_bf16 v[208:211], a[240:243], v[80:83], v[208:211]
v_add_f32 v94, v94, v76
v_add_f32 v95, v95, v77
v_mfma_f32_16x16x32_bf16 v[212:215], a[244:247], v[80:83], v[212:215]
v_exp_f32 v79, v79
v_mfma_f32_16x16x32_bf16 v[216:219], a[248:251], v[80:83], v[216:219]
ds_read_b64_tr_b16 a[210:211], v22 offset:13184
v_cvt_pk_bf16_f32 v87, v78, v79
v_mfma_f32_16x16x32_bf16 v[220:223], a[252:255], v[80:83], v[220:223]
s_waitcnt lgkmcnt(6)
v_add_f32 v94, v94, v78
v_add_f32 v95, v95, v79
v_mfma_f32_16x16x32_bf16 v[72:75], a[128:131], a[80:83], v[100:103]
ds_read_b64_tr_b16 a[212:213], v23 offset:8864
v_exp_f32 v64, v64
v_mfma_f32_16x16x32_bf16 v[72:75], a[132:135], a[84:87], v[72:75]
ds_read_b64_tr_b16 a[214:215], v23 offset:13216
v_exp_f32 v65, v65
v_mfma_f32_16x16x32_bf16 v[72:75], a[136:139], a[88:91], v[72:75]
ds_read_b64_tr_b16 a[216:217], v22 offset:8896
v_cvt_pk_bf16_f32 v80, v64, v65
v_mfma_f32_16x16x32_bf16 v[72:75], a[140:143], a[92:95], v[72:75]
v_exp_f32 v66, v66
v_mfma_f32_16x16x32_bf16 v[224:227], a[224:227], v[84:87], v[224:227]
s_add_u32 m0, s32, 106496
v_add_f32 v88, v88, v64
v_add_f32 v89, v89, v65
v_mfma_f32_16x16x32_bf16 v[228:231], a[228:231], v[84:87], v[228:231]
buffer_load_dwordx4 v4, s[12:15], s28 offen  lds
v_exp_f32 v67, v67
v_mfma_f32_16x16x32_bf16 v[232:235], a[232:235], v[84:87], v[232:235]
ds_read_b64_tr_b16 a[218:219], v22 offset:13248
v_cvt_pk_bf16_f32 v81, v66, v67
v_mfma_f32_16x16x32_bf16 v[236:239], a[236:239], v[84:87], v[236:239]
v_exp_f32 v68, v68
v_mfma_f32_16x16x32_bf16 v[76:79], a[144:147], a[80:83], v[100:103]
v_add_f32 v88, v88, v66
v_add_f32 v89, v89, v67
v_mfma_f32_16x16x32_bf16 v[76:79], a[148:151], a[84:87], v[76:79]
v_exp_f32 v69, v69
v_mfma_f32_16x16x32_bf16 v[76:79], a[152:155], a[88:91], v[76:79]
s_add_u32 m0, s32, 107520
ds_read_b64_tr_b16 a[220:221], v23 offset:8928
v_cvt_pk_bf16_f32 v82, v68, v69
v_mfma_f32_16x16x32_bf16 v[76:79], a[156:159], a[92:95], v[76:79]
buffer_load_dwordx4 v5, s[12:15], s28 offen  lds
v_exp_f32 v70, v70
s_add_u32 s28, s28, 1048576
v_mfma_f32_16x16x32_bf16 v[240:243], a[240:243], v[84:87], v[240:243]
v_add_f32 v88, v88, v68
v_add_f32 v89, v89, v69
v_mfma_f32_16x16x32_bf16 v[244:247], a[244:247], v[84:87], v[244:247]
v_exp_f32 v71, v71
v_mfma_f32_16x16x32_bf16 v[248:251], a[248:251], v[84:87], v[248:251]
ds_read_b64_tr_b16 a[222:223], v23 offset:13280
v_cvt_pk_bf16_f32 v83, v70, v71
v_mfma_f32_16x16x32_bf16 v[252:255], a[252:255], v[84:87], v[252:255]
s_waitcnt lgkmcnt(6)
v_add_f32 v88, v88, v70
v_add_f32 v89, v89, v71
s_waitcnt vmcnt(20)
s_barrier
v_mfma_f32_16x16x32_bf16 v[64:67], a[128:131], a[96:99], v[104:107]
ds_read_b128 a[160:163], v21 offset:17408
v_exp_f32 v72, v72
v_mfma_f32_16x16x32_bf16 v[64:67], a[132:135], a[100:103], v[64:67]
ds_read_b128 a[164:167], v21 offset:17472
v_exp_f32 v73, v73
v_mfma_f32_16x16x32_bf16 v[64:67], a[136:139], a[104:107], v[64:67]
ds_read_b128 a[168:171], v21 offset:17536
v_cvt_pk_bf16_f32 v84, v72, v73
v_mfma_f32_16x16x32_bf16 v[64:67], a[140:143], a[108:111], v[64:67]
v_exp_f32 v74, v74
v_mfma_f32_16x16x32_bf16 v[128:131], a[192:195], v[80:83], v[128:131]
s_add_u32 m0, s32, 121856
v_add_f32 v90, v90, v72
v_add_f32 v91, v91, v73
v_mfma_f32_16x16x32_bf16 v[132:135], a[196:199], v[80:83], v[132:135]
buffer_load_dwordx4 v2, s[12:15], s28 offen  lds
v_exp_f32 v75, v75
v_mfma_f32_16x16x32_bf16 v[136:139], a[200:203], v[80:83], v[136:139]
ds_read_b128 a[172:175], v21 offset:17600
v_cvt_pk_bf16_f32 v85, v74, v75
v_mfma_f32_16x16x32_bf16 v[140:143], a[204:207], v[80:83], v[140:143]
v_exp_f32 v76, v76
v_mfma_f32_16x16x32_bf16 v[68:71], a[144:147], a[96:99], v[104:107]
v_add_f32 v90, v90, v74
v_add_f32 v91, v91, v75
v_mfma_f32_16x16x32_bf16 v[68:71], a[148:151], a[100:103], v[68:71]
v_exp_f32 v77, v77
v_mfma_f32_16x16x32_bf16 v[68:71], a[152:155], a[104:107], v[68:71]
ds_read_b128 a[176:179], v21 offset:21760
v_cvt_pk_bf16_f32 v86, v76, v77
v_mfma_f32_16x16x32_bf16 v[68:71], a[156:159], a[108:111], v[68:71]
s_waitcnt lgkmcnt(5)
v_exp_f32 v78, v78
v_mfma_f32_16x16x32_bf16 v[144:147], a[208:211], v[80:83], v[144:147]
v_add_f32 v90, v90, v76
v_add_f32 v91, v91, v77
v_mfma_f32_16x16x32_bf16 v[148:151], a[212:215], v[80:83], v[148:151]
v_exp_f32 v79, v79
v_mfma_f32_16x16x32_bf16 v[152:155], a[216:219], v[80:83], v[152:155]
ds_read_b128 a[180:183], v21 offset:21824
v_cvt_pk_bf16_f32 v87, v78, v79
v_mfma_f32_16x16x32_bf16 v[156:159], a[220:223], v[80:83], v[156:159]
v_add_f32 v90, v90, v78
v_add_f32 v91, v91, v79
v_mfma_f32_16x16x32_bf16 v[72:75], a[128:131], a[112:115], v[108:111]
ds_read_b128 a[184:187], v21 offset:21888
v_exp_f32 v64, v64
s_lshl_b32 s22, s21, 8
s_lshl_b32 s23, s20, 19
v_mfma_f32_16x16x32_bf16 v[72:75], a[132:135], a[116:119], v[72:75]
ds_read_b128 a[188:191], v21 offset:21952
v_exp_f32 v65, v65
s_lshl_b32 s31, s6, 11
s_add_u32 s23, s23, s31
s_add_u32 s23, s23, s22
v_mfma_f32_16x16x32_bf16 v[72:75], a[136:139], a[120:123], v[72:75]
ds_read_b64_tr_b16 a[224:225], v22 offset:26112
v_cvt_pk_bf16_f32 v80, v64, v65
s_add_u32 s16, s58, s23
s_addc_u32 s17, s59, 0
s_sub_u32 s18, 7864320, s23
v_mfma_f32_16x16x32_bf16 v[72:75], a[140:143], a[124:127], v[72:75]
v_exp_f32 v66, v66
s_mov_b32 s19, 0x20000
s_mov_b32 s36, 4287102976
v_lshrrev_b32 v50, 2, v49
v_mfma_f32_16x16x32_bf16 v[160:163], a[192:195], v[84:87], v[160:163]
s_add_u32 m0, s32, 122880
v_add_f32 v92, v92, v64
v_add_f32 v93, v93, v65
v_and_b32 v51, 3, v49
v_lshl_add_u32 v52, v48, 2, v50
v_and_b32 v53, 7, v52
v_mfma_f32_16x16x32_bf16 v[164:167], a[196:199], v[84:87], v[164:167]
buffer_load_dwordx4 v3, s[12:15], s28 offen  lds
v_exp_f32 v67, v67
v_lshlrev_b32 v52, 8, v52
v_lshl_add_u32 v52, v51, 3, v52
v_mfma_f32_16x16x32_bf16 v[168:171], a[200:203], v[84:87], v[168:171]
ds_read_b64_tr_b16 a[226:227], v22 offset:30464
v_cvt_pk_bf16_f32 v81, v66, v67
v_lshl_add_u32 v52, v53, 5, v52
v_xor_b32 v32, 0, v52
v_xor_b32 v33, 32, v52
v_mfma_f32_16x16x32_bf16 v[172:175], a[204:207], v[84:87], v[172:175]
v_exp_f32 v68, v68
v_xor_b32 v34, 64, v52
v_xor_b32 v35, 96, v52
v_mfma_f32_16x16x32_bf16 v[76:79], a[144:147], a[112:115], v[108:111]
v_add_f32 v92, v92, v66
v_add_f32 v93, v93, v67
v_xor_b32 v36, 128, v52
v_xor_b32 v37, 160, v52
v_xor_b32 v38, 192, v52
v_mfma_f32_16x16x32_bf16 v[76:79], a[148:151], a[116:119], v[76:79]
v_exp_f32 v69, v69
v_xor_b32 v39, 224, v52
v_add_u32 v40, 69632, v32
v_add_u32 v41, 69632, v33
v_mfma_f32_16x16x32_bf16 v[76:79], a[152:155], a[120:123], v[76:79]
ds_read_b64_tr_b16 a[228:229], v23 offset:26144
v_cvt_pk_bf16_f32 v82, v68, v69
v_add_u32 v42, 69632, v34
v_add_u32 v43, 69632, v35
v_mfma_f32_16x16x32_bf16 v[76:79], a[156:159], a[124:127], v[76:79]
v_exp_f32 v70, v70
v_add_u32 v44, 69632, v36
v_add_u32 v45, 69632, v37
v_add_u32 v46, 69632, v38
v_mfma_f32_16x16x32_bf16 v[176:179], a[208:211], v[84:87], v[176:179]
v_add_f32 v92, v92, v68
v_add_f32 v93, v93, v69
v_add_u32 v47, 69632, v39
s_lshl_b32 s22, s3, 17
v_mfma_f32_16x16x32_bf16 v[180:183], a[212:215], v[84:87], v[180:183]
v_exp_f32 v71, v71
v_lshlrev_b32 v10, 12, v49
v_and_b32 v52, 1, v48
v_lshl_add_u32 v10, v52, 5, v10
v_mfma_f32_16x16x32_bf16 v[184:187], a[216:219], v[84:87], v[184:187]
ds_read_b64_tr_b16 a[230:231], v23 offset:30496
v_cvt_pk_bf16_f32 v83, v70, v71
v_lshrrev_b32 v52, 1, v48
v_lshl_add_u32 v10, v52, 4, v10
v_add_u32 v10, s22, v10
v_mfma_f32_16x16x32_bf16 v[188:191], a[220:223], v[84:87], v[188:191]
s_waitcnt lgkmcnt(6)
v_add_f32 v92, v92, v70
v_add_f32 v93, v93, v71
v_mfma_f32_16x16x32_bf16 v[64:67], a[160:163], a[64:67], v[96:99]
ds_read_b64_tr_b16 a[232:233], v22 offset:26176
v_exp_f32 v72, v72
v_mfma_f32_16x16x32_bf16 v[64:67], a[164:167], a[68:71], v[64:67]
ds_read_b64_tr_b16 a[234:235], v22 offset:30528
v_exp_f32 v73, v73
v_mfma_f32_16x16x32_bf16 v[64:67], a[168:171], a[72:75], v[64:67]
ds_read_b64_tr_b16 a[236:237], v23 offset:26208
v_cvt_pk_bf16_f32 v84, v72, v73
v_mfma_f32_16x16x32_bf16 v[64:67], a[172:175], a[76:79], v[64:67]
v_exp_f32 v74, v74
v_mfma_f32_16x16x32_bf16 v[192:195], a[192:195], v[80:83], v[192:195]
s_add_u32 m0, s32, 123904
v_add_f32 v94, v94, v72
v_add_f32 v95, v95, v73
v_mfma_f32_16x16x32_bf16 v[196:199], a[196:199], v[80:83], v[196:199]
buffer_load_dwordx4 v4, s[12:15], s28 offen  lds
v_exp_f32 v75, v75
v_mfma_f32_16x16x32_bf16 v[200:203], a[200:203], v[80:83], v[200:203]
ds_read_b64_tr_b16 a[238:239], v23 offset:30560
v_cvt_pk_bf16_f32 v85, v74, v75
v_mfma_f32_16x16x32_bf16 v[204:207], a[204:207], v[80:83], v[204:207]
s_waitcnt lgkmcnt(8)
v_exp_f32 v76, v76
v_mfma_f32_16x16x32_bf16 v[68:71], a[176:179], a[64:67], v[96:99]
v_add_f32 v94, v94, v74
v_add_f32 v95, v95, v75
v_mfma_f32_16x16x32_bf16 v[68:71], a[180:183], a[68:71], v[68:71]
v_exp_f32 v77, v77
v_mfma_f32_16x16x32_bf16 v[68:71], a[184:187], a[72:75], v[68:71]
ds_read_b64_tr_b16 a[240:241], v22 offset:26240
v_cvt_pk_bf16_f32 v86, v76, v77
v_mfma_f32_16x16x32_bf16 v[68:71], a[188:191], a[76:79], v[68:71]
v_exp_f32 v78, v78
v_mfma_f32_16x16x32_bf16 v[208:211], a[208:211], v[80:83], v[208:211]
v_add_f32 v94, v94, v76
v_add_f32 v95, v95, v77
v_mfma_f32_16x16x32_bf16 v[212:215], a[212:215], v[80:83], v[212:215]
v_exp_f32 v79, v79
v_mfma_f32_16x16x32_bf16 v[216:219], a[216:219], v[80:83], v[216:219]
ds_read_b64_tr_b16 a[242:243], v22 offset:30592
v_cvt_pk_bf16_f32 v87, v78, v79
v_mfma_f32_16x16x32_bf16 v[220:223], a[220:223], v[80:83], v[220:223]
s_waitcnt lgkmcnt(6)
v_add_f32 v94, v94, v78
v_add_f32 v95, v95, v79
v_mfma_f32_16x16x32_bf16 v[72:75], a[160:163], a[80:83], v[100:103]
ds_read_b64_tr_b16 a[244:245], v23 offset:26272
v_exp_f32 v64, v64
v_mfma_f32_16x16x32_bf16 v[72:75], a[164:167], a[84:87], v[72:75]
ds_read_b64_tr_b16 a[246:247], v23 offset:30624
v_exp_f32 v65, v65
v_mfma_f32_16x16x32_bf16 v[72:75], a[168:171], a[88:91], v[72:75]
ds_read_b64_tr_b16 a[248:249], v22 offset:26304
v_cvt_pk_bf16_f32 v80, v64, v65
v_mfma_f32_16x16x32_bf16 v[72:75], a[172:175], a[92:95], v[72:75]
s_add_u32 s41, s41, 34816
v_exp_f32 v66, v66
v_mfma_f32_16x16x32_bf16 v[224:227], a[192:195], v[84:87], v[224:227]
s_add_u32 m0, s32, 124928
v_add_f32 v88, v88, v64
v_add_f32 v89, v89, v65
v_mfma_f32_16x16x32_bf16 v[228:231], a[196:199], v[84:87], v[228:231]
s_cmp_eq_u32 s41, 139264
buffer_load_dwordx4 v5, s[12:15], s28 offen  lds
v_exp_f32 v67, v67
v_mfma_f32_16x16x32_bf16 v[232:235], a[200:203], v[84:87], v[232:235]
ds_read_b64_tr_b16 a[250:251], v22 offset:30656
v_cvt_pk_bf16_f32 v81, v66, v67
v_mfma_f32_16x16x32_bf16 v[236:239], a[204:207], v[84:87], v[236:239]
s_cselect_b32 s41, 0, s41
v_exp_f32 v68, v68
v_mfma_f32_16x16x32_bf16 v[76:79], a[176:179], a[80:83], v[100:103]
v_add_f32 v88, v88, v66
v_add_f32 v89, v89, v67
v_mfma_f32_16x16x32_bf16 v[76:79], a[180:183], a[84:87], v[76:79]
v_exp_f32 v69, v69
s_add_u32 s28, s28, 1048576
v_mfma_f32_16x16x32_bf16 v[76:79], a[184:187], a[88:91], v[76:79]
ds_read_b64_tr_b16 a[252:253], v23 offset:26336
v_cvt_pk_bf16_f32 v82, v68, v69
v_mfma_f32_16x16x32_bf16 v[76:79], a[188:191], a[92:95], v[76:79]
v_exp_f32 v70, v70
v_mfma_f32_16x16x32_bf16 v[240:243], a[208:211], v[84:87], v[240:243]
v_add_f32 v88, v88, v68
v_add_f32 v89, v89, v69
v_mfma_f32_16x16x32_bf16 v[244:247], a[212:215], v[84:87], v[244:247]
v_exp_f32 v71, v71
v_mfma_f32_16x16x32_bf16 v[248:251], a[216:219], v[84:87], v[248:251]
ds_read_b64_tr_b16 a[254:255], v23 offset:30688
v_cvt_pk_bf16_f32 v83, v70, v71
v_mfma_f32_16x16x32_bf16 v[252:255], a[220:223], v[84:87], v[252:255]
s_waitcnt lgkmcnt(6)
v_add_u32 v21, s41, v18
v_add_u32 v22, s41, v19
v_add_u32 v23, s41, v20
v_add_f32 v88, v88, v70
v_add_f32 v89, v89, v71
s_waitcnt vmcnt(20)
s_barrier
v_mfma_f32_16x16x32_bf16 v[64:67], a[160:163], a[96:99], v[104:107]
ds_read_b128 a[128:131], v21 offset:0
v_exp_f32 v72, v72
v_mfma_f32_16x16x32_bf16 v[64:67], a[164:167], a[100:103], v[64:67]
ds_read_b128 a[132:135], v21 offset:64
v_exp_f32 v73, v73
v_mfma_f32_16x16x32_bf16 v[64:67], a[168:171], a[104:107], v[64:67]
ds_read_b128 a[136:139], v21 offset:128
v_cvt_pk_bf16_f32 v84, v72, v73
v_mfma_f32_16x16x32_bf16 v[64:67], a[172:175], a[108:111], v[64:67]
v_exp_f32 v74, v74
v_mfma_f32_16x16x32_bf16 v[128:131], a[224:227], v[80:83], v[128:131]
s_add_u32 m0, s32, 0
v_add_f32 v90, v90, v72
v_add_f32 v91, v91, v73
v_mfma_f32_16x16x32_bf16 v[132:135], a[228:231], v[80:83], v[132:135]
buffer_load_dwordx4 v2, s[12:15], s28 offen  lds
v_exp_f32 v75, v75
v_mfma_f32_16x16x32_bf16 v[136:139], a[232:235], v[80:83], v[136:139]
ds_read_b128 a[140:143], v21 offset:192
v_cvt_pk_bf16_f32 v85, v74, v75
v_mfma_f32_16x16x32_bf16 v[140:143], a[236:239], v[80:83], v[140:143]
v_exp_f32 v76, v76
v_mfma_f32_16x16x32_bf16 v[68:71], a[176:179], a[96:99], v[104:107]
v_add_f32 v90, v90, v74
v_add_f32 v91, v91, v75
v_mfma_f32_16x16x32_bf16 v[68:71], a[180:183], a[100:103], v[68:71]
v_exp_f32 v77, v77
v_mfma_f32_16x16x32_bf16 v[68:71], a[184:187], a[104:107], v[68:71]
ds_read_b128 a[144:147], v21 offset:4352
v_cvt_pk_bf16_f32 v86, v76, v77
v_mfma_f32_16x16x32_bf16 v[68:71], a[188:191], a[108:111], v[68:71]
s_waitcnt lgkmcnt(5)
v_exp_f32 v78, v78
v_mfma_f32_16x16x32_bf16 v[144:147], a[240:243], v[80:83], v[144:147]
v_add_f32 v90, v90, v76
v_add_f32 v91, v91, v77
v_mfma_f32_16x16x32_bf16 v[148:151], a[244:247], v[80:83], v[148:151]
v_exp_f32 v79, v79
v_mfma_f32_16x16x32_bf16 v[152:155], a[248:251], v[80:83], v[152:155]
ds_read_b128 a[148:151], v21 offset:4416
v_cvt_pk_bf16_f32 v87, v78, v79
v_mfma_f32_16x16x32_bf16 v[156:159], a[252:255], v[80:83], v[156:159]
v_add_f32 v90, v90, v78
v_add_f32 v91, v91, v79
v_mfma_f32_16x16x32_bf16 v[72:75], a[160:163], a[112:115], v[108:111]
ds_read_b128 a[152:155], v21 offset:4480
v_exp_f32 v64, v64
v_mfma_f32_16x16x32_bf16 v[72:75], a[164:167], a[116:119], v[72:75]
ds_read_b128 a[156:159], v21 offset:4544
v_exp_f32 v65, v65
v_mfma_f32_16x16x32_bf16 v[72:75], a[168:171], a[120:123], v[72:75]
ds_read_b64_tr_b16 a[192:193], v22 offset:8704
v_cvt_pk_bf16_f32 v80, v64, v65
v_mfma_f32_16x16x32_bf16 v[72:75], a[172:175], a[124:127], v[72:75]
v_exp_f32 v66, v66
v_mfma_f32_16x16x32_bf16 v[160:163], a[224:227], v[84:87], v[160:163]
s_add_u32 m0, s32, 1024
v_add_f32 v92, v92, v64
v_add_f32 v93, v93, v65
v_mfma_f32_16x16x32_bf16 v[164:167], a[228:231], v[84:87], v[164:167]
buffer_load_dwordx4 v3, s[12:15], s28 offen  lds
v_exp_f32 v67, v67
v_mfma_f32_16x16x32_bf16 v[168:171], a[232:235], v[84:87], v[168:171]
ds_read_b64_tr_b16 a[194:195], v22 offset:13056
v_cvt_pk_bf16_f32 v81, v66, v67
v_mfma_f32_16x16x32_bf16 v[172:175], a[236:239], v[84:87], v[172:175]
v_exp_f32 v68, v68
v_mfma_f32_16x16x32_bf16 v[76:79], a[176:179], a[112:115], v[108:111]
v_add_f32 v92, v92, v66
v_add_f32 v93, v93, v67
v_mfma_f32_16x16x32_bf16 v[76:79], a[180:183], a[116:119], v[76:79]
v_exp_f32 v69, v69
v_mfma_f32_16x16x32_bf16 v[76:79], a[184:187], a[120:123], v[76:79]
ds_read_b64_tr_b16 a[196:197], v23 offset:8736
v_cvt_pk_bf16_f32 v82, v68, v69
v_mfma_f32_16x16x32_bf16 v[76:79], a[188:191], a[124:127], v[76:79]
v_exp_f32 v70, v70
v_mfma_f32_16x16x32_bf16 v[176:179], a[240:243], v[84:87], v[176:179]
v_add_f32 v92, v92, v68
v_add_f32 v93, v93, v69
v_mfma_f32_16x16x32_bf16 v[180:183], a[244:247], v[84:87], v[180:183]
v_exp_f32 v71, v71
v_mfma_f32_16x16x32_bf16 v[184:187], a[248:251], v[84:87], v[184:187]
ds_read_b64_tr_b16 a[198:199], v23 offset:13088
v_cvt_pk_bf16_f32 v83, v70, v71
v_mfma_f32_16x16x32_bf16 v[188:191], a[252:255], v[84:87], v[188:191]
s_waitcnt lgkmcnt(6)
v_add_f32 v92, v92, v70
v_add_f32 v93, v93, v71
v_mfma_f32_16x16x32_bf16 v[64:67], a[128:131], a[64:67], v[96:99]
ds_read_b64_tr_b16 a[200:201], v22 offset:8768
v_exp_f32 v72, v72
v_mfma_f32_16x16x32_bf16 v[64:67], a[132:135], a[68:71], v[64:67]
ds_read_b64_tr_b16 a[202:203], v22 offset:13120
v_exp_f32 v73, v73
v_mfma_f32_16x16x32_bf16 v[64:67], a[136:139], a[72:75], v[64:67]
ds_read_b64_tr_b16 a[204:205], v23 offset:8800
v_cvt_pk_bf16_f32 v84, v72, v73
v_mfma_f32_16x16x32_bf16 v[64:67], a[140:143], a[76:79], v[64:67]
v_exp_f32 v74, v74
v_mfma_f32_16x16x32_bf16 v[192:195], a[224:227], v[80:83], v[192:195]
s_add_u32 m0, s32, 2048
v_add_f32 v94, v94, v72
v_add_f32 v95, v95, v73
v_mfma_f32_16x16x32_bf16 v[196:199], a[228:231], v[80:83], v[196:199]
buffer_load_dwordx4 v4, s[12:15], s28 offen  lds
v_exp_f32 v75, v75
v_mfma_f32_16x16x32_bf16 v[200:203], a[232:235], v[80:83], v[200:203]
ds_read_b64_tr_b16 a[206:207], v23 offset:13152
v_cvt_pk_bf16_f32 v85, v74, v75
v_mfma_f32_16x16x32_bf16 v[204:207], a[236:239], v[80:83], v[204:207]
s_waitcnt lgkmcnt(8)
v_exp_f32 v76, v76
v_mfma_f32_16x16x32_bf16 v[68:71], a[144:147], a[64:67], v[96:99]
v_add_f32 v94, v94, v74
v_add_f32 v95, v95, v75
v_mfma_f32_16x16x32_bf16 v[68:71], a[148:151], a[68:71], v[68:71]
v_exp_f32 v77, v77
v_mfma_f32_16x16x32_bf16 v[68:71], a[152:155], a[72:75], v[68:71]
ds_read_b64_tr_b16 a[208:209], v22 offset:8832
v_cvt_pk_bf16_f32 v86, v76, v77
v_mfma_f32_16x16x32_bf16 v[68:71], a[156:159], a[76:79], v[68:71]
v_exp_f32 v78, v78
v_mfma_f32_16x16x32_bf16 v[208:211], a[240:243], v[80:83], v[208:211]
v_add_f32 v94, v94, v76
v_add_f32 v95, v95, v77
v_mfma_f32_16x16x32_bf16 v[212:215], a[244:247], v[80:83], v[212:215]
v_exp_f32 v79, v79
v_mfma_f32_16x16x32_bf16 v[216:219], a[248:251], v[80:83], v[216:219]
ds_read_b64_tr_b16 a[210:211], v22 offset:13184
v_cvt_pk_bf16_f32 v87, v78, v79
v_mfma_f32_16x16x32_bf16 v[220:223], a[252:255], v[80:83], v[220:223]
s_waitcnt lgkmcnt(6)
v_add_f32 v94, v94, v78
v_add_f32 v95, v95, v79
v_mfma_f32_16x16x32_bf16 v[72:75], a[128:131], a[80:83], v[100:103]
ds_read_b64_tr_b16 a[212:213], v23 offset:8864
v_exp_f32 v64, v64
v_mfma_f32_16x16x32_bf16 v[72:75], a[132:135], a[84:87], v[72:75]
ds_read_b64_tr_b16 a[214:215], v23 offset:13216
v_exp_f32 v65, v65
v_mfma_f32_16x16x32_bf16 v[72:75], a[136:139], a[88:91], v[72:75]
ds_read_b64_tr_b16 a[216:217], v22 offset:8896
v_cvt_pk_bf16_f32 v80, v64, v65
v_mfma_f32_16x16x32_bf16 v[72:75], a[140:143], a[92:95], v[72:75]
v_exp_f32 v66, v66
v_mfma_f32_16x16x32_bf16 v[224:227], a[224:227], v[84:87], v[224:227]
s_add_u32 m0, s32, 3072
v_add_f32 v88, v88, v64
v_add_f32 v89, v89, v65
v_mfma_f32_16x16x32_bf16 v[228:231], a[228:231], v[84:87], v[228:231]
buffer_load_dwordx4 v5, s[12:15], s28 offen  lds
v_exp_f32 v67, v67
v_mfma_f32_16x16x32_bf16 v[232:235], a[232:235], v[84:87], v[232:235]
ds_read_b64_tr_b16 a[218:219], v22 offset:13248
v_cvt_pk_bf16_f32 v81, v66, v67
v_mfma_f32_16x16x32_bf16 v[236:239], a[236:239], v[84:87], v[236:239]
v_exp_f32 v68, v68
v_mfma_f32_16x16x32_bf16 v[76:79], a[144:147], a[80:83], v[100:103]
v_add_f32 v88, v88, v66
v_add_f32 v89, v89, v67
v_mfma_f32_16x16x32_bf16 v[76:79], a[148:151], a[84:87], v[76:79]
v_exp_f32 v69, v69
s_add_u32 s28, s28, 1048576
v_mfma_f32_16x16x32_bf16 v[76:79], a[152:155], a[88:91], v[76:79]
ds_read_b64_tr_b16 a[220:221], v23 offset:8928
v_cvt_pk_bf16_f32 v82, v68, v69
v_mfma_f32_16x16x32_bf16 v[76:79], a[156:159], a[92:95], v[76:79]
v_exp_f32 v70, v70
v_mfma_f32_16x16x32_bf16 v[240:243], a[240:243], v[84:87], v[240:243]
v_add_f32 v88, v88, v68
v_add_f32 v89, v89, v69
v_mfma_f32_16x16x32_bf16 v[244:247], a[244:247], v[84:87], v[244:247]
v_exp_f32 v71, v71
v_mfma_f32_16x16x32_bf16 v[248:251], a[248:251], v[84:87], v[248:251]
ds_read_b64_tr_b16 a[222:223], v23 offset:13280
v_cvt_pk_bf16_f32 v83, v70, v71
v_mfma_f32_16x16x32_bf16 v[252:255], a[252:255], v[84:87], v[252:255]
s_waitcnt lgkmcnt(6)
v_add_f32 v88, v88, v70
v_add_f32 v89, v89, v71
s_cmp_eq_u32 s34, 0
s_cbranch_scc1 L_tback
s_waitcnt lgkmcnt(0)
s_and_b32 s48, s48, s49
s_and_b32 s48, s48, s34
s_cmp_lg_u32 s48, s34
s_cbranch_scc1 L_tslow
L_tback:
s_waitcnt vmcnt(20)
s_barrier
v_mfma_f32_16x16x32_bf16 v[64:67], a[128:131], a[96:99], v[104:107]
ds_read_b128 a[160:163], v21 offset:17408
v_exp_f32 v72, v72
v_mfma_f32_16x16x32_bf16 v[64:67], a[132:135], a[100:103], v[64:67]
ds_read_b128 a[164:167], v21 offset:17472
v_exp_f32 v73, v73
v_mfma_f32_16x16x32_bf16 v[64:67], a[136:139], a[104:107], v[64:67]
ds_read_b128 a[168:171], v21 offset:17536
v_cvt_pk_bf16_f32 v84, v72, v73
v_mfma_f32_16x16x32_bf16 v[64:67], a[140:143], a[108:111], v[64:67]
v_exp_f32 v74, v74
v_mfma_f32_16x16x32_bf16 v[128:131], a[192:195], v[80:83], v[128:131]
s_add_u32 m0, s32, 17408
v_add_f32 v90, v90, v72
v_add_f32 v91, v91, v73
v_mfma_f32_16x16x32_bf16 v[132:135], a[196:199], v[80:83], v[132:135]
buffer_load_dwordx4 v2, s[12:15], s28 offen  lds
v_exp_f32 v75, v75
v_mfma_f32_16x16x32_bf16 v[136:139], a[200:203], v[80:83], v[136:139]
ds_read_b128 a[172:175], v21 offset:17600
v_cvt_pk_bf16_f32 v85, v74, v75
v_mfma_f32_16x16x32_bf16 v[140:143], a[204:207], v[80:83], v[140:143]
v_exp_f32 v76, v76
v_mfma_f32_16x16x32_bf16 v[68:71], a[144:147], a[96:99], v[104:107]
buffer_load_dwordx4 a[0:3], v6, s[8:11], s29 offen offset:0 sc1
v_add_f32 v90, v90, v74
v_add_f32 v91, v91, v75
v_mfma_f32_16x16x32_bf16 v[68:71], a[148:151], a[100:103], v[68:71]
v_exp_f32 v77, v77
v_mfma_f32_16x16x32_bf16 v[68:71], a[152:155], a[104:107], v[68:71]
ds_read_b128 a[176:179], v21 offset:21760
v_cvt_pk_bf16_f32 v86, v76, v77
v_mfma_f32_16x16x32_bf16 v[68:71], a[156:159], a[108:111], v[68:71]
s_waitcnt lgkmcnt(5)
v_exp_f32 v78, v78
v_mfma_f32_16x16x32_bf16 v[144:147], a[208:211], v[80:83], v[144:147]
buffer_load_dwordx4 a[4:7], v7, s[8:11], s29 offen offset:0 sc1
v_add_f32 v90, v90, v76
v_add_f32 v91, v91, v77
v_mfma_f32_16x16x32_bf16 v[148:151], a[212:215], v[80:83], v[148:151]
v_exp_f32 v79, v79
v_mfma_f32_16x16x32_bf16 v[152:155], a[216:219], v[80:83], v[152:155]
ds_read_b128 a[180:183], v21 offset:21824
v_cvt_pk_bf16_f32 v87, v78, v79
v_mfma_f32_16x16x32_bf16 v[156:159], a[220:223], v[80:83], v[156:159]
v_add_f32 v90, v90, v78
v_add_f32 v91, v91, v79
v_mfma_f32_16x16x32_bf16 v[72:75], a[128:131], a[112:115], v[108:111]
ds_read_b128 a[184:187], v21 offset:21888
v_exp_f32 v64, v64
v_mfma_f32_16x16x32_bf16 v[72:75], a[132:135], a[116:119], v[72:75]
ds_read_b128 a[188:191], v21 offset:21952
v_exp_f32 v65, v65
v_mfma_f32_16x16x32_bf16 v[72:75], a[136:139], a[120:123], v[72:75]
ds_read_b64_tr_b16 a[224:225], v22 offset:26112
v_cvt_pk_bf16_f32 v80, v64, v65
v_mfma_f32_16x16x32_bf16 v[72:75], a[140:143], a[124:127], v[72:75]
v_exp_f32 v66, v66
v_mfma_f32_16x16x32_bf16 v[160:163], a[192:195], v[84:87], v[160:163]
s_add_u32 m0, s32, 18432
v_add_f32 v92, v92, v64
v_add_f32 v93, v93, v65
v_mfma_f32_16x16x32_bf16 v[164:167], a[196:199], v[84:87], v[164:167]
buffer_load_dwordx4 v3, s[12:15], s28 offen  lds
v_exp_f32 v67, v67
v_mfma_f32_16x16x32_bf16 v[168:171], a[200:203], v[84:87], v[168:171]
ds_read_b64_tr_b16 a[226:227], v22 offset:30464
v_cvt_pk_bf16_f32 v81, v66, v67
v_mfma_f32_16x16x32_bf16 v[172:175], a[204:207], v[84:87], v[172:175]
v_exp_f32 v68, v68
v_mfma_f32_16x16x32_bf16 v[76:79], a[144:147], a[112:115], v[108:111]
buffer_load_dwordx4 a[8:11], v6, s[8:11], s29 offen offset:1024 sc1
v_add_f32 v92, v92, v66
v_add_f32 v93, v93, v67
v_mfma_f32_16x16x32_bf16 v[76:79], a[148:151], a[116:119], v[76:79]
v_exp_f32 v69, v69
v_mfma_f32_16x16x32_bf16 v[76:79], a[152:155], a[120:123], v[76:79]
ds_read_b64_tr_b16 a[228:229], v23 offset:26144
v_cvt_pk_bf16_f32 v82, v68, v69
v_mfma_f32_16x16x32_bf16 v[76:79], a[156:159], a[124:127], v[76:79]
v_exp_f32 v70, v70
v_mfma_f32_16x16x32_bf16 v[176:179], a[208:211], v[84:87], v[176:179]
buffer_load_dwordx4 a[12:15], v7, s[8:11], s29 offen offset:1024 sc1
v_add_f32 v92, v92, v68
v_add_f32 v93, v93, v69
s_add_u32 s29, s29, 2048
v_mfma_f32_16x16x32_bf16 v[180:183], a[212:215], v[84:87], v[180:183]
v_exp_f32 v71, v71
v_mfma_f32_16x16x32_bf16 v[184:187], a[216:219], v[84:87], v[184:187]
ds_read_b64_tr_b16 a[230:231], v23 offset:30496
v_cvt_pk_bf16_f32 v83, v70, v71
v_mfma_f32_16x16x32_bf16 v[188:191], a[220:223], v[84:87], v[188:191]
s_waitcnt lgkmcnt(6)
v_add_f32 v92, v92, v70
v_add_f32 v93, v93, v71
v_mfma_f32_16x16x32_bf16 v[64:67], a[160:163], a[64:67], v[96:99]
ds_read_b64_tr_b16 a[232:233], v22 offset:26176
v_exp_f32 v72, v72
v_mfma_f32_16x16x32_bf16 v[64:67], a[164:167], a[68:71], v[64:67]
ds_read_b64_tr_b16 a[234:235], v22 offset:30528
v_exp_f32 v73, v73
v_mfma_f32_16x16x32_bf16 v[64:67], a[168:171], a[72:75], v[64:67]
ds_read_b64_tr_b16 a[236:237], v23 offset:26208
v_cvt_pk_bf16_f32 v84, v72, v73
v_mfma_f32_16x16x32_bf16 v[64:67], a[172:175], a[76:79], v[64:67]
v_exp_f32 v74, v74
v_mfma_f32_16x16x32_bf16 v[192:195], a[192:195], v[80:83], v[192:195]
s_add_u32 m0, s32, 19456
v_add_f32 v94, v94, v72
v_add_f32 v95, v95, v73
v_mfma_f32_16x16x32_bf16 v[196:199], a[196:199], v[80:83], v[196:199]
buffer_load_dwordx4 v4, s[12:15], s28 offen  lds
v_exp_f32 v75, v75
v_mfma_f32_16x16x32_bf16 v[200:203], a[200:203], v[80:83], v[200:203]
ds_read_b64_tr_b16 a[238:239], v23 offset:30560
v_cvt_pk_bf16_f32 v85, v74, v75
v_mfma_f32_16x16x32_bf16 v[204:207], a[204:207], v[80:83], v[204:207]
s_waitcnt lgkmcnt(8)
v_exp_f32 v76, v76
v_mfma_f32_16x16x32_bf16 v[68:71], a[176:179], a[64:67], v[96:99]
buffer_load_dwordx4 a[16:19], v6, s[8:11], s29 offen offset:0 sc1
v_add_f32 v94, v94, v74
v_add_f32 v95, v95, v75
v_mfma_f32_16x16x32_bf16 v[68:71], a[180:183], a[68:71], v[68:71]
v_exp_f32 v77, v77
v_mfma_f32_16x16x32_bf16 v[68:71], a[184:187], a[72:75], v[68:71]
ds_read_b64_tr_b16 a[240:241], v22 offset:26240
v_cvt_pk_bf16_f32 v86, v76, v77
v_mfma_f32_16x16x32_bf16 v[68:71], a[188:191], a[76:79], v[68:71]
v_exp_f32 v78, v78
v_mfma_f32_16x16x32_bf16 v[208:211], a[208:211], v[80:83], v[208:211]
buffer_load_dwordx4 a[20:23], v7, s[8:11], s29 offen offset:0 sc1
v_add_f32 v94, v94, v76
v_add_f32 v95, v95, v77
v_mfma_f32_16x16x32_bf16 v[212:215], a[212:215], v[80:83], v[212:215]
v_exp_f32 v79, v79
v_mfma_f32_16x16x32_bf16 v[216:219], a[216:219], v[80:83], v[216:219]
ds_read_b64_tr_b16 a[242:243], v22 offset:30592
v_cvt_pk_bf16_f32 v87, v78, v79
v_mfma_f32_16x16x32_bf16 v[220:223], a[220:223], v[80:83], v[220:223]
s_waitcnt lgkmcnt(6)
v_add_f32 v94, v94, v78
v_add_f32 v95, v95, v79
v_mfma_f32_16x16x32_bf16 v[72:75], a[160:163], a[80:83], v[100:103]
ds_read_b64_tr_b16 a[244:245], v23 offset:26272
v_exp_f32 v64, v64
v_mfma_f32_16x16x32_bf16 v[72:75], a[164:167], a[84:87], v[72:75]
ds_read_b64_tr_b16 a[246:247], v23 offset:30624
v_exp_f32 v65, v65
v_mfma_f32_16x16x32_bf16 v[72:75], a[168:171], a[88:91], v[72:75]
ds_read_b64_tr_b16 a[248:249], v22 offset:26304
v_cvt_pk_bf16_f32 v80, v64, v65
v_mfma_f32_16x16x32_bf16 v[72:75], a[172:175], a[92:95], v[72:75]
s_add_u32 s41, s41, 34816
v_exp_f32 v66, v66
v_mfma_f32_16x16x32_bf16 v[224:227], a[192:195], v[84:87], v[224:227]
s_add_u32 m0, s32, 20480
v_add_f32 v88, v88, v64
v_add_f32 v89, v89, v65
v_mfma_f32_16x16x32_bf16 v[228:231], a[196:199], v[84:87], v[228:231]
s_cmp_eq_u32 s41, 139264
buffer_load_dwordx4 v5, s[12:15], s28 offen  lds
v_exp_f32 v67, v67
v_mfma_f32_16x16x32_bf16 v[232:235], a[200:203], v[84:87], v[232:235]
ds_read_b64_tr_b16 a[250:251], v22 offset:30656
v_cvt_pk_bf16_f32 v81, v66, v67
v_mfma_f32_16x16x32_bf16 v[236:239], a[204:207], v[84:87], v[236:239]
s_cselect_b32 s41, 0, s41
v_exp_f32 v68, v68
v_mfma_f32_16x16x32_bf16 v[76:79], a[176:179], a[80:83], v[100:103]
buffer_load_dwordx4 a[24:27], v6, s[8:11], s29 offen offset:1024 sc1
v_add_f32 v88, v88, v66
v_add_f32 v89, v89, v67
v_mfma_f32_16x16x32_bf16 v[76:79], a[180:183], a[84:87], v[76:79]
v_exp_f32 v69, v69
s_add_u32 s28, s28, 1048576
v_mfma_f32_16x16x32_bf16 v[76:79], a[184:187], a[88:91], v[76:79]
ds_read_b64_tr_b16 a[252:253], v23 offset:26336
v_cvt_pk_bf16_f32 v82, v68, v69
v_mfma_f32_16x16x32_bf16 v[76:79], a[188:191], a[92:95], v[76:79]
v_exp_f32 v70, v70
v_mfma_f32_16x16x32_bf16 v[240:243], a[208:211], v[84:87], v[240:243]
buffer_load_dwordx4 a[28:31], v7, s[8:11], s29 offen offset:1024 sc1
v_add_f32 v88, v88, v68
v_add_f32 v89, v89, v69
s_add_u32 s29, s29, 2048
v_mfma_f32_16x16x32_bf16 v[244:247], a[212:215], v[84:87], v[244:247]
v_exp_f32 v71, v71
v_mfma_f32_16x16x32_bf16 v[248:251], a[216:219], v[84:87], v[248:251]
ds_read_b64_tr_b16 a[254:255], v23 offset:30688
v_cvt_pk_bf16_f32 v83, v70, v71
v_mfma_f32_16x16x32_bf16 v[252:255], a[220:223], v[84:87], v[252:255]
s_waitcnt lgkmcnt(6)
v_add_u32 v21, s41, v18
v_add_u32 v22, s41, v19
v_add_u32 v23, s41, v20
v_add_f32 v88, v88, v70
v_add_f32 v89, v89, v71
s_waitcnt vmcnt(28)
s_barrier
v_mfma_f32_16x16x32_bf16 v[64:67], a[160:163], a[96:99], v[104:107]
ds_read_b128 a[128:131], v21 offset:0
v_exp_f32 v72, v72
v_mfma_f32_16x16x32_bf16 v[64:67], a[164:167], a[100:103], v[64:67]
ds_read_b128 a[132:135], v21 offset:64
v_exp_f32 v73, v73
v_mfma_f32_16x16x32_bf16 v[64:67], a[168:171], a[104:107], v[64:67]
ds_read_b128 a[136:139], v21 offset:128
v_cvt_pk_bf16_f32 v84, v72, v73
v_mfma_f32_16x16x32_bf16 v[64:67], a[172:175], a[108:111], v[64:67]
v_exp_f32 v74, v74
v_mfma_f32_16x16x32_bf16 v[128:131], a[224:227], v[80:83], v[128:131]
s_add_u32 m0, s32, 34816
v_add_f32 v90, v90, v72
v_add_f32 v91, v91, v73
v_mfma_f32_16x16x32_bf16 v[132:135], a[228:231], v[80:83], v[132:135]
buffer_load_dwordx4 v2, s[12:15], s28 offen  lds
v_exp_f32 v75, v75
v_mfma_f32_16x16x32_bf16 v[136:139], a[232:235], v[80:83], v[136:139]
ds_read_b128 a[140:143], v21 offset:192
v_cvt_pk_bf16_f32 v85, v74, v75
v_mfma_f32_16x16x32_bf16 v[140:143], a[236:239], v[80:83], v[140:143]
v_exp_f32 v76, v76
v_mfma_f32_16x16x32_bf16 v[68:71], a[176:179], a[96:99], v[104:107]
buffer_load_dwordx4 a[32:35], v6, s[8:11], s29 offen offset:0 sc1
v_add_f32 v90, v90, v74
v_add_f32 v91, v91, v75
v_mfma_f32_16x16x32_bf16 v[68:71], a[180:183], a[100:103], v[68:71]
v_exp_f32 v77, v77
v_mfma_f32_16x16x32_bf16 v[68:71], a[184:187], a[104:107], v[68:71]
ds_read_b128 a[144:147], v21 offset:4352
v_cvt_pk_bf16_f32 v86, v76, v77
v_mfma_f32_16x16x32_bf16 v[68:71], a[188:191], a[108:111], v[68:71]
s_waitcnt lgkmcnt(5)
v_exp_f32 v78, v78
v_mfma_f32_16x16x32_bf16 v[144:147], a[240:243], v[80:83], v[144:147]
buffer_load_dwordx4 a[36:39], v7, s[8:11], s29 offen offset:0 sc1
v_add_f32 v90, v90, v76
v_add_f32 v91, v91, v77
v_mfma_f32_16x16x32_bf16 v[148:151], a[244:247], v[80:83], v[148:151]
v_exp_f32 v79, v79
v_mfma_f32_16x16x32_bf16 v[152:155], a[248:251], v[80:83], v[152:155]
ds_read_b128 a[148:151], v21 offset:4416
v_cvt_pk_bf16_f32 v87, v78, v79
v_mfma_f32_16x16x32_bf16 v[156:159], a[252:255], v[80:83], v[156:159]
v_add_f32 v90, v90, v78
v_add_f32 v91, v91, v79
v_mfma_f32_16x16x32_bf16 v[72:75], a[160:163], a[112:115], v[108:111]
ds_read_b128 a[152:155], v21 offset:4480
v_exp_f32 v64, v64
v_mfma_f32_16x16x32_bf16 v[72:75], a[164:167], a[116:119], v[72:75]
ds_read_b128 a[156:159], v21 offset:4544
v_exp_f32 v65, v65
v_mfma_f32_16x16x32_bf16 v[72:75], a[168:171], a[120:123], v[72:75]
ds_read_b64_tr_b16 a[192:193], v22 offset:8704
v_cvt_pk_bf16_f32 v80, v64, v65
v_mfma_f32_16x16x32_bf16 v[72:75], a[172:175], a[124:127], v[72:75]
v_exp_f32 v66, v66
v_mfma_f32_16x16x32_bf16 v[160:163], a[224:227], v[84:87], v[160:163]
s_add_u32 m0, s32, 35840
v_add_f32 v92, v92, v64
v_add_f32 v93, v93, v65
v_mfma_f32_16x16x32_bf16 v[164:167], a[228:231], v[84:87], v[164:167]
buffer_load_dwordx4 v3, s[12:15], s28 offen  lds
v_exp_f32 v67, v67
v_mfma_f32_16x16x32_bf16 v[168:171], a[232:235], v[84:87], v[168:171]
ds_read_b64_tr_b16 a[194:195], v22 offset:13056
v_cvt_pk_bf16_f32 v81, v66, v67
v_mfma_f32_16x16x32_bf16 v[172:175], a[236:239], v[84:87], v[172:175]
v_exp_f32 v68, v68
v_mfma_f32_16x16x32_bf16 v[76:79], a[176:179], a[112:115], v[108:111]
buffer_load_dwordx4 a[40:43], v6, s[8:11], s29 offen offset:1024 sc1
v_add_f32 v92, v92, v66
v_add_f32 v93, v93, v67
v_mfma_f32_16x16x32_bf16 v[76:79], a[180:183], a[116:119], v[76:79]
v_exp_f32 v69, v69
v_mfma_f32_16x16x32_bf16 v[76:79], a[184:187], a[120:123], v[76:79]
ds_read_b64_tr_b16 a[196:197], v23 offset:8736
v_cvt_pk_bf16_f32 v82, v68, v69
v_mfma_f32_16x16x32_bf16 v[76:79], a[188:191], a[124:127], v[76:79]
v_exp_f32 v70, v70
v_mfma_f32_16x16x32_bf16 v[176:179], a[240:243], v[84:87], v[176:179]
buffer_load_dwordx4 a[44:47], v7, s[8:11], s29 offen offset:1024 sc1
v_add_f32 v92, v92, v68
v_add_f32 v93, v93, v69
s_add_u32 s29, s29, 2048
v_mfma_f32_16x16x32_bf16 v[180:183], a[244:247], v[84:87], v[180:183]
v_exp_f32 v71, v71
v_mfma_f32_16x16x32_bf16 v[184:187], a[248:251], v[84:87], v[184:187]
ds_read_b64_tr_b16 a[198:199], v23 offset:13088
v_cvt_pk_bf16_f32 v83, v70, v71
v_mfma_f32_16x16x32_bf16 v[188:191], a[252:255], v[84:87], v[188:191]
s_waitcnt lgkmcnt(6)
v_add_f32 v92, v92, v70
v_add_f32 v93, v93, v71
v_mfma_f32_16x16x32_bf16 v[64:67], a[128:131], a[64:67], v[96:99]
ds_read_b64_tr_b16 a[200:201], v22 offset:8768
v_exp_f32 v72, v72
v_mfma_f32_16x16x32_bf16 v[64:67], a[132:135], a[68:71], v[64:67]
ds_read_b64_tr_b16 a[202:203], v22 offset:13120
v_exp_f32 v73, v73
v_mfma_f32_16x16x32_bf16 v[64:67], a[136:139], a[72:75], v[64:67]
ds_read_b64_tr_b16 a[204:205], v23 offset:8800
v_cvt_pk_bf16_f32 v84, v72, v73
v_mfma_f32_16x16x32_bf16 v[64:67], a[140:143], a[76:79], v[64:67]
v_exp_f32 v74, v74
v_mfma_f32_16x16x32_bf16 v[192:195], a[224:227], v[80:83], v[192:195]
s_add_u32 m0, s32, 36864
v_add_f32 v94, v94, v72
v_add_f32 v95, v95, v73
v_mfma_f32_16x16x32_bf16 v[196:199], a[228:231], v[80:83], v[196:199]
buffer_load_dwordx4 v4, s[12:15], s28 offen  lds
v_exp_f32 v75, v75
v_mfma_f32_16x16x32_bf16 v[200:203], a[232:235], v[80:83], v[200:203]
ds_read_b64_tr_b16 a[206:207], v23 offset:13152
v_cvt_pk_bf16_f32 v85, v74, v75
v_mfma_f32_16x16x32_bf16 v[204:207], a[236:239], v[80:83], v[204:207]
s_waitcnt lgkmcnt(8)
v_exp_f32 v76, v76
v_mfma_f32_16x16x32_bf16 v[68:71], a[144:147], a[64:67], v[96:99]
buffer_load_dwordx4 a[48:51], v6, s[8:11], s29 offen offset:0 sc1
v_add_f32 v94, v94, v74
v_add_f32 v95, v95, v75
v_mfma_f32_16x16x32_bf16 v[68:71], a[148:151], a[68:71], v[68:71]
v_exp_f32 v77, v77
v_mfma_f32_16x16x32_bf16 v[68:71], a[152:155], a[72:75], v[68:71]
ds_read_b64_tr_b16 a[208:209], v22 offset:8832
v_cvt_pk_bf16_f32 v86, v76, v77
v_mfma_f32_16x16x32_bf16 v[68:71], a[156:159], a[76:79], v[68:71]
v_exp_f32 v78, v78
v_mfma_f32_16x16x32_bf16 v[208:211], a[240:243], v[80:83], v[208:211]
buffer_load_dwordx4 a[52:55], v7, s[8:11], s29 offen offset:0 sc1
v_add_f32 v94, v94, v76
v_add_f32 v95, v95, v77
v_mfma_f32_16x16x32_bf16 v[212:215], a[244:247], v[80:83], v[212:215]
v_exp_f32 v79, v79
v_mfma_f32_16x16x32_bf16 v[216:219], a[248:251], v[80:83], v[216:219]
ds_read_b64_tr_b16 a[210:211], v22 offset:13184
v_cvt_pk_bf16_f32 v87, v78, v79
v_mfma_f32_16x16x32_bf16 v[220:223], a[252:255], v[80:83], v[220:223]
s_waitcnt lgkmcnt(6)
v_add_f32 v94, v94, v78
v_add_f32 v95, v95, v79
v_mfma_f32_16x16x32_bf16 v[72:75], a[128:131], a[80:83], v[100:103]
ds_read_b64_tr_b16 a[212:213], v23 offset:8864
v_exp_f32 v64, v64
v_mfma_f32_16x16x32_bf16 v[72:75], a[132:135], a[84:87], v[72:75]
ds_read_b64_tr_b16 a[214:215], v23 offset:13216
v_exp_f32 v65, v65
v_mfma_f32_16x16x32_bf16 v[72:75], a[136:139], a[88:91], v[72:75]
ds_read_b64_tr_b16 a[216:217], v22 offset:8896
v_cvt_pk_bf16_f32 v80, v64, v65
v_mfma_f32_16x16x32_bf16 v[72:75], a[140:143], a[92:95], v[72:75]
v_exp_f32 v66, v66
v_mfma_f32_16x16x32_bf16 v[224:227], a[224:227], v[84:87], v[224:227]
s_add_u32 m0, s32, 37888
v_add_f32 v88, v88, v64
v_add_f32 v89, v89, v65
v_mfma_f32_16x16x32_bf16 v[228:231], a[228:231], v[84:87], v[228:231]
buffer_load_dwordx4 v5, s[12:15], s28 offen  lds
v_exp_f32 v67, v67
v_mfma_f32_16x16x32_bf16 v[232:235], a[232:235], v[84:87], v[232:235]
ds_read_b64_tr_b16 a[218:219], v22 offset:13248
v_cvt_pk_bf16_f32 v81, v66, v67
v_mfma_f32_16x16x32_bf16 v[236:239], a[236:239], v[84:87], v[236:239]
v_exp_f32 v68, v68
v_mfma_f32_16x16x32_bf16 v[76:79], a[144:147], a[80:83], v[100:103]
buffer_load_dwordx4 a[56:59], v6, s[8:11], s29 offen offset:1024 sc1
v_add_f32 v88, v88, v66
v_add_f32 v89, v89, v67
v_mfma_f32_16x16x32_bf16 v[76:79], a[148:151], a[84:87], v[76:79]
v_exp_f32 v69, v69
s_add_u32 s28, s28, 1048576
v_mfma_f32_16x16x32_bf16 v[76:79], a[152:155], a[88:91], v[76:79]
ds_read_b64_tr_b16 a[220:221], v23 offset:8928
v_cvt_pk_bf16_f32 v82, v68, v69
v_mfma_f32_16x16x32_bf16 v[76:79], a[156:159], a[92:95], v[76:79]
v_exp_f32 v70, v70
v_mfma_f32_16x16x32_bf16 v[240:243], a[240:243], v[84:87], v[240:243]
buffer_load_dwordx4 a[60:63], v7, s[8:11], s29 offen offset:1024 sc1
v_add_f32 v88, v88, v68
v_add_f32 v89, v89, v69
s_add_u32 s29, s29, 2048
v_mfma_f32_16x16x32_bf16 v[244:247], a[244:247], v[84:87], v[244:247]
v_exp_f32 v71, v71
v_mfma_f32_16x16x32_bf16 v[248:251], a[248:251], v[84:87], v[248:251]
ds_read_b64_tr_b16 a[222:223], v23 offset:13280
v_cvt_pk_bf16_f32 v83, v70, v71
v_mfma_f32_16x16x32_bf16 v[252:255], a[252:255], v[84:87], v[252:255]
s_waitcnt lgkmcnt(6)
v_add_f32 v88, v88, v70
v_add_f32 v89, v89, v71
s_waitcnt vmcnt(36)
s_barrier
v_mfma_f32_16x16x32_bf16 v[64:67], a[128:131], a[96:99], v[104:107]
ds_read_b128 a[160:163], v21 offset:17408
v_exp_f32 v72, v72
v_mfma_f32_16x16x32_bf16 v[64:67], a[132:135], a[100:103], v[64:67]
ds_read_b128 a[164:167], v21 offset:17472
v_exp_f32 v73, v73
v_mfma_f32_16x16x32_bf16 v[64:67], a[136:139], a[104:107], v[64:67]
ds_read_b128 a[168:171], v21 offset:17536
v_cvt_pk_bf16_f32 v84, v72, v73
v_mfma_f32_16x16x32_bf16 v[64:67], a[140:143], a[108:111], v[64:67]
v_exp_f32 v74, v74
v_mfma_f32_16x16x32_bf16 v[128:131], a[192:195], v[80:83], v[128:131]
s_add_u32 m0, s32, 52224
v_add_f32 v90, v90, v72
v_add_f32 v91, v91, v73
v_mfma_f32_16x16x32_bf16 v[132:135], a[196:199], v[80:83], v[132:135]
buffer_load_dwordx4 v2, s[12:15], s28 offen  lds
v_exp_f32 v75, v75
v_mfma_f32_16x16x32_bf16 v[136:139], a[200:203], v[80:83], v[136:139]
ds_read_b128 a[172:175], v21 offset:17600
v_cvt_pk_bf16_f32 v85, v74, v75
v_mfma_f32_16x16x32_bf16 v[140:143], a[204:207], v[80:83], v[140:143]
v_exp_f32 v76, v76
v_mfma_f32_16x16x32_bf16 v[68:71], a[144:147], a[96:99], v[104:107]
v_add_f32 v90, v90, v74
v_add_f32 v91, v91, v75
v_mfma_f32_16x16x32_bf16 v[68:71], a[148:151], a[100:103], v[68:71]
v_exp_f32 v77, v77
v_mfma_f32_16x16x32_bf16 v[68:71], a[152:155], a[104:107], v[68:71]
ds_read_b128 a[176:179], v21 offset:21760
v_cvt_pk_bf16_f32 v86, v76, v77
v_mfma_f32_16x16x32_bf16 v[68:71], a[156:159], a[108:111], v[68:71]
s_waitcnt lgkmcnt(5)
v_exp_f32 v78, v78
v_mfma_f32_16x16x32_bf16 v[144:147], a[208:211], v[80:83], v[144:147]
v_add_f32 v90, v90, v76
v_add_f32 v91, v91, v77
v_mfma_f32_16x16x32_bf16 v[148:151], a[212:215], v[80:83], v[148:151]
v_exp_f32 v79, v79
v_mfma_f32_16x16x32_bf16 v[152:155], a[216:219], v[80:83], v[152:155]
ds_read_b128 a[180:183], v21 offset:21824
v_cvt_pk_bf16_f32 v87, v78, v79
v_mfma_f32_16x16x32_bf16 v[156:159], a[220:223], v[80:83], v[156:159]
v_add_f32 v90, v90, v78
v_add_f32 v91, v91, v79
v_mfma_f32_16x16x32_bf16 v[72:75], a[128:131], a[112:115], v[108:111]
ds_read_b128 a[184:187], v21 offset:21888
v_exp_f32 v64, v64
v_mfma_f32_16x16x32_bf16 v[72:75], a[132:135], a[116:119], v[72:75]
ds_read_b128 a[188:191], v21 offset:21952
v_exp_f32 v65, v65
v_mfma_f32_16x16x32_bf16 v[72:75], a[136:139], a[120:123], v[72:75]
ds_read_b64_tr_b16 a[224:225], v22 offset:26112
v_cvt_pk_bf16_f32 v80, v64, v65
v_mfma_f32_16x16x32_bf16 v[72:75], a[140:143], a[124:127], v[72:75]
v_exp_f32 v66, v66
v_mfma_f32_16x16x32_bf16 v[160:163], a[192:195], v[84:87], v[160:163]
s_add_u32 m0, s32, 53248
v_add_f32 v92, v92, v64
v_add_f32 v93, v93, v65
v_mfma_f32_16x16x32_bf16 v[164:167], a[196:199], v[84:87], v[164:167]
buffer_load_dwordx4 v3, s[12:15], s28 offen  lds
v_exp_f32 v67, v67
v_mfma_f32_16x16x32_bf16 v[168:171], a[200:203], v[84:87], v[168:171]
ds_read_b64_tr_b16 a[226:227], v22 offset:30464
v_cvt_pk_bf16_f32 v81, v66, v67
v_mfma_f32_16x16x32_bf16 v[172:175], a[204:207], v[84:87], v[172:175]
v_exp_f32 v68, v68
v_mfma_f32_16x16x32_bf16 v[76:79], a[144:147], a[112:115], v[108:111]
v_add_f32 v92, v92, v66
v_add_f32 v93, v93, v67
v_mfma_f32_16x16x32_bf16 v[76:79], a[148:151], a[116:119], v[76:79]
v_exp_f32 v69, v69
v_mfma_f32_16x16x32_bf16 v[76:79], a[152:155], a[120:123], v[76:79]
ds_read_b64_tr_b16 a[228:229], v23 offset:26144
v_cvt_pk_bf16_f32 v82, v68, v69
v_mfma_f32_16x16x32_bf16 v[76:79], a[156:159], a[124:127], v[76:79]
v_exp_f32 v70, v70
v_mfma_f32_16x16x32_bf16 v[176:179], a[208:211], v[84:87], v[176:179]
v_add_f32 v92, v92, v68
v_add_f32 v93, v93, v69
v_mfma_f32_16x16x32_bf16 v[180:183], a[212:215], v[84:87], v[180:183]
v_exp_f32 v71, v71
v_mfma_f32_16x16x32_bf16 v[184:187], a[216:219], v[84:87], v[184:187]
ds_read_b64_tr_b16 a[230:231], v23 offset:30496
v_cvt_pk_bf16_f32 v83, v70, v71
v_mfma_f32_16x16x32_bf16 v[188:191], a[220:223], v[84:87], v[188:191]
s_waitcnt lgkmcnt(6)
v_add_f32 v92, v92, v70
v_add_f32 v93, v93, v71
v_mfma_f32_16x16x32_bf16 v[64:67], a[160:163], a[64:67], v[96:99]
ds_read_b64_tr_b16 a[232:233], v22 offset:26176
v_exp_f32 v72, v72
v_mfma_f32_16x16x32_bf16 v[64:67], a[164:167], a[68:71], v[64:67]
ds_read_b64_tr_b16 a[234:235], v22 offset:30528
v_exp_f32 v73, v73
v_mfma_f32_16x16x32_bf16 v[64:67], a[168:171], a[72:75], v[64:67]
ds_read_b64_tr_b16 a[236:237], v23 offset:26208
v_cvt_pk_bf16_f32 v84, v72, v73
v_mfma_f32_16x16x32_bf16 v[64:67], a[172:175], a[76:79], v[64:67]
v_exp_f32 v74, v74
v_mfma_f32_16x16x32_bf16 v[192:195], a[192:195], v[80:83], v[192:195]
s_add_u32 m0, s32, 54272
v_add_f32 v94, v94, v72
v_add_f32 v95, v95, v73
v_mfma_f32_16x16x32_bf16 v[196:199], a[196:199], v[80:83], v[196:199]
buffer_load_dwordx4 v4, s[12:15], s28 offen  lds
v_exp_f32 v75, v75
v_mfma_f32_16x16x32_bf16 v[200:203], a[200:203], v[80:83], v[200:203]
ds_read_b64_tr_b16 a[238:239], v23 offset:30560
v_cvt_pk_bf16_f32 v85, v74, v75
v_mfma_f32_16x16x32_bf16 v[204:207], a[204:207], v[80:83], v[204:207]
s_waitcnt lgkmcnt(8)
v_exp_f32 v76, v76
v_mfma_f32_16x16x32_bf16 v[68:71], a[176:179], a[64:67], v[96:99]
v_add_f32 v94, v94, v74
v_add_f32 v95, v95, v75
v_mfma_f32_16x16x32_bf16 v[68:71], a[180:183], a[68:71], v[68:71]
v_exp_f32 v77, v77
v_mfma_f32_16x16x32_bf16 v[68:71], a[184:187], a[72:75], v[68:71]
ds_read_b64_tr_b16 a[240:241], v22 offset:26240
v_cvt_pk_bf16_f32 v86, v76, v77
v_mfma_f32_16x16x32_bf16 v[68:71], a[188:191], a[76:79], v[68:71]
v_exp_f32 v78, v78
v_mfma_f32_16x16x32_bf16 v[208:211], a[208:211], v[80:83], v[208:211]
v_add_f32 v94, v94, v76
v_add_f32 v95, v95, v77
v_mfma_f32_16x16x32_bf16 v[212:215], a[212:215], v[80:83], v[212:215]
v_exp_f32 v79, v79
v_mfma_f32_16x16x32_bf16 v[216:219], a[216:219], v[80:83], v[216:219]
ds_read_b64_tr_b16 a[242:243], v22 offset:30592
v_cvt_pk_bf16_f32 v87, v78, v79
v_mfma_f32_16x16x32_bf16 v[220:223], a[220:223], v[80:83], v[220:223]
s_waitcnt lgkmcnt(6)
v_add_f32 v94, v94, v78
v_add_f32 v95, v95, v79
v_mfma_f32_16x16x32_bf16 v[72:75], a[160:163], a[80:83], v[100:103]
ds_read_b64_tr_b16 a[244:245], v23 offset:26272
v_exp_f32 v64, v64
v_mfma_f32_16x16x32_bf16 v[72:75], a[164:167], a[84:87], v[72:75]
ds_read_b64_tr_b16 a[246:247], v23 offset:30624
v_exp_f32 v65, v65
v_mfma_f32_16x16x32_bf16 v[72:75], a[168:171], a[88:91], v[72:75]
ds_read_b64_tr_b16 a[248:249], v22 offset:26304
v_cvt_pk_bf16_f32 v80, v64, v65
v_mfma_f32_16x16x32_bf16 v[72:75], a[172:175], a[92:95], v[72:75]
s_add_u32 s41, s41, 34816
v_exp_f32 v66, v66
v_mfma_f32_16x16x32_bf16 v[224:227], a[192:195], v[84:87], v[224:227]
s_add_u32 m0, s32, 55296
v_add_f32 v88, v88, v64
v_add_f32 v89, v89, v65
v_mfma_f32_16x16x32_bf16 v[228:231], a[196:199], v[84:87], v[228:231]
s_cmp_eq_u32 s41, 139264
buffer_load_dwordx4 v5, s[12:15], s28 offen  lds
v_exp_f32 v67, v67
v_mfma_f32_16x16x32_bf16 v[232:235], a[200:203], v[84:87], v[232:235]
ds_read_b64_tr_b16 a[250:251], v22 offset:30656
v_cvt_pk_bf16_f32 v81, v66, v67
v_mfma_f32_16x16x32_bf16 v[236:239], a[204:207], v[84:87], v[236:239]
s_cselect_b32 s41, 0, s41
v_exp_f32 v68, v68
v_mfma_f32_16x16x32_bf16 v[76:79], a[176:179], a[80:83], v[100:103]
v_add_f32 v88, v88, v66
v_add_f32 v89, v89, v67
v_mfma_f32_16x16x32_bf16 v[76:79], a[180:183], a[84:87], v[76:79]
v_exp_f32 v69, v69
s_add_u32 s28, s28, 1048576
v_mfma_f32_16x16x32_bf16 v[76:79], a[184:187], a[88:91], v[76:79]
ds_read_b64_tr_b16 a[252:253], v23 offset:26336
v_cvt_pk_bf16_f32 v82, v68, v69
v_mfma_f32_16x16x32_bf16 v[76:79], a[188:191], a[92:95], v[76:79]
v_exp_f32 v70, v70
v_mfma_f32_16x16x32_bf16 v[240:243], a[208:211], v[84:87], v[240:243]
v_add_f32 v88, v88, v68
v_add_f32 v89, v89, v69
v_mfma_f32_16x16x32_bf16 v[244:247], a[212:215], v[84:87], v[244:247]
v_exp_f32 v71, v71
v_mfma_f32_16x16x32_bf16 v[248:251], a[216:219], v[84:87], v[248:251]
ds_read_b64_tr_b16 a[254:255], v23 offset:30688
v_cvt_pk_bf16_f32 v83, v70, v71
v_mfma_f32_16x16x32_bf16 v[252:255], a[220:223], v[84:87], v[252:255]
s_waitcnt lgkmcnt(6)
v_add_u32 v21, s41, v18
v_add_u32 v22, s41, v19
v_add_u32 v23, s41, v20
v_add_f32 v88, v88, v70
v_add_f32 v89, v89, v71
s_barrier
v_mfma_f32_16x16x32_bf16 v[64:67], a[160:163], a[96:99], v[104:107]
v_exp_f32 v72, v72
v_mfma_f32_16x16x32_bf16 v[64:67], a[164:167], a[100:103], v[64:67]
v_exp_f32 v73, v73
v_mfma_f32_16x16x32_bf16 v[64:67], a[168:171], a[104:107], v[64:67]
v_cvt_pk_bf16_f32 v84, v72, v73
v_mfma_f32_16x16x32_bf16 v[64:67], a[172:175], a[108:111], v[64:67]
v_exp_f32 v74, v74
v_mfma_f32_16x16x32_bf16 v[128:131], a[224:227], v[80:83], v[128:131]
s_add_u32 m0, s32, 69632
v_add_f32 v90, v90, v72
v_add_f32 v91, v91, v73
v_mfma_f32_16x16x32_bf16 v[132:135], a[228:231], v[80:83], v[132:135]
buffer_load_dwordx4 v2, s[12:15], s28 offen  lds
v_exp_f32 v75, v75
v_mfma_f32_16x16x32_bf16 v[136:139], a[232:235], v[80:83], v[136:139]
v_cvt_pk_bf16_f32 v85, v74, v75
v_mfma_f32_16x16x32_bf16 v[140:143], a[236:239], v[80:83], v[140:143]
v_exp_f32 v76, v76
v_mfma_f32_16x16x32_bf16 v[68:71], a[176:179], a[96:99], v[104:107]
v_add_f32 v90, v90, v74
v_add_f32 v91, v91, v75
v_mfma_f32_16x16x32_bf16 v[68:71], a[180:183], a[100:103], v[68:71]
v_exp_f32 v77, v77
v_mfma_f32_16x16x32_bf16 v[68:71], a[184:187], a[104:107], v[68:71]
v_cvt_pk_bf16_f32 v86, v76, v77
v_mfma_f32_16x16x32_bf16 v[68:71], a[188:191], a[108:111], v[68:71]
s_waitcnt lgkmcnt(0)
v_exp_f32 v78, v78
v_mfma_f32_16x16x32_bf16 v[144:147], a[240:243], v[80:83], v[144:147]
v_add_f32 v90, v90, v76
v_add_f32 v91, v91, v77
v_mfma_f32_16x16x32_bf16 v[148:151], a[244:247], v[80:83], v[148:151]
v_exp_f32 v79, v79
v_mfma_f32_16x16x32_bf16 v[152:155], a[248:251], v[80:83], v[152:155]
v_cvt_pk_bf16_f32 v87, v78, v79
v_mfma_f32_16x16x32_bf16 v[156:159], a[252:255], v[80:83], v[156:159]
v_add_f32 v90, v90, v78
v_add_f32 v91, v91, v79
v_mfma_f32_16x16x32_bf16 v[72:75], a[160:163], a[112:115], v[108:111]
v_exp_f32 v64, v64
v_mfma_f32_16x16x32_bf16 v[72:75], a[164:167], a[116:119], v[72:75]
v_exp_f32 v65, v65
v_mfma_f32_16x16x32_bf16 v[72:75], a[168:171], a[120:123], v[72:75]
v_cvt_pk_bf16_f32 v80, v64, v65
v_mfma_f32_16x16x32_bf16 v[72:75], a[172:175], a[124:127], v[72:75]
v_exp_f32 v66, v66
v_mfma_f32_16x16x32_bf16 v[160:163], a[224:227], v[84:87], v[160:163]
s_add_u32 m0, s32, 70656
v_add_f32 v92, v92, v64
v_add_f32 v93, v93, v65
v_mfma_f32_16x16x32_bf16 v[164:167], a[228:231], v[84:87], v[164:167]
buffer_load_dwordx4 v3, s[12:15], s28 offen  lds
v_exp_f32 v67, v67
v_mfma_f32_16x16x32_bf16 v[168:171], a[232:235], v[84:87], v[168:171]
v_cvt_pk_bf16_f32 v81, v66, v67
v_mfma_f32_16x16x32_bf16 v[172:175], a[236:239], v[84:87], v[172:175]
v_exp_f32 v68, v68
v_mfma_f32_16x16x32_bf16 v[76:79], a[176:179], a[112:115], v[108:111]
v_add_f32 v92, v92, v66
v_add_f32 v93, v93, v67
v_mfma_f32_16x16x32_bf16 v[76:79], a[180:183], a[116:119], v[76:79]
v_exp_f32 v69, v69
v_mfma_f32_16x16x32_bf16 v[76:79], a[184:187], a[120:123], v[76:79]
v_cvt_pk_bf16_f32 v82, v68, v69
v_mfma_f32_16x16x32_bf16 v[76:79], a[188:191], a[124:127], v[76:79]
v_exp_f32 v70, v70
v_mfma_f32_16x16x32_bf16 v[176:179], a[240:243], v[84:87], v[176:179]
v_add_f32 v92, v92, v68
v_add_f32 v93, v93, v69
v_mfma_f32_16x16x32_bf16 v[180:183], a[244:247], v[84:87], v[180:183]
v_exp_f32 v71, v71
v_mfma_f32_16x16x32_bf16 v[184:187], a[248:251], v[84:87], v[184:187]
v_cvt_pk_bf16_f32 v83, v70, v71
v_mfma_f32_16x16x32_bf16 v[188:191], a[252:255], v[84:87], v[188:191]
v_add_f32 v92, v92, v70
v_add_f32 v93, v93, v71
v_exp_f32 v72, v72
v_exp_f32 v73, v73
s_nop 0
v_cvt_pk_bf16_f32 v84, v72, v73
v_exp_f32 v74, v74
v_mfma_f32_16x16x32_bf16 v[192:195], a[224:227], v[80:83], v[192:195]
s_add_u32 m0, s32, 71680
buffer_load_dwordx4 a[64:67], v6, s[8:11], s29 offen offset:0 sc1
v_add_f32 v94, v94, v72
v_add_f32 v95, v95, v73
v_mfma_f32_16x16x32_bf16 v[196:199], a[228:231], v[80:83], v[196:199]
buffer_load_dwordx4 v4, s[12:15], s28 offen  lds
buffer_load_dwordx4 a[68:71], v7, s[8:11], s29 offen offset:0 sc1
v_exp_f32 v75, v75
v_mfma_f32_16x16x32_bf16 v[200:203], a[232:235], v[80:83], v[200:203]
buffer_load_dwordx4 a[72:75], v6, s[8:11], s29 offen offset:1024 sc1
v_cvt_pk_bf16_f32 v85, v74, v75
v_mfma_f32_16x16x32_bf16 v[204:207], a[236:239], v[80:83], v[204:207]
buffer_load_dwordx4 a[76:79], v7, s[8:11], s29 offen offset:1024 sc1
v_exp_f32 v76, v76
s_add_u32 s29, s29, 2048
v_add_f32 v94, v94, v74
v_add_f32 v95, v95, v75
v_exp_f32 v77, v77
s_nop 0
v_cvt_pk_bf16_f32 v86, v76, v77
v_exp_f32 v78, v78
v_mfma_f32_16x16x32_bf16 v[208:211], a[240:243], v[80:83], v[208:211]
buffer_load_dwordx4 a[80:83], v6, s[8:11], s29 offen offset:0 sc1
v_add_f32 v94, v94, v76
v_add_f32 v95, v95, v77
v_mfma_f32_16x16x32_bf16 v[212:215], a[244:247], v[80:83], v[212:215]
buffer_load_dwordx4 a[84:87], v7, s[8:11], s29 offen offset:0 sc1
v_exp_f32 v79, v79
v_mfma_f32_16x16x32_bf16 v[216:219], a[248:251], v[80:83], v[216:219]
buffer_load_dwordx4 a[88:91], v6, s[8:11], s29 offen offset:1024 sc1
v_cvt_pk_bf16_f32 v87, v78, v79
v_mfma_f32_16x16x32_bf16 v[220:223], a[252:255], v[80:83], v[220:223]
buffer_load_dwordx4 a[92:95], v7, s[8:11], s29 offen offset:1024 sc1
v_add_f32 v94, v94, v78
v_add_f32 v95, v95, v79
s_add_u32 s29, s29, 2048
v_mfma_f32_16x16x32_bf16 v[224:227], a[224:227], v[84:87], v[224:227]
s_add_u32 m0, s32, 72704
buffer_load_dwordx4 a[96:99], v6, s[8:11], s29 offen offset:0 sc1
v_mfma_f32_16x16x32_bf16 v[228:231], a[228:231], v[84:87], v[228:231]
buffer_load_dwordx4 v5, s[12:15], s28 offen  lds
buffer_load_dwordx4 a[100:103], v7, s[8:11], s29 offen offset:0 sc1
v_mfma_f32_16x16x32_bf16 v[232:235], a[232:235], v[84:87], v[232:235]
buffer_load_dwordx4 a[104:107], v6, s[8:11], s29 offen offset:1024 sc1
v_mfma_f32_16x16x32_bf16 v[236:239], a[236:239], v[84:87], v[236:239]
buffer_load_dwordx4 a[108:111], v7, s[8:11], s29 offen offset:1024 sc1
s_add_u32 s29, s29, 2048
s_add_u32 s28, s28, 1048576
v_mfma_f32_16x16x32_bf16 v[240:243], a[240:243], v[84:87], v[240:243]
v_mfma_f32_16x16x32_bf16 v[244:247], a[244:247], v[84:87], v[244:247]
v_mfma_f32_16x16x32_bf16 v[248:251], a[248:251], v[84:87], v[248:251]
v_mfma_f32_16x16x32_bf16 v[252:255], a[252:255], v[84:87], v[252:255]
s_nop 7
v_add_f32 v116, v88, v89
v_mov_b32 v88, 0
v_mov_b32 v89, 0
v_mov_b32 v27, v116
s_nop 1
v_permlane32_swap_b32 v116, v27
s_nop 1
v_add_f32 v116, v116, v27
v_mov_b32 v27, v116
s_nop 1
v_permlane16_swap_b32 v116, v27
s_nop 1
v_add_f32 v116, v116, v27
v_cmp_nge_f32 vcc, 0x4e800000, v116
v_rcp_f32 v116, v116
s_nop 1
s_nop 0
s_or_b64 s[46:47], s[46:47], vcc
v_add_f32 v117, v90, v91
v_mov_b32 v90, 0
v_mov_b32 v91, 0
v_mov_b32 v27, v117
s_nop 1
v_permlane32_swap_b32 v117, v27
s_nop 1
v_add_f32 v117, v117, v27
v_mov_b32 v27, v117
s_nop 1
v_permlane16_swap_b32 v117, v27
s_nop 1
v_add_f32 v117, v117, v27
v_cmp_nge_f32 vcc, 0x4e800000, v117
v_rcp_f32 v117, v117
s_nop 1
s_nop 0
s_or_b64 s[46:47], s[46:47], vcc
v_add_f32 v118, v92, v93
v_mov_b32 v92, 0
v_mov_b32 v93, 0
v_mov_b32 v27, v118
s_nop 1
v_permlane32_swap_b32 v118, v27
s_nop 1
v_add_f32 v118, v118, v27
v_mov_b32 v27, v118
s_nop 1
v_permlane16_swap_b32 v118, v27
s_nop 1
v_add_f32 v118, v118, v27
v_cmp_nge_f32 vcc, 0x4e800000, v118
v_rcp_f32 v118, v118
s_nop 1
s_nop 0
s_or_b64 s[46:47], s[46:47], vcc
v_add_f32 v119, v94, v95
v_mov_b32 v94, 0
v_mov_b32 v95, 0
v_mov_b32 v27, v119
s_nop 1
v_permlane32_swap_b32 v119, v27
s_nop 1
v_add_f32 v119, v119, v27
v_mov_b32 v27, v119
s_nop 1
v_permlane16_swap_b32 v119, v27
s_nop 1
v_add_f32 v119, v119, v27
v_cmp_nge_f32 vcc, 0x4e800000, v119
v_rcp_f32 v119, v119
s_nop 1
s_nop 0
s_or_b64 s[46:47], s[46:47], vcc
s_mov_b32 s43, 65536
v_pk_mul_f32 v[128:129], v[128:129], v[116:117] op_sel:[0,0] op_sel_hi:[1,0]
v_pk_mul_f32 v[130:131], v[130:131], v[116:117] op_sel:[0,0] op_sel_hi:[1,0]
v_pk_mul_f32 v[132:133], v[132:133], v[116:117] op_sel:[0,0] op_sel_hi:[1,0]
v_pk_mul_f32 v[134:135], v[134:135], v[116:117] op_sel:[0,0] op_sel_hi:[1,0]
v_cvt_pk_bf16_f32 v120, v128, v129
v_cvt_pk_bf16_f32 v121, v130, v131
v_cvt_pk_bf16_f32 v122, v132, v133
v_cvt_pk_bf16_f32 v123, v134, v135
buffer_store_dwordx4 v[120:123], v26, s[24:27], s43 offen offset:0 sc1
v_pk_mul_f32 v[136:137], v[136:137], v[116:117] op_sel:[0,0] op_sel_hi:[1,0]
v_pk_mul_f32 v[138:139], v[138:139], v[116:117] op_sel:[0,0] op_sel_hi:[1,0]
v_pk_mul_f32 v[140:141], v[140:141], v[116:117] op_sel:[0,0] op_sel_hi:[1,0]
v_pk_mul_f32 v[142:143], v[142:143], v[116:117] op_sel:[0,0] op_sel_hi:[1,0]
v_cvt_pk_bf16_f32 v124, v136, v137
v_cvt_pk_bf16_f32 v125, v138, v139
v_cvt_pk_bf16_f32 v126, v140, v141
v_cvt_pk_bf16_f32 v127, v142, v143
buffer_store_dwordx4 v[124:127], v26, s[24:27], s43 offen offset:1024 sc1
s_mov_b32 s43, 98304
v_pk_mul_f32 v[144:145], v[144:145], v[116:117] op_sel:[0,0] op_sel_hi:[1,0]
v_pk_mul_f32 v[146:147], v[146:147], v[116:117] op_sel:[0,0] op_sel_hi:[1,0]
v_pk_mul_f32 v[148:149], v[148:149], v[116:117] op_sel:[0,0] op_sel_hi:[1,0]
v_pk_mul_f32 v[150:151], v[150:151], v[116:117] op_sel:[0,0] op_sel_hi:[1,0]
v_cvt_pk_bf16_f32 v120, v144, v145
v_cvt_pk_bf16_f32 v121, v146, v147
v_cvt_pk_bf16_f32 v122, v148, v149
v_cvt_pk_bf16_f32 v123, v150, v151
buffer_store_dwordx4 v[120:123], v26, s[24:27], s43 offen offset:0 sc1
v_pk_mul_f32 v[152:153], v[152:153], v[116:117] op_sel:[0,0] op_sel_hi:[1,0]
v_pk_mul_f32 v[154:155], v[154:155], v[116:117] op_sel:[0,0] op_sel_hi:[1,0]
v_pk_mul_f32 v[156:157], v[156:157], v[116:117] op_sel:[0,0] op_sel_hi:[1,0]
v_pk_mul_f32 v[158:159], v[158:159], v[116:117] op_sel:[0,0] op_sel_hi:[1,0]
v_cvt_pk_bf16_f32 v124, v152, v153
v_cvt_pk_bf16_f32 v125, v154, v155
v_cvt_pk_bf16_f32 v126, v156, v157
v_cvt_pk_bf16_f32 v127, v158, v159
buffer_store_dwordx4 v[124:127], v26, s[24:27], s43 offen offset:1024 sc1
s_mov_b32 s43, 196608
v_pk_mul_f32 v[160:161], v[160:161], v[116:117] op_sel:[0,1] op_sel_hi:[1,1]
v_pk_mul_f32 v[162:163], v[162:163], v[116:117] op_sel:[0,1] op_sel_hi:[1,1]
v_pk_mul_f32 v[164:165], v[164:165], v[116:117] op_sel:[0,1] op_sel_hi:[1,1]
v_pk_mul_f32 v[166:167], v[166:167], v[116:117] op_sel:[0,1] op_sel_hi:[1,1]
v_cvt_pk_bf16_f32 v120, v160, v161
v_cvt_pk_bf16_f32 v121, v162, v163
v_cvt_pk_bf16_f32 v122, v164, v165
v_cvt_pk_bf16_f32 v123, v166, v167
buffer_store_dwordx4 v[120:123], v26, s[24:27], s43 offen offset:0 sc1
v_pk_mul_f32 v[168:169], v[168:169], v[116:117] op_sel:[0,1] op_sel_hi:[1,1]
v_pk_mul_f32 v[170:171], v[170:171], v[116:117] op_sel:[0,1] op_sel_hi:[1,1]
v_pk_mul_f32 v[172:173], v[172:173], v[116:117] op_sel:[0,1] op_sel_hi:[1,1]
v_pk_mul_f32 v[174:175], v[174:175], v[116:117] op_sel:[0,1] op_sel_hi:[1,1]
v_cvt_pk_bf16_f32 v124, v168, v169
v_cvt_pk_bf16_f32 v125, v170, v171
v_cvt_pk_bf16_f32 v126, v172, v173
v_cvt_pk_bf16_f32 v127, v174, v175
buffer_store_dwordx4 v[124:127], v26, s[24:27], s43 offen offset:1024 sc1
s_mov_b32 s43, 229376
v_pk_mul_f32 v[176:177], v[176:177], v[116:117] op_sel:[0,1] op_sel_hi:[1,1]
v_pk_mul_f32 v[178:179], v[178:179], v[116:117] op_sel:[0,1] op_sel_hi:[1,1]
v_pk_mul_f32 v[180:181], v[180:181], v[116:117] op_sel:[0,1] op_sel_hi:[1,1]
v_pk_mul_f32 v[182:183], v[182:183], v[116:117] op_sel:[0,1] op_sel_hi:[1,1]
v_cvt_pk_bf16_f32 v120, v176, v177
v_cvt_pk_bf16_f32 v121, v178, v179
v_cvt_pk_bf16_f32 v122, v180, v181
v_cvt_pk_bf16_f32 v123, v182, v183
buffer_store_dwordx4 v[120:123], v26, s[24:27], s43 offen offset:0 sc1
v_pk_mul_f32 v[184:185], v[184:185], v[116:117] op_sel:[0,1] op_sel_hi:[1,1]
v_pk_mul_f32 v[186:187], v[186:187], v[116:117] op_sel:[0,1] op_sel_hi:[1,1]
v_pk_mul_f32 v[188:189], v[188:189], v[116:117] op_sel:[0,1] op_sel_hi:[1,1]
v_pk_mul_f32 v[190:191], v[190:191], v[116:117] op_sel:[0,1] op_sel_hi:[1,1]
v_cvt_pk_bf16_f32 v124, v184, v185
v_cvt_pk_bf16_f32 v125, v186, v187
v_cvt_pk_bf16_f32 v126, v188, v189
v_cvt_pk_bf16_f32 v127, v190, v191
s_waitcnt vmcnt(62)
buffer_store_dwordx4 v[124:127], v26, s[24:27], s43 offen offset:1024 sc1
s_mov_b32 s43, 327680
v_pk_mul_f32 v[192:193], v[192:193], v[118:119] op_sel:[0,0] op_sel_hi:[1,0]
v_pk_mul_f32 v[194:195], v[194:195], v[118:119] op_sel:[0,0] op_sel_hi:[1,0]
v_pk_mul_f32 v[196:197], v[196:197], v[118:119] op_sel:[0,0] op_sel_hi:[1,0]
v_pk_mul_f32 v[198:199], v[198:199], v[118:119] op_sel:[0,0] op_sel_hi:[1,0]
v_cvt_pk_bf16_f32 v120, v192, v193
v_cvt_pk_bf16_f32 v121, v194, v195
v_cvt_pk_bf16_f32 v122, v196, v197
v_cvt_pk_bf16_f32 v123, v198, v199
s_waitcnt vmcnt(62)
buffer_store_dwordx4 v[120:123], v26, s[24:27], s43 offen offset:0 sc1
v_pk_mul_f32 v[200:201], v[200:201], v[118:119] op_sel:[0,0] op_sel_hi:[1,0]
v_pk_mul_f32 v[202:203], v[202:203], v[118:119] op_sel:[0,0] op_sel_hi:[1,0]
v_pk_mul_f32 v[204:205], v[204:205], v[118:119] op_sel:[0,0] op_sel_hi:[1,0]
v_pk_mul_f32 v[206:207], v[206:207], v[118:119] op_sel:[0,0] op_sel_hi:[1,0]
v_cvt_pk_bf16_f32 v124, v200, v201
v_cvt_pk_bf16_f32 v125, v202, v203
v_cvt_pk_bf16_f32 v126, v204, v205
v_cvt_pk_bf16_f32 v127, v206, v207
s_waitcnt vmcnt(62)
buffer_store_dwordx4 v[124:127], v26, s[24:27], s43 offen offset:1024 sc1
s_mov_b32 s43, 360448
v_pk_mul_f32 v[208:209], v[208:209], v[118:119] op_sel:[0,0] op_sel_hi:[1,0]
v_pk_mul_f32 v[210:211], v[210:211], v[118:119] op_sel:[0,0] op_sel_hi:[1,0]
v_pk_mul_f32 v[212:213], v[212:213], v[118:119] op_sel:[0,0] op_sel_hi:[1,0]
v_pk_mul_f32 v[214:215], v[214:215], v[118:119] op_sel:[0,0] op_sel_hi:[1,0]
v_cvt_pk_bf16_f32 v120, v208, v209
v_cvt_pk_bf16_f32 v121, v210, v211
v_cvt_pk_bf16_f32 v122, v212, v213
v_cvt_pk_bf16_f32 v123, v214, v215
s_waitcnt vmcnt(62)
buffer_store_dwordx4 v[120:123], v26, s[24:27], s43 offen offset:0 sc1
v_pk_mul_f32 v[216:217], v[216:217], v[118:119] op_sel:[0,0] op_sel_hi:[1,0]
v_pk_mul_f32 v[218:219], v[218:219], v[118:119] op_sel:[0,0] op_sel_hi:[1,0]
v_pk_mul_f32 v[220:221], v[220:221], v[118:119] op_sel:[0,0] op_sel_hi:[1,0]
v_pk_mul_f32 v[222:223], v[222:223], v[118:119] op_sel:[0,0] op_sel_hi:[1,0]
v_cvt_pk_bf16_f32 v124, v216, v217
v_cvt_pk_bf16_f32 v125, v218, v219
v_cvt_pk_bf16_f32 v126, v220, v221
v_cvt_pk_bf16_f32 v127, v222, v223
s_waitcnt vmcnt(62)
buffer_store_dwordx4 v[124:127], v26, s[24:27], s43 offen offset:1024 sc1
s_mov_b32 s43, 458752
v_pk_mul_f32 v[224:225], v[224:225], v[118:119] op_sel:[0,1] op_sel_hi:[1,1]
v_pk_mul_f32 v[226:227], v[226:227], v[118:119] op_sel:[0,1] op_sel_hi:[1,1]
v_pk_mul_f32 v[228:229], v[228:229], v[118:119] op_sel:[0,1] op_sel_hi:[1,1]
v_pk_mul_f32 v[230:231], v[230:231], v[118:119] op_sel:[0,1] op_sel_hi:[1,1]
v_cvt_pk_bf16_f32 v120, v224, v225
v_cvt_pk_bf16_f32 v121, v226, v227
v_cvt_pk_bf16_f32 v122, v228, v229
v_cvt_pk_bf16_f32 v123, v230, v231
s_waitcnt vmcnt(62)
buffer_store_dwordx4 v[120:123], v26, s[24:27], s43 offen offset:0 sc1
v_pk_mul_f32 v[232:233], v[232:233], v[118:119] op_sel:[0,1] op_sel_hi:[1,1]
v_pk_mul_f32 v[234:235], v[234:235], v[118:119] op_sel:[0,1] op_sel_hi:[1,1]
v_pk_mul_f32 v[236:237], v[236:237], v[118:119] op_sel:[0,1] op_sel_hi:[1,1]
v_pk_mul_f32 v[238:239], v[238:239], v[118:119] op_sel:[0,1] op_sel_hi:[1,1]
v_cvt_pk_bf16_f32 v124, v232, v233
v_cvt_pk_bf16_f32 v125, v234, v235
v_cvt_pk_bf16_f32 v126, v236, v237
v_cvt_pk_bf16_f32 v127, v238, v239
s_waitcnt vmcnt(62)
buffer_store_dwordx4 v[124:127], v26, s[24:27], s43 offen offset:1024 sc1
s_mov_b32 s43, 491520
v_pk_mul_f32 v[240:241], v[240:241], v[118:119] op_sel:[0,1] op_sel_hi:[1,1]
v_pk_mul_f32 v[242:243], v[242:243], v[118:119] op_sel:[0,1] op_sel_hi:[1,1]
v_pk_mul_f32 v[244:245], v[244:245], v[118:119] op_sel:[0,1] op_sel_hi:[1,1]
v_pk_mul_f32 v[246:247], v[246:247], v[118:119] op_sel:[0,1] op_sel_hi:[1,1]
v_cvt_pk_bf16_f32 v120, v240, v241
v_cvt_pk_bf16_f32 v121, v242, v243
v_cvt_pk_bf16_f32 v122, v244, v245
v_cvt_pk_bf16_f32 v123, v246, v247
s_waitcnt vmcnt(62)
buffer_store_dwordx4 v[120:123], v26, s[24:27], s43 offen offset:0 sc1
v_pk_mul_f32 v[248:249], v[248:249], v[118:119] op_sel:[0,1] op_sel_hi:[1,1]
v_pk_mul_f32 v[250:251], v[250:251], v[118:119] op_sel:[0,1] op_sel_hi:[1,1]
v_pk_mul_f32 v[252:253], v[252:253], v[118:119] op_sel:[0,1] op_sel_hi:[1,1]
v_pk_mul_f32 v[254:255], v[254:255], v[118:119] op_sel:[0,1] op_sel_hi:[1,1]
v_cvt_pk_bf16_f32 v124, v248, v249
v_cvt_pk_bf16_f32 v125, v250, v251
v_cvt_pk_bf16_f32 v126, v252, v253
v_cvt_pk_bf16_f32 v127, v254, v255
s_waitcnt vmcnt(62)
buffer_store_dwordx4 v[124:127], v26, s[24:27], s43 offen offset:1024 sc1
s_branch L_fuse
L_tm:
v_lshrrev_b32 v27, 4, v1
v_and_b32 v28, 15, v1
v_lshlrev_b32 v31, 8, v28
v_lshl_add_u32 v31, v27, 4, v31
v_mov_b32 v192, 0xff7fffff
v_mov_b32 v193, 0xff7fffff
v_mov_b32 v194, 0xff7fffff
v_mov_b32 v195, 0xff7fffff
s_mov_b32 s37, 0
s_mov_b32 s32, 64
L_tm_0:
s_waitcnt vmcnt(62)
buffer_load_dwordx4 v[32:35], v31, s[16:19], s37 offen offset:0
s_waitcnt vmcnt(62)
buffer_load_dwordx4 v[36:39], v31, s[16:19], s37 offen offset:64
s_waitcnt vmcnt(62)
buffer_load_dwordx4 v[40:43], v31, s[16:19], s37 offen offset:128
s_waitcnt vmcnt(62)
buffer_load_dwordx4 v[44:47], v31, s[16:19], s37 offen offset:192
s_waitcnt vmcnt(0)
v_mfma_f32_16x16x32_bf16 v[128:131], v[32:35], a[0:3], 0
v_mfma_f32_16x16x32_bf16 v[128:131], v[36:39], a[4:7], v[128:131]
v_mfma_f32_16x16x32_bf16 v[128:131], v[40:43], a[8:11], v[128:131]
v_mfma_f32_16x16x32_bf16 v[128:131], v[44:47], a[12:15], v[128:131]
v_mfma_f32_16x16x32_bf16 v[132:135], v[32:35], a[16:19], 0
v_mfma_f32_16x16x32_bf16 v[132:135], v[36:39], a[20:23], v[132:135]
v_mfma_f32_16x16x32_bf16 v[132:135], v[40:43], a[24:27], v[132:135]
v_mfma_f32_16x16x32_bf16 v[132:135], v[44:47], a[28:31], v[132:135]
v_mfma_f32_16x16x32_bf16 v[136:139], v[32:35], a[32:35], 0
v_mfma_f32_16x16x32_bf16 v[136:139], v[36:39], a[36:39], v[136:139]
v_mfma_f32_16x16x32_bf16 v[136:139], v[40:43], a[40:43], v[136:139]
v_mfma_f32_16x16x32_bf16 v[136:139], v[44:47], a[44:47], v[136:139]
v_mfma_f32_16x16x32_bf16 v[140:143], v[32:35], a[48:51], 0
v_mfma_f32_16x16x32_bf16 v[140:143], v[36:39], a[52:55], v[140:143]
v_mfma_f32_16x16x32_bf16 v[140:143], v[40:43], a[56:59], v[140:143]
v_mfma_f32_16x16x32_bf16 v[140:143], v[44:47], a[60:63], v[140:143]
s_nop 7
v_max3_f32 v192, v192, v128, v129
v_max3_f32 v192, v192, v130, v131
v_max3_f32 v193, v193, v132, v133
v_max3_f32 v193, v193, v134, v135
v_max3_f32 v194, v194, v136, v137
v_max3_f32 v194, v194, v138, v139
v_max3_f32 v195, v195, v140, v141
v_max3_f32 v195, v195, v142, v143
s_add_u32 s37, s37, 4096
s_sub_u32 s32, s32, 1
s_cmp_lg_u32 s32, 0
s_cbranch_scc1 L_tm_0
v_mov_b32 v196, 0xff7fffff
v_mov_b32 v197, 0xff7fffff
v_mov_b32 v198, 0xff7fffff
v_mov_b32 v199, 0xff7fffff
s_mov_b32 s37, 262144
s_mov_b32 s32, 64
L_tm_1:
buffer_load_dwordx4 v[32:35], v31, s[16:19], s37 offen offset:0
buffer_load_dwordx4 v[36:39], v31, s[16:19], s37 offen offset:64
buffer_load_dwordx4 v[40:43], v31, s[16:19], s37 offen offset:128
buffer_load_dwordx4 v[44:47], v31, s[16:19], s37 offen offset:192
s_waitcnt vmcnt(0)
v_mfma_f32_16x16x32_bf16 v[128:131], v[32:35], a[64:67], 0
v_mfma_f32_16x16x32_bf16 v[128:131], v[36:39], a[68:71], v[128:131]
v_mfma_f32_16x16x32_bf16 v[128:131], v[40:43], a[72:75], v[128:131]
v_mfma_f32_16x16x32_bf16 v[128:131], v[44:47], a[76:79], v[128:131]
v_mfma_f32_16x16x32_bf16 v[132:135], v[32:35], a[80:83], 0
v_mfma_f32_16x16x32_bf16 v[132:135], v[36:39], a[84:87], v[132:135]
v_mfma_f32_16x16x32_bf16 v[132:135], v[40:43], a[88:91], v[132:135]
v_mfma_f32_16x16x32_bf16 v[132:135], v[44:47], a[92:95], v[132:135]
v_mfma_f32_16x16x32_bf16 v[136:139], v[32:35], a[96:99], 0
v_mfma_f32_16x16x32_bf16 v[136:139], v[36:39], a[100:103], v[136:139]
v_mfma_f32_16x16x32_bf16 v[136:139], v[40:43], a[104:107], v[136:139]
v_mfma_f32_16x16x32_bf16 v[136:139], v[44:47], a[108:111], v[136:139]
v_mfma_f32_16x16x32_bf16 v[140:143], v[32:35], a[112:115], 0
v_mfma_f32_16x16x32_bf16 v[140:143], v[36:39], a[116:119], v[140:143]
v_mfma_f32_16x16x32_bf16 v[140:143], v[40:43], a[120:123], v[140:143]
v_mfma_f32_16x16x32_bf16 v[140:143], v[44:47], a[124:127], v[140:143]
s_nop 7
v_max3_f32 v196, v196, v128, v129
v_max3_f32 v196, v196, v130, v131
v_max3_f32 v197, v197, v132, v133
v_max3_f32 v197, v197, v134, v135
v_max3_f32 v198, v198, v136, v137
v_max3_f32 v198, v198, v138, v139
v_max3_f32 v199, v199, v140, v141
v_max3_f32 v199, v199, v142, v143
s_add_u32 s37, s37, 4096
s_sub_u32 s32, s32, 1
s_cmp_lg_u32 s32, 0
s_cbranch_scc1 L_tm_1
v_mov_b32 v208, v192
v_mov_b32 v209, v193
v_mov_b32 v210, v194
v_mov_b32 v211, v195
v_mov_b32 v212, v196
v_mov_b32 v213, v197
v_mov_b32 v214, v198
v_mov_b32 v215, v199
s_nop 1
v_permlane32_swap_b32 v192, v208
v_permlane32_swap_b32 v193, v209
v_permlane32_swap_b32 v194, v210
v_permlane32_swap_b32 v195, v211
v_permlane32_swap_b32 v196, v212
v_permlane32_swap_b32 v197, v213
v_permlane32_swap_b32 v198, v214
v_permlane32_swap_b32 v199, v215
s_nop 1
v_max_f32 v192, v192, v208
v_max_f32 v193, v193, v209
v_max_f32 v194, v194, v210
v_max_f32 v195, v195, v211
v_max_f32 v196, v196, v212
v_max_f32 v197, v197, v213
v_max_f32 v198, v198, v214
v_max_f32 v199, v199, v215
v_mov_b32 v208, v192
v_mov_b32 v209, v193
v_mov_b32 v210, v194
v_mov_b32 v211, v195
v_mov_b32 v212, v196
v_mov_b32 v213, v197
v_mov_b32 v214, v198
v_mov_b32 v215, v199
s_nop 1
v_permlane16_swap_b32 v192, v208
v_permlane16_swap_b32 v193, v209
v_permlane16_swap_b32 v194, v210
v_permlane16_swap_b32 v195, v211
v_permlane16_swap_b32 v196, v212
v_permlane16_swap_b32 v197, v213
v_permlane16_swap_b32 v198, v214
v_permlane16_swap_b32 v199, v215
s_nop 1
v_max_f32 v192, v192, v208
v_max_f32 v193, v193, v209
v_max_f32 v194, v194, v210
v_max_f32 v195, v195, v211
v_max_f32 v196, v196, v212
v_max_f32 v197, v197, v213
v_max_f32 v198, v198, v214
v_max_f32 v199, v199, v215
v_sub_f32 v96, 0, v192
v_sub_f32 v97, 0, v192
v_sub_f32 v98, 0, v192
v_sub_f32 v99, 0, v192
v_sub_f32 v112, 0, v196
v_sub_f32 v100, 0, v193
v_sub_f32 v101, 0, v193
v_sub_f32 v102, 0, v193
v_sub_f32 v103, 0, v193
v_sub_f32 v113, 0, v197
v_sub_f32 v104, 0, v194
v_sub_f32 v105, 0, v194
v_sub_f32 v106, 0, v194
v_sub_f32 v107, 0, v194
v_sub_f32 v114, 0, v198
v_sub_f32 v108, 0, v195
v_sub_f32 v109, 0, v195
v_sub_f32 v110, 0, v195
v_sub_f32 v111, 0, v195
v_sub_f32 v115, 0, v199
s_nop 7
s_branch L_attn
L_w3:
s_mov_b32 s34, 139264
s_mov_b32 s35, 145408
v_add_u32 v16, 139264, v16
v_xor_b32 v17, 64, v16
s_add_u32 s29, s33, 52224
s_mov_b32 s30, 256
s_add_u32 m0, s29, 0
s_nop 0
buffer_load_dwordx4 v2, s[12:15], s30 offen  lds
s_add_u32 m0, s29, 1088
s_nop 0
buffer_load_dwordx4 v3, s[12:15], s30 offen  lds
s_add_u32 m0, s29, 2176
s_nop 0
buffer_load_dwordx4 v4, s[12:15], s30 offen  lds
s_add_u32 m0, s29, 3264
s_nop 0
buffer_load_dwordx4 v5, s[12:15], s30 offen  lds
s_mov_b32 s31, 0
s_add_u32 m0, s34, 0
s_nop 0
buffer_load_dwordx4 v6, s[8:11], s31 offen  lds
s_add_u32 m0, s34, 1024
s_nop 0
buffer_load_dwordx4 v7, s[8:11], s31 offen  lds
s_add_u32 m0, s34, 2048
s_nop 0
buffer_load_dwordx4 v8, s[8:11], s31 offen  lds
s_add_u32 m0, s34, 3072
s_nop 0
buffer_load_dwordx4 v9, s[8:11], s31 offen  lds
s_add_u32 m0, s34, 4096
s_nop 0
buffer_load_dwordx4 v10, s[8:11], s31 offen  lds
s_add_u32 m0, s34, 5120
s_nop 0
buffer_load_dwordx4 v11, s[8:11], s31 offen  lds
s_mov_b32 s31, 128
s_add_u32 m0, s35, 0
s_nop 0
buffer_load_dwordx4 v6, s[8:11], s31 offen  lds
s_add_u32 m0, s35, 1024
s_nop 0
buffer_load_dwordx4 v7, s[8:11], s31 offen  lds
s_add_u32 m0, s35, 2048
s_nop 0
buffer_load_dwordx4 v8, s[8:11], s31 offen  lds
s_add_u32 m0, s35, 3072
s_nop 0
buffer_load_dwordx4 v9, s[8:11], s31 offen  lds
s_add_u32 m0, s35, 4096
s_nop 0
buffer_load_dwordx4 v10, s[8:11], s31 offen  lds
s_add_u32 m0, s35, 5120
s_nop 0
buffer_load_dwordx4 v11, s[8:11], s31 offen  lds
s_and_b32 s29, s68, 7
s_lshl_b32 s29, s29, 2
s_lshl_b32 s28, s7, 5
s_add_u32 s28, s28, s29
s_lshr_b32 s29, s68, 3
s_xor_b32 s29, s29, 1
s_lshl_b32 s29, s29, 1
s_add_u32 s28, s28, s29
s_lshl_b32 s28, s28, 18
s_add_u32 s16, s46, s28
s_addc_u32 s17, s47, 0
s_mov_b32 s18, 524288
s_mov_b32 s19, 0x20000
s_add_u32 s20, s48, s28
s_addc_u32 s21, s49, 0
s_mov_b32 s22, 524288
s_mov_b32 s23, 0x20000
s_mul_i32 s28, s6, 120
s_mul_i32 s29, s7, 15
s_add_u32 s28, s28, s29
s_lshl_b32 s28, s28, 17
s_lshl_b32 s29, s68, 11
s_add_u32 s28, s28, s29
s_add_u32 s24, s64, s28
s_addc_u32 s25, s65, 0
s_sub_u32 s26, 1966080, s29
s_mov_b32 s27, 0x20000
s_mov_b64 s[46:47], 0
s_add_u32 s29, s33, 69632
s_mov_b32 s30, 524544
s_add_u32 m0, s29, 0
s_nop 0
buffer_load_dwordx4 v2, s[12:15], s30 offen  lds
s_add_u32 m0, s29, 1088
s_nop 0
buffer_load_dwordx4 v3, s[12:15], s30 offen  lds
s_add_u32 m0, s29, 2176
s_nop 0
buffer_load_dwordx4 v4, s[12:15], s30 offen  lds
s_add_u32 m0, s29, 3264
s_nop 0
buffer_load_dwordx4 v5, s[12:15], s30 offen  lds
s_add_u32 s29, s33, 87040
s_mov_b32 s30, 0
s_add_u32 m0, s29, 0
s_nop 0
buffer_load_dwordx4 v2, s[12:15], s30 offen  lds
s_add_u32 m0, s29, 1088
s_nop 0
buffer_load_dwordx4 v3, s[12:15], s30 offen  lds
s_add_u32 m0, s29, 2176
s_nop 0
buffer_load_dwordx4 v4, s[12:15], s30 offen  lds
s_add_u32 m0, s29, 3264
s_nop 0
buffer_load_dwordx4 v5, s[12:15], s30 offen  lds
s_add_u32 s29, s33, 104448
s_mov_b32 s30, 524288
s_add_u32 m0, s29, 0
s_nop 0
buffer_load_dwordx4 v2, s[12:15], s30 offen  lds
s_add_u32 m0, s29, 1088
s_nop 0
buffer_load_dwordx4 v3, s[12:15], s30 offen  lds
s_add_u32 m0, s29, 2176
s_nop 0
buffer_load_dwordx4 v4, s[12:15], s30 offen  lds
s_add_u32 m0, s29, 3264
s_nop 0
buffer_load_dwordx4 v5, s[12:15], s30 offen  lds
s_mov_b32 s37, 0
buffer_load_dwordx4 v[32:35], v31, s[16:19], s37 offen offset:0
buffer_load_dwordx4 v[36:39], v31, s[16:19], s37 offen offset:64
buffer_load_dwordx4 v[40:43], v31, s[16:19], s37 offen offset:128
buffer_load_dwordx4 v[44:47], v31, s[16:19], s37 offen offset:192
s_mov_b32 s37, 262144
buffer_load_dwordx4 v[48:51], v31, s[16:19], s37 offen offset:0
buffer_load_dwordx4 v[52:55], v31, s[16:19], s37 offen offset:64
buffer_load_dwordx4 v[56:59], v31, s[16:19], s37 offen offset:128
buffer_load_dwordx4 v[60:63], v31, s[16:19], s37 offen offset:192
s_getpc_b64 s[98:99]
L_pc03:
s_sub_u32 s98, s98, L_pc03-concat_heads__mha_block_cached__gqa_block_cached__near_ridge_kernel
s_subb_u32 s99, s99, 0
s_lshr_b32 s69, s2, 3
s_lshl_b32 s69, s69, 2
s_add_u32 s69, s69, s3
s_lshl_b32 s69, s69, 10
v_and_b32 v124, 7, v1
v_lshlrev_b32 v124, 7, v124
v_add_u32 v124, s69, v124
v_min_u32 v124, L_endall-4-concat_heads__mha_block_cached__gqa_block_cached__near_ridge_kernel, v124
v_mov_b32 v123, s99
v_add_co_u32 v122, vcc, s98, v124
s_nop 1
v_addc_co_u32 v123, vcc, 0, v123, vcc
global_load_dword v127, v[122:123], off
s_lshl_b32 s37, s3, 3
v_add_u32 v126, s37, v1
v_lshlrev_b32 v126, 7, v126
v_mov_b32 v124, 0x40000000
v_cmp_gt_u32 vcc, 8, v1
s_nop 1
v_cndmask_b32 v126, v124, v126, vcc
s_mov_b32 s69, 0
s_and_b32 s50, s5, 3
s_lshl_b32 s50, s50, 2
s_add_u32 s50, s50, s3
s_lshl_b32 s50, s50, 3
v_lshrrev_b32 v122, 2, v1
v_add_u32 v122, s50, v122
v_lshlrev_b32 v122, 13, v122
v_and_b32 v124, 3, v1
v_lshl_add_u32 v122, v124, 7, v122
v_mov_b32 v124, 0x40000000
v_cmp_gt_u32 vcc, 32, v1
s_nop 1
v_cndmask_b32 v122, v124, v122, vcc
s_lshl_b32 s51, s3, 4
v_add_u32 v121, s51, v1
s_lshr_b32 s51, s5, 2
s_mul_i32 s51, s51, 30
v_lshrrev_b32 v123, 1, v121
v_add_u32 v123, s51, v123
v_lshlrev_b32 v123, 11, v123
v_and_b32 v120, 1, v121
v_lshl_add_u32 v123, v120, 7, v123
v_cmp_gt_u32 vcc, 16, v1
s_nop 1
v_cndmask_b32 v123, v124, v123, vcc
v_cmp_gt_u32 vcc, 60, v121
s_nop 1
v_cndmask_b32 v123, v124, v123, vcc
s_mov_b32 s50, 0x100000
s_mov_b32 s51, 256
buffer_load_dword v127, v122, s[12:15], s50 offen
buffer_load_dword v127, v123, s[8:11], s51 offen
s_mov_b32 s50, 0x200000
s_mov_b32 s51, 512
s_mul_i32 s37, s3, 16
v_add_u32 v124, s37, v1
s_lshl_b32 s37, s3, 16
v_lshlrev_b32 v125, 7, v1
v_add_u32 v125, s37, v125
v_mov_b32 v124, 0x40000000
v_cmp_gt_u32 vcc, 16, v1
s_nop 1
v_cndmask_b32 v125, v124, v125, vcc
s_mov_b32 s49, s100
s_add_u32 s29, s33, 121856
s_mov_b32 s30, 1048832
s_mov_b32 s31, 256
s_mov_b32 s28, 52224
v_add_u32 v15, s28, v14
s_waitcnt vmcnt(29)
s_waitcnt lgkmcnt(0)
s_barrier
ds_read_b128 a[128:131], v16 offset:0
ds_read_b128 a[132:135], v17 offset:0
ds_read_b128 a[136:139], v16 offset:2048
ds_read_b128 a[140:143], v17 offset:2048
ds_read_b128 a[144:147], v16 offset:4096
ds_read_b128 a[148:151], v17 offset:4096
ds_read_b64_tr_b16 a[192:193], v15 offset:0
ds_read_b64_tr_b16 a[194:195], v15 offset:256
ds_read_b64_tr_b16 a[196:197], v15 offset:8704
ds_read_b64_tr_b16 a[198:199], v15 offset:8960
ds_read_b64_tr_b16 a[200:201], v15 offset:8
ds_read_b64_tr_b16 a[202:203], v15 offset:264
ds_read_b64_tr_b16 a[204:205], v15 offset:8712
ds_read_b64_tr_b16 a[206:207], v15 offset:8968
s_waitcnt lgkmcnt(4)
v_mfma_f32_16x16x32_bf16 a[0:3], a[192:195], a[128:131], 0
ds_read_b64_tr_b16 a[208:209], v15 offset:64
v_mfma_f32_16x16x32_bf16 a[0:3], a[196:199], a[132:135], a[0:3]
ds_read_b64_tr_b16 a[210:211], v15 offset:320
v_mfma_f32_16x16x32_bf16 a[32:35], a[192:195], a[136:139], 0
ds_read_b64_tr_b16 a[212:213], v15 offset:8768
v_mfma_f32_16x16x32_bf16 a[32:35], a[196:199], a[140:143], a[32:35]
s_add_u32 m0, s29, 0
ds_read_b64_tr_b16 a[214:215], v15 offset:9024
v_mfma_f32_16x16x32_bf16 a[64:67], a[192:195], a[144:147], 0
buffer_load_dwordx4 v2, s[12:15], s30 offen  lds
s_add_u32 m0, s29, 1088
v_mfma_f32_16x16x32_bf16 a[64:67], a[196:199], a[148:151], a[64:67]
s_waitcnt lgkmcnt(4)
buffer_load_dwordx4 v3, s[12:15], s30 offen  lds
v_mfma_f32_16x16x32_bf16 a[4:7], a[200:203], a[128:131], 0
ds_read_b64_tr_b16 a[216:217], v15 offset:72
v_mfma_f32_16x16x32_bf16 a[4:7], a[204:207], a[132:135], a[4:7]
ds_read_b64_tr_b16 a[218:219], v15 offset:328
v_mfma_f32_16x16x32_bf16 a[36:39], a[200:203], a[136:139], 0
ds_read_b64_tr_b16 a[220:221], v15 offset:8776
v_mfma_f32_16x16x32_bf16 a[36:39], a[204:207], a[140:143], a[36:39]
s_add_u32 m0, s29, 2176
ds_read_b64_tr_b16 a[222:223], v15 offset:9032
v_mfma_f32_16x16x32_bf16 a[68:71], a[200:203], a[144:147], 0
buffer_load_dwordx4 v4, s[12:15], s30 offen  lds
s_add_u32 m0, s29, 3264
v_mfma_f32_16x16x32_bf16 a[68:71], a[204:207], a[148:151], a[68:71]
s_waitcnt lgkmcnt(4)
buffer_load_dwordx4 v5, s[12:15], s30 offen  lds
v_mfma_f32_16x16x32_bf16 a[8:11], a[208:211], a[128:131], 0
ds_read_b64_tr_b16 a[192:193], v15 offset:128
v_mfma_f32_16x16x32_bf16 a[8:11], a[212:215], a[132:135], a[8:11]
s_add_u32 s30, s30, 0x80000
ds_read_b64_tr_b16 a[194:195], v15 offset:384
v_mfma_f32_16x16x32_bf16 a[40:43], a[208:211], a[136:139], 0
ds_read_b64_tr_b16 a[196:197], v15 offset:8832
v_mfma_f32_16x16x32_bf16 a[40:43], a[212:215], a[140:143], a[40:43]
s_waitcnt vmcnt(27)
s_add_u32 m0, s34, 0
ds_read_b64_tr_b16 a[198:199], v15 offset:9088
v_mfma_f32_16x16x32_bf16 a[72:75], a[208:211], a[144:147], 0
buffer_load_dwordx4 v6, s[8:11], s31 offen  lds
s_add_u32 m0, s34, 1024
ds_read_b128 a[160:163], v16 offset:6144
v_mfma_f32_16x16x32_bf16 a[72:75], a[212:215], a[148:151], a[72:75]
s_waitcnt lgkmcnt(5)
buffer_load_dwordx4 v7, s[8:11], s31 offen  lds
ds_read_b128 a[164:167], v17 offset:6144
v_mfma_f32_16x16x32_bf16 a[12:15], a[216:219], a[128:131], 0
ds_read_b64_tr_b16 a[200:201], v15 offset:136
v_mfma_f32_16x16x32_bf16 a[12:15], a[220:223], a[132:135], a[12:15]
ds_read_b64_tr_b16 a[202:203], v15 offset:392
v_mfma_f32_16x16x32_bf16 a[44:47], a[216:219], a[136:139], 0
ds_read_b64_tr_b16 a[204:205], v15 offset:8840
v_mfma_f32_16x16x32_bf16 a[44:47], a[220:223], a[140:143], a[44:47]
s_add_u32 m0, s34, 2048
ds_read_b64_tr_b16 a[206:207], v15 offset:9096
v_mfma_f32_16x16x32_bf16 a[76:79], a[216:219], a[144:147], 0
buffer_load_dwordx4 v8, s[8:11], s31 offen  lds
s_add_u32 m0, s34, 3072
ds_read_b128 a[168:171], v16 offset:8192
v_mfma_f32_16x16x32_bf16 a[76:79], a[220:223], a[148:151], a[76:79]
s_waitcnt lgkmcnt(7)
buffer_load_dwordx4 v9, s[8:11], s31 offen  lds
ds_read_b128 a[172:175], v17 offset:8192
v_mfma_f32_16x16x32_bf16 a[16:19], a[192:195], a[128:131], 0
s_add_u32 s37, s28, 17408
ds_read_b64_tr_b16 a[208:209], v15 offset:192
v_mfma_f32_16x16x32_bf16 a[16:19], a[196:199], a[132:135], a[16:19]
s_cmp_eq_u32 s37, 139264
ds_read_b64_tr_b16 a[210:211], v15 offset:448
v_mfma_f32_16x16x32_bf16 a[48:51], a[192:195], a[136:139], 0
s_cselect_b32 s36, 52224, s37
ds_read_b64_tr_b16 a[212:213], v15 offset:8896
v_mfma_f32_16x16x32_bf16 a[48:51], a[196:199], a[140:143], a[48:51]
s_add_u32 m0, s34, 4096
ds_read_b64_tr_b16 a[214:215], v15 offset:9152
v_mfma_f32_16x16x32_bf16 a[80:83], a[192:195], a[144:147], 0
buffer_load_dwordx4 v10, s[8:11], s31 offen  lds
s_add_u32 m0, s34, 5120
ds_read_b128 a[176:179], v16 offset:10240
v_mfma_f32_16x16x32_bf16 a[80:83], a[196:199], a[148:151], a[80:83]
s_waitcnt lgkmcnt(7)
buffer_load_dwordx4 v11, s[8:11], s31 offen  lds
ds_read_b128 a[180:183], v17 offset:10240
v_mfma_f32_16x16x32_bf16 a[20:23], a[200:203], a[128:131], 0
ds_read_b64_tr_b16 a[216:217], v15 offset:200
v_mfma_f32_16x16x32_bf16 a[20:23], a[204:207], a[132:135], a[20:23]
ds_read_b64_tr_b16 a[218:219], v15 offset:456
v_mfma_f32_16x16x32_bf16 a[52:55], a[200:203], a[136:139], 0
ds_read_b64_tr_b16 a[220:221], v15 offset:8904
v_mfma_f32_16x16x32_bf16 a[52:55], a[204:207], a[140:143], a[52:55]
ds_read_b64_tr_b16 a[222:223], v15 offset:9160
v_mfma_f32_16x16x32_bf16 a[84:87], a[200:203], a[144:147], 0
v_mfma_f32_16x16x32_bf16 a[84:87], a[204:207], a[148:151], a[84:87]
s_waitcnt vmcnt(29) lgkmcnt(0)
s_barrier
v_add_u32 v15, s36, v14
v_mfma_f32_16x16x32_bf16 a[24:27], a[208:211], a[128:131], 0
ds_read_b64_tr_b16 a[192:193], v15 offset:0
v_mfma_f32_16x16x32_bf16 a[24:27], a[212:215], a[132:135], a[24:27]
s_add_u32 s29, s28, s33
ds_read_b64_tr_b16 a[194:195], v15 offset:256
v_mfma_f32_16x16x32_bf16 a[56:59], a[208:211], a[136:139], 0
s_mov_b32 s28, s36
ds_read_b64_tr_b16 a[196:197], v15 offset:8704
v_mfma_f32_16x16x32_bf16 a[56:59], a[212:215], a[140:143], a[56:59]
ds_read_b64_tr_b16 a[198:199], v15 offset:8960
v_mfma_f32_16x16x32_bf16 a[88:91], a[208:211], a[144:147], 0
s_add_u32 s31, s31, 128
v_mfma_f32_16x16x32_bf16 a[88:91], a[212:215], a[148:151], a[88:91]
v_mfma_f32_16x16x32_bf16 a[28:31], a[216:219], a[128:131], 0
ds_read_b64_tr_b16 a[200:201], v15 offset:8
v_mfma_f32_16x16x32_bf16 a[28:31], a[220:223], a[132:135], a[28:31]
ds_read_b64_tr_b16 a[202:203], v15 offset:264
v_mfma_f32_16x16x32_bf16 a[60:63], a[216:219], a[136:139], 0
ds_read_b64_tr_b16 a[204:205], v15 offset:8712
buffer_load_dword v127, v122, s[12:15], s50 offen
v_mfma_f32_16x16x32_bf16 a[60:63], a[220:223], a[140:143], a[60:63]
ds_read_b64_tr_b16 a[206:207], v15 offset:8968
v_mfma_f32_16x16x32_bf16 a[92:95], a[216:219], a[144:147], 0
s_add_u32 s50, s50, 0x100000
v_mfma_f32_16x16x32_bf16 a[92:95], a[220:223], a[148:151], a[92:95]
s_waitcnt lgkmcnt(4)
v_mfma_f32_16x16x32_bf16 a[0:3], a[192:195], a[160:163], a[0:3]
ds_read_b64_tr_b16 a[208:209], v15 offset:64
v_mfma_f32_16x16x32_bf16 a[0:3], a[196:199], a[164:167], a[0:3]
ds_read_b64_tr_b16 a[210:211], v15 offset:320
v_mfma_f32_16x16x32_bf16 a[32:35], a[192:195], a[168:171], a[32:35]
ds_read_b64_tr_b16 a[212:213], v15 offset:8768
v_mfma_f32_16x16x32_bf16 a[32:35], a[196:199], a[172:175], a[32:35]
s_add_u32 m0, s29, 0
ds_read_b64_tr_b16 a[214:215], v15 offset:9024
v_mfma_f32_16x16x32_bf16 a[64:67], a[192:195], a[176:179], a[64:67]
buffer_load_dwordx4 v2, s[12:15], s30 offen  lds
s_add_u32 m0, s29, 1088
v_mfma_f32_16x16x32_bf16 a[64:67], a[196:199], a[180:183], a[64:67]
s_waitcnt lgkmcnt(4)
buffer_load_dwordx4 v3, s[12:15], s30 offen  lds
v_mfma_f32_16x16x32_bf16 a[4:7], a[200:203], a[160:163], a[4:7]
ds_read_b64_tr_b16 a[216:217], v15 offset:72
v_mfma_f32_16x16x32_bf16 a[4:7], a[204:207], a[164:167], a[4:7]
ds_read_b64_tr_b16 a[218:219], v15 offset:328
v_mfma_f32_16x16x32_bf16 a[36:39], a[200:203], a[168:171], a[36:39]
ds_read_b64_tr_b16 a[220:221], v15 offset:8776
v_mfma_f32_16x16x32_bf16 a[36:39], a[204:207], a[172:175], a[36:39]
s_add_u32 m0, s29, 2176
ds_read_b64_tr_b16 a[222:223], v15 offset:9032
v_mfma_f32_16x16x32_bf16 a[68:71], a[200:203], a[176:179], a[68:71]
buffer_load_dwordx4 v4, s[12:15], s30 offen  lds
s_add_u32 m0, s29, 3264
v_mfma_f32_16x16x32_bf16 a[68:71], a[204:207], a[180:183], a[68:71]
s_waitcnt lgkmcnt(4)
buffer_load_dwordx4 v5, s[12:15], s30 offen  lds
v_mfma_f32_16x16x32_bf16 a[8:11], a[208:211], a[160:163], a[8:11]
ds_read_b64_tr_b16 a[192:193], v15 offset:128
v_mfma_f32_16x16x32_bf16 a[8:11], a[212:215], a[164:167], a[8:11]
s_add_u32 s30, s30, 0xfff7ff00
ds_read_b64_tr_b16 a[194:195], v15 offset:384
v_mfma_f32_16x16x32_bf16 a[40:43], a[208:211], a[168:171], a[40:43]
ds_read_b64_tr_b16 a[196:197], v15 offset:8832
v_mfma_f32_16x16x32_bf16 a[40:43], a[212:215], a[172:175], a[40:43]
s_add_u32 m0, s35, 0
ds_read_b64_tr_b16 a[198:199], v15 offset:9088
v_mfma_f32_16x16x32_bf16 a[72:75], a[208:211], a[176:179], a[72:75]
buffer_load_dwordx4 v6, s[8:11], s31 offen  lds
s_add_u32 m0, s35, 1024
v_mfma_f32_16x16x32_bf16 a[72:75], a[212:215], a[180:183], a[72:75]
s_waitcnt lgkmcnt(4)
buffer_load_dwordx4 v7, s[8:11], s31 offen  lds
v_mfma_f32_16x16x32_bf16 a[12:15], a[216:219], a[160:163], a[12:15]
ds_read_b64_tr_b16 a[200:201], v15 offset:136
v_mfma_f32_16x16x32_bf16 a[12:15], a[220:223], a[164:167], a[12:15]
ds_read_b64_tr_b16 a[202:203], v15 offset:392
v_mfma_f32_16x16x32_bf16 a[44:47], a[216:219], a[168:171], a[44:47]
ds_read_b64_tr_b16 a[204:205], v15 offset:8840
v_mfma_f32_16x16x32_bf16 a[44:47], a[220:223], a[172:175], a[44:47]
s_add_u32 m0, s35, 2048
ds_read_b64_tr_b16 a[206:207], v15 offset:9096
v_mfma_f32_16x16x32_bf16 a[76:79], a[216:219], a[176:179], a[76:79]
buffer_load_dwordx4 v8, s[8:11], s31 offen  lds
s_add_u32 m0, s35, 3072
v_mfma_f32_16x16x32_bf16 a[76:79], a[220:223], a[180:183], a[76:79]
s_waitcnt lgkmcnt(4)
buffer_load_dwordx4 v9, s[8:11], s31 offen  lds
v_mfma_f32_16x16x32_bf16 a[16:19], a[192:195], a[160:163], a[16:19]
s_add_u32 s37, s28, 17408
ds_read_b64_tr_b16 a[208:209], v15 offset:192
v_mfma_f32_16x16x32_bf16 a[16:19], a[196:199], a[164:167], a[16:19]
s_cmp_eq_u32 s37, 139264
ds_read_b64_tr_b16 a[210:211], v15 offset:448
v_mfma_f32_16x16x32_bf16 a[48:51], a[192:195], a[168:171], a[48:51]
s_cselect_b32 s36, 52224, s37
ds_read_b64_tr_b16 a[212:213], v15 offset:8896
v_mfma_f32_16x16x32_bf16 a[48:51], a[196:199], a[172:175], a[48:51]
s_add_u32 m0, s35, 4096
ds_read_b64_tr_b16 a[214:215], v15 offset:9152
v_mfma_f32_16x16x32_bf16 a[80:83], a[192:195], a[176:179], a[80:83]
buffer_load_dwordx4 v10, s[8:11], s31 offen  lds
s_add_u32 m0, s35, 5120
v_mfma_f32_16x16x32_bf16 a[80:83], a[196:199], a[180:183], a[80:83]
s_waitcnt lgkmcnt(4)
buffer_load_dwordx4 v11, s[8:11], s31 offen  lds
v_mfma_f32_16x16x32_bf16 a[20:23], a[200:203], a[160:163], a[20:23]
ds_read_b64_tr_b16 a[216:217], v15 offset:200
v_mfma_f32_16x16x32_bf16 a[20:23], a[204:207], a[164:167], a[20:23]
ds_read_b64_tr_b16 a[218:219], v15 offset:456
v_mfma_f32_16x16x32_bf16 a[52:55], a[200:203], a[168:171], a[52:55]
ds_read_b64_tr_b16 a[220:221], v15 offset:8904
v_mfma_f32_16x16x32_bf16 a[52:55], a[204:207], a[172:175], a[52:55]
ds_read_b64_tr_b16 a[222:223], v15 offset:9160
v_mfma_f32_16x16x32_bf16 a[84:87], a[200:203], a[176:179], a[84:87]
v_mfma_f32_16x16x32_bf16 a[84:87], a[204:207], a[180:183], a[84:87]
s_waitcnt vmcnt(36) lgkmcnt(0)
s_barrier
v_add_u32 v15, s36, v14
v_mfma_f32_16x16x32_bf16 a[24:27], a[208:211], a[160:163], a[24:27]
ds_read_b64_tr_b16 a[192:193], v15 offset:0
v_mfma_f32_16x16x32_bf16 a[24:27], a[212:215], a[164:167], a[24:27]
s_add_u32 s29, s28, s33
ds_read_b64_tr_b16 a[194:195], v15 offset:256
v_mfma_f32_16x16x32_bf16 a[56:59], a[208:211], a[168:171], a[56:59]
s_mov_b32 s28, s36
ds_read_b64_tr_b16 a[196:197], v15 offset:8704
v_mfma_f32_16x16x32_bf16 a[56:59], a[212:215], a[172:175], a[56:59]
ds_read_b64_tr_b16 a[198:199], v15 offset:8960
v_mfma_f32_16x16x32_bf16 a[88:91], a[208:211], a[176:179], a[88:91]
s_add_u32 s31, s31, 128
v_mfma_f32_16x16x32_bf16 a[88:91], a[212:215], a[180:183], a[88:91]
v_mfma_f32_16x16x32_bf16 a[28:31], a[216:219], a[160:163], a[28:31]
ds_read_b64_tr_b16 a[200:201], v15 offset:8
v_mfma_f32_16x16x32_bf16 a[28:31], a[220:223], a[164:167], a[28:31]
ds_read_b64_tr_b16 a[202:203], v15 offset:264
v_mfma_f32_16x16x32_bf16 a[60:63], a[216:219], a[168:171], a[60:63]
ds_read_b64_tr_b16 a[204:205], v15 offset:8712
buffer_load_dword v127, v123, s[8:11], s51 offen
v_mfma_f32_16x16x32_bf16 a[60:63], a[220:223], a[172:175], a[60:63]
ds_read_b64_tr_b16 a[206:207], v15 offset:8968
v_mfma_f32_16x16x32_bf16 a[92:95], a[216:219], a[176:179], a[92:95]
s_add_u32 s51, s51, 256
v_mfma_f32_16x16x32_bf16 a[92:95], a[220:223], a[180:183], a[92:95]
s_waitcnt lgkmcnt(4)
v_mfma_f32_16x16x32_bf16 v[128:131], a[192:195], a[128:131], 0
ds_read_b64_tr_b16 a[208:209], v15 offset:64
v_mfma_f32_16x16x32_bf16 v[128:131], a[196:199], a[132:135], v[128:131]
ds_read_b64_tr_b16 a[210:211], v15 offset:320
v_mfma_f32_16x16x32_bf16 v[160:163], a[192:195], a[136:139], 0
ds_read_b64_tr_b16 a[212:213], v15 offset:8768
v_mfma_f32_16x16x32_bf16 v[160:163], a[196:199], a[140:143], v[160:163]
s_add_u32 m0, s29, 0
ds_read_b64_tr_b16 a[214:215], v15 offset:9024
v_mfma_f32_16x16x32_bf16 v[192:195], a[192:195], a[144:147], 0
buffer_load_dwordx4 v2, s[12:15], s30 offen  lds
s_add_u32 m0, s29, 1088
v_mfma_f32_16x16x32_bf16 v[192:195], a[196:199], a[148:151], v[192:195]
s_waitcnt lgkmcnt(4)
buffer_load_dwordx4 v3, s[12:15], s30 offen  lds
v_mfma_f32_16x16x32_bf16 v[132:135], a[200:203], a[128:131], 0
ds_read_b64_tr_b16 a[216:217], v15 offset:72
v_mfma_f32_16x16x32_bf16 v[132:135], a[204:207], a[132:135], v[132:135]
ds_read_b64_tr_b16 a[218:219], v15 offset:328
v_mfma_f32_16x16x32_bf16 v[164:167], a[200:203], a[136:139], 0
ds_read_b64_tr_b16 a[220:221], v15 offset:8776
v_mfma_f32_16x16x32_bf16 v[164:167], a[204:207], a[140:143], v[164:167]
s_add_u32 m0, s29, 2176
ds_read_b64_tr_b16 a[222:223], v15 offset:9032
v_mfma_f32_16x16x32_bf16 v[196:199], a[200:203], a[144:147], 0
buffer_load_dwordx4 v4, s[12:15], s30 offen  lds
s_add_u32 m0, s29, 3264
v_mfma_f32_16x16x32_bf16 v[196:199], a[204:207], a[148:151], v[196:199]
s_waitcnt lgkmcnt(4)
buffer_load_dwordx4 v5, s[12:15], s30 offen  lds
v_mfma_f32_16x16x32_bf16 v[136:139], a[208:211], a[128:131], 0
ds_read_b64_tr_b16 a[192:193], v15 offset:128
v_mfma_f32_16x16x32_bf16 v[136:139], a[212:215], a[132:135], v[136:139]
s_add_u32 s30, s30, 0x80000
ds_read_b64_tr_b16 a[194:195], v15 offset:384
v_mfma_f32_16x16x32_bf16 v[168:171], a[208:211], a[136:139], 0
ds_read_b64_tr_b16 a[196:197], v15 offset:8832
v_mfma_f32_16x16x32_bf16 v[168:171], a[212:215], a[140:143], v[168:171]
ds_read_b64_tr_b16 a[198:199], v15 offset:9088
v_mfma_f32_16x16x32_bf16 v[200:203], a[208:211], a[144:147], 0
v_mfma_f32_16x16x32_bf16 v[200:203], a[212:215], a[148:151], v[200:203]
s_waitcnt lgkmcnt(4)
v_mfma_f32_16x16x32_bf16 v[140:143], a[216:219], a[128:131], 0
ds_read_b64_tr_b16 a[200:201], v15 offset:136
v_mfma_f32_16x16x32_bf16 v[140:143], a[220:223], a[132:135], v[140:143]
ds_read_b64_tr_b16 a[202:203], v15 offset:392
v_mfma_f32_16x16x32_bf16 v[172:175], a[216:219], a[136:139], 0
ds_read_b64_tr_b16 a[204:205], v15 offset:8840
v_mfma_f32_16x16x32_bf16 v[172:175], a[220:223], a[140:143], v[172:175]
ds_read_b64_tr_b16 a[206:207], v15 offset:9096
v_mfma_f32_16x16x32_bf16 v[204:207], a[216:219], a[144:147], 0
v_mfma_f32_16x16x32_bf16 v[204:207], a[220:223], a[148:151], v[204:207]
s_waitcnt lgkmcnt(4)
v_mfma_f32_16x16x32_bf16 v[144:147], a[192:195], a[128:131], 0
s_add_u32 s37, s28, 17408
ds_read_b64_tr_b16 a[208:209], v15 offset:192
v_mfma_f32_16x16x32_bf16 v[144:147], a[196:199], a[132:135], v[144:147]
s_cmp_eq_u32 s37, 139264
ds_read_b64_tr_b16 a[210:211], v15 offset:448
v_mfma_f32_16x16x32_bf16 v[176:179], a[192:195], a[136:139], 0
s_cselect_b32 s36, 52224, s37
ds_read_b64_tr_b16 a[212:213], v15 offset:8896
v_mfma_f32_16x16x32_bf16 v[176:179], a[196:199], a[140:143], v[176:179]
ds_read_b64_tr_b16 a[214:215], v15 offset:9152
v_mfma_f32_16x16x32_bf16 v[208:211], a[192:195], a[144:147], 0
v_mfma_f32_16x16x32_bf16 v[208:211], a[196:199], a[148:151], v[208:211]
s_waitcnt lgkmcnt(4)
v_mfma_f32_16x16x32_bf16 v[148:151], a[200:203], a[128:131], 0
ds_read_b64_tr_b16 a[216:217], v15 offset:200
v_mfma_f32_16x16x32_bf16 v[148:151], a[204:207], a[132:135], v[148:151]
ds_read_b64_tr_b16 a[218:219], v15 offset:456
v_mfma_f32_16x16x32_bf16 v[180:183], a[200:203], a[136:139], 0
ds_read_b64_tr_b16 a[220:221], v15 offset:8904
v_mfma_f32_16x16x32_bf16 v[180:183], a[204:207], a[140:143], v[180:183]
ds_read_b64_tr_b16 a[222:223], v15 offset:9160
v_mfma_f32_16x16x32_bf16 v[212:215], a[200:203], a[144:147], 0
v_mfma_f32_16x16x32_bf16 v[212:215], a[204:207], a[148:151], v[212:215]
s_waitcnt vmcnt(37) lgkmcnt(0)
s_barrier
v_add_u32 v15, s36, v14
v_mfma_f32_16x16x32_bf16 v[152:155], a[208:211], a[128:131], 0
ds_read_b64_tr_b16 a[192:193], v15 offset:0
v_mfma_f32_16x16x32_bf16 v[152:155], a[212:215], a[132:135], v[152:155]
s_add_u32 s29, s28, s33
ds_read_b64_tr_b16 a[194:195], v15 offset:256
v_mfma_f32_16x16x32_bf16 v[184:187], a[208:211], a[136:139], 0
s_mov_b32 s28, s36
ds_read_b64_tr_b16 a[196:197], v15 offset:8704
buffer_load_dword v127, v126, s[52:55], s69 offen
v_mfma_f32_16x16x32_bf16 v[184:187], a[212:215], a[140:143], v[184:187]
ds_read_b64_tr_b16 a[198:199], v15 offset:8960
v_mfma_f32_16x16x32_bf16 v[216:219], a[208:211], a[144:147], 0
v_mfma_f32_16x16x32_bf16 v[216:219], a[212:215], a[148:151], v[216:219]
v_mfma_f32_16x16x32_bf16 v[156:159], a[216:219], a[128:131], 0
ds_read_b64_tr_b16 a[200:201], v15 offset:8
v_mfma_f32_16x16x32_bf16 v[156:159], a[220:223], a[132:135], v[156:159]
s_add_u32 s69, s69, 4096
ds_read_b64_tr_b16 a[202:203], v15 offset:264
v_mfma_f32_16x16x32_bf16 v[188:191], a[216:219], a[136:139], 0
ds_read_b64_tr_b16 a[204:205], v15 offset:8712
v_mfma_f32_16x16x32_bf16 v[188:191], a[220:223], a[140:143], v[188:191]
ds_read_b64_tr_b16 a[206:207], v15 offset:8968
v_mfma_f32_16x16x32_bf16 v[220:223], a[216:219], a[144:147], 0
v_mfma_f32_16x16x32_bf16 v[220:223], a[220:223], a[148:151], v[220:223]
s_waitcnt lgkmcnt(4)
v_mfma_f32_16x16x32_bf16 v[128:131], a[192:195], a[160:163], v[128:131]
ds_read_b64_tr_b16 a[208:209], v15 offset:64
v_mfma_f32_16x16x32_bf16 v[128:131], a[196:199], a[164:167], v[128:131]
ds_read_b64_tr_b16 a[210:211], v15 offset:320
v_mfma_f32_16x16x32_bf16 v[160:163], a[192:195], a[168:171], v[160:163]
ds_read_b64_tr_b16 a[212:213], v15 offset:8768
v_mfma_f32_16x16x32_bf16 v[160:163], a[196:199], a[172:175], v[160:163]
s_add_u32 m0, s29, 0
ds_read_b64_tr_b16 a[214:215], v15 offset:9024
v_mfma_f32_16x16x32_bf16 v[192:195], a[192:195], a[176:179], v[192:195]
buffer_load_dwordx4 v2, s[12:15], s30 offen  lds
s_add_u32 m0, s29, 1088
v_mfma_f32_16x16x32_bf16 v[192:195], a[196:199], a[180:183], v[192:195]
s_waitcnt lgkmcnt(4)
buffer_load_dwordx4 v3, s[12:15], s30 offen  lds
v_mfma_f32_16x16x32_bf16 v[132:135], a[200:203], a[160:163], v[132:135]
ds_read_b64_tr_b16 a[216:217], v15 offset:72
v_mfma_f32_16x16x32_bf16 v[132:135], a[204:207], a[164:167], v[132:135]
ds_read_b64_tr_b16 a[218:219], v15 offset:328
v_mfma_f32_16x16x32_bf16 v[164:167], a[200:203], a[168:171], v[164:167]
ds_read_b64_tr_b16 a[220:221], v15 offset:8776
v_mfma_f32_16x16x32_bf16 v[164:167], a[204:207], a[172:175], v[164:167]
s_add_u32 m0, s29, 2176
ds_read_b64_tr_b16 a[222:223], v15 offset:9032
v_mfma_f32_16x16x32_bf16 v[196:199], a[200:203], a[176:179], v[196:199]
buffer_load_dwordx4 v4, s[12:15], s30 offen  lds
s_add_u32 m0, s29, 3264
v_mfma_f32_16x16x32_bf16 v[196:199], a[204:207], a[180:183], v[196:199]
s_waitcnt lgkmcnt(4)
buffer_load_dwordx4 v5, s[12:15], s30 offen  lds
v_mfma_f32_16x16x32_bf16 v[136:139], a[208:211], a[160:163], v[136:139]
ds_read_b64_tr_b16 a[192:193], v15 offset:128
v_mfma_f32_16x16x32_bf16 v[136:139], a[212:215], a[164:167], v[136:139]
s_add_u32 s30, s30, 0x80100
ds_read_b64_tr_b16 a[194:195], v15 offset:384
v_mfma_f32_16x16x32_bf16 v[168:171], a[208:211], a[168:171], v[168:171]
ds_read_b64_tr_b16 a[196:197], v15 offset:8832
buffer_load_dword v127, v125, s[16:19], s49 offen
v_mfma_f32_16x16x32_bf16 v[168:171], a[212:215], a[172:175], v[168:171]
s_waitcnt vmcnt(22)
ds_read_b64_tr_b16 a[198:199], v15 offset:9088
v_mfma_f32_16x16x32_bf16 v[200:203], a[208:211], a[176:179], v[200:203]
ds_read_b128 a[128:131], v16 offset:0
v_mfma_f32_16x16x32_bf16 v[200:203], a[212:215], a[180:183], v[200:203]
s_waitcnt lgkmcnt(5)
ds_read_b128 a[132:135], v17 offset:0
v_mfma_f32_16x16x32_bf16 v[140:143], a[216:219], a[160:163], v[140:143]
ds_read_b64_tr_b16 a[200:201], v15 offset:136
v_mfma_f32_16x16x32_bf16 v[140:143], a[220:223], a[164:167], v[140:143]
ds_read_b64_tr_b16 a[202:203], v15 offset:392
v_mfma_f32_16x16x32_bf16 v[172:175], a[216:219], a[168:171], v[172:175]
ds_read_b64_tr_b16 a[204:205], v15 offset:8840
v_mfma_f32_16x16x32_bf16 v[172:175], a[220:223], a[172:175], v[172:175]
ds_read_b64_tr_b16 a[206:207], v15 offset:9096
v_mfma_f32_16x16x32_bf16 v[204:207], a[216:219], a[176:179], v[204:207]
buffer_load_dword v127, v125, s[20:23], s49 offen
s_add_u32 s49, s49, s92
s_and_b32 s49, s49, 0xf800
ds_read_b128 a[136:139], v16 offset:2048
v_mfma_f32_16x16x32_bf16 v[204:207], a[220:223], a[180:183], v[204:207]
s_waitcnt lgkmcnt(7)
ds_read_b128 a[140:143], v17 offset:2048
v_mfma_f32_16x16x32_bf16 v[144:147], a[192:195], a[160:163], v[144:147]
s_add_u32 s37, s28, 17408
ds_read_b64_tr_b16 a[208:209], v15 offset:192
v_mfma_f32_16x16x32_bf16 v[144:147], a[196:199], a[164:167], v[144:147]
s_cmp_eq_u32 s37, 139264
ds_read_b64_tr_b16 a[210:211], v15 offset:448
v_mfma_f32_16x16x32_bf16 v[176:179], a[192:195], a[168:171], v[176:179]
s_cselect_b32 s36, 52224, s37
ds_read_b64_tr_b16 a[212:213], v15 offset:8896
v_mfma_f32_16x16x32_bf16 v[176:179], a[196:199], a[172:175], v[176:179]
ds_read_b64_tr_b16 a[214:215], v15 offset:9152
v_mfma_f32_16x16x32_bf16 v[208:211], a[192:195], a[176:179], v[208:211]
ds_read_b128 a[144:147], v16 offset:4096
v_mfma_f32_16x16x32_bf16 v[208:211], a[196:199], a[180:183], v[208:211]
s_waitcnt lgkmcnt(7)
ds_read_b128 a[148:151], v17 offset:4096
v_mfma_f32_16x16x32_bf16 v[148:151], a[200:203], a[160:163], v[148:151]
ds_read_b64_tr_b16 a[216:217], v15 offset:200
v_mfma_f32_16x16x32_bf16 v[148:151], a[204:207], a[164:167], v[148:151]
ds_read_b64_tr_b16 a[218:219], v15 offset:456
v_mfma_f32_16x16x32_bf16 v[180:183], a[200:203], a[168:171], v[180:183]
ds_read_b64_tr_b16 a[220:221], v15 offset:8904
v_mfma_f32_16x16x32_bf16 v[180:183], a[204:207], a[172:175], v[180:183]
ds_read_b64_tr_b16 a[222:223], v15 offset:9160
v_mfma_f32_16x16x32_bf16 v[212:215], a[200:203], a[176:179], v[212:215]
v_mfma_f32_16x16x32_bf16 v[212:215], a[204:207], a[180:183], v[212:215]
s_waitcnt lgkmcnt(0)
s_barrier
v_add_u32 v15, s36, v14
v_mfma_f32_16x16x32_bf16 v[152:155], a[208:211], a[160:163], v[152:155]
ds_read_b64_tr_b16 a[192:193], v15 offset:0
v_mfma_f32_16x16x32_bf16 v[152:155], a[212:215], a[164:167], v[152:155]
s_add_u32 s29, s28, s33
ds_read_b64_tr_b16 a[194:195], v15 offset:256
v_mfma_f32_16x16x32_bf16 v[184:187], a[208:211], a[168:171], v[184:187]
s_mov_b32 s28, s36
ds_read_b64_tr_b16 a[196:197], v15 offset:8704
buffer_load_dword v127, v126, s[52:55], s69 offen
v_mfma_f32_16x16x32_bf16 v[184:187], a[212:215], a[172:175], v[184:187]
ds_read_b64_tr_b16 a[198:199], v15 offset:8960
v_mfma_f32_16x16x32_bf16 v[216:219], a[208:211], a[176:179], v[216:219]
v_mfma_f32_16x16x32_bf16 v[216:219], a[212:215], a[180:183], v[216:219]
v_mfma_f32_16x16x32_bf16 v[156:159], a[216:219], a[160:163], v[156:159]
ds_read_b64_tr_b16 a[200:201], v15 offset:8
v_mfma_f32_16x16x32_bf16 v[156:159], a[220:223], a[164:167], v[156:159]
s_add_u32 s69, s69, 4096
ds_read_b64_tr_b16 a[202:203], v15 offset:264
v_mfma_f32_16x16x32_bf16 v[188:191], a[216:219], a[168:171], v[188:191]
ds_read_b64_tr_b16 a[204:205], v15 offset:8712
v_mfma_f32_16x16x32_bf16 v[188:191], a[220:223], a[172:175], v[188:191]
s_sub_u32 s32, s32, 1
ds_read_b64_tr_b16 a[206:207], v15 offset:8968
v_mfma_f32_16x16x32_bf16 v[220:223], a[216:219], a[176:179], v[220:223]
s_cmp_lg_u32 s32, 0
v_mfma_f32_16x16x32_bf16 v[220:223], a[220:223], a[180:183], v[220:223]
s_waitcnt lgkmcnt(4)
s_mov_b32 s32, 6
L_qp3:
v_mfma_f32_16x16x32_bf16 a[0:3], a[192:195], a[128:131], a[0:3]
ds_read_b64_tr_b16 a[208:209], v15 offset:64
v_mfma_f32_16x16x32_bf16 a[0:3], a[196:199], a[132:135], a[0:3]
ds_read_b64_tr_b16 a[210:211], v15 offset:320
v_mfma_f32_16x16x32_bf16 a[32:35], a[192:195], a[136:139], a[32:35]
ds_read_b64_tr_b16 a[212:213], v15 offset:8768
v_mfma_f32_16x16x32_bf16 a[32:35], a[196:199], a[140:143], a[32:35]
s_add_u32 m0, s29, 0
ds_read_b64_tr_b16 a[214:215], v15 offset:9024
v_mfma_f32_16x16x32_bf16 a[64:67], a[192:195], a[144:147], a[64:67]
buffer_load_dwordx4 v2, s[12:15], s30 offen  lds
s_add_u32 m0, s29, 1088
v_mfma_f32_16x16x32_bf16 a[64:67], a[196:199], a[148:151], a[64:67]
s_waitcnt lgkmcnt(4)
buffer_load_dwordx4 v3, s[12:15], s30 offen  lds
v_mfma_f32_16x16x32_bf16 a[4:7], a[200:203], a[128:131], a[4:7]
ds_read_b64_tr_b16 a[216:217], v15 offset:72
v_mfma_f32_16x16x32_bf16 a[4:7], a[204:207], a[132:135], a[4:7]
ds_read_b64_tr_b16 a[218:219], v15 offset:328
v_mfma_f32_16x16x32_bf16 a[36:39], a[200:203], a[136:139], a[36:39]
ds_read_b64_tr_b16 a[220:221], v15 offset:8776
v_mfma_f32_16x16x32_bf16 a[36:39], a[204:207], a[140:143], a[36:39]
s_add_u32 m0, s29, 2176
ds_read_b64_tr_b16 a[222:223], v15 offset:9032
v_mfma_f32_16x16x32_bf16 a[68:71], a[200:203], a[144:147], a[68:71]
buffer_load_dwordx4 v4, s[12:15], s30 offen  lds
s_add_u32 m0, s29, 3264
v_mfma_f32_16x16x32_bf16 a[68:71], a[204:207], a[148:151], a[68:71]
s_waitcnt lgkmcnt(4)
buffer_load_dwordx4 v5, s[12:15], s30 offen  lds
v_mfma_f32_16x16x32_bf16 a[8:11], a[208:211], a[128:131], a[8:11]
ds_read_b64_tr_b16 a[192:193], v15 offset:128
v_mfma_f32_16x16x32_bf16 a[8:11], a[212:215], a[132:135], a[8:11]
s_add_u32 s30, s30, 0x80000
ds_read_b64_tr_b16 a[194:195], v15 offset:384
v_mfma_f32_16x16x32_bf16 a[40:43], a[208:211], a[136:139], a[40:43]
ds_read_b64_tr_b16 a[196:197], v15 offset:8832
v_mfma_f32_16x16x32_bf16 a[40:43], a[212:215], a[140:143], a[40:43]
s_waitcnt vmcnt(17)
s_add_u32 m0, s34, 0
ds_read_b64_tr_b16 a[198:199], v15 offset:9088
v_mfma_f32_16x16x32_bf16 a[72:75], a[208:211], a[144:147], a[72:75]
buffer_load_dwordx4 v6, s[8:11], s31 offen  lds
s_add_u32 m0, s34, 1024
ds_read_b128 a[160:163], v16 offset:6144
v_mfma_f32_16x16x32_bf16 a[72:75], a[212:215], a[148:151], a[72:75]
s_waitcnt lgkmcnt(5)
buffer_load_dwordx4 v7, s[8:11], s31 offen  lds
ds_read_b128 a[164:167], v17 offset:6144
v_mfma_f32_16x16x32_bf16 a[12:15], a[216:219], a[128:131], a[12:15]
ds_read_b64_tr_b16 a[200:201], v15 offset:136
v_mfma_f32_16x16x32_bf16 a[12:15], a[220:223], a[132:135], a[12:15]
ds_read_b64_tr_b16 a[202:203], v15 offset:392
v_mfma_f32_16x16x32_bf16 a[44:47], a[216:219], a[136:139], a[44:47]
ds_read_b64_tr_b16 a[204:205], v15 offset:8840
v_mfma_f32_16x16x32_bf16 a[44:47], a[220:223], a[140:143], a[44:47]
s_add_u32 m0, s34, 2048
ds_read_b64_tr_b16 a[206:207], v15 offset:9096
v_mfma_f32_16x16x32_bf16 a[76:79], a[216:219], a[144:147], a[76:79]
buffer_load_dwordx4 v8, s[8:11], s31 offen  lds
s_add_u32 m0, s34, 3072
ds_read_b128 a[168:171], v16 offset:8192
v_mfma_f32_16x16x32_bf16 a[76:79], a[220:223], a[148:151], a[76:79]
s_waitcnt lgkmcnt(7)
buffer_load_dwordx4 v9, s[8:11], s31 offen  lds
ds_read_b128 a[172:175], v17 offset:8192
v_mfma_f32_16x16x32_bf16 a[16:19], a[192:195], a[128:131], a[16:19]
s_add_u32 s37, s28, 17408
ds_read_b64_tr_b16 a[208:209], v15 offset:192
v_mfma_f32_16x16x32_bf16 a[16:19], a[196:199], a[132:135], a[16:19]
s_cmp_eq_u32 s37, 139264
ds_read_b64_tr_b16 a[210:211], v15 offset:448
v_mfma_f32_16x16x32_bf16 a[48:51], a[192:195], a[136:139], a[48:51]
s_cselect_b32 s36, 52224, s37
ds_read_b64_tr_b16 a[212:213], v15 offset:8896
v_mfma_f32_16x16x32_bf16 a[48:51], a[196:199], a[140:143], a[48:51]
s_add_u32 m0, s34, 4096
ds_read_b64_tr_b16 a[214:215], v15 offset:9152
v_mfma_f32_16x16x32_bf16 a[80:83], a[192:195], a[144:147], a[80:83]
buffer_load_dwordx4 v10, s[8:11], s31 offen  lds
s_add_u32 m0, s34, 5120
ds_read_b128 a[176:179], v16 offset:10240
v_mfma_f32_16x16x32_bf16 a[80:83], a[196:199], a[148:151], a[80:83]
s_waitcnt lgkmcnt(7)
buffer_load_dwordx4 v11, s[8:11], s31 offen  lds
ds_read_b128 a[180:183], v17 offset:10240
v_mfma_f32_16x16x32_bf16 a[20:23], a[200:203], a[128:131], a[20:23]
ds_read_b64_tr_b16 a[216:217], v15 offset:200
v_mfma_f32_16x16x32_bf16 a[20:23], a[204:207], a[132:135], a[20:23]
ds_read_b64_tr_b16 a[218:219], v15 offset:456
v_mfma_f32_16x16x32_bf16 a[52:55], a[200:203], a[136:139], a[52:55]
ds_read_b64_tr_b16 a[220:221], v15 offset:8904
v_mfma_f32_16x16x32_bf16 a[52:55], a[204:207], a[140:143], a[52:55]
ds_read_b64_tr_b16 a[222:223], v15 offset:9160
v_mfma_f32_16x16x32_bf16 a[84:87], a[200:203], a[144:147], a[84:87]
v_mfma_f32_16x16x32_bf16 a[84:87], a[204:207], a[148:151], a[84:87]
s_waitcnt lgkmcnt(0)
s_barrier
v_add_u32 v15, s36, v14
v_mfma_f32_16x16x32_bf16 a[24:27], a[208:211], a[128:131], a[24:27]
ds_read_b64_tr_b16 a[192:193], v15 offset:0
v_mfma_f32_16x16x32_bf16 a[24:27], a[212:215], a[132:135], a[24:27]
s_add_u32 s29, s28, s33
ds_read_b64_tr_b16 a[194:195], v15 offset:256
v_mfma_f32_16x16x32_bf16 a[56:59], a[208:211], a[136:139], a[56:59]
s_mov_b32 s28, s36
ds_read_b64_tr_b16 a[196:197], v15 offset:8704
v_mfma_f32_16x16x32_bf16 a[56:59], a[212:215], a[140:143], a[56:59]
ds_read_b64_tr_b16 a[198:199], v15 offset:8960
v_mfma_f32_16x16x32_bf16 a[88:91], a[208:211], a[144:147], a[88:91]
s_add_u32 s31, s31, 128
v_mfma_f32_16x16x32_bf16 a[88:91], a[212:215], a[148:151], a[88:91]
v_mfma_f32_16x16x32_bf16 a[28:31], a[216:219], a[128:131], a[28:31]
ds_read_b64_tr_b16 a[200:201], v15 offset:8
v_mfma_f32_16x16x32_bf16 a[28:31], a[220:223], a[132:135], a[28:31]
ds_read_b64_tr_b16 a[202:203], v15 offset:264
v_mfma_f32_16x16x32_bf16 a[60:63], a[216:219], a[136:139], a[60:63]
ds_read_b64_tr_b16 a[204:205], v15 offset:8712
buffer_load_dword v127, v122, s[12:15], s50 offen
v_mfma_f32_16x16x32_bf16 a[60:63], a[220:223], a[140:143], a[60:63]
ds_read_b64_tr_b16 a[206:207], v15 offset:8968
v_mfma_f32_16x16x32_bf16 a[92:95], a[216:219], a[144:147], a[92:95]
s_add_u32 s50, s50, 0x100000
v_mfma_f32_16x16x32_bf16 a[92:95], a[220:223], a[148:151], a[92:95]
s_waitcnt lgkmcnt(4)
v_mfma_f32_16x16x32_bf16 a[0:3], a[192:195], a[160:163], a[0:3]
ds_read_b64_tr_b16 a[208:209], v15 offset:64
v_mfma_f32_16x16x32_bf16 a[0:3], a[196:199], a[164:167], a[0:3]
ds_read_b64_tr_b16 a[210:211], v15 offset:320
v_mfma_f32_16x16x32_bf16 a[32:35], a[192:195], a[168:171], a[32:35]
ds_read_b64_tr_b16 a[212:213], v15 offset:8768
v_mfma_f32_16x16x32_bf16 a[32:35], a[196:199], a[172:175], a[32:35]
s_add_u32 m0, s29, 0
ds_read_b64_tr_b16 a[214:215], v15 offset:9024
v_mfma_f32_16x16x32_bf16 a[64:67], a[192:195], a[176:179], a[64:67]
buffer_load_dwordx4 v2, s[12:15], s30 offen  lds
s_add_u32 m0, s29, 1088
v_mfma_f32_16x16x32_bf16 a[64:67], a[196:199], a[180:183], a[64:67]
s_waitcnt lgkmcnt(4)
buffer_load_dwordx4 v3, s[12:15], s30 offen  lds
v_mfma_f32_16x16x32_bf16 a[4:7], a[200:203], a[160:163], a[4:7]
ds_read_b64_tr_b16 a[216:217], v15 offset:72
v_mfma_f32_16x16x32_bf16 a[4:7], a[204:207], a[164:167], a[4:7]
ds_read_b64_tr_b16 a[218:219], v15 offset:328
v_mfma_f32_16x16x32_bf16 a[36:39], a[200:203], a[168:171], a[36:39]
ds_read_b64_tr_b16 a[220:221], v15 offset:8776
v_mfma_f32_16x16x32_bf16 a[36:39], a[204:207], a[172:175], a[36:39]
s_add_u32 m0, s29, 2176
ds_read_b64_tr_b16 a[222:223], v15 offset:9032
v_mfma_f32_16x16x32_bf16 a[68:71], a[200:203], a[176:179], a[68:71]
buffer_load_dwordx4 v4, s[12:15], s30 offen  lds
s_add_u32 m0, s29, 3264
v_mfma_f32_16x16x32_bf16 a[68:71], a[204:207], a[180:183], a[68:71]
s_waitcnt lgkmcnt(4)
buffer_load_dwordx4 v5, s[12:15], s30 offen  lds
v_mfma_f32_16x16x32_bf16 a[8:11], a[208:211], a[160:163], a[8:11]
ds_read_b64_tr_b16 a[192:193], v15 offset:128
v_mfma_f32_16x16x32_bf16 a[8:11], a[212:215], a[164:167], a[8:11]
s_add_u32 s30, s30, 0xfff7ff00
ds_read_b64_tr_b16 a[194:195], v15 offset:384
v_mfma_f32_16x16x32_bf16 a[40:43], a[208:211], a[168:171], a[40:43]
ds_read_b64_tr_b16 a[196:197], v15 offset:8832
v_mfma_f32_16x16x32_bf16 a[40:43], a[212:215], a[172:175], a[40:43]
s_add_u32 m0, s35, 0
ds_read_b64_tr_b16 a[198:199], v15 offset:9088
v_mfma_f32_16x16x32_bf16 a[72:75], a[208:211], a[176:179], a[72:75]
buffer_load_dwordx4 v6, s[8:11], s31 offen  lds
s_add_u32 m0, s35, 1024
v_mfma_f32_16x16x32_bf16 a[72:75], a[212:215], a[180:183], a[72:75]
s_waitcnt lgkmcnt(4)
buffer_load_dwordx4 v7, s[8:11], s31 offen  lds
v_mfma_f32_16x16x32_bf16 a[12:15], a[216:219], a[160:163], a[12:15]
ds_read_b64_tr_b16 a[200:201], v15 offset:136
v_mfma_f32_16x16x32_bf16 a[12:15], a[220:223], a[164:167], a[12:15]
ds_read_b64_tr_b16 a[202:203], v15 offset:392
v_mfma_f32_16x16x32_bf16 a[44:47], a[216:219], a[168:171], a[44:47]
ds_read_b64_tr_b16 a[204:205], v15 offset:8840
v_mfma_f32_16x16x32_bf16 a[44:47], a[220:223], a[172:175], a[44:47]
s_add_u32 m0, s35, 2048
ds_read_b64_tr_b16 a[206:207], v15 offset:9096
v_mfma_f32_16x16x32_bf16 a[76:79], a[216:219], a[176:179], a[76:79]
buffer_load_dwordx4 v8, s[8:11], s31 offen  lds
s_add_u32 m0, s35, 3072
v_mfma_f32_16x16x32_bf16 a[76:79], a[220:223], a[180:183], a[76:79]
s_waitcnt lgkmcnt(4)
buffer_load_dwordx4 v9, s[8:11], s31 offen  lds
v_mfma_f32_16x16x32_bf16 a[16:19], a[192:195], a[160:163], a[16:19]
s_add_u32 s37, s28, 17408
ds_read_b64_tr_b16 a[208:209], v15 offset:192
v_mfma_f32_16x16x32_bf16 a[16:19], a[196:199], a[164:167], a[16:19]
s_cmp_eq_u32 s37, 139264
ds_read_b64_tr_b16 a[210:211], v15 offset:448
v_mfma_f32_16x16x32_bf16 a[48:51], a[192:195], a[168:171], a[48:51]
s_cselect_b32 s36, 52224, s37
ds_read_b64_tr_b16 a[212:213], v15 offset:8896
v_mfma_f32_16x16x32_bf16 a[48:51], a[196:199], a[172:175], a[48:51]
s_add_u32 m0, s35, 4096
ds_read_b64_tr_b16 a[214:215], v15 offset:9152
v_mfma_f32_16x16x32_bf16 a[80:83], a[192:195], a[176:179], a[80:83]
buffer_load_dwordx4 v10, s[8:11], s31 offen  lds
s_add_u32 m0, s35, 5120
v_mfma_f32_16x16x32_bf16 a[80:83], a[196:199], a[180:183], a[80:83]
s_waitcnt lgkmcnt(4)
buffer_load_dwordx4 v11, s[8:11], s31 offen  lds
v_mfma_f32_16x16x32_bf16 a[20:23], a[200:203], a[160:163], a[20:23]
ds_read_b64_tr_b16 a[216:217], v15 offset:200
v_mfma_f32_16x16x32_bf16 a[20:23], a[204:207], a[164:167], a[20:23]
ds_read_b64_tr_b16 a[218:219], v15 offset:456
v_mfma_f32_16x16x32_bf16 a[52:55], a[200:203], a[168:171], a[52:55]
ds_read_b64_tr_b16 a[220:221], v15 offset:8904
v_mfma_f32_16x16x32_bf16 a[52:55], a[204:207], a[172:175], a[52:55]
ds_read_b64_tr_b16 a[222:223], v15 offset:9160
v_mfma_f32_16x16x32_bf16 a[84:87], a[200:203], a[176:179], a[84:87]
v_mfma_f32_16x16x32_bf16 a[84:87], a[204:207], a[180:183], a[84:87]
s_waitcnt vmcnt(29) lgkmcnt(0)
s_barrier
v_add_u32 v15, s36, v14
v_mfma_f32_16x16x32_bf16 a[24:27], a[208:211], a[160:163], a[24:27]
ds_read_b64_tr_b16 a[192:193], v15 offset:0
v_mfma_f32_16x16x32_bf16 a[24:27], a[212:215], a[164:167], a[24:27]
s_add_u32 s29, s28, s33
ds_read_b64_tr_b16 a[194:195], v15 offset:256
v_mfma_f32_16x16x32_bf16 a[56:59], a[208:211], a[168:171], a[56:59]
s_mov_b32 s28, s36
ds_read_b64_tr_b16 a[196:197], v15 offset:8704
v_mfma_f32_16x16x32_bf16 a[56:59], a[212:215], a[172:175], a[56:59]
ds_read_b64_tr_b16 a[198:199], v15 offset:8960
v_mfma_f32_16x16x32_bf16 a[88:91], a[208:211], a[176:179], a[88:91]
s_add_u32 s31, s31, 128
v_mfma_f32_16x16x32_bf16 a[88:91], a[212:215], a[180:183], a[88:91]
v_mfma_f32_16x16x32_bf16 a[28:31], a[216:219], a[160:163], a[28:31]
ds_read_b64_tr_b16 a[200:201], v15 offset:8
v_mfma_f32_16x16x32_bf16 a[28:31], a[220:223], a[164:167], a[28:31]
ds_read_b64_tr_b16 a[202:203], v15 offset:264
v_mfma_f32_16x16x32_bf16 a[60:63], a[216:219], a[168:171], a[60:63]
ds_read_b64_tr_b16 a[204:205], v15 offset:8712
buffer_load_dword v127, v123, s[8:11], s51 offen
v_mfma_f32_16x16x32_bf16 a[60:63], a[220:223], a[172:175], a[60:63]
ds_read_b64_tr_b16 a[206:207], v15 offset:8968
v_mfma_f32_16x16x32_bf16 a[92:95], a[216:219], a[176:179], a[92:95]
s_add_u32 s51, s51, 256
v_mfma_f32_16x16x32_bf16 a[92:95], a[220:223], a[180:183], a[92:95]
s_waitcnt lgkmcnt(4)
v_mfma_f32_16x16x32_bf16 v[128:131], a[192:195], a[128:131], v[128:131]
ds_read_b64_tr_b16 a[208:209], v15 offset:64
v_mfma_f32_16x16x32_bf16 v[128:131], a[196:199], a[132:135], v[128:131]
ds_read_b64_tr_b16 a[210:211], v15 offset:320
v_mfma_f32_16x16x32_bf16 v[160:163], a[192:195], a[136:139], v[160:163]
ds_read_b64_tr_b16 a[212:213], v15 offset:8768
v_mfma_f32_16x16x32_bf16 v[160:163], a[196:199], a[140:143], v[160:163]
s_add_u32 m0, s29, 0
ds_read_b64_tr_b16 a[214:215], v15 offset:9024
v_mfma_f32_16x16x32_bf16 v[192:195], a[192:195], a[144:147], v[192:195]
buffer_load_dwordx4 v2, s[12:15], s30 offen  lds
s_add_u32 m0, s29, 1088
v_mfma_f32_16x16x32_bf16 v[192:195], a[196:199], a[148:151], v[192:195]
s_waitcnt lgkmcnt(4)
buffer_load_dwordx4 v3, s[12:15], s30 offen  lds
v_mfma_f32_16x16x32_bf16 v[132:135], a[200:203], a[128:131], v[132:135]
ds_read_b64_tr_b16 a[216:217], v15 offset:72
v_mfma_f32_16x16x32_bf16 v[132:135], a[204:207], a[132:135], v[132:135]
ds_read_b64_tr_b16 a[218:219], v15 offset:328
v_mfma_f32_16x16x32_bf16 v[164:167], a[200:203], a[136:139], v[164:167]
ds_read_b64_tr_b16 a[220:221], v15 offset:8776
v_mfma_f32_16x16x32_bf16 v[164:167], a[204:207], a[140:143], v[164:167]
s_add_u32 m0, s29, 2176
ds_read_b64_tr_b16 a[222:223], v15 offset:9032
v_mfma_f32_16x16x32_bf16 v[196:199], a[200:203], a[144:147], v[196:199]
buffer_load_dwordx4 v4, s[12:15], s30 offen  lds
s_add_u32 m0, s29, 3264
v_mfma_f32_16x16x32_bf16 v[196:199], a[204:207], a[148:151], v[196:199]
s_waitcnt lgkmcnt(4)
buffer_load_dwordx4 v5, s[12:15], s30 offen  lds
v_mfma_f32_16x16x32_bf16 v[136:139], a[208:211], a[128:131], v[136:139]
ds_read_b64_tr_b16 a[192:193], v15 offset:128
v_mfma_f32_16x16x32_bf16 v[136:139], a[212:215], a[132:135], v[136:139]
s_add_u32 s30, s30, 0x80000
ds_read_b64_tr_b16 a[194:195], v15 offset:384
v_mfma_f32_16x16x32_bf16 v[168:171], a[208:211], a[136:139], v[168:171]
ds_read_b64_tr_b16 a[196:197], v15 offset:8832
v_mfma_f32_16x16x32_bf16 v[168:171], a[212:215], a[140:143], v[168:171]
ds_read_b64_tr_b16 a[198:199], v15 offset:9088
v_mfma_f32_16x16x32_bf16 v[200:203], a[208:211], a[144:147], v[200:203]
v_mfma_f32_16x16x32_bf16 v[200:203], a[212:215], a[148:151], v[200:203]
s_waitcnt lgkmcnt(4)
v_mfma_f32_16x16x32_bf16 v[140:143], a[216:219], a[128:131], v[140:143]
ds_read_b64_tr_b16 a[200:201], v15 offset:136
v_mfma_f32_16x16x32_bf16 v[140:143], a[220:223], a[132:135], v[140:143]
ds_read_b64_tr_b16 a[202:203], v15 offset:392
v_mfma_f32_16x16x32_bf16 v[172:175], a[216:219], a[136:139], v[172:175]
ds_read_b64_tr_b16 a[204:205], v15 offset:8840
v_mfma_f32_16x16x32_bf16 v[172:175], a[220:223], a[140:143], v[172:175]
ds_read_b64_tr_b16 a[206:207], v15 offset:9096
v_mfma_f32_16x16x32_bf16 v[204:207], a[216:219], a[144:147], v[204:207]
v_mfma_f32_16x16x32_bf16 v[204:207], a[220:223], a[148:151], v[204:207]
s_waitcnt lgkmcnt(4)
v_mfma_f32_16x16x32_bf16 v[144:147], a[192:195], a[128:131], v[144:147]
s_add_u32 s37, s28, 17408
ds_read_b64_tr_b16 a[208:209], v15 offset:192
v_mfma_f32_16x16x32_bf16 v[144:147], a[196:199], a[132:135], v[144:147]
s_cmp_eq_u32 s37, 139264
ds_read_b64_tr_b16 a[210:211], v15 offset:448
v_mfma_f32_16x16x32_bf16 v[176:179], a[192:195], a[136:139], v[176:179]
s_cselect_b32 s36, 52224, s37
ds_read_b64_tr_b16 a[212:213], v15 offset:8896
v_mfma_f32_16x16x32_bf16 v[176:179], a[196:199], a[140:143], v[176:179]
ds_read_b64_tr_b16 a[214:215], v15 offset:9152
v_mfma_f32_16x16x32_bf16 v[208:211], a[192:195], a[144:147], v[208:211]
v_mfma_f32_16x16x32_bf16 v[208:211], a[196:199], a[148:151], v[208:211]
s_waitcnt lgkmcnt(4)
v_mfma_f32_16x16x32_bf16 v[148:151], a[200:203], a[128:131], v[148:151]
ds_read_b64_tr_b16 a[216:217], v15 offset:200
v_mfma_f32_16x16x32_bf16 v[148:151], a[204:207], a[132:135], v[148:151]
ds_read_b64_tr_b16 a[218:219], v15 offset:456
v_mfma_f32_16x16x32_bf16 v[180:183], a[200:203], a[136:139], v[180:183]
ds_read_b64_tr_b16 a[220:221], v15 offset:8904
v_mfma_f32_16x16x32_bf16 v[180:183], a[204:207], a[140:143], v[180:183]
ds_read_b64_tr_b16 a[222:223], v15 offset:9160
v_mfma_f32_16x16x32_bf16 v[212:215], a[200:203], a[144:147], v[212:215]
v_mfma_f32_16x16x32_bf16 v[212:215], a[204:207], a[148:151], v[212:215]
s_waitcnt vmcnt(29) lgkmcnt(0)
s_barrier
v_add_u32 v15, s36, v14
v_mfma_f32_16x16x32_bf16 v[152:155], a[208:211], a[128:131], v[152:155]
ds_read_b64_tr_b16 a[192:193], v15 offset:0
v_mfma_f32_16x16x32_bf16 v[152:155], a[212:215], a[132:135], v[152:155]
s_add_u32 s29, s28, s33
ds_read_b64_tr_b16 a[194:195], v15 offset:256
v_mfma_f32_16x16x32_bf16 v[184:187], a[208:211], a[136:139], v[184:187]
s_mov_b32 s28, s36
ds_read_b64_tr_b16 a[196:197], v15 offset:8704
buffer_load_dword v127, v126, s[52:55], s69 offen
v_mfma_f32_16x16x32_bf16 v[184:187], a[212:215], a[140:143], v[184:187]
ds_read_b64_tr_b16 a[198:199], v15 offset:8960
v_mfma_f32_16x16x32_bf16 v[216:219], a[208:211], a[144:147], v[216:219]
v_mfma_f32_16x16x32_bf16 v[216:219], a[212:215], a[148:151], v[216:219]
v_mfma_f32_16x16x32_bf16 v[156:159], a[216:219], a[128:131], v[156:159]
ds_read_b64_tr_b16 a[200:201], v15 offset:8
v_mfma_f32_16x16x32_bf16 v[156:159], a[220:223], a[132:135], v[156:159]
s_add_u32 s69, s69, 4096
ds_read_b64_tr_b16 a[202:203], v15 offset:264
v_mfma_f32_16x16x32_bf16 v[188:191], a[216:219], a[136:139], v[188:191]
ds_read_b64_tr_b16 a[204:205], v15 offset:8712
v_mfma_f32_16x16x32_bf16 v[188:191], a[220:223], a[140:143], v[188:191]
ds_read_b64_tr_b16 a[206:207], v15 offset:8968
v_mfma_f32_16x16x32_bf16 v[220:223], a[216:219], a[144:147], v[220:223]
v_mfma_f32_16x16x32_bf16 v[220:223], a[220:223], a[148:151], v[220:223]
s_waitcnt lgkmcnt(4)
v_mfma_f32_16x16x32_bf16 v[128:131], a[192:195], a[160:163], v[128:131]
ds_read_b64_tr_b16 a[208:209], v15 offset:64
v_mfma_f32_16x16x32_bf16 v[128:131], a[196:199], a[164:167], v[128:131]
ds_read_b64_tr_b16 a[210:211], v15 offset:320
v_mfma_f32_16x16x32_bf16 v[160:163], a[192:195], a[168:171], v[160:163]
ds_read_b64_tr_b16 a[212:213], v15 offset:8768
v_mfma_f32_16x16x32_bf16 v[160:163], a[196:199], a[172:175], v[160:163]
s_add_u32 m0, s29, 0
ds_read_b64_tr_b16 a[214:215], v15 offset:9024
v_mfma_f32_16x16x32_bf16 v[192:195], a[192:195], a[176:179], v[192:195]
buffer_load_dwordx4 v2, s[12:15], s30 offen  lds
s_add_u32 m0, s29, 1088
v_mfma_f32_16x16x32_bf16 v[192:195], a[196:199], a[180:183], v[192:195]
s_waitcnt lgkmcnt(4)
buffer_load_dwordx4 v3, s[12:15], s30 offen  lds
v_mfma_f32_16x16x32_bf16 v[132:135], a[200:203], a[160:163], v[132:135]
ds_read_b64_tr_b16 a[216:217], v15 offset:72
v_mfma_f32_16x16x32_bf16 v[132:135], a[204:207], a[164:167], v[132:135]
ds_read_b64_tr_b16 a[218:219], v15 offset:328
v_mfma_f32_16x16x32_bf16 v[164:167], a[200:203], a[168:171], v[164:167]
ds_read_b64_tr_b16 a[220:221], v15 offset:8776
v_mfma_f32_16x16x32_bf16 v[164:167], a[204:207], a[172:175], v[164:167]
s_add_u32 m0, s29, 2176
ds_read_b64_tr_b16 a[222:223], v15 offset:9032
v_mfma_f32_16x16x32_bf16 v[196:199], a[200:203], a[176:179], v[196:199]
buffer_load_dwordx4 v4, s[12:15], s30 offen  lds
s_add_u32 m0, s29, 3264
v_mfma_f32_16x16x32_bf16 v[196:199], a[204:207], a[180:183], v[196:199]
s_waitcnt lgkmcnt(4)
buffer_load_dwordx4 v5, s[12:15], s30 offen  lds
v_mfma_f32_16x16x32_bf16 v[136:139], a[208:211], a[160:163], v[136:139]
ds_read_b64_tr_b16 a[192:193], v15 offset:128
v_mfma_f32_16x16x32_bf16 v[136:139], a[212:215], a[164:167], v[136:139]
s_add_u32 s30, s30, 0x80100
ds_read_b64_tr_b16 a[194:195], v15 offset:384
v_mfma_f32_16x16x32_bf16 v[168:171], a[208:211], a[168:171], v[168:171]
ds_read_b64_tr_b16 a[196:197], v15 offset:8832
buffer_load_dword v127, v125, s[16:19], s49 offen
v_mfma_f32_16x16x32_bf16 v[168:171], a[212:215], a[172:175], v[168:171]
s_waitcnt vmcnt(22)
ds_read_b64_tr_b16 a[198:199], v15 offset:9088
v_mfma_f32_16x16x32_bf16 v[200:203], a[208:211], a[176:179], v[200:203]
ds_read_b128 a[128:131], v16 offset:0
v_mfma_f32_16x16x32_bf16 v[200:203], a[212:215], a[180:183], v[200:203]
s_waitcnt lgkmcnt(5)
ds_read_b128 a[132:135], v17 offset:0
v_mfma_f32_16x16x32_bf16 v[140:143], a[216:219], a[160:163], v[140:143]
ds_read_b64_tr_b16 a[200:201], v15 offset:136
v_mfma_f32_16x16x32_bf16 v[140:143], a[220:223], a[164:167], v[140:143]
ds_read_b64_tr_b16 a[202:203], v15 offset:392
v_mfma_f32_16x16x32_bf16 v[172:175], a[216:219], a[168:171], v[172:175]
ds_read_b64_tr_b16 a[204:205], v15 offset:8840
v_mfma_f32_16x16x32_bf16 v[172:175], a[220:223], a[172:175], v[172:175]
ds_read_b64_tr_b16 a[206:207], v15 offset:9096
v_mfma_f32_16x16x32_bf16 v[204:207], a[216:219], a[176:179], v[204:207]
buffer_load_dword v127, v125, s[20:23], s49 offen
s_add_u32 s49, s49, s92
s_and_b32 s49, s49, 0xf800
ds_read_b128 a[136:139], v16 offset:2048
v_mfma_f32_16x16x32_bf16 v[204:207], a[220:223], a[180:183], v[204:207]
s_waitcnt lgkmcnt(7)
ds_read_b128 a[140:143], v17 offset:2048
v_mfma_f32_16x16x32_bf16 v[144:147], a[192:195], a[160:163], v[144:147]
s_add_u32 s37, s28, 17408
ds_read_b64_tr_b16 a[208:209], v15 offset:192
v_mfma_f32_16x16x32_bf16 v[144:147], a[196:199], a[164:167], v[144:147]
s_cmp_eq_u32 s37, 139264
ds_read_b64_tr_b16 a[210:211], v15 offset:448
v_mfma_f32_16x16x32_bf16 v[176:179], a[192:195], a[168:171], v[176:179]
s_cselect_b32 s36, 52224, s37
ds_read_b64_tr_b16 a[212:213], v15 offset:8896
v_mfma_f32_16x16x32_bf16 v[176:179], a[196:199], a[172:175], v[176:179]
ds_read_b64_tr_b16 a[214:215], v15 offset:9152
v_mfma_f32_16x16x32_bf16 v[208:211], a[192:195], a[176:179], v[208:211]
ds_read_b128 a[144:147], v16 offset:4096
v_mfma_f32_16x16x32_bf16 v[208:211], a[196:199], a[180:183], v[208:211]
s_waitcnt lgkmcnt(7)
ds_read_b128 a[148:151], v17 offset:4096
v_mfma_f32_16x16x32_bf16 v[148:151], a[200:203], a[160:163], v[148:151]
ds_read_b64_tr_b16 a[216:217], v15 offset:200
v_mfma_f32_16x16x32_bf16 v[148:151], a[204:207], a[164:167], v[148:151]
ds_read_b64_tr_b16 a[218:219], v15 offset:456
v_mfma_f32_16x16x32_bf16 v[180:183], a[200:203], a[168:171], v[180:183]
ds_read_b64_tr_b16 a[220:221], v15 offset:8904
v_mfma_f32_16x16x32_bf16 v[180:183], a[204:207], a[172:175], v[180:183]
ds_read_b64_tr_b16 a[222:223], v15 offset:9160
v_mfma_f32_16x16x32_bf16 v[212:215], a[200:203], a[176:179], v[212:215]
v_mfma_f32_16x16x32_bf16 v[212:215], a[204:207], a[180:183], v[212:215]
s_waitcnt lgkmcnt(0)
s_barrier
v_add_u32 v15, s36, v14
v_mfma_f32_16x16x32_bf16 v[152:155], a[208:211], a[160:163], v[152:155]
ds_read_b64_tr_b16 a[192:193], v15 offset:0
v_mfma_f32_16x16x32_bf16 v[152:155], a[212:215], a[164:167], v[152:155]
s_add_u32 s29, s28, s33
ds_read_b64_tr_b16 a[194:195], v15 offset:256
v_mfma_f32_16x16x32_bf16 v[184:187], a[208:211], a[168:171], v[184:187]
s_mov_b32 s28, s36
ds_read_b64_tr_b16 a[196:197], v15 offset:8704
buffer_load_dword v127, v126, s[52:55], s69 offen
v_mfma_f32_16x16x32_bf16 v[184:187], a[212:215], a[172:175], v[184:187]
ds_read_b64_tr_b16 a[198:199], v15 offset:8960
v_mfma_f32_16x16x32_bf16 v[216:219], a[208:211], a[176:179], v[216:219]
v_mfma_f32_16x16x32_bf16 v[216:219], a[212:215], a[180:183], v[216:219]
v_mfma_f32_16x16x32_bf16 v[156:159], a[216:219], a[160:163], v[156:159]
ds_read_b64_tr_b16 a[200:201], v15 offset:8
v_mfma_f32_16x16x32_bf16 v[156:159], a[220:223], a[164:167], v[156:159]
s_add_u32 s69, s69, 4096
ds_read_b64_tr_b16 a[202:203], v15 offset:264
v_mfma_f32_16x16x32_bf16 v[188:191], a[216:219], a[168:171], v[188:191]
ds_read_b64_tr_b16 a[204:205], v15 offset:8712
v_mfma_f32_16x16x32_bf16 v[188:191], a[220:223], a[172:175], v[188:191]
s_sub_u32 s32, s32, 1
ds_read_b64_tr_b16 a[206:207], v15 offset:8968
v_mfma_f32_16x16x32_bf16 v[220:223], a[216:219], a[176:179], v[220:223]
s_cmp_lg_u32 s32, 0
v_mfma_f32_16x16x32_bf16 v[220:223], a[220:223], a[180:183], v[220:223]
s_waitcnt lgkmcnt(4)
s_cbranch_scc1 L_qp3
v_mfma_f32_16x16x32_bf16 a[0:3], a[192:195], a[128:131], a[0:3]
ds_read_b64_tr_b16 a[208:209], v15 offset:64
v_mfma_f32_16x16x32_bf16 a[0:3], a[196:199], a[132:135], a[0:3]
s_mov_b32 s48, 0x3e0293ee
s_mov_b32 s101, 0
s_mov_b32 s39, s100
s_add_u32 s38, s70, 104448
ds_read_b64_tr_b16 a[210:211], v15 offset:320
v_mfma_f32_16x16x32_bf16 a[32:35], a[192:195], a[136:139], a[32:35]
ds_read_b64_tr_b16 a[212:213], v15 offset:8768
v_mfma_f32_16x16x32_bf16 a[32:35], a[196:199], a[140:143], a[32:35]
ds_read_b64_tr_b16 a[214:215], v15 offset:9024
v_mfma_f32_16x16x32_bf16 a[64:67], a[192:195], a[144:147], a[64:67]
v_mfma_f32_16x16x32_bf16 a[64:67], a[196:199], a[148:151], a[64:67]
s_waitcnt lgkmcnt(4)
v_mfma_f32_16x16x32_bf16 a[4:7], a[200:203], a[128:131], a[4:7]
ds_read_b64_tr_b16 a[216:217], v15 offset:72
v_mfma_f32_16x16x32_bf16 a[4:7], a[204:207], a[132:135], a[4:7]
ds_read_b64_tr_b16 a[218:219], v15 offset:328
v_mfma_f32_16x16x32_bf16 a[36:39], a[200:203], a[136:139], a[36:39]
ds_read_b64_tr_b16 a[220:221], v15 offset:8776
v_mfma_f32_16x16x32_bf16 a[36:39], a[204:207], a[140:143], a[36:39]
ds_read_b64_tr_b16 a[222:223], v15 offset:9032
v_mfma_f32_16x16x32_bf16 a[68:71], a[200:203], a[144:147], a[68:71]
v_mfma_f32_16x16x32_bf16 a[68:71], a[204:207], a[148:151], a[68:71]
s_waitcnt lgkmcnt(4)
v_mfma_f32_16x16x32_bf16 a[8:11], a[208:211], a[128:131], a[8:11]
ds_read_b64_tr_b16 a[192:193], v15 offset:128
v_mfma_f32_16x16x32_bf16 a[8:11], a[212:215], a[132:135], a[8:11]
ds_read_b64_tr_b16 a[194:195], v15 offset:384
v_mfma_f32_16x16x32_bf16 a[40:43], a[208:211], a[136:139], a[40:43]
ds_read_b64_tr_b16 a[196:197], v15 offset:8832
v_mfma_f32_16x16x32_bf16 a[40:43], a[212:215], a[140:143], a[40:43]
s_waitcnt vmcnt(13)
ds_read_b64_tr_b16 a[198:199], v15 offset:9088
v_mfma_f32_16x16x32_bf16 a[72:75], a[208:211], a[144:147], a[72:75]
ds_read_b128 a[160:163], v16 offset:6144
v_mfma_f32_16x16x32_bf16 a[72:75], a[212:215], a[148:151], a[72:75]
s_waitcnt lgkmcnt(5)
ds_read_b128 a[164:167], v17 offset:6144
v_mfma_f32_16x16x32_bf16 a[12:15], a[216:219], a[128:131], a[12:15]
ds_read_b64_tr_b16 a[200:201], v15 offset:136
v_mfma_f32_16x16x32_bf16 a[12:15], a[220:223], a[132:135], a[12:15]
ds_read_b64_tr_b16 a[202:203], v15 offset:392
v_mfma_f32_16x16x32_bf16 a[44:47], a[216:219], a[136:139], a[44:47]
ds_read_b64_tr_b16 a[204:205], v15 offset:8840
v_mfma_f32_16x16x32_bf16 a[44:47], a[220:223], a[140:143], a[44:47]
ds_read_b64_tr_b16 a[206:207], v15 offset:9096
v_mfma_f32_16x16x32_bf16 a[76:79], a[216:219], a[144:147], a[76:79]
ds_read_b128 a[168:171], v16 offset:8192
v_mfma_f32_16x16x32_bf16 a[76:79], a[220:223], a[148:151], a[76:79]
s_waitcnt lgkmcnt(7)
ds_read_b128 a[172:175], v17 offset:8192
v_mfma_f32_16x16x32_bf16 a[16:19], a[192:195], a[128:131], a[16:19]
s_add_u32 s37, s28, 17408
ds_read_b64_tr_b16 a[208:209], v15 offset:192
v_mfma_f32_16x16x32_bf16 a[16:19], a[196:199], a[132:135], a[16:19]
s_cmp_eq_u32 s37, 139264
ds_read_b64_tr_b16 a[210:211], v15 offset:448
v_mfma_f32_16x16x32_bf16 a[48:51], a[192:195], a[136:139], a[48:51]
s_cselect_b32 s36, 52224, s37
ds_read_b64_tr_b16 a[212:213], v15 offset:8896
v_mfma_f32_16x16x32_bf16 a[48:51], a[196:199], a[140:143], a[48:51]
ds_read_b64_tr_b16 a[214:215], v15 offset:9152
v_mfma_f32_16x16x32_bf16 a[80:83], a[192:195], a[144:147], a[80:83]
ds_read_b128 a[176:179], v16 offset:10240
v_mfma_f32_16x16x32_bf16 a[80:83], a[196:199], a[148:151], a[80:83]
s_waitcnt lgkmcnt(7)
ds_read_b128 a[180:183], v17 offset:10240
v_mfma_f32_16x16x32_bf16 a[20:23], a[200:203], a[128:131], a[20:23]
ds_read_b64_tr_b16 a[216:217], v15 offset:200
v_mfma_f32_16x16x32_bf16 a[20:23], a[204:207], a[132:135], a[20:23]
ds_read_b64_tr_b16 a[218:219], v15 offset:456
v_mfma_f32_16x16x32_bf16 a[52:55], a[200:203], a[136:139], a[52:55]
ds_read_b64_tr_b16 a[220:221], v15 offset:8904
v_mfma_f32_16x16x32_bf16 a[52:55], a[204:207], a[140:143], a[52:55]
ds_read_b64_tr_b16 a[222:223], v15 offset:9160
v_mfma_f32_16x16x32_bf16 a[84:87], a[200:203], a[144:147], a[84:87]
v_mfma_f32_16x16x32_bf16 a[84:87], a[204:207], a[148:151], a[84:87]
s_waitcnt lgkmcnt(0)
s_barrier
v_add_u32 v15, s36, v14
v_mfma_f32_16x16x32_bf16 a[24:27], a[208:211], a[128:131], a[24:27]
ds_read_b64_tr_b16 a[192:193], v15 offset:0
v_mfma_f32_16x16x32_bf16 a[24:27], a[212:215], a[132:135], a[24:27]
s_add_u32 s29, s28, s33
ds_read_b64_tr_b16 a[194:195], v15 offset:256
v_mfma_f32_16x16x32_bf16 a[56:59], a[208:211], a[136:139], a[56:59]
s_mov_b32 s28, s36
ds_read_b64_tr_b16 a[196:197], v15 offset:8704
v_mfma_f32_16x16x32_bf16 a[56:59], a[212:215], a[140:143], a[56:59]
ds_read_b64_tr_b16 a[198:199], v15 offset:8960
v_mfma_f32_16x16x32_bf16 a[88:91], a[208:211], a[144:147], a[88:91]
v_mfma_f32_16x16x32_bf16 a[88:91], a[212:215], a[148:151], a[88:91]
v_mfma_f32_16x16x32_bf16 a[28:31], a[216:219], a[128:131], a[28:31]
ds_read_b64_tr_b16 a[200:201], v15 offset:8
v_mfma_f32_16x16x32_bf16 a[28:31], a[220:223], a[132:135], a[28:31]
ds_read_b64_tr_b16 a[202:203], v15 offset:264
v_mfma_f32_16x16x32_bf16 a[60:63], a[216:219], a[136:139], a[60:63]
ds_read_b64_tr_b16 a[204:205], v15 offset:8712
v_mfma_f32_16x16x32_bf16 a[60:63], a[220:223], a[140:143], a[60:63]
ds_read_b64_tr_b16 a[206:207], v15 offset:8968
v_mfma_f32_16x16x32_bf16 a[92:95], a[216:219], a[144:147], a[92:95]
v_mfma_f32_16x16x32_bf16 a[92:95], a[220:223], a[148:151], a[92:95]
s_waitcnt lgkmcnt(4)
v_mfma_f32_16x16x32_bf16 a[0:3], a[192:195], a[160:163], a[0:3]
ds_read_b64_tr_b16 a[208:209], v15 offset:64
v_mfma_f32_16x16x32_bf16 a[0:3], a[196:199], a[164:167], a[0:3]
ds_read_b64_tr_b16 a[210:211], v15 offset:320
v_mfma_f32_16x16x32_bf16 a[32:35], a[192:195], a[168:171], a[32:35]
ds_read_b64_tr_b16 a[212:213], v15 offset:8768
v_mfma_f32_16x16x32_bf16 a[32:35], a[196:199], a[172:175], a[32:35]
ds_read_b64_tr_b16 a[214:215], v15 offset:9024
v_mfma_f32_16x16x32_bf16 a[64:67], a[192:195], a[176:179], a[64:67]
v_mfma_f32_16x16x32_bf16 a[64:67], a[196:199], a[180:183], a[64:67]
s_waitcnt lgkmcnt(4)
v_mfma_f32_16x16x32_bf16 a[4:7], a[200:203], a[160:163], a[4:7]
ds_read_b64_tr_b16 a[216:217], v15 offset:72
v_mfma_f32_16x16x32_bf16 a[4:7], a[204:207], a[164:167], a[4:7]
ds_read_b64_tr_b16 a[218:219], v15 offset:328
v_mfma_f32_16x16x32_bf16 a[36:39], a[200:203], a[168:171], a[36:39]
ds_read_b64_tr_b16 a[220:221], v15 offset:8776
v_mfma_f32_16x16x32_bf16 a[36:39], a[204:207], a[172:175], a[36:39]
ds_read_b64_tr_b16 a[222:223], v15 offset:9032
v_mfma_f32_16x16x32_bf16 a[68:71], a[200:203], a[176:179], a[68:71]
v_mfma_f32_16x16x32_bf16 a[68:71], a[204:207], a[180:183], a[68:71]
s_waitcnt lgkmcnt(4)
v_mfma_f32_16x16x32_bf16 a[8:11], a[208:211], a[160:163], a[8:11]
ds_read_b64_tr_b16 a[192:193], v15 offset:128
v_mfma_f32_16x16x32_bf16 a[8:11], a[212:215], a[164:167], a[8:11]
ds_read_b64_tr_b16 a[194:195], v15 offset:384
v_mfma_f32_16x16x32_bf16 a[40:43], a[208:211], a[168:171], a[40:43]
ds_read_b64_tr_b16 a[196:197], v15 offset:8832
v_mfma_f32_16x16x32_bf16 a[40:43], a[212:215], a[172:175], a[40:43]
ds_read_b64_tr_b16 a[198:199], v15 offset:9088
v_mfma_f32_16x16x32_bf16 a[72:75], a[208:211], a[176:179], a[72:75]
v_mfma_f32_16x16x32_bf16 a[72:75], a[212:215], a[180:183], a[72:75]
s_waitcnt lgkmcnt(4)
v_mfma_f32_16x16x32_bf16 a[12:15], a[216:219], a[160:163], a[12:15]
ds_read_b64_tr_b16 a[200:201], v15 offset:136
v_mfma_f32_16x16x32_bf16 a[12:15], a[220:223], a[164:167], a[12:15]
ds_read_b64_tr_b16 a[202:203], v15 offset:392
v_mfma_f32_16x16x32_bf16 a[44:47], a[216:219], a[168:171], a[44:47]
ds_read_b64_tr_b16 a[204:205], v15 offset:8840
v_mfma_f32_16x16x32_bf16 a[44:47], a[220:223], a[172:175], a[44:47]
ds_read_b64_tr_b16 a[206:207], v15 offset:9096
v_mfma_f32_16x16x32_bf16 a[76:79], a[216:219], a[176:179], a[76:79]
v_mfma_f32_16x16x32_bf16 a[76:79], a[220:223], a[180:183], a[76:79]
s_waitcnt lgkmcnt(4)
v_mfma_f32_16x16x32_bf16 a[16:19], a[192:195], a[160:163], a[16:19]
s_add_u32 s37, s28, 17408
ds_read_b64_tr_b16 a[208:209], v15 offset:192
v_mfma_f32_16x16x32_bf16 a[16:19], a[196:199], a[164:167], a[16:19]
s_cmp_eq_u32 s37, 139264
ds_read_b64_tr_b16 a[210:211], v15 offset:448
v_mfma_f32_16x16x32_bf16 a[48:51], a[192:195], a[168:171], a[48:51]
s_cselect_b32 s36, 52224, s37
ds_read_b64_tr_b16 a[212:213], v15 offset:8896
v_mfma_f32_16x16x32_bf16 a[48:51], a[196:199], a[172:175], a[48:51]
ds_read_b64_tr_b16 a[214:215], v15 offset:9152
v_mfma_f32_16x16x32_bf16 a[80:83], a[192:195], a[176:179], a[80:83]
v_mfma_f32_16x16x32_bf16 a[80:83], a[196:199], a[180:183], a[80:83]
s_waitcnt lgkmcnt(4)
v_mfma_f32_16x16x32_bf16 a[20:23], a[200:203], a[160:163], a[20:23]
ds_read_b64_tr_b16 a[216:217], v15 offset:200
v_mfma_f32_16x16x32_bf16 a[20:23], a[204:207], a[164:167], a[20:23]
ds_read_b64_tr_b16 a[218:219], v15 offset:456
v_mfma_f32_16x16x32_bf16 a[52:55], a[200:203], a[168:171], a[52:55]
ds_read_b64_tr_b16 a[220:221], v15 offset:8904
v_mfma_f32_16x16x32_bf16 a[52:55], a[204:207], a[172:175], a[52:55]
ds_read_b64_tr_b16 a[222:223], v15 offset:9160
v_mfma_f32_16x16x32_bf16 a[84:87], a[200:203], a[176:179], a[84:87]
v_mfma_f32_16x16x32_bf16 a[84:87], a[204:207], a[180:183], a[84:87]
s_waitcnt vmcnt(8) lgkmcnt(0)
s_barrier
v_add_u32 v15, s36, v14
v_mfma_f32_16x16x32_bf16 a[24:27], a[208:211], a[160:163], a[24:27]
ds_read_b64_tr_b16 a[192:193], v15 offset:0
v_mfma_f32_16x16x32_bf16 a[24:27], a[212:215], a[164:167], a[24:27]
s_add_u32 s29, s28, s33
ds_read_b64_tr_b16 a[194:195], v15 offset:256
v_mfma_f32_16x16x32_bf16 a[56:59], a[208:211], a[168:171], a[56:59]
s_mov_b32 s28, s36
ds_read_b64_tr_b16 a[196:197], v15 offset:8704
v_mfma_f32_16x16x32_bf16 a[56:59], a[212:215], a[172:175], a[56:59]
ds_read_b64_tr_b16 a[198:199], v15 offset:8960
v_mfma_f32_16x16x32_bf16 a[88:91], a[208:211], a[176:179], a[88:91]
v_mfma_f32_16x16x32_bf16 a[88:91], a[212:215], a[180:183], a[88:91]
v_mfma_f32_16x16x32_bf16 a[28:31], a[216:219], a[160:163], a[28:31]
ds_read_b64_tr_b16 a[200:201], v15 offset:8
v_mfma_f32_16x16x32_bf16 a[28:31], a[220:223], a[164:167], a[28:31]
ds_read_b64_tr_b16 a[202:203], v15 offset:264
v_mfma_f32_16x16x32_bf16 a[60:63], a[216:219], a[168:171], a[60:63]
ds_read_b64_tr_b16 a[204:205], v15 offset:8712
v_mfma_f32_16x16x32_bf16 a[60:63], a[220:223], a[172:175], a[60:63]
ds_read_b64_tr_b16 a[206:207], v15 offset:8968
v_mfma_f32_16x16x32_bf16 a[92:95], a[216:219], a[176:179], a[92:95]
v_mfma_f32_16x16x32_bf16 a[92:95], a[220:223], a[180:183], a[92:95]
s_waitcnt lgkmcnt(4)
v_mfma_f32_16x16x32_bf16 v[128:131], a[192:195], a[128:131], v[128:131]
ds_read_b64_tr_b16 a[208:209], v15 offset:64
s_add_u32 m0, s38, 0
v_mfma_f32_16x16x32_bf16 v[128:131], a[196:199], a[132:135], v[128:131]
buffer_load_dwordx4 v24, s[16:19], s39 offen offset:0 nt lds
ds_read_b64_tr_b16 a[210:211], v15 offset:320
v_accvgpr_read_b32 v72, a88
v_accvgpr_read_b32 v73, a89
v_accvgpr_read_b32 v74, a90
v_accvgpr_read_b32 v75, a91
v_mfma_f32_16x16x32_bf16 v[160:163], a[192:195], a[136:139], v[160:163]
ds_read_b64_tr_b16 a[212:213], v15 offset:8768
v_accvgpr_read_b32 v76, a92
v_accvgpr_read_b32 v77, a93
v_accvgpr_read_b32 v78, a94
v_accvgpr_read_b32 v79, a95
v_mul_f32 v72, s48, v72
v_mfma_f32_16x16x32_bf16 v[160:163], a[196:199], a[140:143], v[160:163]
ds_read_b64_tr_b16 a[214:215], v15 offset:9024
s_add_u32 m0, s38, 8704
v_mul_f32 v73, s48, v73
v_mul_f32 v74, s48, v74
v_mul_f32 v75, s48, v75
v_mul_f32 v76, s48, v76
v_mul_f32 v77, s48, v77
v_mfma_f32_16x16x32_bf16 v[192:195], a[192:195], a[144:147], v[192:195]
buffer_load_dwordx4 v25, s[20:23], s39 offen offset:0 nt lds
v_mul_f32 v78, s48, v78
v_mul_f32 v79, s48, v79
v_cvt_pk_bf16_f32 v72, v72, v73
v_cvt_pk_bf16_f32 v73, v74, v75
v_cvt_pk_bf16_f32 v74, v76, v77
v_mfma_f32_16x16x32_bf16 v[192:195], a[196:199], a[148:151], v[192:195]
s_waitcnt lgkmcnt(4)
v_cvt_pk_bf16_f32 v75, v78, v79
v_accvgpr_write_b32 a108, v72
v_accvgpr_write_b32 a109, v73
v_accvgpr_write_b32 a110, v74
v_accvgpr_write_b32 a111, v75
v_mfma_f32_16x16x32_bf16 v[132:135], a[200:203], a[128:131], v[132:135]
ds_read_b64_tr_b16 a[216:217], v15 offset:72
s_add_u32 m0, s38, 64
v_accvgpr_read_b32 v64, a80
v_accvgpr_read_b32 v65, a81
v_accvgpr_read_b32 v66, a82
v_accvgpr_read_b32 v67, a83
v_accvgpr_read_b32 v68, a84
v_mfma_f32_16x16x32_bf16 v[132:135], a[204:207], a[132:135], v[132:135]
buffer_load_dwordx4 v24, s[16:19], s39 offen offset:1024 nt lds
ds_read_b64_tr_b16 a[218:219], v15 offset:328
v_accvgpr_read_b32 v69, a85
v_accvgpr_read_b32 v70, a86
v_accvgpr_read_b32 v71, a87
v_mul_f32 v64, s48, v64
v_mul_f32 v65, s48, v65
v_mfma_f32_16x16x32_bf16 v[164:167], a[200:203], a[136:139], v[164:167]
ds_read_b64_tr_b16 a[220:221], v15 offset:8776
v_mul_f32 v66, s48, v66
v_mul_f32 v67, s48, v67
v_mul_f32 v68, s48, v68
v_mul_f32 v69, s48, v69
v_mfma_f32_16x16x32_bf16 v[164:167], a[204:207], a[140:143], v[164:167]
ds_read_b64_tr_b16 a[222:223], v15 offset:9032
s_add_u32 m0, s38, 9536
v_mul_f32 v70, s48, v70
v_mul_f32 v71, s48, v71
v_cvt_pk_bf16_f32 v64, v64, v65
v_cvt_pk_bf16_f32 v65, v66, v67
v_cvt_pk_bf16_f32 v66, v68, v69
v_mfma_f32_16x16x32_bf16 v[196:199], a[200:203], a[144:147], v[196:199]
buffer_load_dwordx4 v25, s[20:23], s39 offen offset:256 nt lds
v_cvt_pk_bf16_f32 v67, v70, v71
v_accvgpr_write_b32 a104, v64
v_accvgpr_write_b32 a105, v65
v_accvgpr_write_b32 a106, v66
v_accvgpr_write_b32 a107, v67
v_mfma_f32_16x16x32_bf16 v[196:199], a[204:207], a[148:151], v[196:199]
s_waitcnt lgkmcnt(4)
s_add_u32 s101, s101, 8192
s_add_u32 s100, s100, s92
s_and_b32 s39, s100, 0xf800
s_and_b32 s93, s101, 0x40000
s_or_b32 s39, s39, s93
s_add_u32 s38, s38, 17408
s_cmp_eq_u32 s38, s71
s_cselect_b32 s38, s70, s38
v_accvgpr_read_b32 v72, a72
v_accvgpr_read_b32 v73, a73
v_accvgpr_read_b32 v74, a74
v_accvgpr_read_b32 v75, a75
v_accvgpr_read_b32 v76, a76
v_mfma_f32_16x16x32_bf16 v[136:139], a[208:211], a[128:131], v[136:139]
ds_read_b64_tr_b16 a[192:193], v15 offset:128
v_accvgpr_read_b32 v77, a77
v_accvgpr_read_b32 v78, a78
v_accvgpr_read_b32 v79, a79
v_mul_f32 v72, s48, v72
v_mul_f32 v73, s48, v73
v_mfma_f32_16x16x32_bf16 v[136:139], a[212:215], a[132:135], v[136:139]
ds_read_b64_tr_b16 a[194:195], v15 offset:384
v_mul_f32 v74, s48, v74
v_mul_f32 v75, s48, v75
v_mul_f32 v76, s48, v76
v_mul_f32 v77, s48, v77
v_mul_f32 v78, s48, v78
v_mfma_f32_16x16x32_bf16 v[168:171], a[208:211], a[136:139], v[168:171]
ds_read_b64_tr_b16 a[196:197], v15 offset:8832
v_mul_f32 v79, s48, v79
v_cvt_pk_bf16_f32 v72, v72, v73
v_cvt_pk_bf16_f32 v73, v74, v75
v_cvt_pk_bf16_f32 v74, v76, v77
v_cvt_pk_bf16_f32 v75, v78, v79
v_mfma_f32_16x16x32_bf16 v[168:171], a[212:215], a[140:143], v[168:171]
ds_read_b64_tr_b16 a[198:199], v15 offset:9088
v_accvgpr_write_b32 a100, v72
v_accvgpr_write_b32 a101, v73
v_accvgpr_write_b32 a102, v74
v_accvgpr_write_b32 a103, v75
v_accvgpr_read_b32 v64, a64
v_mfma_f32_16x16x32_bf16 v[200:203], a[208:211], a[144:147], v[200:203]
v_accvgpr_read_b32 v65, a65
v_accvgpr_read_b32 v66, a66
v_accvgpr_read_b32 v67, a67
v_accvgpr_read_b32 v68, a68
v_mfma_f32_16x16x32_bf16 v[200:203], a[212:215], a[148:151], v[200:203]
s_waitcnt lgkmcnt(4)
v_accvgpr_read_b32 v69, a69
v_accvgpr_read_b32 v70, a70
v_accvgpr_read_b32 v71, a71
v_mul_f32 v64, s48, v64
v_mul_f32 v65, s48, v65
v_mfma_f32_16x16x32_bf16 v[140:143], a[216:219], a[128:131], v[140:143]
ds_read_b64_tr_b16 a[200:201], v15 offset:136
s_add_u32 m0, s38, 0
v_mul_f32 v66, s48, v66
v_mul_f32 v67, s48, v67
v_mul_f32 v68, s48, v68
v_mul_f32 v69, s48, v69
v_mul_f32 v70, s48, v70
v_mfma_f32_16x16x32_bf16 v[140:143], a[220:223], a[132:135], v[140:143]
buffer_load_dwordx4 v24, s[16:19], s39 offen offset:0 nt lds
ds_read_b64_tr_b16 a[202:203], v15 offset:392
v_mul_f32 v71, s48, v71
v_cvt_pk_bf16_f32 v64, v64, v65
v_cvt_pk_bf16_f32 v65, v66, v67
v_cvt_pk_bf16_f32 v66, v68, v69
v_cvt_pk_bf16_f32 v67, v70, v71
v_mfma_f32_16x16x32_bf16 v[172:175], a[216:219], a[136:139], v[172:175]
ds_read_b64_tr_b16 a[204:205], v15 offset:8840
v_accvgpr_write_b32 a96, v64
v_accvgpr_write_b32 a97, v65
v_accvgpr_write_b32 a98, v66
v_accvgpr_write_b32 a99, v67
v_accvgpr_read_b32 v72, a56
v_mfma_f32_16x16x32_bf16 v[172:175], a[220:223], a[140:143], v[172:175]
ds_read_b64_tr_b16 a[206:207], v15 offset:9096
s_add_u32 m0, s38, 8704
v_accvgpr_read_b32 v73, a57
v_accvgpr_read_b32 v74, a58
v_accvgpr_read_b32 v75, a59
v_accvgpr_read_b32 v76, a60
v_accvgpr_read_b32 v77, a61
v_mfma_f32_16x16x32_bf16 v[204:207], a[216:219], a[144:147], v[204:207]
buffer_load_dwordx4 v25, s[20:23], s39 offen offset:0 nt lds
v_accvgpr_read_b32 v78, a62
v_accvgpr_read_b32 v79, a63
v_mul_f32 v72, s48, v72
v_mul_f32 v73, s48, v73
v_mul_f32 v74, s48, v74
v_mfma_f32_16x16x32_bf16 v[204:207], a[220:223], a[148:151], v[204:207]
s_waitcnt lgkmcnt(4)
v_mul_f32 v75, s48, v75
v_mul_f32 v76, s48, v76
v_mul_f32 v77, s48, v77
v_mul_f32 v78, s48, v78
v_mul_f32 v79, s48, v79
v_mfma_f32_16x16x32_bf16 v[144:147], a[192:195], a[128:131], v[144:147]
s_add_u32 s37, s28, 17408
ds_read_b64_tr_b16 a[208:209], v15 offset:192
s_add_u32 m0, s38, 64
v_cvt_pk_bf16_f32 v72, v72, v73
v_cvt_pk_bf16_f32 v73, v74, v75
v_cvt_pk_bf16_f32 v74, v76, v77
v_cvt_pk_bf16_f32 v75, v78, v79
v_mfma_f32_16x16x32_bf16 v[144:147], a[196:199], a[132:135], v[144:147]
buffer_load_dwordx4 v24, s[16:19], s39 offen offset:1024 nt lds
s_cmp_eq_u32 s37, 139264
ds_read_b64_tr_b16 a[210:211], v15 offset:448
v_accvgpr_write_b32 a92, v72
v_accvgpr_write_b32 a93, v73
v_accvgpr_write_b32 a94, v74
v_accvgpr_write_b32 a95, v75
v_accvgpr_read_b32 v64, a48
v_mfma_f32_16x16x32_bf16 v[176:179], a[192:195], a[136:139], v[176:179]
s_cselect_b32 s36, 52224, s37
ds_read_b64_tr_b16 a[212:213], v15 offset:8896
v_accvgpr_read_b32 v65, a49
v_accvgpr_read_b32 v66, a50
v_accvgpr_read_b32 v67, a51
v_accvgpr_read_b32 v68, a52
v_accvgpr_read_b32 v69, a53
v_mfma_f32_16x16x32_bf16 v[176:179], a[196:199], a[140:143], v[176:179]
ds_read_b64_tr_b16 a[214:215], v15 offset:9152
s_add_u32 m0, s38, 9536
v_accvgpr_read_b32 v70, a54
v_accvgpr_read_b32 v71, a55
v_mul_f32 v64, s48, v64
v_mul_f32 v65, s48, v65
v_mul_f32 v66, s48, v66
v_mfma_f32_16x16x32_bf16 v[208:211], a[192:195], a[144:147], v[208:211]
buffer_load_dwordx4 v25, s[20:23], s39 offen offset:256 nt lds
v_mul_f32 v67, s48, v67
v_mul_f32 v68, s48, v68
v_mul_f32 v69, s48, v69
v_mul_f32 v70, s48, v70
v_mul_f32 v71, s48, v71
v_mfma_f32_16x16x32_bf16 v[208:211], a[196:199], a[148:151], v[208:211]
s_waitcnt lgkmcnt(4)
s_add_u32 s101, s101, 8192
s_add_u32 s100, s100, s92
s_and_b32 s39, s100, 0xf800
s_and_b32 s93, s101, 0x40000
s_or_b32 s39, s39, s93
s_add_u32 s38, s38, 17408
s_cmp_eq_u32 s38, s71
s_cselect_b32 s38, s70, s38
v_cvt_pk_bf16_f32 v64, v64, v65
v_cvt_pk_bf16_f32 v65, v66, v67
v_cvt_pk_bf16_f32 v66, v68, v69
v_cvt_pk_bf16_f32 v67, v70, v71
v_accvgpr_write_b32 a88, v64
v_mfma_f32_16x16x32_bf16 v[148:151], a[200:203], a[128:131], v[148:151]
ds_read_b64_tr_b16 a[216:217], v15 offset:200
v_accvgpr_write_b32 a89, v65
v_accvgpr_write_b32 a90, v66
v_accvgpr_write_b32 a91, v67
v_accvgpr_read_b32 v72, a40
v_accvgpr_read_b32 v73, a41
v_mfma_f32_16x16x32_bf16 v[148:151], a[204:207], a[132:135], v[148:151]
ds_read_b64_tr_b16 a[218:219], v15 offset:456
v_accvgpr_read_b32 v74, a42
v_accvgpr_read_b32 v75, a43
v_accvgpr_read_b32 v76, a44
v_accvgpr_read_b32 v77, a45
v_accvgpr_read_b32 v78, a46
v_mfma_f32_16x16x32_bf16 v[180:183], a[200:203], a[136:139], v[180:183]
ds_read_b64_tr_b16 a[220:221], v15 offset:8904
v_accvgpr_read_b32 v79, a47
v_mul_f32 v72, s48, v72
v_mul_f32 v73, s48, v73
v_mul_f32 v74, s48, v74
v_mfma_f32_16x16x32_bf16 v[180:183], a[204:207], a[140:143], v[180:183]
ds_read_b64_tr_b16 a[222:223], v15 offset:9160
v_mul_f32 v75, s48, v75
v_mul_f32 v76, s48, v76
v_mul_f32 v77, s48, v77
v_mul_f32 v78, s48, v78
v_mul_f32 v79, s48, v79
v_mfma_f32_16x16x32_bf16 v[212:215], a[200:203], a[144:147], v[212:215]
v_cvt_pk_bf16_f32 v72, v72, v73
v_cvt_pk_bf16_f32 v73, v74, v75
v_cvt_pk_bf16_f32 v74, v76, v77
v_cvt_pk_bf16_f32 v75, v78, v79
v_accvgpr_write_b32 a84, v72
v_mfma_f32_16x16x32_bf16 v[212:215], a[204:207], a[148:151], v[212:215]
s_waitcnt vmcnt(11) lgkmcnt(0)
s_barrier
v_add_u32 v15, s36, v14
v_accvgpr_write_b32 a85, v73
v_accvgpr_write_b32 a86, v74
v_accvgpr_write_b32 a87, v75
v_accvgpr_read_b32 v64, a32
v_accvgpr_read_b32 v65, a33
v_mfma_f32_16x16x32_bf16 v[152:155], a[208:211], a[128:131], v[152:155]
ds_read_b64_tr_b16 a[192:193], v15 offset:0
s_add_u32 m0, s38, 0
v_accvgpr_read_b32 v66, a34
v_accvgpr_read_b32 v67, a35
v_accvgpr_read_b32 v68, a36
v_accvgpr_read_b32 v69, a37
v_accvgpr_read_b32 v70, a38
v_mfma_f32_16x16x32_bf16 v[152:155], a[212:215], a[132:135], v[152:155]
buffer_load_dwordx4 v24, s[16:19], s39 offen offset:0 nt lds
s_add_u32 s29, s28, s33
ds_read_b64_tr_b16 a[194:195], v15 offset:256
v_accvgpr_read_b32 v71, a39
v_mul_f32 v64, s48, v64
v_mul_f32 v65, s48, v65
v_mul_f32 v66, s48, v66
v_mul_f32 v67, s48, v67
v_mfma_f32_16x16x32_bf16 v[184:187], a[208:211], a[136:139], v[184:187]
s_mov_b32 s28, s36
ds_read_b64_tr_b16 a[196:197], v15 offset:8704
buffer_load_dword v127, v126, s[52:55], s69 offen
v_mul_f32 v68, s48, v68
v_mul_f32 v69, s48, v69
v_mul_f32 v70, s48, v70
v_mul_f32 v71, s48, v71
v_cvt_pk_bf16_f32 v64, v64, v65
v_mfma_f32_16x16x32_bf16 v[184:187], a[212:215], a[140:143], v[184:187]
ds_read_b64_tr_b16 a[198:199], v15 offset:8960
s_add_u32 m0, s38, 8704
v_cvt_pk_bf16_f32 v65, v66, v67
v_cvt_pk_bf16_f32 v66, v68, v69
v_cvt_pk_bf16_f32 v67, v70, v71
v_accvgpr_write_b32 a80, v64
v_accvgpr_write_b32 a81, v65
v_mfma_f32_16x16x32_bf16 v[216:219], a[208:211], a[144:147], v[216:219]
buffer_load_dwordx4 v25, s[20:23], s39 offen offset:0 nt lds
v_accvgpr_write_b32 a82, v66
v_accvgpr_write_b32 a83, v67
v_accvgpr_read_b32 v72, a24
v_accvgpr_read_b32 v73, a25
v_mfma_f32_16x16x32_bf16 v[216:219], a[212:215], a[148:151], v[216:219]
v_accvgpr_read_b32 v74, a26
v_accvgpr_read_b32 v75, a27
v_accvgpr_read_b32 v76, a28
v_accvgpr_read_b32 v77, a29
v_accvgpr_read_b32 v78, a30
v_mfma_f32_16x16x32_bf16 v[156:159], a[216:219], a[128:131], v[156:159]
ds_read_b64_tr_b16 a[200:201], v15 offset:8
s_add_u32 m0, s38, 64
v_accvgpr_read_b32 v79, a31
v_mul_f32 v72, s48, v72
v_mul_f32 v73, s48, v73
v_mul_f32 v74, s48, v74
v_mul_f32 v75, s48, v75
v_mfma_f32_16x16x32_bf16 v[156:159], a[220:223], a[132:135], v[156:159]
buffer_load_dwordx4 v24, s[16:19], s39 offen offset:1024 nt lds
s_add_u32 s69, s69, 4096
ds_read_b64_tr_b16 a[202:203], v15 offset:264
v_mul_f32 v76, s48, v76
v_mul_f32 v77, s48, v77
v_mul_f32 v78, s48, v78
v_mul_f32 v79, s48, v79
v_cvt_pk_bf16_f32 v72, v72, v73
v_mfma_f32_16x16x32_bf16 v[188:191], a[216:219], a[136:139], v[188:191]
ds_read_b64_tr_b16 a[204:205], v15 offset:8712
v_cvt_pk_bf16_f32 v73, v74, v75
v_cvt_pk_bf16_f32 v74, v76, v77
v_cvt_pk_bf16_f32 v75, v78, v79
v_accvgpr_write_b32 a76, v72
v_accvgpr_write_b32 a77, v73
v_mfma_f32_16x16x32_bf16 v[188:191], a[220:223], a[140:143], v[188:191]
ds_read_b64_tr_b16 a[206:207], v15 offset:8968
s_add_u32 m0, s38, 9536
v_accvgpr_write_b32 a78, v74
v_accvgpr_write_b32 a79, v75
v_accvgpr_read_b32 v64, a16
v_accvgpr_read_b32 v65, a17
v_accvgpr_read_b32 v66, a18
v_mfma_f32_16x16x32_bf16 v[220:223], a[216:219], a[144:147], v[220:223]
buffer_load_dwordx4 v25, s[20:23], s39 offen offset:256 nt lds
v_accvgpr_read_b32 v67, a19
v_accvgpr_read_b32 v68, a20
v_accvgpr_read_b32 v69, a21
v_accvgpr_read_b32 v70, a22
v_accvgpr_read_b32 v71, a23
v_mfma_f32_16x16x32_bf16 v[220:223], a[220:223], a[148:151], v[220:223]
s_waitcnt lgkmcnt(4)
s_add_u32 s101, s101, 8192
s_add_u32 s100, s100, s92
s_and_b32 s39, s100, 0xf800
s_and_b32 s93, s101, 0x40000
s_or_b32 s39, s39, s93
s_add_u32 s38, s38, 17408
s_cmp_eq_u32 s38, s71
s_cselect_b32 s38, s70, s38
v_mul_f32 v64, s48, v64
v_mul_f32 v65, s48, v65
v_mul_f32 v66, s48, v66
v_mul_f32 v67, s48, v67
v_mul_f32 v68, s48, v68
v_mfma_f32_16x16x32_bf16 v[128:131], a[192:195], a[160:163], v[128:131]
ds_read_b64_tr_b16 a[208:209], v15 offset:64
v_mul_f32 v69, s48, v69
v_mul_f32 v70, s48, v70
v_mul_f32 v71, s48, v71
v_cvt_pk_bf16_f32 v64, v64, v65
v_mfma_f32_16x16x32_bf16 v[128:131], a[196:199], a[164:167], v[128:131]
ds_read_b64_tr_b16 a[210:211], v15 offset:320
v_cvt_pk_bf16_f32 v65, v66, v67
v_cvt_pk_bf16_f32 v66, v68, v69
v_cvt_pk_bf16_f32 v67, v70, v71
v_accvgpr_write_b32 a72, v64
v_accvgpr_write_b32 a73, v65
v_mfma_f32_16x16x32_bf16 v[160:163], a[192:195], a[168:171], v[160:163]
ds_read_b64_tr_b16 a[212:213], v15 offset:8768
v_accvgpr_write_b32 a74, v66
v_accvgpr_write_b32 a75, v67
v_accvgpr_read_b32 v72, a8
v_accvgpr_read_b32 v73, a9
v_accvgpr_read_b32 v74, a10
v_mfma_f32_16x16x32_bf16 v[160:163], a[196:199], a[172:175], v[160:163]
ds_read_b64_tr_b16 a[214:215], v15 offset:9024
v_accvgpr_read_b32 v75, a11
v_accvgpr_read_b32 v76, a12
v_accvgpr_read_b32 v77, a13
v_accvgpr_read_b32 v78, a14
v_accvgpr_read_b32 v79, a15
v_mfma_f32_16x16x32_bf16 v[192:195], a[192:195], a[176:179], v[192:195]
v_mul_f32 v72, s48, v72
v_mul_f32 v73, s48, v73
v_mul_f32 v74, s48, v74
v_mul_f32 v75, s48, v75
v_mul_f32 v76, s48, v76
v_mfma_f32_16x16x32_bf16 v[192:195], a[196:199], a[180:183], v[192:195]
s_waitcnt lgkmcnt(4)
v_mul_f32 v77, s48, v77
v_mul_f32 v78, s48, v78
v_mul_f32 v79, s48, v79
v_cvt_pk_bf16_f32 v72, v72, v73
v_cvt_pk_bf16_f32 v73, v74, v75
v_mfma_f32_16x16x32_bf16 v[132:135], a[200:203], a[160:163], v[132:135]
ds_read_b64_tr_b16 a[216:217], v15 offset:72
s_add_u32 m0, s38, 0
v_cvt_pk_bf16_f32 v74, v76, v77
v_cvt_pk_bf16_f32 v75, v78, v79
v_accvgpr_write_b32 a68, v72
v_accvgpr_write_b32 a69, v73
v_accvgpr_write_b32 a70, v74
v_mfma_f32_16x16x32_bf16 v[132:135], a[204:207], a[164:167], v[132:135]
buffer_load_dwordx4 v24, s[16:19], s39 offen offset:0 nt lds
ds_read_b64_tr_b16 a[218:219], v15 offset:328
v_accvgpr_write_b32 a71, v75
v_accvgpr_read_b32 v64, a0
v_accvgpr_read_b32 v65, a1
v_accvgpr_read_b32 v66, a2
v_accvgpr_read_b32 v67, a3
v_mfma_f32_16x16x32_bf16 v[164:167], a[200:203], a[168:171], v[164:167]
ds_read_b64_tr_b16 a[220:221], v15 offset:8776
v_accvgpr_read_b32 v68, a4
v_accvgpr_read_b32 v69, a5
v_accvgpr_read_b32 v70, a6
v_accvgpr_read_b32 v71, a7
v_mul_f32 v64, s48, v64
v_mfma_f32_16x16x32_bf16 v[164:167], a[204:207], a[172:175], v[164:167]
ds_read_b64_tr_b16 a[222:223], v15 offset:9032
s_add_u32 m0, s38, 8704
v_mul_f32 v65, s48, v65
v_mul_f32 v66, s48, v66
v_mul_f32 v67, s48, v67
v_mul_f32 v68, s48, v68
v_mul_f32 v69, s48, v69
v_mfma_f32_16x16x32_bf16 v[196:199], a[200:203], a[176:179], v[196:199]
buffer_load_dwordx4 v25, s[20:23], s39 offen offset:0 nt lds
v_mul_f32 v70, s48, v70
v_mul_f32 v71, s48, v71
v_cvt_pk_bf16_f32 v64, v64, v65
v_cvt_pk_bf16_f32 v65, v66, v67
v_cvt_pk_bf16_f32 v66, v68, v69
v_mfma_f32_16x16x32_bf16 v[196:199], a[204:207], a[180:183], v[196:199]
s_waitcnt lgkmcnt(4)
v_cvt_pk_bf16_f32 v67, v70, v71
v_accvgpr_write_b32 a64, v64
v_accvgpr_write_b32 a65, v65
v_accvgpr_write_b32 a66, v66
v_accvgpr_write_b32 a67, v67
v_mfma_f32_16x16x32_bf16 v[136:139], a[208:211], a[160:163], v[136:139]
ds_read_b64_tr_b16 a[192:193], v15 offset:128
s_add_u32 m0, s38, 64
v_mfma_f32_16x16x32_bf16 v[136:139], a[212:215], a[164:167], v[136:139]
buffer_load_dwordx4 v24, s[16:19], s39 offen offset:1024 nt lds
ds_read_b64_tr_b16 a[194:195], v15 offset:384
v_mul_f32 v64, s48, v128
v_mul_f32 v65, s48, v129
v_mul_f32 v66, s48, v130
v_mul_f32 v67, s48, v131
v_mfma_f32_16x16x32_bf16 v[168:171], a[208:211], a[168:171], v[168:171]
ds_read_b64_tr_b16 a[196:197], v15 offset:8832
v_mul_f32 v68, s48, v132
v_mul_f32 v69, s48, v133
v_mul_f32 v70, s48, v134
v_mul_f32 v71, s48, v135
v_mfma_f32_16x16x32_bf16 v[168:171], a[212:215], a[172:175], v[168:171]
ds_read_b64_tr_b16 a[198:199], v15 offset:9088
s_add_u32 m0, s38, 9536
v_cvt_pk_bf16_f32 v64, v64, v65
v_cvt_pk_bf16_f32 v65, v66, v67
v_cvt_pk_bf16_f32 v66, v68, v69
v_cvt_pk_bf16_f32 v67, v70, v71
v_accvgpr_write_b32 a0, v64
v_mfma_f32_16x16x32_bf16 v[200:203], a[208:211], a[176:179], v[200:203]
buffer_load_dwordx4 v25, s[20:23], s39 offen offset:256 nt lds
v_accvgpr_write_b32 a1, v65
v_accvgpr_write_b32 a2, v66
v_accvgpr_write_b32 a3, v67
v_mul_f32 v64, s48, v160
v_mfma_f32_16x16x32_bf16 v[200:203], a[212:215], a[180:183], v[200:203]
s_waitcnt lgkmcnt(4)
s_add_u32 s101, s101, 8192
s_add_u32 s100, s100, s92
s_and_b32 s39, s100, 0xf800
s_and_b32 s93, s101, 0x40000
s_or_b32 s39, s39, s93
s_add_u32 s38, s38, 17408
s_cmp_eq_u32 s38, s71
s_cselect_b32 s38, s70, s38
v_mul_f32 v65, s48, v161
v_mul_f32 v66, s48, v162
v_mul_f32 v67, s48, v163
v_mul_f32 v68, s48, v164
v_mfma_f32_16x16x32_bf16 v[140:143], a[216:219], a[160:163], v[140:143]
ds_read_b64_tr_b16 a[200:201], v15 offset:136
v_mul_f32 v69, s48, v165
v_mul_f32 v70, s48, v166
v_mul_f32 v71, s48, v167
v_cvt_pk_bf16_f32 v64, v64, v65
v_cvt_pk_bf16_f32 v65, v66, v67
v_mfma_f32_16x16x32_bf16 v[140:143], a[220:223], a[164:167], v[140:143]
ds_read_b64_tr_b16 a[202:203], v15 offset:392
v_cvt_pk_bf16_f32 v66, v68, v69
v_cvt_pk_bf16_f32 v67, v70, v71
v_accvgpr_write_b32 a16, v64
v_accvgpr_write_b32 a17, v65
v_mfma_f32_16x16x32_bf16 v[172:175], a[216:219], a[168:171], v[172:175]
ds_read_b64_tr_b16 a[204:205], v15 offset:8840
v_accvgpr_write_b32 a18, v66
v_accvgpr_write_b32 a19, v67
v_mul_f32 v64, s48, v192
v_mul_f32 v65, s48, v193
v_mfma_f32_16x16x32_bf16 v[172:175], a[220:223], a[172:175], v[172:175]
ds_read_b64_tr_b16 a[206:207], v15 offset:9096
v_mul_f32 v66, s48, v194
v_mul_f32 v67, s48, v195
v_mul_f32 v68, s48, v196
v_mul_f32 v69, s48, v197
v_mul_f32 v70, s48, v198
v_mfma_f32_16x16x32_bf16 v[204:207], a[216:219], a[176:179], v[204:207]
v_mul_f32 v71, s48, v199
v_cvt_pk_bf16_f32 v64, v64, v65
v_cvt_pk_bf16_f32 v65, v66, v67
v_cvt_pk_bf16_f32 v66, v68, v69
v_mfma_f32_16x16x32_bf16 v[204:207], a[220:223], a[180:183], v[204:207]
s_waitcnt lgkmcnt(4)
v_cvt_pk_bf16_f32 v67, v70, v71
v_accvgpr_write_b32 a32, v64
v_accvgpr_write_b32 a33, v65
v_accvgpr_write_b32 a34, v66
v_accvgpr_write_b32 a35, v67
v_mfma_f32_16x16x32_bf16 v[144:147], a[192:195], a[160:163], v[144:147]
ds_read_b64_tr_b16 a[208:209], v15 offset:192
s_add_u32 m0, s38, 0
v_mfma_f32_16x16x32_bf16 v[144:147], a[196:199], a[164:167], v[144:147]
buffer_load_dwordx4 v24, s[16:19], s39 offen offset:0 nt lds
ds_read_b64_tr_b16 a[210:211], v15 offset:448
v_mul_f32 v72, s48, v136
v_mul_f32 v73, s48, v137
v_mul_f32 v74, s48, v138
v_mul_f32 v75, s48, v139
v_mfma_f32_16x16x32_bf16 v[176:179], a[192:195], a[168:171], v[176:179]
ds_read_b64_tr_b16 a[212:213], v15 offset:8896
v_mul_f32 v76, s48, v140
v_mul_f32 v77, s48, v141
v_mul_f32 v78, s48, v142
v_mul_f32 v79, s48, v143
v_mfma_f32_16x16x32_bf16 v[176:179], a[196:199], a[172:175], v[176:179]
ds_read_b64_tr_b16 a[214:215], v15 offset:9152
s_add_u32 m0, s38, 8704
v_cvt_pk_bf16_f32 v72, v72, v73
v_cvt_pk_bf16_f32 v73, v74, v75
v_cvt_pk_bf16_f32 v74, v76, v77
v_cvt_pk_bf16_f32 v75, v78, v79
v_accvgpr_write_b32 a4, v72
v_mfma_f32_16x16x32_bf16 v[208:211], a[192:195], a[176:179], v[208:211]
buffer_load_dwordx4 v25, s[20:23], s39 offen offset:0 nt lds
v_accvgpr_write_b32 a5, v73
v_accvgpr_write_b32 a6, v74
v_accvgpr_write_b32 a7, v75
v_mul_f32 v72, s48, v168
v_mfma_f32_16x16x32_bf16 v[208:211], a[196:199], a[180:183], v[208:211]
s_waitcnt lgkmcnt(4)
v_mul_f32 v73, s48, v169
v_mul_f32 v74, s48, v170
v_mul_f32 v75, s48, v171
v_mul_f32 v76, s48, v172
v_mfma_f32_16x16x32_bf16 v[148:151], a[200:203], a[160:163], v[148:151]
ds_read_b64_tr_b16 a[216:217], v15 offset:200
s_add_u32 m0, s38, 64
v_mul_f32 v77, s48, v173
v_mul_f32 v78, s48, v174
v_mul_f32 v79, s48, v175
v_cvt_pk_bf16_f32 v72, v72, v73
v_cvt_pk_bf16_f32 v73, v74, v75
v_mfma_f32_16x16x32_bf16 v[148:151], a[204:207], a[164:167], v[148:151]
buffer_load_dwordx4 v24, s[16:19], s39 offen offset:1024 nt lds
ds_read_b64_tr_b16 a[218:219], v15 offset:456
v_cvt_pk_bf16_f32 v74, v76, v77
v_cvt_pk_bf16_f32 v75, v78, v79
v_accvgpr_write_b32 a20, v72
v_accvgpr_write_b32 a21, v73
v_mfma_f32_16x16x32_bf16 v[180:183], a[200:203], a[168:171], v[180:183]
ds_read_b64_tr_b16 a[220:221], v15 offset:8904
v_accvgpr_write_b32 a22, v74
v_accvgpr_write_b32 a23, v75
v_mul_f32 v72, s48, v200
v_mul_f32 v73, s48, v201
v_mfma_f32_16x16x32_bf16 v[180:183], a[204:207], a[172:175], v[180:183]
ds_read_b64_tr_b16 a[222:223], v15 offset:9160
s_add_u32 m0, s38, 9536
v_mul_f32 v74, s48, v202
v_mul_f32 v75, s48, v203
v_mul_f32 v76, s48, v204
v_mul_f32 v77, s48, v205
v_mul_f32 v78, s48, v206
v_mfma_f32_16x16x32_bf16 v[212:215], a[200:203], a[176:179], v[212:215]
buffer_load_dwordx4 v25, s[20:23], s39 offen offset:256 nt lds
v_mul_f32 v79, s48, v207
v_cvt_pk_bf16_f32 v72, v72, v73
v_cvt_pk_bf16_f32 v73, v74, v75
v_cvt_pk_bf16_f32 v74, v76, v77
v_mfma_f32_16x16x32_bf16 v[212:215], a[204:207], a[180:183], v[212:215]
s_waitcnt lgkmcnt(4)
s_add_u32 s101, s101, 8192
s_add_u32 s100, s100, s92
s_and_b32 s39, s100, 0xf800
s_and_b32 s93, s101, 0x40000
s_or_b32 s39, s39, s93
s_add_u32 s38, s38, 17408
s_cmp_eq_u32 s38, s71
s_cselect_b32 s38, s70, s38
v_cvt_pk_bf16_f32 v75, v78, v79
v_accvgpr_write_b32 a36, v72
v_accvgpr_write_b32 a37, v73
v_accvgpr_write_b32 a38, v74
v_accvgpr_write_b32 a39, v75
v_mfma_f32_16x16x32_bf16 v[152:155], a[208:211], a[160:163], v[152:155]
v_mfma_f32_16x16x32_bf16 v[152:155], a[212:215], a[164:167], v[152:155]
v_mul_f32 v64, s48, v144
v_mul_f32 v65, s48, v145
v_mul_f32 v66, s48, v146
v_mul_f32 v67, s48, v147
v_mfma_f32_16x16x32_bf16 v[184:187], a[208:211], a[168:171], v[184:187]
buffer_load_dword v127, v126, s[52:55], s69 offen
v_mul_f32 v68, s48, v148
v_mul_f32 v69, s48, v149
v_mul_f32 v70, s48, v150
v_mul_f32 v71, s48, v151
v_mfma_f32_16x16x32_bf16 v[184:187], a[212:215], a[172:175], v[184:187]
v_cvt_pk_bf16_f32 v64, v64, v65
v_cvt_pk_bf16_f32 v65, v66, v67
v_cvt_pk_bf16_f32 v66, v68, v69
v_cvt_pk_bf16_f32 v67, v70, v71
v_accvgpr_write_b32 a8, v64
v_mfma_f32_16x16x32_bf16 v[216:219], a[208:211], a[176:179], v[216:219]
v_accvgpr_write_b32 a9, v65
v_accvgpr_write_b32 a10, v66
v_accvgpr_write_b32 a11, v67
v_mul_f32 v64, s48, v176
v_mfma_f32_16x16x32_bf16 v[216:219], a[212:215], a[180:183], v[216:219]
s_waitcnt lgkmcnt(0)
v_mul_f32 v65, s48, v177
v_mul_f32 v66, s48, v178
v_mul_f32 v67, s48, v179
v_mul_f32 v68, s48, v180
v_mfma_f32_16x16x32_bf16 v[156:159], a[216:219], a[160:163], v[156:159]
v_mul_f32 v69, s48, v181
v_mul_f32 v70, s48, v182
v_mul_f32 v71, s48, v183
v_cvt_pk_bf16_f32 v64, v64, v65
v_cvt_pk_bf16_f32 v65, v66, v67
v_mfma_f32_16x16x32_bf16 v[156:159], a[220:223], a[164:167], v[156:159]
s_add_u32 s69, s69, 4096
v_cvt_pk_bf16_f32 v66, v68, v69
v_cvt_pk_bf16_f32 v67, v70, v71
v_accvgpr_write_b32 a24, v64
v_accvgpr_write_b32 a25, v65
v_mfma_f32_16x16x32_bf16 v[188:191], a[216:219], a[168:171], v[188:191]
v_accvgpr_write_b32 a26, v66
v_accvgpr_write_b32 a27, v67
v_mul_f32 v64, s48, v208
v_mul_f32 v65, s48, v209
v_mfma_f32_16x16x32_bf16 v[188:191], a[220:223], a[172:175], v[188:191]
v_mul_f32 v66, s48, v210
v_mul_f32 v67, s48, v211
v_mul_f32 v68, s48, v212
v_mul_f32 v69, s48, v213
v_mul_f32 v70, s48, v214
v_mfma_f32_16x16x32_bf16 v[220:223], a[216:219], a[176:179], v[220:223]
v_mul_f32 v71, s48, v215
v_cvt_pk_bf16_f32 v64, v64, v65
v_cvt_pk_bf16_f32 v65, v66, v67
v_cvt_pk_bf16_f32 v66, v68, v69
v_mfma_f32_16x16x32_bf16 v[220:223], a[220:223], a[180:183], v[220:223]
v_cvt_pk_bf16_f32 v67, v70, v71
v_accvgpr_write_b32 a40, v64
v_accvgpr_write_b32 a41, v65
v_accvgpr_write_b32 a42, v66
v_accvgpr_write_b32 a43, v67
s_add_u32 m0, s38, 0
s_nop 0
buffer_load_dwordx4 v24, s[16:19], s39 offen offset:0 nt lds
s_add_u32 m0, s38, 8704
s_nop 0
buffer_load_dwordx4 v25, s[20:23], s39 offen offset:0 nt lds
s_add_u32 m0, s38, 64
s_nop 0
buffer_load_dwordx4 v24, s[16:19], s39 offen offset:1024 nt lds
s_add_u32 m0, s38, 9536
s_nop 0
buffer_load_dwordx4 v25, s[20:23], s39 offen offset:256 nt lds
s_add_u32 s101, s101, 8192
s_add_u32 s100, s100, s92
s_and_b32 s39, s100, 0xf800
s_and_b32 s93, s101, 0x40000
s_or_b32 s39, s39, s93
s_add_u32 s38, s38, 17408
s_cmp_eq_u32 s38, s71
s_cselect_b32 s38, s70, s38
v_mfma_f32_16x16x32_bf16 v[80:83], v[48:51], a[64:67], 0
v_mul_f32 v72, s48, v152
v_mul_f32 v73, s48, v153
v_mul_f32 v74, s48, v154
v_mul_f32 v75, s48, v155
v_mfma_f32_16x16x32_bf16 v[84:87], v[48:51], a[80:83], 0
v_mul_f32 v76, s48, v156
v_mul_f32 v77, s48, v157
v_mul_f32 v78, s48, v158
v_mul_f32 v79, s48, v159
v_mfma_f32_16x16x32_bf16 v[88:91], v[48:51], a[96:99], 0
v_cvt_pk_bf16_f32 v72, v72, v73
v_cvt_pk_bf16_f32 v73, v74, v75
v_cvt_pk_bf16_f32 v74, v76, v77
v_cvt_pk_bf16_f32 v75, v78, v79
v_mfma_f32_16x16x32_bf16 v[80:83], v[52:55], a[68:71], v[80:83]
v_accvgpr_write_b32 a12, v72
v_accvgpr_write_b32 a13, v73
v_accvgpr_write_b32 a14, v74
v_accvgpr_write_b32 a15, v75
v_mfma_f32_16x16x32_bf16 v[84:87], v[52:55], a[84:87], v[84:87]
v_mul_f32 v72, s48, v184
v_mul_f32 v73, s48, v185
v_mul_f32 v74, s48, v186
v_mul_f32 v75, s48, v187
v_mfma_f32_16x16x32_bf16 v[88:91], v[52:55], a[100:103], v[88:91]
v_mul_f32 v76, s48, v188
v_mul_f32 v77, s48, v189
v_mul_f32 v78, s48, v190
v_mul_f32 v79, s48, v191
v_mfma_f32_16x16x32_bf16 v[80:83], v[56:59], a[72:75], v[80:83]
v_cvt_pk_bf16_f32 v72, v72, v73
v_cvt_pk_bf16_f32 v73, v74, v75
v_cvt_pk_bf16_f32 v74, v76, v77
v_cvt_pk_bf16_f32 v75, v78, v79
v_mfma_f32_16x16x32_bf16 v[84:87], v[56:59], a[88:91], v[84:87]
v_accvgpr_write_b32 a28, v72
v_accvgpr_write_b32 a29, v73
v_accvgpr_write_b32 a30, v74
v_accvgpr_write_b32 a31, v75
v_mfma_f32_16x16x32_bf16 v[88:91], v[56:59], a[104:107], v[88:91]
v_mul_f32 v72, s48, v216
v_mul_f32 v73, s48, v217
v_mul_f32 v74, s48, v218
v_mul_f32 v75, s48, v219
v_mfma_f32_16x16x32_bf16 v[80:83], v[60:63], a[76:79], v[80:83]
v_mul_f32 v76, s48, v220
v_mul_f32 v77, s48, v221
v_mul_f32 v78, s48, v222
v_mul_f32 v79, s48, v223
v_mfma_f32_16x16x32_bf16 v[84:87], v[60:63], a[92:95], v[84:87]
v_cvt_pk_bf16_f32 v72, v72, v73
v_cvt_pk_bf16_f32 v73, v74, v75
v_cvt_pk_bf16_f32 v74, v76, v77
v_cvt_pk_bf16_f32 v75, v78, v79
v_mfma_f32_16x16x32_bf16 v[88:91], v[60:63], a[108:111], v[88:91]
v_accvgpr_write_b32 a44, v72
v_accvgpr_write_b32 a45, v73
v_accvgpr_write_b32 a46, v74
v_accvgpr_write_b32 a47, v75
v_mfma_f32_16x16x32_bf16 v[128:131], v[32:35], a[0:3], 0
v_mfma_f32_16x16x32_bf16 v[132:135], v[32:35], a[16:19], 0
v_mfma_f32_16x16x32_bf16 v[136:139], v[32:35], a[32:35], 0
v_max3_f32 v80, v80, v81, v82
v_max3_f32 v84, v84, v85, v86
v_max3_f32 v88, v88, v89, v90
v_mfma_f32_16x16x32_bf16 v[128:131], v[36:39], a[4:7], v[128:131]
v_max_f32 v80, v80, v83
v_max_f32 v84, v84, v87
v_max_f32 v88, v88, v91
v_mfma_f32_16x16x32_bf16 v[132:135], v[36:39], a[20:23], v[132:135]
v_mov_b32 v81, v80
v_mov_b32 v85, v84
v_mov_b32 v89, v88
v_mfma_f32_16x16x32_bf16 v[136:139], v[36:39], a[36:39], v[136:139]
s_nop 1
v_permlane32_swap_b32 v80, v81
v_permlane32_swap_b32 v84, v85
v_mfma_f32_16x16x32_bf16 v[128:131], v[40:43], a[8:11], v[128:131]
v_permlane32_swap_b32 v88, v89
s_nop 1
v_max_f32 v80, v80, v81
v_mfma_f32_16x16x32_bf16 v[132:135], v[40:43], a[24:27], v[132:135]
v_max_f32 v84, v84, v85
v_max_f32 v88, v88, v89
v_mov_b32 v81, v80
v_mfma_f32_16x16x32_bf16 v[136:139], v[40:43], a[40:43], v[136:139]
v_mov_b32 v85, v84
v_mov_b32 v89, v88
s_nop 1
v_mfma_f32_16x16x32_bf16 v[128:131], v[44:47], a[12:15], v[128:131]
v_permlane16_swap_b32 v80, v81
v_permlane16_swap_b32 v84, v85
v_permlane16_swap_b32 v88, v89
v_mfma_f32_16x16x32_bf16 v[132:135], v[44:47], a[28:31], v[132:135]
s_nop 1
v_max_f32 v80, v80, v81
v_max_f32 v84, v84, v85
v_mfma_f32_16x16x32_bf16 v[136:139], v[44:47], a[44:47], v[136:139]
v_max_f32 v88, v88, v89
v_sub_f32 v112, 0, v80
v_sub_f32 v113, 0, v84
v_sub_f32 v114, 0, v88
s_nop 7
v_max3_f32 v128, v128, v129, v130
v_max3_f32 v132, v132, v133, v134
v_max3_f32 v136, v136, v137, v138
v_max_f32 v128, v128, v131
v_max_f32 v132, v132, v135
v_max_f32 v136, v136, v139
v_mov_b32 v129, v128
v_mov_b32 v133, v132
v_mov_b32 v137, v136
s_nop 1
v_permlane32_swap_b32 v128, v129
v_permlane32_swap_b32 v132, v133
v_permlane32_swap_b32 v136, v137
s_nop 1
v_max_f32 v128, v128, v129
v_max_f32 v132, v132, v133
v_max_f32 v136, v136, v137
v_mov_b32 v129, v128
v_mov_b32 v133, v132
v_mov_b32 v137, v136
s_nop 1
v_permlane16_swap_b32 v128, v129
v_permlane16_swap_b32 v132, v133
v_permlane16_swap_b32 v136, v137
s_nop 1
v_max_f32 v128, v128, v129
v_max_f32 v132, v132, v133
v_max_f32 v136, v136, v137
v_sub_f32 v96, 0, v128
v_sub_f32 v97, 0, v128
v_sub_f32 v98, 0, v128
v_sub_f32 v99, 0, v128
v_sub_f32 v100, 0, v132
v_sub_f32 v101, 0, v132
v_sub_f32 v102, 0, v132
v_sub_f32 v103, 0, v132
v_sub_f32 v104, 0, v136
v_sub_f32 v105, 0, v136
v_sub_f32 v106, 0, v136
v_sub_f32 v107, 0, v136
s_cmp_lg_u32 s42, 0
s_cbranch_scc1 L_tm3
L_attn3:
v_mov_b32 v88, 0
v_mov_b32 v89, 0
v_mov_b32 v90, 0
v_mov_b32 v91, 0
v_mov_b32 v92, 0
v_mov_b32 v93, 0
s_mov_b32 s41, 104448
v_add_u32 v21, 104448, v18
v_add_u32 v22, 104448, v19
v_add_u32 v23, 104448, v20
s_mov_b32 s40, 0
s_waitcnt vmcnt(22)
s_barrier
ds_read_b128 a[128:131], v21 offset:0
ds_read_b128 a[132:135], v21 offset:64
ds_read_b128 a[136:139], v21 offset:128
ds_read_b128 a[140:143], v21 offset:192
ds_read_b128 a[144:147], v21 offset:4352
ds_read_b128 a[148:151], v21 offset:4416
ds_read_b128 a[152:155], v21 offset:4480
ds_read_b128 a[156:159], v21 offset:4544
s_add_u32 m0, s38, 0
s_nop 0
buffer_load_dwordx4 v24, s[16:19], s39 offen offset:0 nt lds
s_add_u32 m0, s38, 8704
s_nop 0
buffer_load_dwordx4 v25, s[20:23], s39 offen offset:0 nt lds
s_add_u32 m0, s38, 64
s_nop 0
buffer_load_dwordx4 v24, s[16:19], s39 offen offset:1024 nt lds
s_add_u32 m0, s38, 9536
s_nop 0
buffer_load_dwordx4 v25, s[20:23], s39 offen offset:256 nt lds
s_waitcnt lgkmcnt(4)
v_mfma_f32_16x16x32_bf16 v[64:67], a[128:131], a[0:3], v[96:99]
ds_read_b64_tr_b16 a[192:193], v22 offset:8704
v_mfma_f32_16x16x32_bf16 v[64:67], a[132:135], a[4:7], v[64:67]
ds_read_b64_tr_b16 a[194:195], v22 offset:13056
v_mfma_f32_16x16x32_bf16 v[64:67], a[136:139], a[8:11], v[64:67]
ds_read_b64_tr_b16 a[196:197], v23 offset:8736
v_mfma_f32_16x16x32_bf16 v[64:67], a[140:143], a[12:15], v[64:67]
s_waitcnt lgkmcnt(3)
ds_read_b64_tr_b16 a[198:199], v23 offset:13088
ds_read_b64_tr_b16 a[200:201], v22 offset:8768
v_mfma_f32_16x16x32_bf16 v[68:71], a[144:147], a[0:3], v[96:99]
ds_read_b64_tr_b16 a[202:203], v22 offset:13120
v_mfma_f32_16x16x32_bf16 v[68:71], a[148:151], a[4:7], v[68:71]
v_mfma_f32_16x16x32_bf16 v[68:71], a[152:155], a[8:11], v[68:71]
ds_read_b64_tr_b16 a[204:205], v23 offset:8800
v_mfma_f32_16x16x32_bf16 v[68:71], a[156:159], a[12:15], v[68:71]
ds_read_b64_tr_b16 a[206:207], v23 offset:13152
s_waitcnt lgkmcnt(6)
v_mfma_f32_16x16x32_bf16 v[72:75], a[128:131], a[16:19], v[100:103]
ds_read_b64_tr_b16 a[208:209], v22 offset:8832
v_exp_f32 v64, v64
v_mfma_f32_16x16x32_bf16 v[72:75], a[132:135], a[20:23], v[72:75]
ds_read_b64_tr_b16 a[210:211], v22 offset:13184
v_exp_f32 v65, v65
v_mfma_f32_16x16x32_bf16 v[72:75], a[136:139], a[24:27], v[72:75]
ds_read_b64_tr_b16 a[212:213], v23 offset:8864
v_cvt_pk_bf16_f32 v80, v64, v65
v_mfma_f32_16x16x32_bf16 v[72:75], a[140:143], a[28:31], v[72:75]
v_exp_f32 v66, v66
ds_read_b64_tr_b16 a[214:215], v23 offset:13216
v_add_f32 v88, v88, v64
v_add_f32 v89, v89, v65
v_exp_f32 v67, v67
ds_read_b64_tr_b16 a[216:217], v22 offset:8896
v_cvt_pk_bf16_f32 v81, v66, v67
v_exp_f32 v68, v68
v_mfma_f32_16x16x32_bf16 v[76:79], a[144:147], a[16:19], v[100:103]
ds_read_b64_tr_b16 a[218:219], v22 offset:13248
v_add_f32 v88, v88, v66
v_add_f32 v89, v89, v67
v_mfma_f32_16x16x32_bf16 v[76:79], a[148:151], a[20:23], v[76:79]
v_exp_f32 v69, v69
v_mfma_f32_16x16x32_bf16 v[76:79], a[152:155], a[24:27], v[76:79]
ds_read_b64_tr_b16 a[220:221], v23 offset:8928
v_cvt_pk_bf16_f32 v82, v68, v69
v_mfma_f32_16x16x32_bf16 v[76:79], a[156:159], a[28:31], v[76:79]
v_exp_f32 v70, v70
v_add_f32 v88, v88, v68
v_add_f32 v89, v89, v69
v_exp_f32 v71, v71
ds_read_b64_tr_b16 a[222:223], v23 offset:13280
v_cvt_pk_bf16_f32 v83, v70, v71
s_waitcnt lgkmcnt(6)
s_add_u32 s101, s101, 8192
s_add_u32 s100, s100, s92
s_and_b32 s39, s100, 0xf800
s_and_b32 s93, s101, 0x40000
s_or_b32 s39, s39, s93
s_add_u32 s38, s38, 17408
s_cmp_eq_u32 s38, s71
s_cselect_b32 s38, s70, s38
v_add_f32 v88, v88, v70
v_add_f32 v89, v89, v71
s_waitcnt vmcnt(22)
s_barrier
v_mfma_f32_16x16x32_bf16 v[64:67], a[128:131], a[32:35], v[104:107]
ds_read_b128 a[160:163], v21 offset:17408
v_exp_f32 v72, v72
v_mfma_f32_16x16x32_bf16 v[64:67], a[132:135], a[36:39], v[64:67]
ds_read_b128 a[164:167], v21 offset:17472
v_exp_f32 v73, v73
v_mfma_f32_16x16x32_bf16 v[64:67], a[136:139], a[40:43], v[64:67]
ds_read_b128 a[168:171], v21 offset:17536
v_cvt_pk_bf16_f32 v84, v72, v73
v_mfma_f32_16x16x32_bf16 v[64:67], a[140:143], a[44:47], v[64:67]
v_exp_f32 v74, v74
v_mfma_f32_16x16x32_bf16 v[128:131], a[192:195], v[80:83], 0
s_add_u32 m0, s38, 0
ds_read_b128 a[172:175], v21 offset:17600
v_add_f32 v90, v90, v72
v_add_f32 v91, v91, v73
v_mfma_f32_16x16x32_bf16 v[132:135], a[196:199], v[80:83], 0
buffer_load_dwordx4 v24, s[16:19], s39 offen offset:0 nt lds
v_exp_f32 v75, v75
v_mfma_f32_16x16x32_bf16 v[136:139], a[200:203], v[80:83], 0
ds_read_b128 a[176:179], v21 offset:21760
v_cvt_pk_bf16_f32 v85, v74, v75
v_mfma_f32_16x16x32_bf16 v[140:143], a[204:207], v[80:83], 0
v_exp_f32 v76, v76
v_mfma_f32_16x16x32_bf16 v[68:71], a[144:147], a[32:35], v[104:107]
ds_read_b128 a[180:183], v21 offset:21824
v_add_f32 v90, v90, v74
v_add_f32 v91, v91, v75
v_mfma_f32_16x16x32_bf16 v[68:71], a[148:151], a[36:39], v[68:71]
v_exp_f32 v77, v77
v_mfma_f32_16x16x32_bf16 v[68:71], a[152:155], a[40:43], v[68:71]
ds_read_b128 a[184:187], v21 offset:21888
v_cvt_pk_bf16_f32 v86, v76, v77
v_mfma_f32_16x16x32_bf16 v[68:71], a[156:159], a[44:47], v[68:71]
s_waitcnt lgkmcnt(7)
v_exp_f32 v78, v78
v_mfma_f32_16x16x32_bf16 v[144:147], a[208:211], v[80:83], 0
v_add_f32 v90, v90, v76
v_add_f32 v91, v91, v77
v_mfma_f32_16x16x32_bf16 v[148:151], a[212:215], v[80:83], 0
v_exp_f32 v79, v79
v_mfma_f32_16x16x32_bf16 v[152:155], a[216:219], v[80:83], 0
ds_read_b128 a[188:191], v21 offset:21952
v_cvt_pk_bf16_f32 v87, v78, v79
v_mfma_f32_16x16x32_bf16 v[156:159], a[220:223], v[80:83], 0
s_waitcnt lgkmcnt(4)
v_add_f32 v90, v90, v78
v_add_f32 v91, v91, v79
v_mfma_f32_16x16x32_bf16 v[72:75], a[160:163], a[0:3], v[96:99]
ds_read_b64_tr_b16 a[224:225], v22 offset:26112
v_exp_f32 v64, v64
v_mfma_f32_16x16x32_bf16 v[72:75], a[164:167], a[4:7], v[72:75]
ds_read_b64_tr_b16 a[226:227], v22 offset:30464
v_exp_f32 v65, v65
v_mfma_f32_16x16x32_bf16 v[72:75], a[168:171], a[8:11], v[72:75]
ds_read_b64_tr_b16 a[228:229], v23 offset:26144
v_cvt_pk_bf16_f32 v80, v64, v65
v_mfma_f32_16x16x32_bf16 v[72:75], a[172:175], a[12:15], v[72:75]
v_exp_f32 v66, v66
v_mfma_f32_16x16x32_bf16 v[160:163], a[192:195], v[84:87], 0
s_add_u32 m0, s38, 8704
ds_read_b64_tr_b16 a[230:231], v23 offset:30496
v_add_f32 v92, v92, v64
v_add_f32 v93, v93, v65
v_mfma_f32_16x16x32_bf16 v[164:167], a[196:199], v[84:87], 0
buffer_load_dwordx4 v25, s[20:23], s39 offen offset:0 nt lds
v_exp_f32 v67, v67
v_mfma_f32_16x16x32_bf16 v[168:171], a[200:203], v[84:87], 0
ds_read_b64_tr_b16 a[232:233], v22 offset:26176
v_cvt_pk_bf16_f32 v81, v66, v67
v_mfma_f32_16x16x32_bf16 v[172:175], a[204:207], v[84:87], 0
s_waitcnt lgkmcnt(5)
v_exp_f32 v68, v68
v_mfma_f32_16x16x32_bf16 v[76:79], a[176:179], a[0:3], v[96:99]
ds_read_b64_tr_b16 a[234:235], v22 offset:30528
v_add_f32 v92, v92, v66
v_add_f32 v93, v93, v67
v_mfma_f32_16x16x32_bf16 v[76:79], a[180:183], a[4:7], v[76:79]
v_exp_f32 v69, v69
v_mfma_f32_16x16x32_bf16 v[76:79], a[184:187], a[8:11], v[76:79]
ds_read_b64_tr_b16 a[236:237], v23 offset:26208
v_cvt_pk_bf16_f32 v82, v68, v69
v_mfma_f32_16x16x32_bf16 v[76:79], a[188:191], a[12:15], v[76:79]
v_exp_f32 v70, v70
v_mfma_f32_16x16x32_bf16 v[176:179], a[208:211], v[84:87], 0
v_add_f32 v92, v92, v68
v_add_f32 v93, v93, v69
v_mfma_f32_16x16x32_bf16 v[180:183], a[212:215], v[84:87], 0
v_exp_f32 v71, v71
v_mfma_f32_16x16x32_bf16 v[184:187], a[216:219], v[84:87], 0
ds_read_b64_tr_b16 a[238:239], v23 offset:30560
v_cvt_pk_bf16_f32 v83, v70, v71
v_mfma_f32_16x16x32_bf16 v[188:191], a[220:223], v[84:87], 0
s_waitcnt lgkmcnt(6)
v_add_f32 v92, v92, v70
v_add_f32 v93, v93, v71
v_mfma_f32_16x16x32_bf16 v[64:67], a[160:163], a[16:19], v[100:103]
ds_read_b64_tr_b16 a[240:241], v22 offset:26240
v_exp_f32 v72, v72
v_mfma_f32_16x16x32_bf16 v[64:67], a[164:167], a[20:23], v[64:67]
ds_read_b64_tr_b16 a[242:243], v22 offset:30592
v_exp_f32 v73, v73
v_mfma_f32_16x16x32_bf16 v[64:67], a[168:171], a[24:27], v[64:67]
ds_read_b64_tr_b16 a[244:245], v23 offset:26272
v_cvt_pk_bf16_f32 v84, v72, v73
v_mfma_f32_16x16x32_bf16 v[64:67], a[172:175], a[28:31], v[64:67]
s_add_u32 s41, s41, 34816
v_exp_f32 v74, v74
v_mfma_f32_16x16x32_bf16 v[192:195], a[192:195], v[80:83], 0
s_add_u32 m0, s38, 64
ds_read_b64_tr_b16 a[246:247], v23 offset:30624
v_add_f32 v88, v88, v72
v_add_f32 v89, v89, v73
v_mfma_f32_16x16x32_bf16 v[196:199], a[196:199], v[80:83], 0
s_cmp_eq_u32 s41, 139264
buffer_load_dwordx4 v24, s[16:19], s39 offen offset:1024 nt lds
v_exp_f32 v75, v75
v_mfma_f32_16x16x32_bf16 v[200:203], a[200:203], v[80:83], 0
ds_read_b64_tr_b16 a[248:249], v22 offset:26304
v_cvt_pk_bf16_f32 v85, v74, v75
v_mfma_f32_16x16x32_bf16 v[204:207], a[204:207], v[80:83], 0
s_cselect_b32 s41, 0, s41
v_exp_f32 v76, v76
v_mfma_f32_16x16x32_bf16 v[68:71], a[176:179], a[16:19], v[100:103]
ds_read_b64_tr_b16 a[250:251], v22 offset:30656
v_add_f32 v88, v88, v74
v_add_f32 v89, v89, v75
v_mfma_f32_16x16x32_bf16 v[68:71], a[180:183], a[20:23], v[68:71]
v_exp_f32 v77, v77
v_mfma_f32_16x16x32_bf16 v[68:71], a[184:187], a[24:27], v[68:71]
s_add_u32 m0, s38, 9536
ds_read_b64_tr_b16 a[252:253], v23 offset:26336
v_cvt_pk_bf16_f32 v86, v76, v77
v_mfma_f32_16x16x32_bf16 v[68:71], a[188:191], a[28:31], v[68:71]
buffer_load_dwordx4 v25, s[20:23], s39 offen offset:256 nt lds
v_exp_f32 v78, v78
v_mfma_f32_16x16x32_bf16 v[208:211], a[208:211], v[80:83], 0
v_add_f32 v88, v88, v76
v_add_f32 v89, v89, v77
v_mfma_f32_16x16x32_bf16 v[212:215], a[212:215], v[80:83], 0
v_exp_f32 v79, v79
v_mfma_f32_16x16x32_bf16 v[216:219], a[216:219], v[80:83], 0
ds_read_b64_tr_b16 a[254:255], v23 offset:30688
v_cvt_pk_bf16_f32 v87, v78, v79
v_mfma_f32_16x16x32_bf16 v[220:223], a[220:223], v[80:83], 0
s_waitcnt lgkmcnt(6)
v_add_u32 v21, s41, v18
v_add_u32 v22, s41, v19
v_add_u32 v23, s41, v20
s_add_u32 s101, s101, 8192
s_add_u32 s100, s100, s92
s_and_b32 s39, s100, 0xf800
s_and_b32 s93, s101, 0x40000
s_or_b32 s39, s39, s93
s_add_u32 s38, s38, 17408
s_cmp_eq_u32 s38, s71
s_cselect_b32 s38, s70, s38
v_add_f32 v88, v88, v78
v_add_f32 v89, v89, v79
s_waitcnt vmcnt(21)
s_barrier
v_mfma_f32_16x16x32_bf16 v[72:75], a[160:163], a[32:35], v[104:107]
ds_read_b128 a[128:131], v21 offset:0
v_exp_f32 v64, v64
v_mfma_f32_16x16x32_bf16 v[72:75], a[164:167], a[36:39], v[72:75]
ds_read_b128 a[132:135], v21 offset:64
v_exp_f32 v65, v65
v_mfma_f32_16x16x32_bf16 v[72:75], a[168:171], a[40:43], v[72:75]
ds_read_b128 a[136:139], v21 offset:128
v_cvt_pk_bf16_f32 v80, v64, v65
v_mfma_f32_16x16x32_bf16 v[72:75], a[172:175], a[44:47], v[72:75]
v_exp_f32 v66, v66
v_mfma_f32_16x16x32_bf16 v[128:131], a[224:227], v[84:87], v[128:131]
s_add_u32 m0, s38, 0
ds_read_b128 a[140:143], v21 offset:192
v_add_f32 v90, v90, v64
v_add_f32 v91, v91, v65
v_mfma_f32_16x16x32_bf16 v[132:135], a[228:231], v[84:87], v[132:135]
buffer_load_dwordx4 v24, s[16:19], s39 offen offset:0 nt lds
v_exp_f32 v67, v67
v_mfma_f32_16x16x32_bf16 v[136:139], a[232:235], v[84:87], v[136:139]
ds_read_b128 a[144:147], v21 offset:4352
v_cvt_pk_bf16_f32 v81, v66, v67
v_mfma_f32_16x16x32_bf16 v[140:143], a[236:239], v[84:87], v[140:143]
v_exp_f32 v68, v68
v_mfma_f32_16x16x32_bf16 v[76:79], a[176:179], a[32:35], v[104:107]
ds_read_b128 a[148:151], v21 offset:4416
v_add_f32 v90, v90, v66
v_add_f32 v91, v91, v67
v_mfma_f32_16x16x32_bf16 v[76:79], a[180:183], a[36:39], v[76:79]
v_exp_f32 v69, v69
v_mfma_f32_16x16x32_bf16 v[76:79], a[184:187], a[40:43], v[76:79]
ds_read_b128 a[152:155], v21 offset:4480
v_cvt_pk_bf16_f32 v82, v68, v69
v_mfma_f32_16x16x32_bf16 v[76:79], a[188:191], a[44:47], v[76:79]
s_waitcnt lgkmcnt(7)
v_exp_f32 v70, v70
v_mfma_f32_16x16x32_bf16 v[144:147], a[240:243], v[84:87], v[144:147]
v_add_f32 v90, v90, v68
v_add_f32 v91, v91, v69
v_mfma_f32_16x16x32_bf16 v[148:151], a[244:247], v[84:87], v[148:151]
v_exp_f32 v71, v71
v_mfma_f32_16x16x32_bf16 v[152:155], a[248:251], v[84:87], v[152:155]
ds_read_b128 a[156:159], v21 offset:4544
v_cvt_pk_bf16_f32 v83, v70, v71
v_mfma_f32_16x16x32_bf16 v[156:159], a[252:255], v[84:87], v[156:159]
s_waitcnt lgkmcnt(4)
v_add_f32 v90, v90, v70
v_add_f32 v91, v91, v71
v_mfma_f32_16x16x32_bf16 v[64:67], a[128:131], a[0:3], v[96:99]
ds_read_b64_tr_b16 a[192:193], v22 offset:8704
v_exp_f32 v72, v72
v_mfma_f32_16x16x32_bf16 v[64:67], a[132:135], a[4:7], v[64:67]
ds_read_b64_tr_b16 a[194:195], v22 offset:13056
v_exp_f32 v73, v73
v_mfma_f32_16x16x32_bf16 v[64:67], a[136:139], a[8:11], v[64:67]
ds_read_b64_tr_b16 a[196:197], v23 offset:8736
v_cvt_pk_bf16_f32 v84, v72, v73
v_mfma_f32_16x16x32_bf16 v[64:67], a[140:143], a[12:15], v[64:67]
v_exp_f32 v74, v74
v_mfma_f32_16x16x32_bf16 v[160:163], a[224:227], v[80:83], v[160:163]
s_add_u32 m0, s38, 8704
ds_read_b64_tr_b16 a[198:199], v23 offset:13088
v_add_f32 v92, v92, v72
v_add_f32 v93, v93, v73
v_mfma_f32_16x16x32_bf16 v[164:167], a[228:231], v[80:83], v[164:167]
buffer_load_dwordx4 v25, s[20:23], s39 offen offset:0 nt lds
v_exp_f32 v75, v75
v_mfma_f32_16x16x32_bf16 v[168:171], a[232:235], v[80:83], v[168:171]
ds_read_b64_tr_b16 a[200:201], v22 offset:8768
v_cvt_pk_bf16_f32 v85, v74, v75
v_mfma_f32_16x16x32_bf16 v[172:175], a[236:239], v[80:83], v[172:175]
s_waitcnt lgkmcnt(5)
v_exp_f32 v76, v76
v_mfma_f32_16x16x32_bf16 v[68:71], a[144:147], a[0:3], v[96:99]
ds_read_b64_tr_b16 a[202:203], v22 offset:13120
v_add_f32 v92, v92, v74
v_add_f32 v93, v93, v75
v_mfma_f32_16x16x32_bf16 v[68:71], a[148:151], a[4:7], v[68:71]
v_exp_f32 v77, v77
v_mfma_f32_16x16x32_bf16 v[68:71], a[152:155], a[8:11], v[68:71]
ds_read_b64_tr_b16 a[204:205], v23 offset:8800
v_cvt_pk_bf16_f32 v86, v76, v77
v_mfma_f32_16x16x32_bf16 v[68:71], a[156:159], a[12:15], v[68:71]
v_exp_f32 v78, v78
v_mfma_f32_16x16x32_bf16 v[176:179], a[240:243], v[80:83], v[176:179]
v_add_f32 v92, v92, v76
v_add_f32 v93, v93, v77
v_mfma_f32_16x16x32_bf16 v[180:183], a[244:247], v[80:83], v[180:183]
v_exp_f32 v79, v79
v_mfma_f32_16x16x32_bf16 v[184:187], a[248:251], v[80:83], v[184:187]
ds_read_b64_tr_b16 a[206:207], v23 offset:13152
v_cvt_pk_bf16_f32 v87, v78, v79
v_mfma_f32_16x16x32_bf16 v[188:191], a[252:255], v[80:83], v[188:191]
s_waitcnt lgkmcnt(6)
v_add_f32 v92, v92, v78
v_add_f32 v93, v93, v79
v_mfma_f32_16x16x32_bf16 v[72:75], a[128:131], a[16:19], v[100:103]
ds_read_b64_tr_b16 a[208:209], v22 offset:8832
v_exp_f32 v64, v64
v_mfma_f32_16x16x32_bf16 v[72:75], a[132:135], a[20:23], v[72:75]
ds_read_b64_tr_b16 a[210:211], v22 offset:13184
v_exp_f32 v65, v65
v_mfma_f32_16x16x32_bf16 v[72:75], a[136:139], a[24:27], v[72:75]
ds_read_b64_tr_b16 a[212:213], v23 offset:8864
v_cvt_pk_bf16_f32 v80, v64, v65
v_mfma_f32_16x16x32_bf16 v[72:75], a[140:143], a[28:31], v[72:75]
v_exp_f32 v66, v66
v_mfma_f32_16x16x32_bf16 v[192:195], a[224:227], v[84:87], v[192:195]
s_add_u32 m0, s38, 64
ds_read_b64_tr_b16 a[214:215], v23 offset:13216
v_add_f32 v88, v88, v64
v_add_f32 v89, v89, v65
v_mfma_f32_16x16x32_bf16 v[196:199], a[228:231], v[84:87], v[196:199]
buffer_load_dwordx4 v24, s[16:19], s39 offen offset:1024 nt lds
v_exp_f32 v67, v67
v_mfma_f32_16x16x32_bf16 v[200:203], a[232:235], v[84:87], v[200:203]
ds_read_b64_tr_b16 a[216:217], v22 offset:8896
v_cvt_pk_bf16_f32 v81, v66, v67
v_mfma_f32_16x16x32_bf16 v[204:207], a[236:239], v[84:87], v[204:207]
v_exp_f32 v68, v68
v_mfma_f32_16x16x32_bf16 v[76:79], a[144:147], a[16:19], v[100:103]
ds_read_b64_tr_b16 a[218:219], v22 offset:13248
v_add_f32 v88, v88, v66
v_add_f32 v89, v89, v67
v_mfma_f32_16x16x32_bf16 v[76:79], a[148:151], a[20:23], v[76:79]
v_exp_f32 v69, v69
v_mfma_f32_16x16x32_bf16 v[76:79], a[152:155], a[24:27], v[76:79]
s_add_u32 m0, s38, 9536
ds_read_b64_tr_b16 a[220:221], v23 offset:8928
v_cvt_pk_bf16_f32 v82, v68, v69
v_mfma_f32_16x16x32_bf16 v[76:79], a[156:159], a[28:31], v[76:79]
buffer_load_dwordx4 v25, s[20:23], s39 offen offset:256 nt lds
v_exp_f32 v70, v70
v_mfma_f32_16x16x32_bf16 v[208:211], a[240:243], v[84:87], v[208:211]
v_add_f32 v88, v88, v68
v_add_f32 v89, v89, v69
v_mfma_f32_16x16x32_bf16 v[212:215], a[244:247], v[84:87], v[212:215]
v_exp_f32 v71, v71
v_mfma_f32_16x16x32_bf16 v[216:219], a[248:251], v[84:87], v[216:219]
ds_read_b64_tr_b16 a[222:223], v23 offset:13280
v_cvt_pk_bf16_f32 v83, v70, v71
v_mfma_f32_16x16x32_bf16 v[220:223], a[252:255], v[84:87], v[220:223]
s_waitcnt lgkmcnt(6)
s_add_u32 s101, s101, 8192
s_add_u32 s100, s100, s92
s_and_b32 s39, s100, 0xf800
s_and_b32 s93, s101, 0x40000
s_or_b32 s39, s39, s93
s_add_u32 s38, s38, 17408
s_cmp_eq_u32 s38, s71
s_cselect_b32 s38, s70, s38
v_add_f32 v88, v88, v70
v_add_f32 v89, v89, v71
s_waitcnt vmcnt(21)
s_barrier
v_mfma_f32_16x16x32_bf16 v[64:67], a[128:131], a[32:35], v[104:107]
ds_read_b128 a[160:163], v21 offset:17408
v_exp_f32 v72, v72
v_mfma_f32_16x16x32_bf16 v[64:67], a[132:135], a[36:39], v[64:67]
ds_read_b128 a[164:167], v21 offset:17472
v_exp_f32 v73, v73
v_mfma_f32_16x16x32_bf16 v[64:67], a[136:139], a[40:43], v[64:67]
ds_read_b128 a[168:171], v21 offset:17536
v_cvt_pk_bf16_f32 v84, v72, v73
v_mfma_f32_16x16x32_bf16 v[64:67], a[140:143], a[44:47], v[64:67]
v_exp_f32 v74, v74
v_mfma_f32_16x16x32_bf16 v[128:131], a[192:195], v[80:83], v[128:131]
s_add_u32 m0, s38, 0
ds_read_b128 a[172:175], v21 offset:17600
v_add_f32 v90, v90, v72
v_add_f32 v91, v91, v73
v_mfma_f32_16x16x32_bf16 v[132:135], a[196:199], v[80:83], v[132:135]
buffer_load_dwordx4 v24, s[16:19], s39 offen offset:0 nt lds
v_exp_f32 v75, v75
v_mfma_f32_16x16x32_bf16 v[136:139], a[200:203], v[80:83], v[136:139]
ds_read_b128 a[176:179], v21 offset:21760
v_cvt_pk_bf16_f32 v85, v74, v75
v_mfma_f32_16x16x32_bf16 v[140:143], a[204:207], v[80:83], v[140:143]
v_exp_f32 v76, v76
v_mfma_f32_16x16x32_bf16 v[68:71], a[144:147], a[32:35], v[104:107]
ds_read_b128 a[180:183], v21 offset:21824
v_add_f32 v90, v90, v74
v_add_f32 v91, v91, v75
v_mfma_f32_16x16x32_bf16 v[68:71], a[148:151], a[36:39], v[68:71]
v_exp_f32 v77, v77
v_mfma_f32_16x16x32_bf16 v[68:71], a[152:155], a[40:43], v[68:71]
ds_read_b128 a[184:187], v21 offset:21888
v_cvt_pk_bf16_f32 v86, v76, v77
v_mfma_f32_16x16x32_bf16 v[68:71], a[156:159], a[44:47], v[68:71]
s_waitcnt lgkmcnt(7)
v_exp_f32 v78, v78
v_mfma_f32_16x16x32_bf16 v[144:147], a[208:211], v[80:83], v[144:147]
v_add_f32 v90, v90, v76
v_add_f32 v91, v91, v77
v_mfma_f32_16x16x32_bf16 v[148:151], a[212:215], v[80:83], v[148:151]
v_exp_f32 v79, v79
v_mfma_f32_16x16x32_bf16 v[152:155], a[216:219], v[80:83], v[152:155]
ds_read_b128 a[188:191], v21 offset:21952
v_cvt_pk_bf16_f32 v87, v78, v79
v_mfma_f32_16x16x32_bf16 v[156:159], a[220:223], v[80:83], v[156:159]
s_waitcnt lgkmcnt(4)
v_add_f32 v90, v90, v78
v_add_f32 v91, v91, v79
v_mfma_f32_16x16x32_bf16 v[72:75], a[160:163], a[0:3], v[96:99]
ds_read_b64_tr_b16 a[224:225], v22 offset:26112
v_exp_f32 v64, v64
v_mfma_f32_16x16x32_bf16 v[72:75], a[164:167], a[4:7], v[72:75]
ds_read_b64_tr_b16 a[226:227], v22 offset:30464
v_exp_f32 v65, v65
v_mfma_f32_16x16x32_bf16 v[72:75], a[168:171], a[8:11], v[72:75]
ds_read_b64_tr_b16 a[228:229], v23 offset:26144
v_cvt_pk_bf16_f32 v80, v64, v65
v_mfma_f32_16x16x32_bf16 v[72:75], a[172:175], a[12:15], v[72:75]
v_exp_f32 v66, v66
v_mfma_f32_16x16x32_bf16 v[160:163], a[192:195], v[84:87], v[160:163]
s_add_u32 m0, s38, 8704
ds_read_b64_tr_b16 a[230:231], v23 offset:30496
v_add_f32 v92, v92, v64
v_add_f32 v93, v93, v65
v_mfma_f32_16x16x32_bf16 v[164:167], a[196:199], v[84:87], v[164:167]
buffer_load_dwordx4 v25, s[20:23], s39 offen offset:0 nt lds
v_exp_f32 v67, v67
v_mfma_f32_16x16x32_bf16 v[168:171], a[200:203], v[84:87], v[168:171]
ds_read_b64_tr_b16 a[232:233], v22 offset:26176
v_cvt_pk_bf16_f32 v81, v66, v67
v_mfma_f32_16x16x32_bf16 v[172:175], a[204:207], v[84:87], v[172:175]
s_waitcnt lgkmcnt(5)
v_exp_f32 v68, v68
v_mfma_f32_16x16x32_bf16 v[76:79], a[176:179], a[0:3], v[96:99]
ds_read_b64_tr_b16 a[234:235], v22 offset:30528
v_add_f32 v92, v92, v66
v_add_f32 v93, v93, v67
v_mfma_f32_16x16x32_bf16 v[76:79], a[180:183], a[4:7], v[76:79]
v_exp_f32 v69, v69
v_mfma_f32_16x16x32_bf16 v[76:79], a[184:187], a[8:11], v[76:79]
ds_read_b64_tr_b16 a[236:237], v23 offset:26208
v_cvt_pk_bf16_f32 v82, v68, v69
v_mfma_f32_16x16x32_bf16 v[76:79], a[188:191], a[12:15], v[76:79]
v_exp_f32 v70, v70
v_mfma_f32_16x16x32_bf16 v[176:179], a[208:211], v[84:87], v[176:179]
v_add_f32 v92, v92, v68
v_add_f32 v93, v93, v69
v_mfma_f32_16x16x32_bf16 v[180:183], a[212:215], v[84:87], v[180:183]
v_exp_f32 v71, v71
v_mfma_f32_16x16x32_bf16 v[184:187], a[216:219], v[84:87], v[184:187]
ds_read_b64_tr_b16 a[238:239], v23 offset:30560
v_cvt_pk_bf16_f32 v83, v70, v71
v_mfma_f32_16x16x32_bf16 v[188:191], a[220:223], v[84:87], v[188:191]
s_waitcnt lgkmcnt(6)
v_add_f32 v92, v92, v70
v_add_f32 v93, v93, v71
v_mfma_f32_16x16x32_bf16 v[64:67], a[160:163], a[16:19], v[100:103]
ds_read_b64_tr_b16 a[240:241], v22 offset:26240
v_exp_f32 v72, v72
v_mfma_f32_16x16x32_bf16 v[64:67], a[164:167], a[20:23], v[64:67]
ds_read_b64_tr_b16 a[242:243], v22 offset:30592
v_exp_f32 v73, v73
v_mfma_f32_16x16x32_bf16 v[64:67], a[168:171], a[24:27], v[64:67]
ds_read_b64_tr_b16 a[244:245], v23 offset:26272
v_cvt_pk_bf16_f32 v84, v72, v73
v_mfma_f32_16x16x32_bf16 v[64:67], a[172:175], a[28:31], v[64:67]
s_add_u32 s41, s41, 34816
v_exp_f32 v74, v74
v_mfma_f32_16x16x32_bf16 v[192:195], a[192:195], v[80:83], v[192:195]
s_add_u32 m0, s38, 64
ds_read_b64_tr_b16 a[246:247], v23 offset:30624
v_add_f32 v88, v88, v72
v_add_f32 v89, v89, v73
v_mfma_f32_16x16x32_bf16 v[196:199], a[196:199], v[80:83], v[196:199]
s_cmp_eq_u32 s41, 139264
buffer_load_dwordx4 v24, s[16:19], s39 offen offset:1024 nt lds
v_exp_f32 v75, v75
v_mfma_f32_16x16x32_bf16 v[200:203], a[200:203], v[80:83], v[200:203]
ds_read_b64_tr_b16 a[248:249], v22 offset:26304
v_cvt_pk_bf16_f32 v85, v74, v75
v_mfma_f32_16x16x32_bf16 v[204:207], a[204:207], v[80:83], v[204:207]
s_cselect_b32 s41, 0, s41
v_exp_f32 v76, v76
v_mfma_f32_16x16x32_bf16 v[68:71], a[176:179], a[16:19], v[100:103]
ds_read_b64_tr_b16 a[250:251], v22 offset:30656
v_add_f32 v88, v88, v74
v_add_f32 v89, v89, v75
v_mfma_f32_16x16x32_bf16 v[68:71], a[180:183], a[20:23], v[68:71]
v_exp_f32 v77, v77
v_mfma_f32_16x16x32_bf16 v[68:71], a[184:187], a[24:27], v[68:71]
s_add_u32 m0, s38, 9536
ds_read_b64_tr_b16 a[252:253], v23 offset:26336
v_cvt_pk_bf16_f32 v86, v76, v77
v_mfma_f32_16x16x32_bf16 v[68:71], a[188:191], a[28:31], v[68:71]
buffer_load_dwordx4 v25, s[20:23], s39 offen offset:256 nt lds
v_exp_f32 v78, v78
v_mfma_f32_16x16x32_bf16 v[208:211], a[208:211], v[80:83], v[208:211]
v_add_f32 v88, v88, v76
v_add_f32 v89, v89, v77
v_mfma_f32_16x16x32_bf16 v[212:215], a[212:215], v[80:83], v[212:215]
v_exp_f32 v79, v79
v_mfma_f32_16x16x32_bf16 v[216:219], a[216:219], v[80:83], v[216:219]
ds_read_b64_tr_b16 a[254:255], v23 offset:30688
v_cvt_pk_bf16_f32 v87, v78, v79
v_mfma_f32_16x16x32_bf16 v[220:223], a[220:223], v[80:83], v[220:223]
s_waitcnt lgkmcnt(6)
v_add_u32 v21, s41, v18
v_add_u32 v22, s41, v19
v_add_u32 v23, s41, v20
s_add_u32 s101, s101, 8192
s_add_u32 s100, s100, s92
s_and_b32 s39, s100, 0xf800
s_and_b32 s93, s101, 0x40000
s_or_b32 s39, s39, s93
s_add_u32 s38, s38, 17408
s_cmp_eq_u32 s38, s71
s_cselect_b32 s38, s70, s38
s_sub_u32 s32, s32, 1
s_cmp_lg_u32 s32, 0
v_add_f32 v88, v88, v78
v_add_f32 v89, v89, v79
s_waitcnt vmcnt(21)
s_barrier
v_mfma_f32_16x16x32_bf16 v[72:75], a[160:163], a[32:35], v[104:107]
ds_read_b128 a[128:131], v21 offset:0
v_exp_f32 v64, v64
v_mfma_f32_16x16x32_bf16 v[72:75], a[164:167], a[36:39], v[72:75]
ds_read_b128 a[132:135], v21 offset:64
v_exp_f32 v65, v65
v_mfma_f32_16x16x32_bf16 v[72:75], a[168:171], a[40:43], v[72:75]
ds_read_b128 a[136:139], v21 offset:128
v_cvt_pk_bf16_f32 v80, v64, v65
v_mfma_f32_16x16x32_bf16 v[72:75], a[172:175], a[44:47], v[72:75]
v_exp_f32 v66, v66
v_mfma_f32_16x16x32_bf16 v[128:131], a[224:227], v[84:87], v[128:131]
s_add_u32 m0, s38, 0
ds_read_b128 a[140:143], v21 offset:192
v_add_f32 v90, v90, v64
v_add_f32 v91, v91, v65
v_mfma_f32_16x16x32_bf16 v[132:135], a[228:231], v[84:87], v[132:135]
buffer_load_dwordx4 v24, s[16:19], s39 offen offset:0 nt lds
v_exp_f32 v67, v67
v_mfma_f32_16x16x32_bf16 v[136:139], a[232:235], v[84:87], v[136:139]
ds_read_b128 a[144:147], v21 offset:4352
v_cvt_pk_bf16_f32 v81, v66, v67
v_mfma_f32_16x16x32_bf16 v[140:143], a[236:239], v[84:87], v[140:143]
v_exp_f32 v68, v68
v_mfma_f32_16x16x32_bf16 v[76:79], a[176:179], a[32:35], v[104:107]
ds_read_b128 a[148:151], v21 offset:4416
v_add_f32 v90, v90, v66
v_add_f32 v91, v91, v67
v_mfma_f32_16x16x32_bf16 v[76:79], a[180:183], a[36:39], v[76:79]
v_exp_f32 v69, v69
v_mfma_f32_16x16x32_bf16 v[76:79], a[184:187], a[40:43], v[76:79]
ds_read_b128 a[152:155], v21 offset:4480
v_cvt_pk_bf16_f32 v82, v68, v69
v_mfma_f32_16x16x32_bf16 v[76:79], a[188:191], a[44:47], v[76:79]
s_waitcnt lgkmcnt(7)
v_exp_f32 v70, v70
v_mfma_f32_16x16x32_bf16 v[144:147], a[240:243], v[84:87], v[144:147]
v_add_f32 v90, v90, v68
v_add_f32 v91, v91, v69
v_mfma_f32_16x16x32_bf16 v[148:151], a[244:247], v[84:87], v[148:151]
v_exp_f32 v71, v71
v_mfma_f32_16x16x32_bf16 v[152:155], a[248:251], v[84:87], v[152:155]
ds_read_b128 a[156:159], v21 offset:4544
v_cvt_pk_bf16_f32 v83, v70, v71
v_mfma_f32_16x16x32_bf16 v[156:159], a[252:255], v[84:87], v[156:159]
s_waitcnt lgkmcnt(4)
v_add_f32 v90, v90, v70
v_add_f32 v91, v91, v71
v_mfma_f32_16x16x32_bf16 v[64:67], a[128:131], a[0:3], v[96:99]
ds_read_b64_tr_b16 a[192:193], v22 offset:8704
v_exp_f32 v72, v72
v_mfma_f32_16x16x32_bf16 v[64:67], a[132:135], a[4:7], v[64:67]
ds_read_b64_tr_b16 a[194:195], v22 offset:13056
v_exp_f32 v73, v73
v_mfma_f32_16x16x32_bf16 v[64:67], a[136:139], a[8:11], v[64:67]
ds_read_b64_tr_b16 a[196:197], v23 offset:8736
v_cvt_pk_bf16_f32 v84, v72, v73
v_mfma_f32_16x16x32_bf16 v[64:67], a[140:143], a[12:15], v[64:67]
v_exp_f32 v74, v74
v_mfma_f32_16x16x32_bf16 v[160:163], a[224:227], v[80:83], v[160:163]
s_add_u32 m0, s38, 8704
ds_read_b64_tr_b16 a[198:199], v23 offset:13088
v_add_f32 v92, v92, v72
v_add_f32 v93, v93, v73
v_mfma_f32_16x16x32_bf16 v[164:167], a[228:231], v[80:83], v[164:167]
buffer_load_dwordx4 v25, s[20:23], s39 offen offset:0 nt lds
v_exp_f32 v75, v75
v_mfma_f32_16x16x32_bf16 v[168:171], a[232:235], v[80:83], v[168:171]
ds_read_b64_tr_b16 a[200:201], v22 offset:8768
v_cvt_pk_bf16_f32 v85, v74, v75
v_mfma_f32_16x16x32_bf16 v[172:175], a[236:239], v[80:83], v[172:175]
s_waitcnt lgkmcnt(5)
v_exp_f32 v76, v76
v_mfma_f32_16x16x32_bf16 v[68:71], a[144:147], a[0:3], v[96:99]
ds_read_b64_tr_b16 a[202:203], v22 offset:13120
v_add_f32 v92, v92, v74
v_add_f32 v93, v93, v75
v_mfma_f32_16x16x32_bf16 v[68:71], a[148:151], a[4:7], v[68:71]
v_exp_f32 v77, v77
v_mfma_f32_16x16x32_bf16 v[68:71], a[152:155], a[8:11], v[68:71]
ds_read_b64_tr_b16 a[204:205], v23 offset:8800
v_cvt_pk_bf16_f32 v86, v76, v77
v_mfma_f32_16x16x32_bf16 v[68:71], a[156:159], a[12:15], v[68:71]
v_exp_f32 v78, v78
v_mfma_f32_16x16x32_bf16 v[176:179], a[240:243], v[80:83], v[176:179]
v_add_f32 v92, v92, v76
v_add_f32 v93, v93, v77
v_mfma_f32_16x16x32_bf16 v[180:183], a[244:247], v[80:83], v[180:183]
v_exp_f32 v79, v79
v_mfma_f32_16x16x32_bf16 v[184:187], a[248:251], v[80:83], v[184:187]
ds_read_b64_tr_b16 a[206:207], v23 offset:13152
v_cvt_pk_bf16_f32 v87, v78, v79
v_mfma_f32_16x16x32_bf16 v[188:191], a[252:255], v[80:83], v[188:191]
s_waitcnt lgkmcnt(6)
v_add_f32 v92, v92, v78
v_add_f32 v93, v93, v79
v_mfma_f32_16x16x32_bf16 v[72:75], a[128:131], a[16:19], v[100:103]
ds_read_b64_tr_b16 a[208:209], v22 offset:8832
v_exp_f32 v64, v64
v_mfma_f32_16x16x32_bf16 v[72:75], a[132:135], a[20:23], v[72:75]
ds_read_b64_tr_b16 a[210:211], v22 offset:13184
v_exp_f32 v65, v65
v_mfma_f32_16x16x32_bf16 v[72:75], a[136:139], a[24:27], v[72:75]
ds_read_b64_tr_b16 a[212:213], v23 offset:8864
v_cvt_pk_bf16_f32 v80, v64, v65
v_mfma_f32_16x16x32_bf16 v[72:75], a[140:143], a[28:31], v[72:75]
v_exp_f32 v66, v66
v_mfma_f32_16x16x32_bf16 v[192:195], a[224:227], v[84:87], v[192:195]
s_add_u32 m0, s38, 64
ds_read_b64_tr_b16 a[214:215], v23 offset:13216
v_add_f32 v88, v88, v64
v_add_f32 v89, v89, v65
v_mfma_f32_16x16x32_bf16 v[196:199], a[228:231], v[84:87], v[196:199]
buffer_load_dwordx4 v24, s[16:19], s39 offen offset:1024 nt lds
v_exp_f32 v67, v67
v_mfma_f32_16x16x32_bf16 v[200:203], a[232:235], v[84:87], v[200:203]
ds_read_b64_tr_b16 a[216:217], v22 offset:8896
v_cvt_pk_bf16_f32 v81, v66, v67
v_mfma_f32_16x16x32_bf16 v[204:207], a[236:239], v[84:87], v[204:207]
v_exp_f32 v68, v68
v_mfma_f32_16x16x32_bf16 v[76:79], a[144:147], a[16:19], v[100:103]
ds_read_b64_tr_b16 a[218:219], v22 offset:13248
v_add_f32 v88, v88, v66
v_add_f32 v89, v89, v67
v_mfma_f32_16x16x32_bf16 v[76:79], a[148:151], a[20:23], v[76:79]
v_exp_f32 v69, v69
v_mfma_f32_16x16x32_bf16 v[76:79], a[152:155], a[24:27], v[76:79]
s_add_u32 m0, s38, 9536
ds_read_b64_tr_b16 a[220:221], v23 offset:8928
v_cvt_pk_bf16_f32 v82, v68, v69
v_mfma_f32_16x16x32_bf16 v[76:79], a[156:159], a[28:31], v[76:79]
buffer_load_dwordx4 v25, s[20:23], s39 offen offset:256 nt lds
v_exp_f32 v70, v70
v_mfma_f32_16x16x32_bf16 v[208:211], a[240:243], v[84:87], v[208:211]
v_add_f32 v88, v88, v68
v_add_f32 v89, v89, v69
v_mfma_f32_16x16x32_bf16 v[212:215], a[244:247], v[84:87], v[212:215]
v_exp_f32 v71, v71
v_mfma_f32_16x16x32_bf16 v[216:219], a[248:251], v[84:87], v[216:219]
ds_read_b64_tr_b16 a[222:223], v23 offset:13280
v_cvt_pk_bf16_f32 v83, v70, v71
v_mfma_f32_16x16x32_bf16 v[220:223], a[252:255], v[84:87], v[220:223]
s_waitcnt lgkmcnt(6)
s_add_u32 s101, s101, 8192
s_add_u32 s100, s100, s92
s_and_b32 s39, s100, 0xf800
s_and_b32 s93, s101, 0x40000
s_or_b32 s39, s39, s93
s_add_u32 s38, s38, 17408
s_cmp_eq_u32 s38, s71
s_cselect_b32 s38, s70, s38
v_add_f32 v88, v88, v70
v_add_f32 v89, v89, v71
s_waitcnt vmcnt(20)
s_barrier
v_mfma_f32_16x16x32_bf16 v[64:67], a[128:131], a[32:35], v[104:107]
ds_read_b128 a[160:163], v21 offset:17408
v_exp_f32 v72, v72
v_mfma_f32_16x16x32_bf16 v[64:67], a[132:135], a[36:39], v[64:67]
ds_read_b128 a[164:167], v21 offset:17472
v_exp_f32 v73, v73
v_mfma_f32_16x16x32_bf16 v[64:67], a[136:139], a[40:43], v[64:67]
ds_read_b128 a[168:171], v21 offset:17536
v_cvt_pk_bf16_f32 v84, v72, v73
v_mfma_f32_16x16x32_bf16 v[64:67], a[140:143], a[44:47], v[64:67]
v_exp_f32 v74, v74
v_mfma_f32_16x16x32_bf16 v[128:131], a[192:195], v[80:83], v[128:131]
s_add_u32 m0, s38, 0
ds_read_b128 a[172:175], v21 offset:17600
v_add_f32 v90, v90, v72
v_add_f32 v91, v91, v73
v_mfma_f32_16x16x32_bf16 v[132:135], a[196:199], v[80:83], v[132:135]
buffer_load_dwordx4 v24, s[16:19], s39 offen offset:0 nt lds
v_exp_f32 v75, v75
v_mfma_f32_16x16x32_bf16 v[136:139], a[200:203], v[80:83], v[136:139]
ds_read_b128 a[176:179], v21 offset:21760
v_cvt_pk_bf16_f32 v85, v74, v75
v_mfma_f32_16x16x32_bf16 v[140:143], a[204:207], v[80:83], v[140:143]
v_exp_f32 v76, v76
v_mfma_f32_16x16x32_bf16 v[68:71], a[144:147], a[32:35], v[104:107]
ds_read_b128 a[180:183], v21 offset:21824
v_add_f32 v90, v90, v74
v_add_f32 v91, v91, v75
v_mfma_f32_16x16x32_bf16 v[68:71], a[148:151], a[36:39], v[68:71]
v_exp_f32 v77, v77
v_mfma_f32_16x16x32_bf16 v[68:71], a[152:155], a[40:43], v[68:71]
ds_read_b128 a[184:187], v21 offset:21888
v_cvt_pk_bf16_f32 v86, v76, v77
v_mfma_f32_16x16x32_bf16 v[68:71], a[156:159], a[44:47], v[68:71]
s_waitcnt lgkmcnt(7)
v_exp_f32 v78, v78
v_mfma_f32_16x16x32_bf16 v[144:147], a[208:211], v[80:83], v[144:147]
v_add_f32 v90, v90, v76
v_add_f32 v91, v91, v77
v_mfma_f32_16x16x32_bf16 v[148:151], a[212:215], v[80:83], v[148:151]
v_exp_f32 v79, v79
v_mfma_f32_16x16x32_bf16 v[152:155], a[216:219], v[80:83], v[152:155]
ds_read_b128 a[188:191], v21 offset:21952
v_cvt_pk_bf16_f32 v87, v78, v79
v_mfma_f32_16x16x32_bf16 v[156:159], a[220:223], v[80:83], v[156:159]
s_waitcnt lgkmcnt(4)
v_add_f32 v90, v90, v78
v_add_f32 v91, v91, v79
v_mfma_f32_16x16x32_bf16 v[72:75], a[160:163], a[0:3], v[96:99]
ds_read_b64_tr_b16 a[224:225], v22 offset:26112
v_exp_f32 v64, v64
v_mfma_f32_16x16x32_bf16 v[72:75], a[164:167], a[4:7], v[72:75]
ds_read_b64_tr_b16 a[226:227], v22 offset:30464
v_exp_f32 v65, v65
v_mfma_f32_16x16x32_bf16 v[72:75], a[168:171], a[8:11], v[72:75]
ds_read_b64_tr_b16 a[228:229], v23 offset:26144
v_cvt_pk_bf16_f32 v80, v64, v65
v_mfma_f32_16x16x32_bf16 v[72:75], a[172:175], a[12:15], v[72:75]
v_exp_f32 v66, v66
v_mfma_f32_16x16x32_bf16 v[160:163], a[192:195], v[84:87], v[160:163]
s_add_u32 m0, s38, 8704
ds_read_b64_tr_b16 a[230:231], v23 offset:30496
v_add_f32 v92, v92, v64
v_add_f32 v93, v93, v65
v_mfma_f32_16x16x32_bf16 v[164:167], a[196:199], v[84:87], v[164:167]
buffer_load_dwordx4 v25, s[20:23], s39 offen offset:0 nt lds
v_exp_f32 v67, v67
v_mfma_f32_16x16x32_bf16 v[168:171], a[200:203], v[84:87], v[168:171]
ds_read_b64_tr_b16 a[232:233], v22 offset:26176
v_cvt_pk_bf16_f32 v81, v66, v67
v_mfma_f32_16x16x32_bf16 v[172:175], a[204:207], v[84:87], v[172:175]
s_waitcnt lgkmcnt(5)
v_exp_f32 v68, v68
v_mfma_f32_16x16x32_bf16 v[76:79], a[176:179], a[0:3], v[96:99]
ds_read_b64_tr_b16 a[234:235], v22 offset:30528
v_add_f32 v92, v92, v66
v_add_f32 v93, v93, v67
v_mfma_f32_16x16x32_bf16 v[76:79], a[180:183], a[4:7], v[76:79]
v_exp_f32 v69, v69
v_mfma_f32_16x16x32_bf16 v[76:79], a[184:187], a[8:11], v[76:79]
ds_read_b64_tr_b16 a[236:237], v23 offset:26208
v_cvt_pk_bf16_f32 v82, v68, v69
v_mfma_f32_16x16x32_bf16 v[76:79], a[188:191], a[12:15], v[76:79]
v_exp_f32 v70, v70
v_mfma_f32_16x16x32_bf16 v[176:179], a[208:211], v[84:87], v[176:179]
v_add_f32 v92, v92, v68
v_add_f32 v93, v93, v69
v_mfma_f32_16x16x32_bf16 v[180:183], a[212:215], v[84:87], v[180:183]
v_exp_f32 v71, v71
v_mfma_f32_16x16x32_bf16 v[184:187], a[216:219], v[84:87], v[184:187]
ds_read_b64_tr_b16 a[238:239], v23 offset:30560
v_cvt_pk_bf16_f32 v83, v70, v71
v_mfma_f32_16x16x32_bf16 v[188:191], a[220:223], v[84:87], v[188:191]
s_waitcnt lgkmcnt(6)
v_add_f32 v92, v92, v70
v_add_f32 v93, v93, v71
v_mfma_f32_16x16x32_bf16 v[64:67], a[160:163], a[16:19], v[100:103]
ds_read_b64_tr_b16 a[240:241], v22 offset:26240
v_exp_f32 v72, v72
v_mfma_f32_16x16x32_bf16 v[64:67], a[164:167], a[20:23], v[64:67]
ds_read_b64_tr_b16 a[242:243], v22 offset:30592
v_exp_f32 v73, v73
v_mfma_f32_16x16x32_bf16 v[64:67], a[168:171], a[24:27], v[64:67]
ds_read_b64_tr_b16 a[244:245], v23 offset:26272
v_cvt_pk_bf16_f32 v84, v72, v73
v_mfma_f32_16x16x32_bf16 v[64:67], a[172:175], a[28:31], v[64:67]
s_add_u32 s41, s41, 34816
v_exp_f32 v74, v74
v_mfma_f32_16x16x32_bf16 v[192:195], a[192:195], v[80:83], v[192:195]
s_add_u32 m0, s38, 64
ds_read_b64_tr_b16 a[246:247], v23 offset:30624
v_add_f32 v88, v88, v72
v_add_f32 v89, v89, v73
v_mfma_f32_16x16x32_bf16 v[196:199], a[196:199], v[80:83], v[196:199]
s_cmp_eq_u32 s41, 139264
buffer_load_dwordx4 v24, s[16:19], s39 offen offset:1024 nt lds
v_exp_f32 v75, v75
v_mfma_f32_16x16x32_bf16 v[200:203], a[200:203], v[80:83], v[200:203]
ds_read_b64_tr_b16 a[248:249], v22 offset:26304
v_cvt_pk_bf16_f32 v85, v74, v75
v_mfma_f32_16x16x32_bf16 v[204:207], a[204:207], v[80:83], v[204:207]
s_cselect_b32 s41, 0, s41
v_exp_f32 v76, v76
v_mfma_f32_16x16x32_bf16 v[68:71], a[176:179], a[16:19], v[100:103]
ds_read_b64_tr_b16 a[250:251], v22 offset:30656
v_add_f32 v88, v88, v74
v_add_f32 v89, v89, v75
v_mfma_f32_16x16x32_bf16 v[68:71], a[180:183], a[20:23], v[68:71]
v_exp_f32 v77, v77
v_mfma_f32_16x16x32_bf16 v[68:71], a[184:187], a[24:27], v[68:71]
s_add_u32 m0, s38, 9536
ds_read_b64_tr_b16 a[252:253], v23 offset:26336
v_cvt_pk_bf16_f32 v86, v76, v77
v_mfma_f32_16x16x32_bf16 v[68:71], a[188:191], a[28:31], v[68:71]
buffer_load_dwordx4 v25, s[20:23], s39 offen offset:256 nt lds
v_exp_f32 v78, v78
v_mfma_f32_16x16x32_bf16 v[208:211], a[208:211], v[80:83], v[208:211]
v_add_f32 v88, v88, v76
v_add_f32 v89, v89, v77
v_mfma_f32_16x16x32_bf16 v[212:215], a[212:215], v[80:83], v[212:215]
v_exp_f32 v79, v79
v_mfma_f32_16x16x32_bf16 v[216:219], a[216:219], v[80:83], v[216:219]
ds_read_b64_tr_b16 a[254:255], v23 offset:30688
v_cvt_pk_bf16_f32 v87, v78, v79
v_mfma_f32_16x16x32_bf16 v[220:223], a[220:223], v[80:83], v[220:223]
s_waitcnt lgkmcnt(6)
v_add_u32 v21, s41, v18
v_add_u32 v22, s41, v19
v_add_u32 v23, s41, v20
s_add_u32 s101, s101, 8192
s_add_u32 s100, s100, s92
s_and_b32 s39, s100, 0xf800
s_and_b32 s93, s101, 0x40000
s_or_b32 s39, s39, s93
s_add_u32 s38, s38, 17408
s_cmp_eq_u32 s38, s71
s_cselect_b32 s38, s70, s38
s_sub_u32 s32, s32, 1
s_cmp_lg_u32 s32, 0
v_add_f32 v88, v88, v78
v_add_f32 v89, v89, v79
s_mov_b32 s32, 13
L_at3_1:
s_waitcnt vmcnt(20)
s_barrier
v_mfma_f32_16x16x32_bf16 v[72:75], a[160:163], a[32:35], v[104:107]
ds_read_b128 a[128:131], v21 offset:0
v_exp_f32 v64, v64
v_mfma_f32_16x16x32_bf16 v[72:75], a[164:167], a[36:39], v[72:75]
ds_read_b128 a[132:135], v21 offset:64
v_exp_f32 v65, v65
v_mfma_f32_16x16x32_bf16 v[72:75], a[168:171], a[40:43], v[72:75]
ds_read_b128 a[136:139], v21 offset:128
v_cvt_pk_bf16_f32 v80, v64, v65
v_mfma_f32_16x16x32_bf16 v[72:75], a[172:175], a[44:47], v[72:75]
v_exp_f32 v66, v66
v_mfma_f32_16x16x32_bf16 v[128:131], a[224:227], v[84:87], v[128:131]
s_add_u32 m0, s38, 0
ds_read_b128 a[140:143], v21 offset:192
v_add_f32 v90, v90, v64
v_add_f32 v91, v91, v65
v_mfma_f32_16x16x32_bf16 v[132:135], a[228:231], v[84:87], v[132:135]
buffer_load_dwordx4 v24, s[16:19], s39 offen offset:0 nt lds
v_exp_f32 v67, v67
v_mfma_f32_16x16x32_bf16 v[136:139], a[232:235], v[84:87], v[136:139]
ds_read_b128 a[144:147], v21 offset:4352
v_cvt_pk_bf16_f32 v81, v66, v67
v_mfma_f32_16x16x32_bf16 v[140:143], a[236:239], v[84:87], v[140:143]
v_exp_f32 v68, v68
v_mfma_f32_16x16x32_bf16 v[76:79], a[176:179], a[32:35], v[104:107]
ds_read_b128 a[148:151], v21 offset:4416
v_add_f32 v90, v90, v66
v_add_f32 v91, v91, v67
v_mfma_f32_16x16x32_bf16 v[76:79], a[180:183], a[36:39], v[76:79]
v_exp_f32 v69, v69
v_mfma_f32_16x16x32_bf16 v[76:79], a[184:187], a[40:43], v[76:79]
ds_read_b128 a[152:155], v21 offset:4480
v_cvt_pk_bf16_f32 v82, v68, v69
v_mfma_f32_16x16x32_bf16 v[76:79], a[188:191], a[44:47], v[76:79]
s_waitcnt lgkmcnt(7)
v_exp_f32 v70, v70
v_mfma_f32_16x16x32_bf16 v[144:147], a[240:243], v[84:87], v[144:147]
v_add_f32 v90, v90, v68
v_add_f32 v91, v91, v69
v_mfma_f32_16x16x32_bf16 v[148:151], a[244:247], v[84:87], v[148:151]
v_exp_f32 v71, v71
v_mfma_f32_16x16x32_bf16 v[152:155], a[248:251], v[84:87], v[152:155]
ds_read_b128 a[156:159], v21 offset:4544
v_cvt_pk_bf16_f32 v83, v70, v71
v_mfma_f32_16x16x32_bf16 v[156:159], a[252:255], v[84:87], v[156:159]
s_waitcnt lgkmcnt(4)
v_add_f32 v90, v90, v70
v_add_f32 v91, v91, v71
v_mfma_f32_16x16x32_bf16 v[64:67], a[128:131], a[0:3], v[96:99]
ds_read_b64_tr_b16 a[192:193], v22 offset:8704
v_exp_f32 v72, v72
v_mfma_f32_16x16x32_bf16 v[64:67], a[132:135], a[4:7], v[64:67]
ds_read_b64_tr_b16 a[194:195], v22 offset:13056
v_exp_f32 v73, v73
v_mfma_f32_16x16x32_bf16 v[64:67], a[136:139], a[8:11], v[64:67]
ds_read_b64_tr_b16 a[196:197], v23 offset:8736
v_cvt_pk_bf16_f32 v84, v72, v73
v_mfma_f32_16x16x32_bf16 v[64:67], a[140:143], a[12:15], v[64:67]
v_exp_f32 v74, v74
v_mfma_f32_16x16x32_bf16 v[160:163], a[224:227], v[80:83], v[160:163]
s_add_u32 m0, s38, 8704
ds_read_b64_tr_b16 a[198:199], v23 offset:13088
v_add_f32 v92, v92, v72
v_add_f32 v93, v93, v73
v_mfma_f32_16x16x32_bf16 v[164:167], a[228:231], v[80:83], v[164:167]
buffer_load_dwordx4 v25, s[20:23], s39 offen offset:0 nt lds
v_exp_f32 v75, v75
v_mfma_f32_16x16x32_bf16 v[168:171], a[232:235], v[80:83], v[168:171]
ds_read_b64_tr_b16 a[200:201], v22 offset:8768
v_cvt_pk_bf16_f32 v85, v74, v75
v_mfma_f32_16x16x32_bf16 v[172:175], a[236:239], v[80:83], v[172:175]
s_waitcnt lgkmcnt(5)
v_exp_f32 v76, v76
v_mfma_f32_16x16x32_bf16 v[68:71], a[144:147], a[0:3], v[96:99]
ds_read_b64_tr_b16 a[202:203], v22 offset:13120
v_add_f32 v92, v92, v74
v_add_f32 v93, v93, v75
v_mfma_f32_16x16x32_bf16 v[68:71], a[148:151], a[4:7], v[68:71]
v_exp_f32 v77, v77
v_mfma_f32_16x16x32_bf16 v[68:71], a[152:155], a[8:11], v[68:71]
ds_read_b64_tr_b16 a[204:205], v23 offset:8800
v_cvt_pk_bf16_f32 v86, v76, v77
v_mfma_f32_16x16x32_bf16 v[68:71], a[156:159], a[12:15], v[68:71]
v_exp_f32 v78, v78
v_mfma_f32_16x16x32_bf16 v[176:179], a[240:243], v[80:83], v[176:179]
v_add_f32 v92, v92, v76
v_add_f32 v93, v93, v77
v_mfma_f32_16x16x32_bf16 v[180:183], a[244:247], v[80:83], v[180:183]
v_exp_f32 v79, v79
v_mfma_f32_16x16x32_bf16 v[184:187], a[248:251], v[80:83], v[184:187]
ds_read_b64_tr_b16 a[206:207], v23 offset:13152
v_cvt_pk_bf16_f32 v87, v78, v79
v_mfma_f32_16x16x32_bf16 v[188:191], a[252:255], v[80:83], v[188:191]
s_waitcnt lgkmcnt(6)
v_add_f32 v92, v92, v78
v_add_f32 v93, v93, v79
v_mfma_f32_16x16x32_bf16 v[72:75], a[128:131], a[16:19], v[100:103]
ds_read_b64_tr_b16 a[208:209], v22 offset:8832
v_exp_f32 v64, v64
v_mfma_f32_16x16x32_bf16 v[72:75], a[132:135], a[20:23], v[72:75]
ds_read_b64_tr_b16 a[210:211], v22 offset:13184
v_exp_f32 v65, v65
v_mfma_f32_16x16x32_bf16 v[72:75], a[136:139], a[24:27], v[72:75]
ds_read_b64_tr_b16 a[212:213], v23 offset:8864
v_cvt_pk_bf16_f32 v80, v64, v65
v_mfma_f32_16x16x32_bf16 v[72:75], a[140:143], a[28:31], v[72:75]
v_exp_f32 v66, v66
v_mfma_f32_16x16x32_bf16 v[192:195], a[224:227], v[84:87], v[192:195]
s_add_u32 m0, s38, 64
ds_read_b64_tr_b16 a[214:215], v23 offset:13216
v_add_f32 v88, v88, v64
v_add_f32 v89, v89, v65
v_mfma_f32_16x16x32_bf16 v[196:199], a[228:231], v[84:87], v[196:199]
buffer_load_dwordx4 v24, s[16:19], s39 offen offset:1024 nt lds
v_exp_f32 v67, v67
v_mfma_f32_16x16x32_bf16 v[200:203], a[232:235], v[84:87], v[200:203]
ds_read_b64_tr_b16 a[216:217], v22 offset:8896
v_cvt_pk_bf16_f32 v81, v66, v67
v_mfma_f32_16x16x32_bf16 v[204:207], a[236:239], v[84:87], v[204:207]
v_exp_f32 v68, v68
v_mfma_f32_16x16x32_bf16 v[76:79], a[144:147], a[16:19], v[100:103]
ds_read_b64_tr_b16 a[218:219], v22 offset:13248
v_add_f32 v88, v88, v66
v_add_f32 v89, v89, v67
v_mfma_f32_16x16x32_bf16 v[76:79], a[148:151], a[20:23], v[76:79]
v_exp_f32 v69, v69
v_mfma_f32_16x16x32_bf16 v[76:79], a[152:155], a[24:27], v[76:79]
s_add_u32 m0, s38, 9536
ds_read_b64_tr_b16 a[220:221], v23 offset:8928
v_cvt_pk_bf16_f32 v82, v68, v69
v_mfma_f32_16x16x32_bf16 v[76:79], a[156:159], a[28:31], v[76:79]
buffer_load_dwordx4 v25, s[20:23], s39 offen offset:256 nt lds
v_exp_f32 v70, v70
v_mfma_f32_16x16x32_bf16 v[208:211], a[240:243], v[84:87], v[208:211]
v_add_f32 v88, v88, v68
v_add_f32 v89, v89, v69
v_mfma_f32_16x16x32_bf16 v[212:215], a[244:247], v[84:87], v[212:215]
v_exp_f32 v71, v71
v_mfma_f32_16x16x32_bf16 v[216:219], a[248:251], v[84:87], v[216:219]
ds_read_b64_tr_b16 a[222:223], v23 offset:13280
v_cvt_pk_bf16_f32 v83, v70, v71
v_mfma_f32_16x16x32_bf16 v[220:223], a[252:255], v[84:87], v[220:223]
s_waitcnt lgkmcnt(6)
s_add_u32 s101, s101, 8192
s_add_u32 s100, s100, s92
s_and_b32 s39, s100, 0xf800
s_and_b32 s93, s101, 0x40000
s_or_b32 s39, s39, s93
s_add_u32 s38, s38, 17408
s_cmp_eq_u32 s38, s71
s_cselect_b32 s38, s70, s38
v_add_f32 v88, v88, v70
v_add_f32 v89, v89, v71
s_waitcnt vmcnt(20)
s_barrier
v_mfma_f32_16x16x32_bf16 v[64:67], a[128:131], a[32:35], v[104:107]
ds_read_b128 a[160:163], v21 offset:17408
v_exp_f32 v72, v72
v_mfma_f32_16x16x32_bf16 v[64:67], a[132:135], a[36:39], v[64:67]
ds_read_b128 a[164:167], v21 offset:17472
v_exp_f32 v73, v73
v_mfma_f32_16x16x32_bf16 v[64:67], a[136:139], a[40:43], v[64:67]
ds_read_b128 a[168:171], v21 offset:17536
v_cvt_pk_bf16_f32 v84, v72, v73
v_mfma_f32_16x16x32_bf16 v[64:67], a[140:143], a[44:47], v[64:67]
v_exp_f32 v74, v74
v_mfma_f32_16x16x32_bf16 v[128:131], a[192:195], v[80:83], v[128:131]
s_add_u32 m0, s38, 0
ds_read_b128 a[172:175], v21 offset:17600
v_add_f32 v90, v90, v72
v_add_f32 v91, v91, v73
v_mfma_f32_16x16x32_bf16 v[132:135], a[196:199], v[80:83], v[132:135]
buffer_load_dwordx4 v24, s[16:19], s39 offen offset:0 nt lds
v_exp_f32 v75, v75
v_mfma_f32_16x16x32_bf16 v[136:139], a[200:203], v[80:83], v[136:139]
ds_read_b128 a[176:179], v21 offset:21760
v_cvt_pk_bf16_f32 v85, v74, v75
v_mfma_f32_16x16x32_bf16 v[140:143], a[204:207], v[80:83], v[140:143]
v_exp_f32 v76, v76
v_mfma_f32_16x16x32_bf16 v[68:71], a[144:147], a[32:35], v[104:107]
ds_read_b128 a[180:183], v21 offset:21824
v_add_f32 v90, v90, v74
v_add_f32 v91, v91, v75
v_mfma_f32_16x16x32_bf16 v[68:71], a[148:151], a[36:39], v[68:71]
v_exp_f32 v77, v77
v_mfma_f32_16x16x32_bf16 v[68:71], a[152:155], a[40:43], v[68:71]
ds_read_b128 a[184:187], v21 offset:21888
v_cvt_pk_bf16_f32 v86, v76, v77
v_mfma_f32_16x16x32_bf16 v[68:71], a[156:159], a[44:47], v[68:71]
s_waitcnt lgkmcnt(7)
v_exp_f32 v78, v78
v_mfma_f32_16x16x32_bf16 v[144:147], a[208:211], v[80:83], v[144:147]
v_add_f32 v90, v90, v76
v_add_f32 v91, v91, v77
v_mfma_f32_16x16x32_bf16 v[148:151], a[212:215], v[80:83], v[148:151]
v_exp_f32 v79, v79
v_mfma_f32_16x16x32_bf16 v[152:155], a[216:219], v[80:83], v[152:155]
ds_read_b128 a[188:191], v21 offset:21952
v_cvt_pk_bf16_f32 v87, v78, v79
v_mfma_f32_16x16x32_bf16 v[156:159], a[220:223], v[80:83], v[156:159]
s_waitcnt lgkmcnt(4)
v_add_f32 v90, v90, v78
v_add_f32 v91, v91, v79
v_mfma_f32_16x16x32_bf16 v[72:75], a[160:163], a[0:3], v[96:99]
ds_read_b64_tr_b16 a[224:225], v22 offset:26112
v_exp_f32 v64, v64
v_mfma_f32_16x16x32_bf16 v[72:75], a[164:167], a[4:7], v[72:75]
ds_read_b64_tr_b16 a[226:227], v22 offset:30464
v_exp_f32 v65, v65
v_mfma_f32_16x16x32_bf16 v[72:75], a[168:171], a[8:11], v[72:75]
ds_read_b64_tr_b16 a[228:229], v23 offset:26144
v_cvt_pk_bf16_f32 v80, v64, v65
v_mfma_f32_16x16x32_bf16 v[72:75], a[172:175], a[12:15], v[72:75]
v_exp_f32 v66, v66
v_mfma_f32_16x16x32_bf16 v[160:163], a[192:195], v[84:87], v[160:163]
s_add_u32 m0, s38, 8704
ds_read_b64_tr_b16 a[230:231], v23 offset:30496
v_add_f32 v92, v92, v64
v_add_f32 v93, v93, v65
v_mfma_f32_16x16x32_bf16 v[164:167], a[196:199], v[84:87], v[164:167]
buffer_load_dwordx4 v25, s[20:23], s39 offen offset:0 nt lds
v_exp_f32 v67, v67
v_mfma_f32_16x16x32_bf16 v[168:171], a[200:203], v[84:87], v[168:171]
ds_read_b64_tr_b16 a[232:233], v22 offset:26176
v_cvt_pk_bf16_f32 v81, v66, v67
v_mfma_f32_16x16x32_bf16 v[172:175], a[204:207], v[84:87], v[172:175]
s_waitcnt lgkmcnt(5)
v_exp_f32 v68, v68
v_mfma_f32_16x16x32_bf16 v[76:79], a[176:179], a[0:3], v[96:99]
ds_read_b64_tr_b16 a[234:235], v22 offset:30528
v_add_f32 v92, v92, v66
v_add_f32 v93, v93, v67
v_mfma_f32_16x16x32_bf16 v[76:79], a[180:183], a[4:7], v[76:79]
v_exp_f32 v69, v69
v_mfma_f32_16x16x32_bf16 v[76:79], a[184:187], a[8:11], v[76:79]
ds_read_b64_tr_b16 a[236:237], v23 offset:26208
v_cvt_pk_bf16_f32 v82, v68, v69
v_mfma_f32_16x16x32_bf16 v[76:79], a[188:191], a[12:15], v[76:79]
v_exp_f32 v70, v70
v_mfma_f32_16x16x32_bf16 v[176:179], a[208:211], v[84:87], v[176:179]
v_add_f32 v92, v92, v68
v_add_f32 v93, v93, v69
v_mfma_f32_16x16x32_bf16 v[180:183], a[212:215], v[84:87], v[180:183]
v_exp_f32 v71, v71
v_mfma_f32_16x16x32_bf16 v[184:187], a[216:219], v[84:87], v[184:187]
ds_read_b64_tr_b16 a[238:239], v23 offset:30560
v_cvt_pk_bf16_f32 v83, v70, v71
v_mfma_f32_16x16x32_bf16 v[188:191], a[220:223], v[84:87], v[188:191]
s_waitcnt lgkmcnt(6)
v_add_f32 v92, v92, v70
v_add_f32 v93, v93, v71
v_mfma_f32_16x16x32_bf16 v[64:67], a[160:163], a[16:19], v[100:103]
ds_read_b64_tr_b16 a[240:241], v22 offset:26240
v_exp_f32 v72, v72
v_mfma_f32_16x16x32_bf16 v[64:67], a[164:167], a[20:23], v[64:67]
ds_read_b64_tr_b16 a[242:243], v22 offset:30592
v_exp_f32 v73, v73
v_mfma_f32_16x16x32_bf16 v[64:67], a[168:171], a[24:27], v[64:67]
ds_read_b64_tr_b16 a[244:245], v23 offset:26272
v_cvt_pk_bf16_f32 v84, v72, v73
v_mfma_f32_16x16x32_bf16 v[64:67], a[172:175], a[28:31], v[64:67]
s_add_u32 s41, s41, 34816
v_exp_f32 v74, v74
v_mfma_f32_16x16x32_bf16 v[192:195], a[192:195], v[80:83], v[192:195]
s_add_u32 m0, s38, 64
ds_read_b64_tr_b16 a[246:247], v23 offset:30624
v_add_f32 v88, v88, v72
v_add_f32 v89, v89, v73
v_mfma_f32_16x16x32_bf16 v[196:199], a[196:199], v[80:83], v[196:199]
s_cmp_eq_u32 s41, 139264
buffer_load_dwordx4 v24, s[16:19], s39 offen offset:1024 nt lds
v_exp_f32 v75, v75
v_mfma_f32_16x16x32_bf16 v[200:203], a[200:203], v[80:83], v[200:203]
ds_read_b64_tr_b16 a[248:249], v22 offset:26304
v_cvt_pk_bf16_f32 v85, v74, v75
v_mfma_f32_16x16x32_bf16 v[204:207], a[204:207], v[80:83], v[204:207]
s_cselect_b32 s41, 0, s41
v_exp_f32 v76, v76
v_mfma_f32_16x16x32_bf16 v[68:71], a[176:179], a[16:19], v[100:103]
ds_read_b64_tr_b16 a[250:251], v22 offset:30656
v_add_f32 v88, v88, v74
v_add_f32 v89, v89, v75
v_mfma_f32_16x16x32_bf16 v[68:71], a[180:183], a[20:23], v[68:71]
v_exp_f32 v77, v77
v_mfma_f32_16x16x32_bf16 v[68:71], a[184:187], a[24:27], v[68:71]
s_add_u32 m0, s38, 9536
ds_read_b64_tr_b16 a[252:253], v23 offset:26336
v_cvt_pk_bf16_f32 v86, v76, v77
v_mfma_f32_16x16x32_bf16 v[68:71], a[188:191], a[28:31], v[68:71]
buffer_load_dwordx4 v25, s[20:23], s39 offen offset:256 nt lds
v_exp_f32 v78, v78
v_mfma_f32_16x16x32_bf16 v[208:211], a[208:211], v[80:83], v[208:211]
v_add_f32 v88, v88, v76
v_add_f32 v89, v89, v77
v_mfma_f32_16x16x32_bf16 v[212:215], a[212:215], v[80:83], v[212:215]
v_exp_f32 v79, v79
v_mfma_f32_16x16x32_bf16 v[216:219], a[216:219], v[80:83], v[216:219]
ds_read_b64_tr_b16 a[254:255], v23 offset:30688
v_cvt_pk_bf16_f32 v87, v78, v79
v_mfma_f32_16x16x32_bf16 v[220:223], a[220:223], v[80:83], v[220:223]
s_waitcnt lgkmcnt(6)
v_add_u32 v21, s41, v18
v_add_u32 v22, s41, v19
v_add_u32 v23, s41, v20
s_add_u32 s101, s101, 8192
s_add_u32 s100, s100, s92
s_and_b32 s39, s100, 0xf800
s_and_b32 s93, s101, 0x40000
s_or_b32 s39, s39, s93
s_add_u32 s38, s38, 17408
s_cmp_eq_u32 s38, s71
s_cselect_b32 s38, s70, s38
s_sub_u32 s32, s32, 1
s_cmp_lg_u32 s32, 0
v_add_f32 v88, v88, v78
v_add_f32 v89, v89, v79
s_cbranch_scc1 L_at3_1
L_tr3:
s_waitcnt vmcnt(20)
s_barrier
v_mfma_f32_16x16x32_bf16 v[72:75], a[160:163], a[32:35], v[104:107]
ds_read_b128 a[128:131], v21 offset:0
v_exp_f32 v64, v64
v_mov_b32 v96, v112
v_mov_b32 v97, v112
v_mfma_f32_16x16x32_bf16 v[72:75], a[164:167], a[36:39], v[72:75]
ds_read_b128 a[132:135], v21 offset:64
v_exp_f32 v65, v65
v_mov_b32 v98, v112
v_mov_b32 v99, v112
v_mfma_f32_16x16x32_bf16 v[72:75], a[168:171], a[40:43], v[72:75]
ds_read_b128 a[136:139], v21 offset:128
v_cvt_pk_bf16_f32 v80, v64, v65
v_add_f32 v116, v88, v89
v_mov_b32 v88, 0
v_mfma_f32_16x16x32_bf16 v[72:75], a[172:175], a[44:47], v[72:75]
v_exp_f32 v66, v66
v_mov_b32 v89, 0
v_mov_b32 v27, v116
v_mfma_f32_16x16x32_bf16 v[128:131], a[224:227], v[84:87], v[128:131]
s_add_u32 m0, s38, 0
ds_read_b128 a[140:143], v21 offset:192
v_add_f32 v90, v90, v64
v_add_f32 v91, v91, v65
s_nop 1
v_permlane32_swap_b32 v116, v27
v_mfma_f32_16x16x32_bf16 v[132:135], a[228:231], v[84:87], v[132:135]
buffer_load_dwordx4 v24, s[16:19], s39 offen offset:0 nt lds
v_exp_f32 v67, v67
s_nop 1
v_add_f32 v116, v116, v27
v_mfma_f32_16x16x32_bf16 v[136:139], a[232:235], v[84:87], v[136:139]
ds_read_b128 a[144:147], v21 offset:4352
v_cvt_pk_bf16_f32 v81, v66, v67
v_mov_b32 v27, v116
s_nop 1
v_mfma_f32_16x16x32_bf16 v[140:143], a[236:239], v[84:87], v[140:143]
v_exp_f32 v68, v68
v_permlane16_swap_b32 v116, v27
s_nop 1
v_mfma_f32_16x16x32_bf16 v[76:79], a[176:179], a[32:35], v[104:107]
ds_read_b128 a[148:151], v21 offset:4416
v_add_f32 v90, v90, v66
v_add_f32 v91, v91, v67
v_add_f32 v116, v116, v27
v_cmp_nge_f32 vcc, 0x4e800000, v116
v_mfma_f32_16x16x32_bf16 v[76:79], a[180:183], a[36:39], v[76:79]
v_exp_f32 v69, v69
v_rcp_f32 v116, v116
s_nop 1
v_mfma_f32_16x16x32_bf16 v[76:79], a[184:187], a[40:43], v[76:79]
ds_read_b128 a[152:155], v21 offset:4480
v_cvt_pk_bf16_f32 v82, v68, v69
s_or_b64 s[46:47], s[46:47], vcc
v_mfma_f32_16x16x32_bf16 v[76:79], a[188:191], a[44:47], v[76:79]
s_waitcnt lgkmcnt(7)
v_exp_f32 v70, v70
v_mfma_f32_16x16x32_bf16 v[144:147], a[240:243], v[84:87], v[144:147]
v_add_f32 v90, v90, v68
v_add_f32 v91, v91, v69
v_mfma_f32_16x16x32_bf16 v[148:151], a[244:247], v[84:87], v[148:151]
v_exp_f32 v71, v71
v_mfma_f32_16x16x32_bf16 v[152:155], a[248:251], v[84:87], v[152:155]
ds_read_b128 a[156:159], v21 offset:4544
v_cvt_pk_bf16_f32 v83, v70, v71
v_mfma_f32_16x16x32_bf16 v[156:159], a[252:255], v[84:87], v[156:159]
s_waitcnt lgkmcnt(4)
v_add_f32 v90, v90, v70
v_add_f32 v91, v91, v71
v_mfma_f32_16x16x32_bf16 v[64:67], a[128:131], a[64:67], v[96:99]
ds_read_b64_tr_b16 a[192:193], v22 offset:8704
v_exp_f32 v72, v72
s_mov_b32 s43, 0
v_mul_f32 v128, v128, v116
v_mul_f32 v129, v129, v116
v_mfma_f32_16x16x32_bf16 v[64:67], a[132:135], a[68:71], v[64:67]
ds_read_b64_tr_b16 a[194:195], v22 offset:13056
v_exp_f32 v73, v73
v_mul_f32 v130, v130, v116
v_mul_f32 v131, v131, v116
v_mul_f32 v132, v132, v116
v_mfma_f32_16x16x32_bf16 v[64:67], a[136:139], a[72:75], v[64:67]
ds_read_b64_tr_b16 a[196:197], v23 offset:8736
v_cvt_pk_bf16_f32 v84, v72, v73
v_mul_f32 v133, v133, v116
v_mul_f32 v134, v134, v116
v_mul_f32 v135, v135, v116
v_mfma_f32_16x16x32_bf16 v[64:67], a[140:143], a[76:79], v[64:67]
v_exp_f32 v74, v74
v_cvt_pk_bf16_f32 v120, v128, v129
v_cvt_pk_bf16_f32 v121, v130, v131
v_cvt_pk_bf16_f32 v122, v132, v133
v_mfma_f32_16x16x32_bf16 v[160:163], a[224:227], v[80:83], v[160:163]
s_add_u32 m0, s38, 8704
ds_read_b64_tr_b16 a[198:199], v23 offset:13088
v_add_f32 v92, v92, v72
v_add_f32 v93, v93, v73
v_cvt_pk_bf16_f32 v123, v134, v135
buffer_store_dwordx4 v[120:123], v26, s[24:27], s43 offen offset:0 sc1
v_mul_f32 v136, v136, v116
v_mfma_f32_16x16x32_bf16 v[164:167], a[228:231], v[80:83], v[164:167]
buffer_load_dwordx4 v25, s[20:23], s39 offen offset:0 nt lds
v_exp_f32 v75, v75
v_mul_f32 v137, v137, v116
v_mul_f32 v138, v138, v116
v_mul_f32 v139, v139, v116
v_mfma_f32_16x16x32_bf16 v[168:171], a[232:235], v[80:83], v[168:171]
ds_read_b64_tr_b16 a[200:201], v22 offset:8768
v_cvt_pk_bf16_f32 v85, v74, v75
v_mul_f32 v140, v140, v116
v_mul_f32 v141, v141, v116
v_mul_f32 v142, v142, v116
v_mfma_f32_16x16x32_bf16 v[172:175], a[236:239], v[80:83], v[172:175]
s_waitcnt lgkmcnt(5)
v_exp_f32 v76, v76
v_mul_f32 v143, v143, v116
v_cvt_pk_bf16_f32 v124, v136, v137
v_cvt_pk_bf16_f32 v125, v138, v139
v_mfma_f32_16x16x32_bf16 v[68:71], a[144:147], a[64:67], v[96:99]
ds_read_b64_tr_b16 a[202:203], v22 offset:13120
v_add_f32 v92, v92, v74
v_add_f32 v93, v93, v75
v_cvt_pk_bf16_f32 v126, v140, v141
v_cvt_pk_bf16_f32 v127, v142, v143
buffer_store_dwordx4 v[124:127], v26, s[24:27], s43 offen offset:1024 sc1
v_mfma_f32_16x16x32_bf16 v[68:71], a[148:151], a[68:71], v[68:71]
v_exp_f32 v77, v77
v_mov_b32 v100, v113
v_mov_b32 v101, v113
v_mov_b32 v102, v113
v_mfma_f32_16x16x32_bf16 v[68:71], a[152:155], a[72:75], v[68:71]
ds_read_b64_tr_b16 a[204:205], v23 offset:8800
v_cvt_pk_bf16_f32 v86, v76, v77
v_mov_b32 v103, v113
v_add_f32 v117, v90, v91
v_mov_b32 v90, 0
v_mfma_f32_16x16x32_bf16 v[68:71], a[156:159], a[76:79], v[68:71]
v_exp_f32 v78, v78
v_mov_b32 v91, 0
v_mov_b32 v27, v117
s_nop 1
v_mfma_f32_16x16x32_bf16 v[176:179], a[240:243], v[80:83], v[176:179]
v_add_f32 v92, v92, v76
v_add_f32 v93, v93, v77
v_permlane32_swap_b32 v117, v27
s_nop 1
v_add_f32 v117, v117, v27
v_mfma_f32_16x16x32_bf16 v[180:183], a[244:247], v[80:83], v[180:183]
v_exp_f32 v79, v79
v_mov_b32 v27, v117
s_nop 1
v_permlane16_swap_b32 v117, v27
v_mfma_f32_16x16x32_bf16 v[184:187], a[248:251], v[80:83], v[184:187]
ds_read_b64_tr_b16 a[206:207], v23 offset:13152
v_cvt_pk_bf16_f32 v87, v78, v79
s_nop 1
v_add_f32 v117, v117, v27
v_cmp_nge_f32 vcc, 0x4e800000, v117
v_mfma_f32_16x16x32_bf16 v[188:191], a[252:255], v[80:83], v[188:191]
s_waitcnt lgkmcnt(6)
v_add_f32 v92, v92, v78
v_add_f32 v93, v93, v79
v_rcp_f32 v117, v117
s_nop 1
s_or_b64 s[46:47], s[46:47], vcc
v_mfma_f32_16x16x32_bf16 v[72:75], a[128:131], a[80:83], v[100:103]
ds_read_b64_tr_b16 a[208:209], v22 offset:8832
v_exp_f32 v64, v64
s_mov_b32 s43, 32768
v_mul_f32 v144, v144, v116
v_mul_f32 v145, v145, v116
v_mul_f32 v146, v146, v116
v_mul_f32 v147, v147, v116
v_mfma_f32_16x16x32_bf16 v[72:75], a[132:135], a[84:87], v[72:75]
ds_read_b64_tr_b16 a[210:211], v22 offset:13184
v_exp_f32 v65, v65
v_mul_f32 v148, v148, v116
v_mul_f32 v149, v149, v116
v_mul_f32 v150, v150, v116
v_mul_f32 v151, v151, v116
v_cvt_pk_bf16_f32 v120, v144, v145
v_mfma_f32_16x16x32_bf16 v[72:75], a[136:139], a[88:91], v[72:75]
ds_read_b64_tr_b16 a[212:213], v23 offset:8864
v_cvt_pk_bf16_f32 v80, v64, v65
v_cvt_pk_bf16_f32 v121, v146, v147
v_cvt_pk_bf16_f32 v122, v148, v149
v_cvt_pk_bf16_f32 v123, v150, v151
buffer_store_dwordx4 v[120:123], v26, s[24:27], s43 offen offset:0 sc1
v_mul_f32 v152, v152, v116
v_mfma_f32_16x16x32_bf16 v[72:75], a[140:143], a[92:95], v[72:75]
v_exp_f32 v66, v66
v_mul_f32 v153, v153, v116
v_mul_f32 v154, v154, v116
v_mul_f32 v155, v155, v116
v_mul_f32 v156, v156, v116
v_mul_f32 v157, v157, v116
v_mfma_f32_16x16x32_bf16 v[192:195], a[224:227], v[84:87], v[192:195]
s_add_u32 m0, s38, 64
ds_read_b64_tr_b16 a[214:215], v23 offset:13216
v_add_f32 v88, v88, v64
v_add_f32 v89, v89, v65
v_mul_f32 v158, v158, v116
v_mul_f32 v159, v159, v116
v_cvt_pk_bf16_f32 v124, v152, v153
v_cvt_pk_bf16_f32 v125, v154, v155
v_cvt_pk_bf16_f32 v126, v156, v157
v_mfma_f32_16x16x32_bf16 v[196:199], a[228:231], v[84:87], v[196:199]
buffer_load_dwordx4 v24, s[16:19], s39 offen offset:1024 nt lds
v_exp_f32 v67, v67
v_cvt_pk_bf16_f32 v127, v158, v159
buffer_store_dwordx4 v[124:127], v26, s[24:27], s43 offen offset:1024 sc1
s_mov_b32 s43, 131072
v_mul_f32 v160, v160, v117
v_mul_f32 v161, v161, v117
v_mfma_f32_16x16x32_bf16 v[200:203], a[232:235], v[84:87], v[200:203]
ds_read_b64_tr_b16 a[216:217], v22 offset:8896
v_cvt_pk_bf16_f32 v81, v66, v67
v_mul_f32 v162, v162, v117
v_mul_f32 v163, v163, v117
v_mul_f32 v164, v164, v117
v_mul_f32 v165, v165, v117
v_mul_f32 v166, v166, v117
v_mfma_f32_16x16x32_bf16 v[204:207], a[236:239], v[84:87], v[204:207]
v_exp_f32 v68, v68
v_mul_f32 v167, v167, v117
v_cvt_pk_bf16_f32 v120, v160, v161
v_cvt_pk_bf16_f32 v121, v162, v163
v_cvt_pk_bf16_f32 v122, v164, v165
v_cvt_pk_bf16_f32 v123, v166, v167
v_mfma_f32_16x16x32_bf16 v[76:79], a[144:147], a[80:83], v[100:103]
ds_read_b64_tr_b16 a[218:219], v22 offset:13248
v_add_f32 v88, v88, v66
v_add_f32 v89, v89, v67
buffer_store_dwordx4 v[120:123], v26, s[24:27], s43 offen offset:0 sc1
v_mul_f32 v168, v168, v117
v_mul_f32 v169, v169, v117
v_mul_f32 v170, v170, v117
v_mul_f32 v171, v171, v117
v_mfma_f32_16x16x32_bf16 v[76:79], a[148:151], a[84:87], v[76:79]
v_exp_f32 v69, v69
v_mul_f32 v172, v172, v117
v_mul_f32 v173, v173, v117
v_mul_f32 v174, v174, v117
v_mul_f32 v175, v175, v117
v_cvt_pk_bf16_f32 v124, v168, v169
v_mfma_f32_16x16x32_bf16 v[76:79], a[152:155], a[88:91], v[76:79]
s_add_u32 m0, s38, 9536
ds_read_b64_tr_b16 a[220:221], v23 offset:8928
v_cvt_pk_bf16_f32 v82, v68, v69
v_cvt_pk_bf16_f32 v125, v170, v171
v_cvt_pk_bf16_f32 v126, v172, v173
v_cvt_pk_bf16_f32 v127, v174, v175
buffer_store_dwordx4 v[124:127], v26, s[24:27], s43 offen offset:1024 sc1
v_mov_b32 v104, v114
v_mfma_f32_16x16x32_bf16 v[76:79], a[156:159], a[92:95], v[76:79]
buffer_load_dwordx4 v25, s[20:23], s39 offen offset:256 nt lds
v_exp_f32 v70, v70
v_mov_b32 v105, v114
v_mov_b32 v106, v114
v_mov_b32 v107, v114
v_add_f32 v118, v92, v93
v_mov_b32 v92, 0
v_mfma_f32_16x16x32_bf16 v[208:211], a[240:243], v[84:87], v[208:211]
v_add_f32 v88, v88, v68
v_add_f32 v89, v89, v69
v_mov_b32 v93, 0
v_mov_b32 v27, v118
s_nop 1
v_permlane32_swap_b32 v118, v27
s_nop 1
v_mfma_f32_16x16x32_bf16 v[212:215], a[244:247], v[84:87], v[212:215]
v_exp_f32 v71, v71
v_add_f32 v118, v118, v27
v_mov_b32 v27, v118
s_nop 1
v_permlane16_swap_b32 v118, v27
s_nop 1
v_mfma_f32_16x16x32_bf16 v[216:219], a[248:251], v[84:87], v[216:219]
ds_read_b64_tr_b16 a[222:223], v23 offset:13280
v_cvt_pk_bf16_f32 v83, v70, v71
v_add_f32 v118, v118, v27
v_cmp_nge_f32 vcc, 0x4e800000, v118
v_rcp_f32 v118, v118
s_nop 1
s_nop 0
s_or_b64 s[46:47], s[46:47], vcc
v_mfma_f32_16x16x32_bf16 v[220:223], a[252:255], v[84:87], v[220:223]
s_waitcnt lgkmcnt(6)
s_add_u32 s101, s101, 8192
s_add_u32 s100, s100, s92
s_and_b32 s39, s100, 0xf800
s_and_b32 s93, s101, 0x40000
s_or_b32 s39, s39, s93
s_add_u32 s38, s38, 17408
s_cmp_eq_u32 s38, s71
s_cselect_b32 s38, s70, s38
v_add_f32 v88, v88, v70
v_add_f32 v89, v89, v71
s_waitcnt vmcnt(26)
s_barrier
v_mfma_f32_16x16x32_bf16 v[64:67], a[128:131], a[96:99], v[104:107]
ds_read_b128 a[160:163], v21 offset:17408
v_exp_f32 v72, v72
s_mov_b32 s43, 163840
v_mul_f32 v176, v176, v117
v_mul_f32 v177, v177, v117
v_mul_f32 v178, v178, v117
v_mfma_f32_16x16x32_bf16 v[64:67], a[132:135], a[100:103], v[64:67]
ds_read_b128 a[164:167], v21 offset:17472
v_exp_f32 v73, v73
v_mul_f32 v179, v179, v117
v_mul_f32 v180, v180, v117
v_mul_f32 v181, v181, v117
v_mul_f32 v182, v182, v117
v_mfma_f32_16x16x32_bf16 v[64:67], a[136:139], a[104:107], v[64:67]
ds_read_b128 a[168:171], v21 offset:17536
v_cvt_pk_bf16_f32 v84, v72, v73
v_mul_f32 v183, v183, v117
v_cvt_pk_bf16_f32 v120, v176, v177
v_cvt_pk_bf16_f32 v121, v178, v179
v_cvt_pk_bf16_f32 v122, v180, v181
v_mfma_f32_16x16x32_bf16 v[64:67], a[140:143], a[108:111], v[64:67]
v_exp_f32 v74, v74
v_cvt_pk_bf16_f32 v123, v182, v183
buffer_store_dwordx4 v[120:123], v26, s[24:27], s43 offen offset:0 sc1
v_mul_f32 v184, v184, v117
v_mul_f32 v185, v185, v117
v_mfma_f32_16x16x32_bf16 v[128:131], a[192:195], v[80:83], 0
s_add_u32 m0, s38, 0
ds_read_b128 a[172:175], v21 offset:17600
v_add_f32 v90, v90, v72
v_add_f32 v91, v91, v73
v_mul_f32 v186, v186, v117
v_mul_f32 v187, v187, v117
v_mul_f32 v188, v188, v117
v_mul_f32 v189, v189, v117
v_mfma_f32_16x16x32_bf16 v[132:135], a[196:199], v[80:83], 0
buffer_load_dwordx4 v24, s[16:19], s39 offen offset:0 nt lds
v_exp_f32 v75, v75
v_mul_f32 v190, v190, v117
v_mul_f32 v191, v191, v117
v_cvt_pk_bf16_f32 v124, v184, v185
v_cvt_pk_bf16_f32 v125, v186, v187
v_mfma_f32_16x16x32_bf16 v[136:139], a[200:203], v[80:83], 0
ds_read_b128 a[176:179], v21 offset:21760
v_cvt_pk_bf16_f32 v85, v74, v75
v_cvt_pk_bf16_f32 v126, v188, v189
v_cvt_pk_bf16_f32 v127, v190, v191
buffer_store_dwordx4 v[124:127], v26, s[24:27], s43 offen offset:1024 sc1
s_mov_b32 s43, 262144
v_mfma_f32_16x16x32_bf16 v[140:143], a[204:207], v[80:83], 0
v_exp_f32 v76, v76
v_mul_f32 v192, v192, v118
v_mul_f32 v193, v193, v118
v_mul_f32 v194, v194, v118
v_mul_f32 v195, v195, v118
v_mfma_f32_16x16x32_bf16 v[68:71], a[144:147], a[96:99], v[104:107]
ds_read_b128 a[180:183], v21 offset:21824
v_add_f32 v90, v90, v74
v_add_f32 v91, v91, v75
v_mul_f32 v196, v196, v118
v_mul_f32 v197, v197, v118
v_mul_f32 v198, v198, v118
v_mul_f32 v199, v199, v118
v_mfma_f32_16x16x32_bf16 v[68:71], a[148:151], a[100:103], v[68:71]
v_exp_f32 v77, v77
v_cvt_pk_bf16_f32 v120, v192, v193
v_cvt_pk_bf16_f32 v121, v194, v195
v_cvt_pk_bf16_f32 v122, v196, v197
v_cvt_pk_bf16_f32 v123, v198, v199
v_mfma_f32_16x16x32_bf16 v[68:71], a[152:155], a[104:107], v[68:71]
ds_read_b128 a[184:187], v21 offset:21888
v_cvt_pk_bf16_f32 v86, v76, v77
buffer_store_dwordx4 v[120:123], v26, s[24:27], s43 offen offset:0 sc1
v_mul_f32 v200, v200, v118
v_mul_f32 v201, v201, v118
v_mul_f32 v202, v202, v118
v_mfma_f32_16x16x32_bf16 v[68:71], a[156:159], a[108:111], v[68:71]
s_waitcnt lgkmcnt(7)
v_exp_f32 v78, v78
v_mul_f32 v203, v203, v118
v_mul_f32 v204, v204, v118
v_mul_f32 v205, v205, v118
v_mul_f32 v206, v206, v118
v_mfma_f32_16x16x32_bf16 v[144:147], a[208:211], v[80:83], 0
v_add_f32 v90, v90, v76
v_add_f32 v91, v91, v77
v_mul_f32 v207, v207, v118
v_cvt_pk_bf16_f32 v124, v200, v201
v_cvt_pk_bf16_f32 v125, v202, v203
v_cvt_pk_bf16_f32 v126, v204, v205
v_mfma_f32_16x16x32_bf16 v[148:151], a[212:215], v[80:83], 0
v_exp_f32 v79, v79
v_cvt_pk_bf16_f32 v127, v206, v207
buffer_store_dwordx4 v[124:127], v26, s[24:27], s43 offen offset:1024 sc1
v_mfma_f32_16x16x32_bf16 v[152:155], a[216:219], v[80:83], 0
ds_read_b128 a[188:191], v21 offset:21952
v_cvt_pk_bf16_f32 v87, v78, v79
v_mfma_f32_16x16x32_bf16 v[156:159], a[220:223], v[80:83], 0
s_waitcnt lgkmcnt(4)
v_add_f32 v90, v90, v78
v_add_f32 v91, v91, v79
v_mfma_f32_16x16x32_bf16 v[72:75], a[160:163], a[64:67], v[96:99]
ds_read_b64_tr_b16 a[224:225], v22 offset:26112
v_exp_f32 v64, v64
s_mov_b32 s43, 294912
v_mul_f32 v208, v208, v118
v_mfma_f32_16x16x32_bf16 v[72:75], a[164:167], a[68:71], v[72:75]
ds_read_b64_tr_b16 a[226:227], v22 offset:30464
v_exp_f32 v65, v65
v_mul_f32 v209, v209, v118
v_mul_f32 v210, v210, v118
v_mfma_f32_16x16x32_bf16 v[72:75], a[168:171], a[72:75], v[72:75]
ds_read_b64_tr_b16 a[228:229], v23 offset:26144
v_cvt_pk_bf16_f32 v80, v64, v65
v_mul_f32 v211, v211, v118
v_mul_f32 v212, v212, v118
v_mfma_f32_16x16x32_bf16 v[72:75], a[172:175], a[76:79], v[72:75]
v_exp_f32 v66, v66
v_mul_f32 v213, v213, v118
v_mul_f32 v214, v214, v118
v_mfma_f32_16x16x32_bf16 v[160:163], a[192:195], v[84:87], 0
s_add_u32 m0, s38, 8704
ds_read_b64_tr_b16 a[230:231], v23 offset:30496
v_add_f32 v92, v92, v64
v_add_f32 v93, v93, v65
v_mul_f32 v215, v215, v118
v_cvt_pk_bf16_f32 v120, v208, v209
v_mfma_f32_16x16x32_bf16 v[164:167], a[196:199], v[84:87], 0
buffer_load_dwordx4 v25, s[20:23], s39 offen offset:0 nt lds
v_exp_f32 v67, v67
v_cvt_pk_bf16_f32 v121, v210, v211
v_cvt_pk_bf16_f32 v122, v212, v213
v_mfma_f32_16x16x32_bf16 v[168:171], a[200:203], v[84:87], 0
ds_read_b64_tr_b16 a[232:233], v22 offset:26176
v_cvt_pk_bf16_f32 v81, v66, v67
v_cvt_pk_bf16_f32 v123, v214, v215
buffer_store_dwordx4 v[120:123], v26, s[24:27], s43 offen offset:0 sc1
v_mfma_f32_16x16x32_bf16 v[172:175], a[204:207], v[84:87], 0
s_waitcnt lgkmcnt(5)
v_exp_f32 v68, v68
v_mul_f32 v216, v216, v118
v_mul_f32 v217, v217, v118
v_mfma_f32_16x16x32_bf16 v[76:79], a[176:179], a[64:67], v[96:99]
ds_read_b64_tr_b16 a[234:235], v22 offset:30528
v_add_f32 v92, v92, v66
v_add_f32 v93, v93, v67
v_mul_f32 v218, v218, v118
v_mul_f32 v219, v219, v118
v_mfma_f32_16x16x32_bf16 v[76:79], a[180:183], a[68:71], v[76:79]
v_exp_f32 v69, v69
v_mul_f32 v220, v220, v118
v_mul_f32 v221, v221, v118
v_mfma_f32_16x16x32_bf16 v[76:79], a[184:187], a[72:75], v[76:79]
ds_read_b64_tr_b16 a[236:237], v23 offset:26208
v_cvt_pk_bf16_f32 v82, v68, v69
v_mul_f32 v222, v222, v118
v_mul_f32 v223, v223, v118
v_mfma_f32_16x16x32_bf16 v[76:79], a[188:191], a[76:79], v[76:79]
v_exp_f32 v70, v70
v_cvt_pk_bf16_f32 v124, v216, v217
v_cvt_pk_bf16_f32 v125, v218, v219
v_mfma_f32_16x16x32_bf16 v[176:179], a[208:211], v[84:87], 0
v_add_f32 v92, v92, v68
v_add_f32 v93, v93, v69
v_cvt_pk_bf16_f32 v126, v220, v221
v_cvt_pk_bf16_f32 v127, v222, v223
v_mfma_f32_16x16x32_bf16 v[180:183], a[212:215], v[84:87], 0
v_exp_f32 v71, v71
buffer_store_dwordx4 v[124:127], v26, s[24:27], s43 offen offset:1024 sc1
v_mfma_f32_16x16x32_bf16 v[184:187], a[216:219], v[84:87], 0
ds_read_b64_tr_b16 a[238:239], v23 offset:30560
v_cvt_pk_bf16_f32 v83, v70, v71
v_mfma_f32_16x16x32_bf16 v[188:191], a[220:223], v[84:87], 0
s_waitcnt lgkmcnt(6)
v_add_f32 v92, v92, v70
v_add_f32 v93, v93, v71
v_mfma_f32_16x16x32_bf16 v[64:67], a[160:163], a[80:83], v[100:103]
ds_read_b64_tr_b16 a[240:241], v22 offset:26240
v_exp_f32 v72, v72
v_mfma_f32_16x16x32_bf16 v[64:67], a[164:167], a[84:87], v[64:67]
ds_read_b64_tr_b16 a[242:243], v22 offset:30592
v_exp_f32 v73, v73
v_mfma_f32_16x16x32_bf16 v[64:67], a[168:171], a[88:91], v[64:67]
ds_read_b64_tr_b16 a[244:245], v23 offset:26272
v_cvt_pk_bf16_f32 v84, v72, v73
v_mfma_f32_16x16x32_bf16 v[64:67], a[172:175], a[92:95], v[64:67]
s_add_u32 s41, s41, 34816
v_exp_f32 v74, v74
v_mfma_f32_16x16x32_bf16 v[192:195], a[192:195], v[80:83], 0
s_add_u32 m0, s38, 64
ds_read_b64_tr_b16 a[246:247], v23 offset:30624
v_add_f32 v88, v88, v72
v_add_f32 v89, v89, v73
v_mfma_f32_16x16x32_bf16 v[196:199], a[196:199], v[80:83], 0
s_cmp_eq_u32 s41, 139264
buffer_load_dwordx4 v24, s[16:19], s39 offen offset:1024 nt lds
v_exp_f32 v75, v75
v_mfma_f32_16x16x32_bf16 v[200:203], a[200:203], v[80:83], 0
ds_read_b64_tr_b16 a[248:249], v22 offset:26304
v_cvt_pk_bf16_f32 v85, v74, v75
v_mfma_f32_16x16x32_bf16 v[204:207], a[204:207], v[80:83], 0
s_cselect_b32 s41, 0, s41
v_exp_f32 v76, v76
v_mfma_f32_16x16x32_bf16 v[68:71], a[176:179], a[80:83], v[100:103]
ds_read_b64_tr_b16 a[250:251], v22 offset:30656
v_add_f32 v88, v88, v74
v_add_f32 v89, v89, v75
v_mfma_f32_16x16x32_bf16 v[68:71], a[180:183], a[84:87], v[68:71]
v_exp_f32 v77, v77
v_mfma_f32_16x16x32_bf16 v[68:71], a[184:187], a[88:91], v[68:71]
s_add_u32 m0, s38, 9536
ds_read_b64_tr_b16 a[252:253], v23 offset:26336
v_cvt_pk_bf16_f32 v86, v76, v77
v_mfma_f32_16x16x32_bf16 v[68:71], a[188:191], a[92:95], v[68:71]
buffer_load_dwordx4 v25, s[20:23], s39 offen offset:256 nt lds
v_exp_f32 v78, v78
v_mfma_f32_16x16x32_bf16 v[208:211], a[208:211], v[80:83], 0
v_add_f32 v88, v88, v76
v_add_f32 v89, v89, v77
v_mfma_f32_16x16x32_bf16 v[212:215], a[212:215], v[80:83], 0
v_exp_f32 v79, v79
v_mfma_f32_16x16x32_bf16 v[216:219], a[216:219], v[80:83], 0
ds_read_b64_tr_b16 a[254:255], v23 offset:30688
v_cvt_pk_bf16_f32 v87, v78, v79
v_mfma_f32_16x16x32_bf16 v[220:223], a[220:223], v[80:83], 0
s_waitcnt lgkmcnt(6)
v_add_u32 v21, s41, v18
v_add_u32 v22, s41, v19
v_add_u32 v23, s41, v20
s_add_u32 s101, s101, 8192
s_add_u32 s100, s100, s92
s_and_b32 s39, s100, 0xf800
s_and_b32 s93, s101, 0x40000
s_or_b32 s39, s39, s93
s_add_u32 s38, s38, 17408
s_cmp_eq_u32 s38, s71
s_cselect_b32 s38, s70, s38
v_add_f32 v88, v88, v78
v_add_f32 v89, v89, v79
s_waitcnt vmcnt(32)
s_barrier
s_cmp_eq_u32 s42, 1
s_cbranch_scc1 L_nbw3
s_cmp_eq_u64 s[46:47], 0
s_cbranch_scc1 L_nbw3
v_mov_b32 v27, 1
v_mov_b32 v28, 163832
ds_write_b32 v28, v27
L_nbw3:
v_mfma_f32_16x16x32_bf16 v[72:75], a[160:163], a[96:99], v[104:107]
ds_read_b128 a[128:131], v21 offset:0
v_exp_f32 v64, v64
v_mfma_f32_16x16x32_bf16 v[72:75], a[164:167], a[100:103], v[72:75]
ds_read_b128 a[132:135], v21 offset:64
v_exp_f32 v65, v65
v_mfma_f32_16x16x32_bf16 v[72:75], a[168:171], a[104:107], v[72:75]
ds_read_b128 a[136:139], v21 offset:128
v_cvt_pk_bf16_f32 v80, v64, v65
v_mfma_f32_16x16x32_bf16 v[72:75], a[172:175], a[108:111], v[72:75]
v_exp_f32 v66, v66
v_mfma_f32_16x16x32_bf16 v[128:131], a[224:227], v[84:87], v[128:131]
s_add_u32 m0, s38, 0
ds_read_b128 a[140:143], v21 offset:192
v_add_f32 v90, v90, v64
v_add_f32 v91, v91, v65
v_mfma_f32_16x16x32_bf16 v[132:135], a[228:231], v[84:87], v[132:135]
buffer_load_dwordx4 v24, s[16:19], s39 offen offset:0 nt lds
v_exp_f32 v67, v67
v_mfma_f32_16x16x32_bf16 v[136:139], a[232:235], v[84:87], v[136:139]
ds_read_b128 a[144:147], v21 offset:4352
v_cvt_pk_bf16_f32 v81, v66, v67
v_mfma_f32_16x16x32_bf16 v[140:143], a[236:239], v[84:87], v[140:143]
v_exp_f32 v68, v68
v_mfma_f32_16x16x32_bf16 v[76:79], a[176:179], a[96:99], v[104:107]
ds_read_b128 a[148:151], v21 offset:4416
v_add_f32 v90, v90, v66
v_add_f32 v91, v91, v67
v_mfma_f32_16x16x32_bf16 v[76:79], a[180:183], a[100:103], v[76:79]
v_exp_f32 v69, v69
v_mfma_f32_16x16x32_bf16 v[76:79], a[184:187], a[104:107], v[76:79]
ds_read_b128 a[152:155], v21 offset:4480
v_cvt_pk_bf16_f32 v82, v68, v69
v_mfma_f32_16x16x32_bf16 v[76:79], a[188:191], a[108:111], v[76:79]
s_waitcnt lgkmcnt(7)
v_exp_f32 v70, v70
v_mfma_f32_16x16x32_bf16 v[144:147], a[240:243], v[84:87], v[144:147]
v_add_f32 v90, v90, v68
v_add_f32 v91, v91, v69
v_mfma_f32_16x16x32_bf16 v[148:151], a[244:247], v[84:87], v[148:151]
v_exp_f32 v71, v71
v_mfma_f32_16x16x32_bf16 v[152:155], a[248:251], v[84:87], v[152:155]
ds_read_b128 a[156:159], v21 offset:4544
v_cvt_pk_bf16_f32 v83, v70, v71
v_mfma_f32_16x16x32_bf16 v[156:159], a[252:255], v[84:87], v[156:159]
s_waitcnt lgkmcnt(4)
v_add_f32 v90, v90, v70
v_add_f32 v91, v91, v71
v_mfma_f32_16x16x32_bf16 v[64:67], a[128:131], a[64:67], v[96:99]
ds_read_b64_tr_b16 a[192:193], v22 offset:8704
v_exp_f32 v72, v72
v_mfma_f32_16x16x32_bf16 v[64:67], a[132:135], a[68:71], v[64:67]
ds_read_b64_tr_b16 a[194:195], v22 offset:13056
v_exp_f32 v73, v73
v_mfma_f32_16x16x32_bf16 v[64:67], a[136:139], a[72:75], v[64:67]
ds_read_b64_tr_b16 a[196:197], v23 offset:8736
v_cvt_pk_bf16_f32 v84, v72, v73
v_mfma_f32_16x16x32_bf16 v[64:67], a[140:143], a[76:79], v[64:67]
v_exp_f32 v74, v74
v_mfma_f32_16x16x32_bf16 v[160:163], a[224:227], v[80:83], v[160:163]
s_add_u32 m0, s38, 8704
ds_read_b64_tr_b16 a[198:199], v23 offset:13088
v_add_f32 v92, v92, v72
v_add_f32 v93, v93, v73
v_mfma_f32_16x16x32_bf16 v[164:167], a[228:231], v[80:83], v[164:167]
buffer_load_dwordx4 v25, s[20:23], s39 offen offset:0 nt lds
v_exp_f32 v75, v75
v_mfma_f32_16x16x32_bf16 v[168:171], a[232:235], v[80:83], v[168:171]
ds_read_b64_tr_b16 a[200:201], v22 offset:8768
v_cvt_pk_bf16_f32 v85, v74, v75
v_mfma_f32_16x16x32_bf16 v[172:175], a[236:239], v[80:83], v[172:175]
s_waitcnt lgkmcnt(5)
v_exp_f32 v76, v76
v_mfma_f32_16x16x32_bf16 v[68:71], a[144:147], a[64:67], v[96:99]
ds_read_b64_tr_b16 a[202:203], v22 offset:13120
v_add_f32 v92, v92, v74
v_add_f32 v93, v93, v75
v_mfma_f32_16x16x32_bf16 v[68:71], a[148:151], a[68:71], v[68:71]
v_exp_f32 v77, v77
v_mfma_f32_16x16x32_bf16 v[68:71], a[152:155], a[72:75], v[68:71]
ds_read_b64_tr_b16 a[204:205], v23 offset:8800
v_cvt_pk_bf16_f32 v86, v76, v77
v_mfma_f32_16x16x32_bf16 v[68:71], a[156:159], a[76:79], v[68:71]
v_exp_f32 v78, v78
v_mfma_f32_16x16x32_bf16 v[176:179], a[240:243], v[80:83], v[176:179]
v_add_f32 v92, v92, v76
v_add_f32 v93, v93, v77
v_mfma_f32_16x16x32_bf16 v[180:183], a[244:247], v[80:83], v[180:183]
v_exp_f32 v79, v79
v_mfma_f32_16x16x32_bf16 v[184:187], a[248:251], v[80:83], v[184:187]
ds_read_b64_tr_b16 a[206:207], v23 offset:13152
v_cvt_pk_bf16_f32 v87, v78, v79
v_mfma_f32_16x16x32_bf16 v[188:191], a[252:255], v[80:83], v[188:191]
s_waitcnt lgkmcnt(6)
v_add_f32 v92, v92, v78
v_add_f32 v93, v93, v79
v_mfma_f32_16x16x32_bf16 v[72:75], a[128:131], a[80:83], v[100:103]
ds_read_b64_tr_b16 a[208:209], v22 offset:8832
v_exp_f32 v64, v64
v_mfma_f32_16x16x32_bf16 v[72:75], a[132:135], a[84:87], v[72:75]
ds_read_b64_tr_b16 a[210:211], v22 offset:13184
v_exp_f32 v65, v65
v_mfma_f32_16x16x32_bf16 v[72:75], a[136:139], a[88:91], v[72:75]
ds_read_b64_tr_b16 a[212:213], v23 offset:8864
v_cvt_pk_bf16_f32 v80, v64, v65
v_mfma_f32_16x16x32_bf16 v[72:75], a[140:143], a[92:95], v[72:75]
v_exp_f32 v66, v66
v_mfma_f32_16x16x32_bf16 v[192:195], a[224:227], v[84:87], v[192:195]
s_add_u32 m0, s38, 64
ds_read_b64_tr_b16 a[214:215], v23 offset:13216
v_add_f32 v88, v88, v64
v_add_f32 v89, v89, v65
v_mfma_f32_16x16x32_bf16 v[196:199], a[228:231], v[84:87], v[196:199]
buffer_load_dwordx4 v24, s[16:19], s39 offen offset:1024 nt lds
v_exp_f32 v67, v67
v_mfma_f32_16x16x32_bf16 v[200:203], a[232:235], v[84:87], v[200:203]
ds_read_b64_tr_b16 a[216:217], v22 offset:8896
v_cvt_pk_bf16_f32 v81, v66, v67
v_mfma_f32_16x16x32_bf16 v[204:207], a[236:239], v[84:87], v[204:207]
v_exp_f32 v68, v68
v_mfma_f32_16x16x32_bf16 v[76:79], a[144:147], a[80:83], v[100:103]
ds_read_b64_tr_b16 a[218:219], v22 offset:13248
v_add_f32 v88, v88, v66
v_add_f32 v89, v89, v67
v_mfma_f32_16x16x32_bf16 v[76:79], a[148:151], a[84:87], v[76:79]
v_exp_f32 v69, v69
v_mfma_f32_16x16x32_bf16 v[76:79], a[152:155], a[88:91], v[76:79]
s_add_u32 m0, s38, 9536
ds_read_b64_tr_b16 a[220:221], v23 offset:8928
v_cvt_pk_bf16_f32 v82, v68, v69
v_mfma_f32_16x16x32_bf16 v[76:79], a[156:159], a[92:95], v[76:79]
buffer_load_dwordx4 v25, s[20:23], s39 offen offset:256 nt lds
v_exp_f32 v70, v70
v_mfma_f32_16x16x32_bf16 v[208:211], a[240:243], v[84:87], v[208:211]
v_add_f32 v88, v88, v68
v_add_f32 v89, v89, v69
v_mfma_f32_16x16x32_bf16 v[212:215], a[244:247], v[84:87], v[212:215]
v_exp_f32 v71, v71
v_mfma_f32_16x16x32_bf16 v[216:219], a[248:251], v[84:87], v[216:219]
ds_read_b64_tr_b16 a[222:223], v23 offset:13280
v_cvt_pk_bf16_f32 v83, v70, v71
v_mfma_f32_16x16x32_bf16 v[220:223], a[252:255], v[84:87], v[220:223]
s_waitcnt lgkmcnt(6)
s_add_u32 s101, s101, 8192
s_add_u32 s100, s100, s92
s_and_b32 s39, s100, 0xf800
s_and_b32 s93, s101, 0x40000
s_or_b32 s39, s39, s93
s_add_u32 s38, s38, 17408
s_cmp_eq_u32 s38, s71
s_cselect_b32 s38, s70, s38
v_add_f32 v88, v88, v70
v_add_f32 v89, v89, v71
s_waitcnt vmcnt(32)
s_barrier
v_mfma_f32_16x16x32_bf16 v[64:67], a[128:131], a[96:99], v[104:107]
ds_read_b128 a[160:163], v21 offset:17408
v_exp_f32 v72, v72
v_mfma_f32_16x16x32_bf16 v[64:67], a[132:135], a[100:103], v[64:67]
ds_read_b128 a[164:167], v21 offset:17472
v_exp_f32 v73, v73
v_mfma_f32_16x16x32_bf16 v[64:67], a[136:139], a[104:107], v[64:67]
ds_read_b128 a[168:171], v21 offset:17536
v_cvt_pk_bf16_f32 v84, v72, v73
v_mfma_f32_16x16x32_bf16 v[64:67], a[140:143], a[108:111], v[64:67]
v_exp_f32 v74, v74
v_mfma_f32_16x16x32_bf16 v[128:131], a[192:195], v[80:83], v[128:131]
s_add_u32 m0, s38, 0
ds_read_b128 a[172:175], v21 offset:17600
v_add_f32 v90, v90, v72
v_add_f32 v91, v91, v73
v_mfma_f32_16x16x32_bf16 v[132:135], a[196:199], v[80:83], v[132:135]
buffer_load_dwordx4 v24, s[16:19], s39 offen offset:0 nt lds
v_exp_f32 v75, v75
v_mfma_f32_16x16x32_bf16 v[136:139], a[200:203], v[80:83], v[136:139]
ds_read_b128 a[176:179], v21 offset:21760
v_cvt_pk_bf16_f32 v85, v74, v75
v_mfma_f32_16x16x32_bf16 v[140:143], a[204:207], v[80:83], v[140:143]
v_exp_f32 v76, v76
v_mfma_f32_16x16x32_bf16 v[68:71], a[144:147], a[96:99], v[104:107]
ds_read_b128 a[180:183], v21 offset:21824
v_add_f32 v90, v90, v74
v_add_f32 v91, v91, v75
v_mfma_f32_16x16x32_bf16 v[68:71], a[148:151], a[100:103], v[68:71]
v_exp_f32 v77, v77
v_mfma_f32_16x16x32_bf16 v[68:71], a[152:155], a[104:107], v[68:71]
ds_read_b128 a[184:187], v21 offset:21888
v_cvt_pk_bf16_f32 v86, v76, v77
v_mfma_f32_16x16x32_bf16 v[68:71], a[156:159], a[108:111], v[68:71]
s_waitcnt lgkmcnt(7)
v_exp_f32 v78, v78
v_mfma_f32_16x16x32_bf16 v[144:147], a[208:211], v[80:83], v[144:147]
v_add_f32 v90, v90, v76
v_add_f32 v91, v91, v77
v_mfma_f32_16x16x32_bf16 v[148:151], a[212:215], v[80:83], v[148:151]
v_exp_f32 v79, v79
v_mfma_f32_16x16x32_bf16 v[152:155], a[216:219], v[80:83], v[152:155]
ds_read_b128 a[188:191], v21 offset:21952
v_cvt_pk_bf16_f32 v87, v78, v79
v_mfma_f32_16x16x32_bf16 v[156:159], a[220:223], v[80:83], v[156:159]
s_waitcnt lgkmcnt(4)
v_add_f32 v90, v90, v78
v_add_f32 v91, v91, v79
v_mfma_f32_16x16x32_bf16 v[72:75], a[160:163], a[64:67], v[96:99]
ds_read_b64_tr_b16 a[224:225], v22 offset:26112
v_exp_f32 v64, v64
v_mfma_f32_16x16x32_bf16 v[72:75], a[164:167], a[68:71], v[72:75]
ds_read_b64_tr_b16 a[226:227], v22 offset:30464
v_exp_f32 v65, v65
v_mfma_f32_16x16x32_bf16 v[72:75], a[168:171], a[72:75], v[72:75]
ds_read_b64_tr_b16 a[228:229], v23 offset:26144
v_cvt_pk_bf16_f32 v80, v64, v65
v_mfma_f32_16x16x32_bf16 v[72:75], a[172:175], a[76:79], v[72:75]
v_exp_f32 v66, v66
v_mfma_f32_16x16x32_bf16 v[160:163], a[192:195], v[84:87], v[160:163]
s_add_u32 m0, s38, 8704
ds_read_b64_tr_b16 a[230:231], v23 offset:30496
v_add_f32 v92, v92, v64
v_add_f32 v93, v93, v65
v_mfma_f32_16x16x32_bf16 v[164:167], a[196:199], v[84:87], v[164:167]
buffer_load_dwordx4 v25, s[20:23], s39 offen offset:0 nt lds
v_exp_f32 v67, v67
v_mfma_f32_16x16x32_bf16 v[168:171], a[200:203], v[84:87], v[168:171]
ds_read_b64_tr_b16 a[232:233], v22 offset:26176
v_cvt_pk_bf16_f32 v81, v66, v67
v_mfma_f32_16x16x32_bf16 v[172:175], a[204:207], v[84:87], v[172:175]
s_waitcnt lgkmcnt(5)
v_exp_f32 v68, v68
v_mfma_f32_16x16x32_bf16 v[76:79], a[176:179], a[64:67], v[96:99]
ds_read_b64_tr_b16 a[234:235], v22 offset:30528
v_add_f32 v92, v92, v66
v_add_f32 v93, v93, v67
v_mfma_f32_16x16x32_bf16 v[76:79], a[180:183], a[68:71], v[76:79]
v_exp_f32 v69, v69
v_mfma_f32_16x16x32_bf16 v[76:79], a[184:187], a[72:75], v[76:79]
ds_read_b64_tr_b16 a[236:237], v23 offset:26208
v_cvt_pk_bf16_f32 v82, v68, v69
v_mfma_f32_16x16x32_bf16 v[76:79], a[188:191], a[76:79], v[76:79]
v_exp_f32 v70, v70
v_mfma_f32_16x16x32_bf16 v[176:179], a[208:211], v[84:87], v[176:179]
v_add_f32 v92, v92, v68
v_add_f32 v93, v93, v69
v_mfma_f32_16x16x32_bf16 v[180:183], a[212:215], v[84:87], v[180:183]
v_exp_f32 v71, v71
v_mfma_f32_16x16x32_bf16 v[184:187], a[216:219], v[84:87], v[184:187]
ds_read_b64_tr_b16 a[238:239], v23 offset:30560
v_cvt_pk_bf16_f32 v83, v70, v71
v_mfma_f32_16x16x32_bf16 v[188:191], a[220:223], v[84:87], v[188:191]
s_waitcnt lgkmcnt(6)
v_add_f32 v92, v92, v70
v_add_f32 v93, v93, v71
v_mfma_f32_16x16x32_bf16 v[64:67], a[160:163], a[80:83], v[100:103]
ds_read_b64_tr_b16 a[240:241], v22 offset:26240
v_exp_f32 v72, v72
v_mfma_f32_16x16x32_bf16 v[64:67], a[164:167], a[84:87], v[64:67]
ds_read_b64_tr_b16 a[242:243], v22 offset:30592
v_exp_f32 v73, v73
v_mfma_f32_16x16x32_bf16 v[64:67], a[168:171], a[88:91], v[64:67]
ds_read_b64_tr_b16 a[244:245], v23 offset:26272
v_cvt_pk_bf16_f32 v84, v72, v73
v_mfma_f32_16x16x32_bf16 v[64:67], a[172:175], a[92:95], v[64:67]
s_add_u32 s41, s41, 34816
v_exp_f32 v74, v74
v_mfma_f32_16x16x32_bf16 v[192:195], a[192:195], v[80:83], v[192:195]
s_add_u32 m0, s38, 64
ds_read_b64_tr_b16 a[246:247], v23 offset:30624
v_add_f32 v88, v88, v72
v_add_f32 v89, v89, v73
v_mfma_f32_16x16x32_bf16 v[196:199], a[196:199], v[80:83], v[196:199]
s_cmp_eq_u32 s41, 139264
buffer_load_dwordx4 v24, s[16:19], s39 offen offset:1024 nt lds
v_exp_f32 v75, v75
v_mfma_f32_16x16x32_bf16 v[200:203], a[200:203], v[80:83], v[200:203]
ds_read_b64_tr_b16 a[248:249], v22 offset:26304
v_cvt_pk_bf16_f32 v85, v74, v75
v_mfma_f32_16x16x32_bf16 v[204:207], a[204:207], v[80:83], v[204:207]
s_cselect_b32 s41, 0, s41
v_exp_f32 v76, v76
v_mfma_f32_16x16x32_bf16 v[68:71], a[176:179], a[80:83], v[100:103]
ds_read_b64_tr_b16 a[250:251], v22 offset:30656
v_add_f32 v88, v88, v74
v_add_f32 v89, v89, v75
v_mfma_f32_16x16x32_bf16 v[68:71], a[180:183], a[84:87], v[68:71]
v_exp_f32 v77, v77
v_mfma_f32_16x16x32_bf16 v[68:71], a[184:187], a[88:91], v[68:71]
s_add_u32 m0, s38, 9536
ds_read_b64_tr_b16 a[252:253], v23 offset:26336
v_cvt_pk_bf16_f32 v86, v76, v77
v_mfma_f32_16x16x32_bf16 v[68:71], a[188:191], a[92:95], v[68:71]
buffer_load_dwordx4 v25, s[20:23], s39 offen offset:256 nt lds
v_exp_f32 v78, v78
v_mfma_f32_16x16x32_bf16 v[208:211], a[208:211], v[80:83], v[208:211]
v_add_f32 v88, v88, v76
v_add_f32 v89, v89, v77
v_mfma_f32_16x16x32_bf16 v[212:215], a[212:215], v[80:83], v[212:215]
v_exp_f32 v79, v79
v_mfma_f32_16x16x32_bf16 v[216:219], a[216:219], v[80:83], v[216:219]
ds_read_b64_tr_b16 a[254:255], v23 offset:30688
v_cvt_pk_bf16_f32 v87, v78, v79
v_mfma_f32_16x16x32_bf16 v[220:223], a[220:223], v[80:83], v[220:223]
s_waitcnt lgkmcnt(6)
v_add_u32 v21, s41, v18
v_add_u32 v22, s41, v19
v_add_u32 v23, s41, v20
s_add_u32 s101, s101, 8192
s_add_u32 s100, s100, s92
s_and_b32 s39, s100, 0xf800
s_and_b32 s93, s101, 0x40000
s_or_b32 s39, s39, s93
s_add_u32 s38, s38, 17408
s_cmp_eq_u32 s38, s71
s_cselect_b32 s38, s70, s38
s_sub_u32 s32, s32, 1
s_cmp_lg_u32 s32, 0
v_add_f32 v88, v88, v78
v_add_f32 v89, v89, v79
s_waitcnt vmcnt(32)
s_barrier
v_mfma_f32_16x16x32_bf16 v[72:75], a[160:163], a[96:99], v[104:107]
ds_read_b128 a[128:131], v21 offset:0
v_exp_f32 v64, v64
v_mfma_f32_16x16x32_bf16 v[72:75], a[164:167], a[100:103], v[72:75]
ds_read_b128 a[132:135], v21 offset:64
v_exp_f32 v65, v65
v_mfma_f32_16x16x32_bf16 v[72:75], a[168:171], a[104:107], v[72:75]
ds_read_b128 a[136:139], v21 offset:128
v_cvt_pk_bf16_f32 v80, v64, v65
v_mfma_f32_16x16x32_bf16 v[72:75], a[172:175], a[108:111], v[72:75]
v_exp_f32 v66, v66
v_mfma_f32_16x16x32_bf16 v[128:131], a[224:227], v[84:87], v[128:131]
s_add_u32 m0, s38, 0
ds_read_b128 a[140:143], v21 offset:192
v_add_f32 v90, v90, v64
v_add_f32 v91, v91, v65
v_mfma_f32_16x16x32_bf16 v[132:135], a[228:231], v[84:87], v[132:135]
buffer_load_dwordx4 v24, s[16:19], s39 offen offset:0 nt lds
v_exp_f32 v67, v67
v_mfma_f32_16x16x32_bf16 v[136:139], a[232:235], v[84:87], v[136:139]
ds_read_b128 a[144:147], v21 offset:4352
v_cvt_pk_bf16_f32 v81, v66, v67
v_mfma_f32_16x16x32_bf16 v[140:143], a[236:239], v[84:87], v[140:143]
v_exp_f32 v68, v68
v_mfma_f32_16x16x32_bf16 v[76:79], a[176:179], a[96:99], v[104:107]
ds_read_b128 a[148:151], v21 offset:4416
v_add_f32 v90, v90, v66
v_add_f32 v91, v91, v67
v_mfma_f32_16x16x32_bf16 v[76:79], a[180:183], a[100:103], v[76:79]
v_exp_f32 v69, v69
v_mfma_f32_16x16x32_bf16 v[76:79], a[184:187], a[104:107], v[76:79]
ds_read_b128 a[152:155], v21 offset:4480
v_cvt_pk_bf16_f32 v82, v68, v69
v_mfma_f32_16x16x32_bf16 v[76:79], a[188:191], a[108:111], v[76:79]
s_waitcnt lgkmcnt(7)
v_exp_f32 v70, v70
v_mfma_f32_16x16x32_bf16 v[144:147], a[240:243], v[84:87], v[144:147]
v_add_f32 v90, v90, v68
v_add_f32 v91, v91, v69
v_mfma_f32_16x16x32_bf16 v[148:151], a[244:247], v[84:87], v[148:151]
v_exp_f32 v71, v71
v_mfma_f32_16x16x32_bf16 v[152:155], a[248:251], v[84:87], v[152:155]
ds_read_b128 a[156:159], v21 offset:4544
v_cvt_pk_bf16_f32 v83, v70, v71
v_mfma_f32_16x16x32_bf16 v[156:159], a[252:255], v[84:87], v[156:159]
s_waitcnt lgkmcnt(4)
v_add_f32 v90, v90, v70
v_add_f32 v91, v91, v71
v_mfma_f32_16x16x32_bf16 v[64:67], a[128:131], a[64:67], v[96:99]
ds_read_b64_tr_b16 a[192:193], v22 offset:8704
v_exp_f32 v72, v72
v_mfma_f32_16x16x32_bf16 v[64:67], a[132:135], a[68:71], v[64:67]
ds_read_b64_tr_b16 a[194:195], v22 offset:13056
v_exp_f32 v73, v73
v_mfma_f32_16x16x32_bf16 v[64:67], a[136:139], a[72:75], v[64:67]
ds_read_b64_tr_b16 a[196:197], v23 offset:8736
v_cvt_pk_bf16_f32 v84, v72, v73
v_mfma_f32_16x16x32_bf16 v[64:67], a[140:143], a[76:79], v[64:67]
v_exp_f32 v74, v74
v_mfma_f32_16x16x32_bf16 v[160:163], a[224:227], v[80:83], v[160:163]
s_add_u32 m0, s38, 8704
ds_read_b64_tr_b16 a[198:199], v23 offset:13088
v_add_f32 v92, v92, v72
v_add_f32 v93, v93, v73
v_mfma_f32_16x16x32_bf16 v[164:167], a[228:231], v[80:83], v[164:167]
buffer_load_dwordx4 v25, s[20:23], s39 offen offset:0 nt lds
v_exp_f32 v75, v75
v_mfma_f32_16x16x32_bf16 v[168:171], a[232:235], v[80:83], v[168:171]
ds_read_b64_tr_b16 a[200:201], v22 offset:8768
v_cvt_pk_bf16_f32 v85, v74, v75
v_mfma_f32_16x16x32_bf16 v[172:175], a[236:239], v[80:83], v[172:175]
s_waitcnt lgkmcnt(5)
v_exp_f32 v76, v76
v_mfma_f32_16x16x32_bf16 v[68:71], a[144:147], a[64:67], v[96:99]
ds_read_b64_tr_b16 a[202:203], v22 offset:13120
v_add_f32 v92, v92, v74
v_add_f32 v93, v93, v75
v_mfma_f32_16x16x32_bf16 v[68:71], a[148:151], a[68:71], v[68:71]
v_exp_f32 v77, v77
v_mfma_f32_16x16x32_bf16 v[68:71], a[152:155], a[72:75], v[68:71]
ds_read_b64_tr_b16 a[204:205], v23 offset:8800
v_cvt_pk_bf16_f32 v86, v76, v77
v_mfma_f32_16x16x32_bf16 v[68:71], a[156:159], a[76:79], v[68:71]
v_exp_f32 v78, v78
v_mfma_f32_16x16x32_bf16 v[176:179], a[240:243], v[80:83], v[176:179]
v_add_f32 v92, v92, v76
v_add_f32 v93, v93, v77
v_mfma_f32_16x16x32_bf16 v[180:183], a[244:247], v[80:83], v[180:183]
v_exp_f32 v79, v79
v_mfma_f32_16x16x32_bf16 v[184:187], a[248:251], v[80:83], v[184:187]
ds_read_b64_tr_b16 a[206:207], v23 offset:13152
v_cvt_pk_bf16_f32 v87, v78, v79
v_mfma_f32_16x16x32_bf16 v[188:191], a[252:255], v[80:83], v[188:191]
s_waitcnt lgkmcnt(6)
v_add_f32 v92, v92, v78
v_add_f32 v93, v93, v79
v_mfma_f32_16x16x32_bf16 v[72:75], a[128:131], a[80:83], v[100:103]
ds_read_b64_tr_b16 a[208:209], v22 offset:8832
v_exp_f32 v64, v64
v_mfma_f32_16x16x32_bf16 v[72:75], a[132:135], a[84:87], v[72:75]
ds_read_b64_tr_b16 a[210:211], v22 offset:13184
v_exp_f32 v65, v65
v_mfma_f32_16x16x32_bf16 v[72:75], a[136:139], a[88:91], v[72:75]
ds_read_b64_tr_b16 a[212:213], v23 offset:8864
v_cvt_pk_bf16_f32 v80, v64, v65
v_mfma_f32_16x16x32_bf16 v[72:75], a[140:143], a[92:95], v[72:75]
v_exp_f32 v66, v66
v_mfma_f32_16x16x32_bf16 v[192:195], a[224:227], v[84:87], v[192:195]
s_add_u32 m0, s38, 64
ds_read_b64_tr_b16 a[214:215], v23 offset:13216
v_add_f32 v88, v88, v64
v_add_f32 v89, v89, v65
v_mfma_f32_16x16x32_bf16 v[196:199], a[228:231], v[84:87], v[196:199]
buffer_load_dwordx4 v24, s[16:19], s39 offen offset:1024 nt lds
v_exp_f32 v67, v67
v_mfma_f32_16x16x32_bf16 v[200:203], a[232:235], v[84:87], v[200:203]
ds_read_b64_tr_b16 a[216:217], v22 offset:8896
v_cvt_pk_bf16_f32 v81, v66, v67
v_mfma_f32_16x16x32_bf16 v[204:207], a[236:239], v[84:87], v[204:207]
v_exp_f32 v68, v68
v_mfma_f32_16x16x32_bf16 v[76:79], a[144:147], a[80:83], v[100:103]
ds_read_b64_tr_b16 a[218:219], v22 offset:13248
v_add_f32 v88, v88, v66
v_add_f32 v89, v89, v67
v_mfma_f32_16x16x32_bf16 v[76:79], a[148:151], a[84:87], v[76:79]
v_exp_f32 v69, v69
v_mfma_f32_16x16x32_bf16 v[76:79], a[152:155], a[88:91], v[76:79]
s_add_u32 m0, s38, 9536
ds_read_b64_tr_b16 a[220:221], v23 offset:8928
v_cvt_pk_bf16_f32 v82, v68, v69
v_mfma_f32_16x16x32_bf16 v[76:79], a[156:159], a[92:95], v[76:79]
buffer_load_dwordx4 v25, s[20:23], s39 offen offset:256 nt lds
v_exp_f32 v70, v70
v_mfma_f32_16x16x32_bf16 v[208:211], a[240:243], v[84:87], v[208:211]
v_add_f32 v88, v88, v68
v_add_f32 v89, v89, v69
v_mfma_f32_16x16x32_bf16 v[212:215], a[244:247], v[84:87], v[212:215]
v_exp_f32 v71, v71
v_mfma_f32_16x16x32_bf16 v[216:219], a[248:251], v[84:87], v[216:219]
ds_read_b64_tr_b16 a[222:223], v23 offset:13280
v_cvt_pk_bf16_f32 v83, v70, v71
v_mfma_f32_16x16x32_bf16 v[220:223], a[252:255], v[84:87], v[220:223]
s_waitcnt lgkmcnt(6)
s_add_u32 s101, s101, 8192
s_add_u32 s100, s100, s92
s_and_b32 s39, s100, 0xf800
s_and_b32 s93, s101, 0x40000
s_or_b32 s39, s39, s93
s_add_u32 s38, s38, 17408
s_cmp_eq_u32 s38, s71
s_cselect_b32 s38, s70, s38
v_add_f32 v88, v88, v70
v_add_f32 v89, v89, v71
s_waitcnt vmcnt(32)
s_barrier
v_mov_b32 v28, 163832
ds_read_b32 v29, v28
v_mfma_f32_16x16x32_bf16 v[64:67], a[128:131], a[96:99], v[104:107]
ds_read_b128 a[160:163], v21 offset:17408
v_exp_f32 v72, v72
v_mfma_f32_16x16x32_bf16 v[64:67], a[132:135], a[100:103], v[64:67]
ds_read_b128 a[164:167], v21 offset:17472
v_exp_f32 v73, v73
v_mfma_f32_16x16x32_bf16 v[64:67], a[136:139], a[104:107], v[64:67]
ds_read_b128 a[168:171], v21 offset:17536
v_cvt_pk_bf16_f32 v84, v72, v73
v_mfma_f32_16x16x32_bf16 v[64:67], a[140:143], a[108:111], v[64:67]
v_exp_f32 v74, v74
v_mfma_f32_16x16x32_bf16 v[128:131], a[192:195], v[80:83], v[128:131]
s_add_u32 m0, s38, 0
ds_read_b128 a[172:175], v21 offset:17600
v_add_f32 v90, v90, v72
v_add_f32 v91, v91, v73
v_mfma_f32_16x16x32_bf16 v[132:135], a[196:199], v[80:83], v[132:135]
buffer_load_dwordx4 v24, s[16:19], s39 offen offset:0 nt lds
v_exp_f32 v75, v75
v_mfma_f32_16x16x32_bf16 v[136:139], a[200:203], v[80:83], v[136:139]
ds_read_b128 a[176:179], v21 offset:21760
v_cvt_pk_bf16_f32 v85, v74, v75
v_mfma_f32_16x16x32_bf16 v[140:143], a[204:207], v[80:83], v[140:143]
v_exp_f32 v76, v76
v_mfma_f32_16x16x32_bf16 v[68:71], a[144:147], a[96:99], v[104:107]
ds_read_b128 a[180:183], v21 offset:21824
v_add_f32 v90, v90, v74
v_add_f32 v91, v91, v75
v_mfma_f32_16x16x32_bf16 v[68:71], a[148:151], a[100:103], v[68:71]
v_exp_f32 v77, v77
v_mfma_f32_16x16x32_bf16 v[68:71], a[152:155], a[104:107], v[68:71]
ds_read_b128 a[184:187], v21 offset:21888
v_cvt_pk_bf16_f32 v86, v76, v77
v_mfma_f32_16x16x32_bf16 v[68:71], a[156:159], a[108:111], v[68:71]
s_waitcnt lgkmcnt(8)
v_exp_f32 v78, v78
v_mfma_f32_16x16x32_bf16 v[144:147], a[208:211], v[80:83], v[144:147]
v_add_f32 v90, v90, v76
v_add_f32 v91, v91, v77
v_mfma_f32_16x16x32_bf16 v[148:151], a[212:215], v[80:83], v[148:151]
v_exp_f32 v79, v79
v_mfma_f32_16x16x32_bf16 v[152:155], a[216:219], v[80:83], v[152:155]
ds_read_b128 a[188:191], v21 offset:21952
v_cvt_pk_bf16_f32 v87, v78, v79
v_mfma_f32_16x16x32_bf16 v[156:159], a[220:223], v[80:83], v[156:159]
s_waitcnt lgkmcnt(4)
v_add_f32 v90, v90, v78
v_add_f32 v91, v91, v79
v_mfma_f32_16x16x32_bf16 v[72:75], a[160:163], a[64:67], v[96:99]
ds_read_b64_tr_b16 a[224:225], v22 offset:26112
v_exp_f32 v64, v64
v_mfma_f32_16x16x32_bf16 v[72:75], a[164:167], a[68:71], v[72:75]
ds_read_b64_tr_b16 a[226:227], v22 offset:30464
v_exp_f32 v65, v65
v_mfma_f32_16x16x32_bf16 v[72:75], a[168:171], a[72:75], v[72:75]
ds_read_b64_tr_b16 a[228:229], v23 offset:26144
v_cvt_pk_bf16_f32 v80, v64, v65
v_mfma_f32_16x16x32_bf16 v[72:75], a[172:175], a[76:79], v[72:75]
v_exp_f32 v66, v66
v_mfma_f32_16x16x32_bf16 v[160:163], a[192:195], v[84:87], v[160:163]
s_add_u32 m0, s38, 8704
ds_read_b64_tr_b16 a[230:231], v23 offset:30496
v_add_f32 v92, v92, v64
v_add_f32 v93, v93, v65
v_mfma_f32_16x16x32_bf16 v[164:167], a[196:199], v[84:87], v[164:167]
buffer_load_dwordx4 v25, s[20:23], s39 offen offset:0 nt lds
v_exp_f32 v67, v67
v_mfma_f32_16x16x32_bf16 v[168:171], a[200:203], v[84:87], v[168:171]
ds_read_b64_tr_b16 a[232:233], v22 offset:26176
v_cvt_pk_bf16_f32 v81, v66, v67
v_mfma_f32_16x16x32_bf16 v[172:175], a[204:207], v[84:87], v[172:175]
s_waitcnt lgkmcnt(5)
v_exp_f32 v68, v68
v_mfma_f32_16x16x32_bf16 v[76:79], a[176:179], a[64:67], v[96:99]
ds_read_b64_tr_b16 a[234:235], v22 offset:30528
v_add_f32 v92, v92, v66
v_add_f32 v93, v93, v67
v_mfma_f32_16x16x32_bf16 v[76:79], a[180:183], a[68:71], v[76:79]
v_exp_f32 v69, v69
v_mfma_f32_16x16x32_bf16 v[76:79], a[184:187], a[72:75], v[76:79]
ds_read_b64_tr_b16 a[236:237], v23 offset:26208
v_cvt_pk_bf16_f32 v82, v68, v69
v_mfma_f32_16x16x32_bf16 v[76:79], a[188:191], a[76:79], v[76:79]
v_exp_f32 v70, v70
v_mfma_f32_16x16x32_bf16 v[176:179], a[208:211], v[84:87], v[176:179]
v_add_f32 v92, v92, v68
v_add_f32 v93, v93, v69
v_mfma_f32_16x16x32_bf16 v[180:183], a[212:215], v[84:87], v[180:183]
v_exp_f32 v71, v71
v_mfma_f32_16x16x32_bf16 v[184:187], a[216:219], v[84:87], v[184:187]
ds_read_b64_tr_b16 a[238:239], v23 offset:30560
v_cvt_pk_bf16_f32 v83, v70, v71
v_mfma_f32_16x16x32_bf16 v[188:191], a[220:223], v[84:87], v[188:191]
s_waitcnt lgkmcnt(6)
v_add_f32 v92, v92, v70
v_add_f32 v93, v93, v71
v_mfma_f32_16x16x32_bf16 v[64:67], a[160:163], a[80:83], v[100:103]
ds_read_b64_tr_b16 a[240:241], v22 offset:26240
v_exp_f32 v72, v72
v_mfma_f32_16x16x32_bf16 v[64:67], a[164:167], a[84:87], v[64:67]
ds_read_b64_tr_b16 a[242:243], v22 offset:30592
v_exp_f32 v73, v73
v_mfma_f32_16x16x32_bf16 v[64:67], a[168:171], a[88:91], v[64:67]
ds_read_b64_tr_b16 a[244:245], v23 offset:26272
v_cvt_pk_bf16_f32 v84, v72, v73
v_mfma_f32_16x16x32_bf16 v[64:67], a[172:175], a[92:95], v[64:67]
s_add_u32 s41, s41, 34816
v_exp_f32 v74, v74
v_mfma_f32_16x16x32_bf16 v[192:195], a[192:195], v[80:83], v[192:195]
s_add_u32 m0, s38, 64
ds_read_b64_tr_b16 a[246:247], v23 offset:30624
v_add_f32 v88, v88, v72
v_add_f32 v89, v89, v73
v_mfma_f32_16x16x32_bf16 v[196:199], a[196:199], v[80:83], v[196:199]
s_cmp_eq_u32 s41, 139264
buffer_load_dwordx4 v24, s[16:19], s39 offen offset:1024 nt lds
v_exp_f32 v75, v75
v_mfma_f32_16x16x32_bf16 v[200:203], a[200:203], v[80:83], v[200:203]
ds_read_b64_tr_b16 a[248:249], v22 offset:26304
v_cvt_pk_bf16_f32 v85, v74, v75
v_mfma_f32_16x16x32_bf16 v[204:207], a[204:207], v[80:83], v[204:207]
s_cselect_b32 s41, 0, s41
v_exp_f32 v76, v76
v_mfma_f32_16x16x32_bf16 v[68:71], a[176:179], a[80:83], v[100:103]
ds_read_b64_tr_b16 a[250:251], v22 offset:30656
v_add_f32 v88, v88, v74
v_add_f32 v89, v89, v75
v_mfma_f32_16x16x32_bf16 v[68:71], a[180:183], a[84:87], v[68:71]
v_exp_f32 v77, v77
v_mfma_f32_16x16x32_bf16 v[68:71], a[184:187], a[88:91], v[68:71]
s_add_u32 m0, s38, 9536
ds_read_b64_tr_b16 a[252:253], v23 offset:26336
v_cvt_pk_bf16_f32 v86, v76, v77
v_mfma_f32_16x16x32_bf16 v[68:71], a[188:191], a[92:95], v[68:71]
buffer_load_dwordx4 v25, s[20:23], s39 offen offset:256 nt lds
v_exp_f32 v78, v78
v_mfma_f32_16x16x32_bf16 v[208:211], a[208:211], v[80:83], v[208:211]
v_add_f32 v88, v88, v76
v_add_f32 v89, v89, v77
v_mfma_f32_16x16x32_bf16 v[212:215], a[212:215], v[80:83], v[212:215]
v_exp_f32 v79, v79
v_mfma_f32_16x16x32_bf16 v[216:219], a[216:219], v[80:83], v[216:219]
ds_read_b64_tr_b16 a[254:255], v23 offset:30688
v_cvt_pk_bf16_f32 v87, v78, v79
v_mfma_f32_16x16x32_bf16 v[220:223], a[220:223], v[80:83], v[220:223]
s_waitcnt lgkmcnt(6)
v_add_u32 v21, s41, v18
v_add_u32 v22, s41, v19
v_add_u32 v23, s41, v20
s_add_u32 s101, s101, 8192
s_add_u32 s100, s100, s92
s_and_b32 s39, s100, 0xf800
s_and_b32 s93, s101, 0x40000
s_or_b32 s39, s39, s93
s_add_u32 s38, s38, 17408
s_cmp_eq_u32 s38, s71
s_cselect_b32 s38, s70, s38
s_sub_u32 s32, s32, 1
s_cmp_lg_u32 s32, 0
v_add_f32 v88, v88, v78
v_add_f32 v89, v89, v79
s_waitcnt vmcnt(26)
s_barrier
v_readfirstlane_b32 s66, v29
v_mfma_f32_16x16x32_bf16 v[72:75], a[160:163], a[96:99], v[104:107]
ds_read_b128 a[128:131], v21 offset:0
v_exp_f32 v64, v64
v_mfma_f32_16x16x32_bf16 v[72:75], a[164:167], a[100:103], v[72:75]
ds_read_b128 a[132:135], v21 offset:64
v_exp_f32 v65, v65
v_mfma_f32_16x16x32_bf16 v[72:75], a[168:171], a[104:107], v[72:75]
ds_read_b128 a[136:139], v21 offset:128
v_cvt_pk_bf16_f32 v80, v64, v65
v_mfma_f32_16x16x32_bf16 v[72:75], a[172:175], a[108:111], v[72:75]
v_exp_f32 v66, v66
v_mfma_f32_16x16x32_bf16 v[128:131], a[224:227], v[84:87], v[128:131]
s_add_u32 m0, s38, 0
ds_read_b128 a[140:143], v21 offset:192
v_add_f32 v90, v90, v64
v_add_f32 v91, v91, v65
v_mfma_f32_16x16x32_bf16 v[132:135], a[228:231], v[84:87], v[132:135]
buffer_load_dwordx4 v24, s[16:19], s39 offen offset:0 nt lds
v_exp_f32 v67, v67
v_mfma_f32_16x16x32_bf16 v[136:139], a[232:235], v[84:87], v[136:139]
ds_read_b128 a[144:147], v21 offset:4352
v_cvt_pk_bf16_f32 v81, v66, v67
v_mfma_f32_16x16x32_bf16 v[140:143], a[236:239], v[84:87], v[140:143]
v_exp_f32 v68, v68
v_mfma_f32_16x16x32_bf16 v[76:79], a[176:179], a[96:99], v[104:107]
ds_read_b128 a[148:151], v21 offset:4416
v_add_f32 v90, v90, v66
v_add_f32 v91, v91, v67
v_mfma_f32_16x16x32_bf16 v[76:79], a[180:183], a[100:103], v[76:79]
v_exp_f32 v69, v69
v_mfma_f32_16x16x32_bf16 v[76:79], a[184:187], a[104:107], v[76:79]
ds_read_b128 a[152:155], v21 offset:4480
v_cvt_pk_bf16_f32 v82, v68, v69
v_mfma_f32_16x16x32_bf16 v[76:79], a[188:191], a[108:111], v[76:79]
s_waitcnt lgkmcnt(7)
v_exp_f32 v70, v70
v_mfma_f32_16x16x32_bf16 v[144:147], a[240:243], v[84:87], v[144:147]
v_add_f32 v90, v90, v68
v_add_f32 v91, v91, v69
v_mfma_f32_16x16x32_bf16 v[148:151], a[244:247], v[84:87], v[148:151]
v_exp_f32 v71, v71
v_mfma_f32_16x16x32_bf16 v[152:155], a[248:251], v[84:87], v[152:155]
ds_read_b128 a[156:159], v21 offset:4544
v_cvt_pk_bf16_f32 v83, v70, v71
v_mfma_f32_16x16x32_bf16 v[156:159], a[252:255], v[84:87], v[156:159]
s_waitcnt lgkmcnt(4)
v_add_f32 v90, v90, v70
v_add_f32 v91, v91, v71
v_mfma_f32_16x16x32_bf16 v[64:67], a[128:131], a[64:67], v[96:99]
ds_read_b64_tr_b16 a[192:193], v22 offset:8704
v_exp_f32 v72, v72
v_mfma_f32_16x16x32_bf16 v[64:67], a[132:135], a[68:71], v[64:67]
ds_read_b64_tr_b16 a[194:195], v22 offset:13056
v_exp_f32 v73, v73
v_mfma_f32_16x16x32_bf16 v[64:67], a[136:139], a[72:75], v[64:67]
ds_read_b64_tr_b16 a[196:197], v23 offset:8736
v_cvt_pk_bf16_f32 v84, v72, v73
v_mfma_f32_16x16x32_bf16 v[64:67], a[140:143], a[76:79], v[64:67]
v_exp_f32 v74, v74
v_mfma_f32_16x16x32_bf16 v[160:163], a[224:227], v[80:83], v[160:163]
s_add_u32 m0, s38, 8704
ds_read_b64_tr_b16 a[198:199], v23 offset:13088
v_add_f32 v92, v92, v72
v_add_f32 v93, v93, v73
v_mfma_f32_16x16x32_bf16 v[164:167], a[228:231], v[80:83], v[164:167]
buffer_load_dwordx4 v25, s[20:23], s39 offen offset:0 nt lds
v_exp_f32 v75, v75
v_mfma_f32_16x16x32_bf16 v[168:171], a[232:235], v[80:83], v[168:171]
ds_read_b64_tr_b16 a[200:201], v22 offset:8768
v_cvt_pk_bf16_f32 v85, v74, v75
v_mfma_f32_16x16x32_bf16 v[172:175], a[236:239], v[80:83], v[172:175]
s_waitcnt lgkmcnt(5)
v_exp_f32 v76, v76
v_mfma_f32_16x16x32_bf16 v[68:71], a[144:147], a[64:67], v[96:99]
ds_read_b64_tr_b16 a[202:203], v22 offset:13120
v_add_f32 v92, v92, v74
v_add_f32 v93, v93, v75
v_mfma_f32_16x16x32_bf16 v[68:71], a[148:151], a[68:71], v[68:71]
v_exp_f32 v77, v77
v_mfma_f32_16x16x32_bf16 v[68:71], a[152:155], a[72:75], v[68:71]
ds_read_b64_tr_b16 a[204:205], v23 offset:8800
v_cvt_pk_bf16_f32 v86, v76, v77
v_mfma_f32_16x16x32_bf16 v[68:71], a[156:159], a[76:79], v[68:71]
v_exp_f32 v78, v78
v_mfma_f32_16x16x32_bf16 v[176:179], a[240:243], v[80:83], v[176:179]
v_add_f32 v92, v92, v76
v_add_f32 v93, v93, v77
v_mfma_f32_16x16x32_bf16 v[180:183], a[244:247], v[80:83], v[180:183]
v_exp_f32 v79, v79
v_mfma_f32_16x16x32_bf16 v[184:187], a[248:251], v[80:83], v[184:187]
ds_read_b64_tr_b16 a[206:207], v23 offset:13152
v_cvt_pk_bf16_f32 v87, v78, v79
v_mfma_f32_16x16x32_bf16 v[188:191], a[252:255], v[80:83], v[188:191]
s_waitcnt lgkmcnt(6)
v_add_f32 v92, v92, v78
v_add_f32 v93, v93, v79
v_mfma_f32_16x16x32_bf16 v[72:75], a[128:131], a[80:83], v[100:103]
ds_read_b64_tr_b16 a[208:209], v22 offset:8832
v_exp_f32 v64, v64
v_mfma_f32_16x16x32_bf16 v[72:75], a[132:135], a[84:87], v[72:75]
ds_read_b64_tr_b16 a[210:211], v22 offset:13184
v_exp_f32 v65, v65
v_mfma_f32_16x16x32_bf16 v[72:75], a[136:139], a[88:91], v[72:75]
ds_read_b64_tr_b16 a[212:213], v23 offset:8864
v_cvt_pk_bf16_f32 v80, v64, v65
v_mfma_f32_16x16x32_bf16 v[72:75], a[140:143], a[92:95], v[72:75]
v_exp_f32 v66, v66
v_mfma_f32_16x16x32_bf16 v[192:195], a[224:227], v[84:87], v[192:195]
s_add_u32 m0, s38, 64
ds_read_b64_tr_b16 a[214:215], v23 offset:13216
v_add_f32 v88, v88, v64
v_add_f32 v89, v89, v65
v_mfma_f32_16x16x32_bf16 v[196:199], a[228:231], v[84:87], v[196:199]
buffer_load_dwordx4 v24, s[16:19], s39 offen offset:1024 nt lds
v_exp_f32 v67, v67
v_mfma_f32_16x16x32_bf16 v[200:203], a[232:235], v[84:87], v[200:203]
ds_read_b64_tr_b16 a[216:217], v22 offset:8896
v_cvt_pk_bf16_f32 v81, v66, v67
v_mfma_f32_16x16x32_bf16 v[204:207], a[236:239], v[84:87], v[204:207]
v_exp_f32 v68, v68
v_mfma_f32_16x16x32_bf16 v[76:79], a[144:147], a[80:83], v[100:103]
ds_read_b64_tr_b16 a[218:219], v22 offset:13248
v_add_f32 v88, v88, v66
v_add_f32 v89, v89, v67
v_mfma_f32_16x16x32_bf16 v[76:79], a[148:151], a[84:87], v[76:79]
v_exp_f32 v69, v69
v_mfma_f32_16x16x32_bf16 v[76:79], a[152:155], a[88:91], v[76:79]
s_add_u32 m0, s38, 9536
ds_read_b64_tr_b16 a[220:221], v23 offset:8928
v_cvt_pk_bf16_f32 v82, v68, v69
v_mfma_f32_16x16x32_bf16 v[76:79], a[156:159], a[92:95], v[76:79]
buffer_load_dwordx4 v25, s[20:23], s39 offen offset:256 nt lds
v_exp_f32 v70, v70
v_mfma_f32_16x16x32_bf16 v[208:211], a[240:243], v[84:87], v[208:211]
v_add_f32 v88, v88, v68
v_add_f32 v89, v89, v69
v_mfma_f32_16x16x32_bf16 v[212:215], a[244:247], v[84:87], v[212:215]
v_exp_f32 v71, v71
v_mfma_f32_16x16x32_bf16 v[216:219], a[248:251], v[84:87], v[216:219]
ds_read_b64_tr_b16 a[222:223], v23 offset:13280
v_cvt_pk_bf16_f32 v83, v70, v71
v_mfma_f32_16x16x32_bf16 v[220:223], a[252:255], v[84:87], v[220:223]
s_waitcnt lgkmcnt(6)
s_add_u32 s101, s101, 8192
s_add_u32 s100, s100, s92
s_and_b32 s39, s100, 0xf800
s_and_b32 s93, s101, 0x40000
s_or_b32 s39, s39, s93
s_add_u32 s38, s38, 17408
s_cmp_eq_u32 s38, s71
s_cselect_b32 s38, s70, s38
v_add_f32 v88, v88, v70
v_add_f32 v89, v89, v71
s_waitcnt vmcnt(20)
s_barrier
v_mfma_f32_16x16x32_bf16 v[64:67], a[128:131], a[96:99], v[104:107]
ds_read_b128 a[160:163], v21 offset:17408
v_exp_f32 v72, v72
v_mfma_f32_16x16x32_bf16 v[64:67], a[132:135], a[100:103], v[64:67]
ds_read_b128 a[164:167], v21 offset:17472
v_exp_f32 v73, v73
v_mfma_f32_16x16x32_bf16 v[64:67], a[136:139], a[104:107], v[64:67]
ds_read_b128 a[168:171], v21 offset:17536
v_cvt_pk_bf16_f32 v84, v72, v73
v_mfma_f32_16x16x32_bf16 v[64:67], a[140:143], a[108:111], v[64:67]
v_exp_f32 v74, v74
v_mfma_f32_16x16x32_bf16 v[128:131], a[192:195], v[80:83], v[128:131]
s_add_u32 m0, s38, 0
ds_read_b128 a[172:175], v21 offset:17600
v_add_f32 v90, v90, v72
v_add_f32 v91, v91, v73
v_mfma_f32_16x16x32_bf16 v[132:135], a[196:199], v[80:83], v[132:135]
buffer_load_dwordx4 v24, s[16:19], s39 offen offset:0 nt lds
v_exp_f32 v75, v75
v_mfma_f32_16x16x32_bf16 v[136:139], a[200:203], v[80:83], v[136:139]
ds_read_b128 a[176:179], v21 offset:21760
v_cvt_pk_bf16_f32 v85, v74, v75
v_mfma_f32_16x16x32_bf16 v[140:143], a[204:207], v[80:83], v[140:143]
v_exp_f32 v76, v76
v_mfma_f32_16x16x32_bf16 v[68:71], a[144:147], a[96:99], v[104:107]
ds_read_b128 a[180:183], v21 offset:21824
v_add_f32 v90, v90, v74
v_add_f32 v91, v91, v75
v_mfma_f32_16x16x32_bf16 v[68:71], a[148:151], a[100:103], v[68:71]
v_exp_f32 v77, v77
v_mfma_f32_16x16x32_bf16 v[68:71], a[152:155], a[104:107], v[68:71]
ds_read_b128 a[184:187], v21 offset:21888
v_cvt_pk_bf16_f32 v86, v76, v77
v_mfma_f32_16x16x32_bf16 v[68:71], a[156:159], a[108:111], v[68:71]
s_waitcnt lgkmcnt(7)
v_exp_f32 v78, v78
v_mfma_f32_16x16x32_bf16 v[144:147], a[208:211], v[80:83], v[144:147]
v_add_f32 v90, v90, v76
v_add_f32 v91, v91, v77
v_mfma_f32_16x16x32_bf16 v[148:151], a[212:215], v[80:83], v[148:151]
v_exp_f32 v79, v79
v_mfma_f32_16x16x32_bf16 v[152:155], a[216:219], v[80:83], v[152:155]
ds_read_b128 a[188:191], v21 offset:21952
v_cvt_pk_bf16_f32 v87, v78, v79
v_mfma_f32_16x16x32_bf16 v[156:159], a[220:223], v[80:83], v[156:159]
s_waitcnt lgkmcnt(4)
v_add_f32 v90, v90, v78
v_add_f32 v91, v91, v79
v_mfma_f32_16x16x32_bf16 v[72:75], a[160:163], a[64:67], v[96:99]
ds_read_b64_tr_b16 a[224:225], v22 offset:26112
v_exp_f32 v64, v64
v_mfma_f32_16x16x32_bf16 v[72:75], a[164:167], a[68:71], v[72:75]
ds_read_b64_tr_b16 a[226:227], v22 offset:30464
v_exp_f32 v65, v65
v_mfma_f32_16x16x32_bf16 v[72:75], a[168:171], a[72:75], v[72:75]
ds_read_b64_tr_b16 a[228:229], v23 offset:26144
v_cvt_pk_bf16_f32 v80, v64, v65
v_mfma_f32_16x16x32_bf16 v[72:75], a[172:175], a[76:79], v[72:75]
v_exp_f32 v66, v66
v_mfma_f32_16x16x32_bf16 v[160:163], a[192:195], v[84:87], v[160:163]
s_add_u32 m0, s38, 8704
ds_read_b64_tr_b16 a[230:231], v23 offset:30496
v_add_f32 v92, v92, v64
v_add_f32 v93, v93, v65
v_mfma_f32_16x16x32_bf16 v[164:167], a[196:199], v[84:87], v[164:167]
buffer_load_dwordx4 v25, s[20:23], s39 offen offset:0 nt lds
v_exp_f32 v67, v67
v_mfma_f32_16x16x32_bf16 v[168:171], a[200:203], v[84:87], v[168:171]
ds_read_b64_tr_b16 a[232:233], v22 offset:26176
v_cvt_pk_bf16_f32 v81, v66, v67
v_mfma_f32_16x16x32_bf16 v[172:175], a[204:207], v[84:87], v[172:175]
s_waitcnt lgkmcnt(5)
v_exp_f32 v68, v68
v_mfma_f32_16x16x32_bf16 v[76:79], a[176:179], a[64:67], v[96:99]
ds_read_b64_tr_b16 a[234:235], v22 offset:30528
v_add_f32 v92, v92, v66
v_add_f32 v93, v93, v67
v_mfma_f32_16x16x32_bf16 v[76:79], a[180:183], a[68:71], v[76:79]
v_exp_f32 v69, v69
v_mfma_f32_16x16x32_bf16 v[76:79], a[184:187], a[72:75], v[76:79]
ds_read_b64_tr_b16 a[236:237], v23 offset:26208
v_cvt_pk_bf16_f32 v82, v68, v69
v_mfma_f32_16x16x32_bf16 v[76:79], a[188:191], a[76:79], v[76:79]
v_exp_f32 v70, v70
v_mfma_f32_16x16x32_bf16 v[176:179], a[208:211], v[84:87], v[176:179]
v_add_f32 v92, v92, v68
v_add_f32 v93, v93, v69
v_mfma_f32_16x16x32_bf16 v[180:183], a[212:215], v[84:87], v[180:183]
v_exp_f32 v71, v71
v_mfma_f32_16x16x32_bf16 v[184:187], a[216:219], v[84:87], v[184:187]
ds_read_b64_tr_b16 a[238:239], v23 offset:30560
v_cvt_pk_bf16_f32 v83, v70, v71
v_mfma_f32_16x16x32_bf16 v[188:191], a[220:223], v[84:87], v[188:191]
s_waitcnt lgkmcnt(6)
v_add_f32 v92, v92, v70
v_add_f32 v93, v93, v71
v_mfma_f32_16x16x32_bf16 v[64:67], a[160:163], a[80:83], v[100:103]
ds_read_b64_tr_b16 a[240:241], v22 offset:26240
v_exp_f32 v72, v72
v_mfma_f32_16x16x32_bf16 v[64:67], a[164:167], a[84:87], v[64:67]
ds_read_b64_tr_b16 a[242:243], v22 offset:30592
v_exp_f32 v73, v73
v_mfma_f32_16x16x32_bf16 v[64:67], a[168:171], a[88:91], v[64:67]
ds_read_b64_tr_b16 a[244:245], v23 offset:26272
v_cvt_pk_bf16_f32 v84, v72, v73
v_mfma_f32_16x16x32_bf16 v[64:67], a[172:175], a[92:95], v[64:67]
s_add_u32 s41, s41, 34816
v_exp_f32 v74, v74
v_mfma_f32_16x16x32_bf16 v[192:195], a[192:195], v[80:83], v[192:195]
s_add_u32 m0, s38, 64
ds_read_b64_tr_b16 a[246:247], v23 offset:30624
v_add_f32 v88, v88, v72
v_add_f32 v89, v89, v73
v_mfma_f32_16x16x32_bf16 v[196:199], a[196:199], v[80:83], v[196:199]
s_cmp_eq_u32 s41, 139264
buffer_load_dwordx4 v24, s[16:19], s39 offen offset:1024 nt lds
v_exp_f32 v75, v75
v_mfma_f32_16x16x32_bf16 v[200:203], a[200:203], v[80:83], v[200:203]
ds_read_b64_tr_b16 a[248:249], v22 offset:26304
v_cvt_pk_bf16_f32 v85, v74, v75
v_mfma_f32_16x16x32_bf16 v[204:207], a[204:207], v[80:83], v[204:207]
s_cselect_b32 s41, 0, s41
v_exp_f32 v76, v76
v_mfma_f32_16x16x32_bf16 v[68:71], a[176:179], a[80:83], v[100:103]
ds_read_b64_tr_b16 a[250:251], v22 offset:30656
v_add_f32 v88, v88, v74
v_add_f32 v89, v89, v75
v_mfma_f32_16x16x32_bf16 v[68:71], a[180:183], a[84:87], v[68:71]
v_exp_f32 v77, v77
v_mfma_f32_16x16x32_bf16 v[68:71], a[184:187], a[88:91], v[68:71]
s_add_u32 m0, s38, 9536
ds_read_b64_tr_b16 a[252:253], v23 offset:26336
v_cvt_pk_bf16_f32 v86, v76, v77
v_mfma_f32_16x16x32_bf16 v[68:71], a[188:191], a[92:95], v[68:71]
buffer_load_dwordx4 v25, s[20:23], s39 offen offset:256 nt lds
v_exp_f32 v78, v78
v_mfma_f32_16x16x32_bf16 v[208:211], a[208:211], v[80:83], v[208:211]
v_add_f32 v88, v88, v76
v_add_f32 v89, v89, v77
v_mfma_f32_16x16x32_bf16 v[212:215], a[212:215], v[80:83], v[212:215]
v_exp_f32 v79, v79
v_mfma_f32_16x16x32_bf16 v[216:219], a[216:219], v[80:83], v[216:219]
ds_read_b64_tr_b16 a[254:255], v23 offset:30688
v_cvt_pk_bf16_f32 v87, v78, v79
v_mfma_f32_16x16x32_bf16 v[220:223], a[220:223], v[80:83], v[220:223]
s_waitcnt lgkmcnt(6)
v_add_u32 v21, s41, v18
v_add_u32 v22, s41, v19
v_add_u32 v23, s41, v20
s_add_u32 s101, s101, 8192
s_add_u32 s100, s100, s92
s_and_b32 s39, s100, 0xf800
s_and_b32 s93, s101, 0x40000
s_or_b32 s39, s39, s93
s_add_u32 s38, s38, 17408
s_cmp_eq_u32 s38, s71
s_cselect_b32 s38, s70, s38
s_sub_u32 s32, s32, 1
s_cmp_lg_u32 s32, 0
v_add_f32 v88, v88, v78
v_add_f32 v89, v89, v79
s_mov_b32 s32, 9
L_at3_33:
s_waitcnt vmcnt(20)
s_barrier
v_mfma_f32_16x16x32_bf16 v[72:75], a[160:163], a[96:99], v[104:107]
ds_read_b128 a[128:131], v21 offset:0
v_exp_f32 v64, v64
v_mfma_f32_16x16x32_bf16 v[72:75], a[164:167], a[100:103], v[72:75]
ds_read_b128 a[132:135], v21 offset:64
v_exp_f32 v65, v65
v_mfma_f32_16x16x32_bf16 v[72:75], a[168:171], a[104:107], v[72:75]
ds_read_b128 a[136:139], v21 offset:128
v_cvt_pk_bf16_f32 v80, v64, v65
v_mfma_f32_16x16x32_bf16 v[72:75], a[172:175], a[108:111], v[72:75]
v_exp_f32 v66, v66
v_mfma_f32_16x16x32_bf16 v[128:131], a[224:227], v[84:87], v[128:131]
s_add_u32 m0, s38, 0
ds_read_b128 a[140:143], v21 offset:192
v_add_f32 v90, v90, v64
v_add_f32 v91, v91, v65
v_mfma_f32_16x16x32_bf16 v[132:135], a[228:231], v[84:87], v[132:135]
buffer_load_dwordx4 v24, s[16:19], s39 offen offset:0 nt lds
v_exp_f32 v67, v67
v_mfma_f32_16x16x32_bf16 v[136:139], a[232:235], v[84:87], v[136:139]
ds_read_b128 a[144:147], v21 offset:4352
v_cvt_pk_bf16_f32 v81, v66, v67
v_mfma_f32_16x16x32_bf16 v[140:143], a[236:239], v[84:87], v[140:143]
v_exp_f32 v68, v68
v_mfma_f32_16x16x32_bf16 v[76:79], a[176:179], a[96:99], v[104:107]
ds_read_b128 a[148:151], v21 offset:4416
v_add_f32 v90, v90, v66
v_add_f32 v91, v91, v67
v_mfma_f32_16x16x32_bf16 v[76:79], a[180:183], a[100:103], v[76:79]
v_exp_f32 v69, v69
v_mfma_f32_16x16x32_bf16 v[76:79], a[184:187], a[104:107], v[76:79]
ds_read_b128 a[152:155], v21 offset:4480
v_cvt_pk_bf16_f32 v82, v68, v69
v_mfma_f32_16x16x32_bf16 v[76:79], a[188:191], a[108:111], v[76:79]
s_waitcnt lgkmcnt(7)
v_exp_f32 v70, v70
v_mfma_f32_16x16x32_bf16 v[144:147], a[240:243], v[84:87], v[144:147]
v_add_f32 v90, v90, v68
v_add_f32 v91, v91, v69
v_mfma_f32_16x16x32_bf16 v[148:151], a[244:247], v[84:87], v[148:151]
v_exp_f32 v71, v71
v_mfma_f32_16x16x32_bf16 v[152:155], a[248:251], v[84:87], v[152:155]
ds_read_b128 a[156:159], v21 offset:4544
v_cvt_pk_bf16_f32 v83, v70, v71
v_mfma_f32_16x16x32_bf16 v[156:159], a[252:255], v[84:87], v[156:159]
s_waitcnt lgkmcnt(4)
v_add_f32 v90, v90, v70
v_add_f32 v91, v91, v71
v_mfma_f32_16x16x32_bf16 v[64:67], a[128:131], a[64:67], v[96:99]
ds_read_b64_tr_b16 a[192:193], v22 offset:8704
v_exp_f32 v72, v72
v_mfma_f32_16x16x32_bf16 v[64:67], a[132:135], a[68:71], v[64:67]
ds_read_b64_tr_b16 a[194:195], v22 offset:13056
v_exp_f32 v73, v73
v_mfma_f32_16x16x32_bf16 v[64:67], a[136:139], a[72:75], v[64:67]
ds_read_b64_tr_b16 a[196:197], v23 offset:8736
v_cvt_pk_bf16_f32 v84, v72, v73
v_mfma_f32_16x16x32_bf16 v[64:67], a[140:143], a[76:79], v[64:67]
v_exp_f32 v74, v74
v_mfma_f32_16x16x32_bf16 v[160:163], a[224:227], v[80:83], v[160:163]
s_add_u32 m0, s38, 8704
ds_read_b64_tr_b16 a[198:199], v23 offset:13088
v_add_f32 v92, v92, v72
v_add_f32 v93, v93, v73
v_mfma_f32_16x16x32_bf16 v[164:167], a[228:231], v[80:83], v[164:167]
buffer_load_dwordx4 v25, s[20:23], s39 offen offset:0 nt lds
v_exp_f32 v75, v75
v_mfma_f32_16x16x32_bf16 v[168:171], a[232:235], v[80:83], v[168:171]
ds_read_b64_tr_b16 a[200:201], v22 offset:8768
v_cvt_pk_bf16_f32 v85, v74, v75
v_mfma_f32_16x16x32_bf16 v[172:175], a[236:239], v[80:83], v[172:175]
s_waitcnt lgkmcnt(5)
v_exp_f32 v76, v76
v_mfma_f32_16x16x32_bf16 v[68:71], a[144:147], a[64:67], v[96:99]
ds_read_b64_tr_b16 a[202:203], v22 offset:13120
v_add_f32 v92, v92, v74
v_add_f32 v93, v93, v75
v_mfma_f32_16x16x32_bf16 v[68:71], a[148:151], a[68:71], v[68:71]
v_exp_f32 v77, v77
v_mfma_f32_16x16x32_bf16 v[68:71], a[152:155], a[72:75], v[68:71]
ds_read_b64_tr_b16 a[204:205], v23 offset:8800
v_cvt_pk_bf16_f32 v86, v76, v77
v_mfma_f32_16x16x32_bf16 v[68:71], a[156:159], a[76:79], v[68:71]
v_exp_f32 v78, v78
v_mfma_f32_16x16x32_bf16 v[176:179], a[240:243], v[80:83], v[176:179]
v_add_f32 v92, v92, v76
v_add_f32 v93, v93, v77
v_mfma_f32_16x16x32_bf16 v[180:183], a[244:247], v[80:83], v[180:183]
v_exp_f32 v79, v79
v_mfma_f32_16x16x32_bf16 v[184:187], a[248:251], v[80:83], v[184:187]
ds_read_b64_tr_b16 a[206:207], v23 offset:13152
v_cvt_pk_bf16_f32 v87, v78, v79
v_mfma_f32_16x16x32_bf16 v[188:191], a[252:255], v[80:83], v[188:191]
s_waitcnt lgkmcnt(6)
v_add_f32 v92, v92, v78
v_add_f32 v93, v93, v79
v_mfma_f32_16x16x32_bf16 v[72:75], a[128:131], a[80:83], v[100:103]
ds_read_b64_tr_b16 a[208:209], v22 offset:8832
v_exp_f32 v64, v64
v_mfma_f32_16x16x32_bf16 v[72:75], a[132:135], a[84:87], v[72:75]
ds_read_b64_tr_b16 a[210:211], v22 offset:13184
v_exp_f32 v65, v65
v_mfma_f32_16x16x32_bf16 v[72:75], a[136:139], a[88:91], v[72:75]
ds_read_b64_tr_b16 a[212:213], v23 offset:8864
v_cvt_pk_bf16_f32 v80, v64, v65
v_mfma_f32_16x16x32_bf16 v[72:75], a[140:143], a[92:95], v[72:75]
v_exp_f32 v66, v66
v_mfma_f32_16x16x32_bf16 v[192:195], a[224:227], v[84:87], v[192:195]
s_add_u32 m0, s38, 64
ds_read_b64_tr_b16 a[214:215], v23 offset:13216
v_add_f32 v88, v88, v64
v_add_f32 v89, v89, v65
v_mfma_f32_16x16x32_bf16 v[196:199], a[228:231], v[84:87], v[196:199]
buffer_load_dwordx4 v24, s[16:19], s39 offen offset:1024 nt lds
v_exp_f32 v67, v67
v_mfma_f32_16x16x32_bf16 v[200:203], a[232:235], v[84:87], v[200:203]
ds_read_b64_tr_b16 a[216:217], v22 offset:8896
v_cvt_pk_bf16_f32 v81, v66, v67
v_mfma_f32_16x16x32_bf16 v[204:207], a[236:239], v[84:87], v[204:207]
v_exp_f32 v68, v68
v_mfma_f32_16x16x32_bf16 v[76:79], a[144:147], a[80:83], v[100:103]
ds_read_b64_tr_b16 a[218:219], v22 offset:13248
v_add_f32 v88, v88, v66
v_add_f32 v89, v89, v67
v_mfma_f32_16x16x32_bf16 v[76:79], a[148:151], a[84:87], v[76:79]
v_exp_f32 v69, v69
v_mfma_f32_16x16x32_bf16 v[76:79], a[152:155], a[88:91], v[76:79]
s_add_u32 m0, s38, 9536
ds_read_b64_tr_b16 a[220:221], v23 offset:8928
v_cvt_pk_bf16_f32 v82, v68, v69
v_mfma_f32_16x16x32_bf16 v[76:79], a[156:159], a[92:95], v[76:79]
buffer_load_dwordx4 v25, s[20:23], s39 offen offset:256 nt lds
v_exp_f32 v70, v70
v_mfma_f32_16x16x32_bf16 v[208:211], a[240:243], v[84:87], v[208:211]
v_add_f32 v88, v88, v68
v_add_f32 v89, v89, v69
v_mfma_f32_16x16x32_bf16 v[212:215], a[244:247], v[84:87], v[212:215]
v_exp_f32 v71, v71
v_mfma_f32_16x16x32_bf16 v[216:219], a[248:251], v[84:87], v[216:219]
ds_read_b64_tr_b16 a[222:223], v23 offset:13280
v_cvt_pk_bf16_f32 v83, v70, v71
v_mfma_f32_16x16x32_bf16 v[220:223], a[252:255], v[84:87], v[220:223]
s_waitcnt lgkmcnt(6)
s_add_u32 s101, s101, 8192
s_add_u32 s100, s100, s92
s_and_b32 s39, s100, 0xf800
s_and_b32 s93, s101, 0x40000
s_or_b32 s39, s39, s93
s_add_u32 s38, s38, 17408
s_cmp_eq_u32 s38, s71
s_cselect_b32 s38, s70, s38
v_add_f32 v88, v88, v70
v_add_f32 v89, v89, v71
s_waitcnt vmcnt(20)
s_barrier
v_mfma_f32_16x16x32_bf16 v[64:67], a[128:131], a[96:99], v[104:107]
ds_read_b128 a[160:163], v21 offset:17408
v_exp_f32 v72, v72
v_mfma_f32_16x16x32_bf16 v[64:67], a[132:135], a[100:103], v[64:67]
ds_read_b128 a[164:167], v21 offset:17472
v_exp_f32 v73, v73
v_mfma_f32_16x16x32_bf16 v[64:67], a[136:139], a[104:107], v[64:67]
ds_read_b128 a[168:171], v21 offset:17536
v_cvt_pk_bf16_f32 v84, v72, v73
v_mfma_f32_16x16x32_bf16 v[64:67], a[140:143], a[108:111], v[64:67]
v_exp_f32 v74, v74
v_mfma_f32_16x16x32_bf16 v[128:131], a[192:195], v[80:83], v[128:131]
s_add_u32 m0, s38, 0
ds_read_b128 a[172:175], v21 offset:17600
v_add_f32 v90, v90, v72
v_add_f32 v91, v91, v73
v_mfma_f32_16x16x32_bf16 v[132:135], a[196:199], v[80:83], v[132:135]
buffer_load_dwordx4 v24, s[16:19], s39 offen offset:0 nt lds
v_exp_f32 v75, v75
v_mfma_f32_16x16x32_bf16 v[136:139], a[200:203], v[80:83], v[136:139]
ds_read_b128 a[176:179], v21 offset:21760
v_cvt_pk_bf16_f32 v85, v74, v75
v_mfma_f32_16x16x32_bf16 v[140:143], a[204:207], v[80:83], v[140:143]
v_exp_f32 v76, v76
v_mfma_f32_16x16x32_bf16 v[68:71], a[144:147], a[96:99], v[104:107]
ds_read_b128 a[180:183], v21 offset:21824
v_add_f32 v90, v90, v74
v_add_f32 v91, v91, v75
v_mfma_f32_16x16x32_bf16 v[68:71], a[148:151], a[100:103], v[68:71]
v_exp_f32 v77, v77
v_mfma_f32_16x16x32_bf16 v[68:71], a[152:155], a[104:107], v[68:71]
ds_read_b128 a[184:187], v21 offset:21888
v_cvt_pk_bf16_f32 v86, v76, v77
v_mfma_f32_16x16x32_bf16 v[68:71], a[156:159], a[108:111], v[68:71]
s_waitcnt lgkmcnt(7)
v_exp_f32 v78, v78
v_mfma_f32_16x16x32_bf16 v[144:147], a[208:211], v[80:83], v[144:147]
v_add_f32 v90, v90, v76
v_add_f32 v91, v91, v77
v_mfma_f32_16x16x32_bf16 v[148:151], a[212:215], v[80:83], v[148:151]
v_exp_f32 v79, v79
v_mfma_f32_16x16x32_bf16 v[152:155], a[216:219], v[80:83], v[152:155]
ds_read_b128 a[188:191], v21 offset:21952
v_cvt_pk_bf16_f32 v87, v78, v79
v_mfma_f32_16x16x32_bf16 v[156:159], a[220:223], v[80:83], v[156:159]
s_waitcnt lgkmcnt(4)
v_add_f32 v90, v90, v78
v_add_f32 v91, v91, v79
v_mfma_f32_16x16x32_bf16 v[72:75], a[160:163], a[64:67], v[96:99]
ds_read_b64_tr_b16 a[224:225], v22 offset:26112
v_exp_f32 v64, v64
v_mfma_f32_16x16x32_bf16 v[72:75], a[164:167], a[68:71], v[72:75]
ds_read_b64_tr_b16 a[226:227], v22 offset:30464
v_exp_f32 v65, v65
v_mfma_f32_16x16x32_bf16 v[72:75], a[168:171], a[72:75], v[72:75]
ds_read_b64_tr_b16 a[228:229], v23 offset:26144
v_cvt_pk_bf16_f32 v80, v64, v65
v_mfma_f32_16x16x32_bf16 v[72:75], a[172:175], a[76:79], v[72:75]
v_exp_f32 v66, v66
v_mfma_f32_16x16x32_bf16 v[160:163], a[192:195], v[84:87], v[160:163]
s_add_u32 m0, s38, 8704
ds_read_b64_tr_b16 a[230:231], v23 offset:30496
v_add_f32 v92, v92, v64
v_add_f32 v93, v93, v65
v_mfma_f32_16x16x32_bf16 v[164:167], a[196:199], v[84:87], v[164:167]
buffer_load_dwordx4 v25, s[20:23], s39 offen offset:0 nt lds
v_exp_f32 v67, v67
v_mfma_f32_16x16x32_bf16 v[168:171], a[200:203], v[84:87], v[168:171]
ds_read_b64_tr_b16 a[232:233], v22 offset:26176
v_cvt_pk_bf16_f32 v81, v66, v67
v_mfma_f32_16x16x32_bf16 v[172:175], a[204:207], v[84:87], v[172:175]
s_waitcnt lgkmcnt(5)
v_exp_f32 v68, v68
v_mfma_f32_16x16x32_bf16 v[76:79], a[176:179], a[64:67], v[96:99]
ds_read_b64_tr_b16 a[234:235], v22 offset:30528
v_add_f32 v92, v92, v66
v_add_f32 v93, v93, v67
v_mfma_f32_16x16x32_bf16 v[76:79], a[180:183], a[68:71], v[76:79]
v_exp_f32 v69, v69
v_mfma_f32_16x16x32_bf16 v[76:79], a[184:187], a[72:75], v[76:79]
ds_read_b64_tr_b16 a[236:237], v23 offset:26208
v_cvt_pk_bf16_f32 v82, v68, v69
v_mfma_f32_16x16x32_bf16 v[76:79], a[188:191], a[76:79], v[76:79]
v_exp_f32 v70, v70
v_mfma_f32_16x16x32_bf16 v[176:179], a[208:211], v[84:87], v[176:179]
v_add_f32 v92, v92, v68
v_add_f32 v93, v93, v69
v_mfma_f32_16x16x32_bf16 v[180:183], a[212:215], v[84:87], v[180:183]
v_exp_f32 v71, v71
v_mfma_f32_16x16x32_bf16 v[184:187], a[216:219], v[84:87], v[184:187]
ds_read_b64_tr_b16 a[238:239], v23 offset:30560
v_cvt_pk_bf16_f32 v83, v70, v71
v_mfma_f32_16x16x32_bf16 v[188:191], a[220:223], v[84:87], v[188:191]
s_waitcnt lgkmcnt(6)
v_add_f32 v92, v92, v70
v_add_f32 v93, v93, v71
v_mfma_f32_16x16x32_bf16 v[64:67], a[160:163], a[80:83], v[100:103]
ds_read_b64_tr_b16 a[240:241], v22 offset:26240
v_exp_f32 v72, v72
v_mfma_f32_16x16x32_bf16 v[64:67], a[164:167], a[84:87], v[64:67]
ds_read_b64_tr_b16 a[242:243], v22 offset:30592
v_exp_f32 v73, v73
v_mfma_f32_16x16x32_bf16 v[64:67], a[168:171], a[88:91], v[64:67]
ds_read_b64_tr_b16 a[244:245], v23 offset:26272
v_cvt_pk_bf16_f32 v84, v72, v73
v_mfma_f32_16x16x32_bf16 v[64:67], a[172:175], a[92:95], v[64:67]
s_add_u32 s41, s41, 34816
v_exp_f32 v74, v74
v_mfma_f32_16x16x32_bf16 v[192:195], a[192:195], v[80:83], v[192:195]
s_add_u32 m0, s38, 64
ds_read_b64_tr_b16 a[246:247], v23 offset:30624
v_add_f32 v88, v88, v72
v_add_f32 v89, v89, v73
v_mfma_f32_16x16x32_bf16 v[196:199], a[196:199], v[80:83], v[196:199]
s_cmp_eq_u32 s41, 139264
buffer_load_dwordx4 v24, s[16:19], s39 offen offset:1024 nt lds
v_exp_f32 v75, v75
v_mfma_f32_16x16x32_bf16 v[200:203], a[200:203], v[80:83], v[200:203]
ds_read_b64_tr_b16 a[248:249], v22 offset:26304
v_cvt_pk_bf16_f32 v85, v74, v75
v_mfma_f32_16x16x32_bf16 v[204:207], a[204:207], v[80:83], v[204:207]
s_cselect_b32 s41, 0, s41
v_exp_f32 v76, v76
v_mfma_f32_16x16x32_bf16 v[68:71], a[176:179], a[80:83], v[100:103]
ds_read_b64_tr_b16 a[250:251], v22 offset:30656
v_add_f32 v88, v88, v74
v_add_f32 v89, v89, v75
v_mfma_f32_16x16x32_bf16 v[68:71], a[180:183], a[84:87], v[68:71]
v_exp_f32 v77, v77
v_mfma_f32_16x16x32_bf16 v[68:71], a[184:187], a[88:91], v[68:71]
s_add_u32 m0, s38, 9536
ds_read_b64_tr_b16 a[252:253], v23 offset:26336
v_cvt_pk_bf16_f32 v86, v76, v77
v_mfma_f32_16x16x32_bf16 v[68:71], a[188:191], a[92:95], v[68:71]
buffer_load_dwordx4 v25, s[20:23], s39 offen offset:256 nt lds
v_exp_f32 v78, v78
v_mfma_f32_16x16x32_bf16 v[208:211], a[208:211], v[80:83], v[208:211]
v_add_f32 v88, v88, v76
v_add_f32 v89, v89, v77
v_mfma_f32_16x16x32_bf16 v[212:215], a[212:215], v[80:83], v[212:215]
v_exp_f32 v79, v79
v_mfma_f32_16x16x32_bf16 v[216:219], a[216:219], v[80:83], v[216:219]
ds_read_b64_tr_b16 a[254:255], v23 offset:30688
v_cvt_pk_bf16_f32 v87, v78, v79
v_mfma_f32_16x16x32_bf16 v[220:223], a[220:223], v[80:83], v[220:223]
s_waitcnt lgkmcnt(6)
v_add_u32 v21, s41, v18
v_add_u32 v22, s41, v19
v_add_u32 v23, s41, v20
s_add_u32 s101, s101, 8192
s_add_u32 s100, s100, s92
s_and_b32 s39, s100, 0xf800
s_and_b32 s93, s101, 0x40000
s_or_b32 s39, s39, s93
s_add_u32 s38, s38, 17408
s_cmp_eq_u32 s38, s71
s_cselect_b32 s38, s70, s38
s_sub_u32 s32, s32, 1
s_cmp_lg_u32 s32, 0
v_add_f32 v88, v88, v78
v_add_f32 v89, v89, v79
s_cbranch_scc1 L_at3_33
s_waitcnt vmcnt(20)
s_barrier
v_mfma_f32_16x16x32_bf16 v[72:75], a[160:163], a[96:99], v[104:107]
ds_read_b128 a[128:131], v21 offset:0
v_exp_f32 v64, v64
s_bfe_u32 s22, s4, 0x10001
s_mul_i32 s22, s22, 30
s_add_u32 s22, s22, s5
s_lshr_b32 s20, s22, 2
v_mfma_f32_16x16x32_bf16 v[72:75], a[164:167], a[100:103], v[72:75]
ds_read_b128 a[132:135], v21 offset:64
v_exp_f32 v65, v65
s_and_b32 s21, s22, 3
s_lshl_b32 s21, s21, 1
s_and_b32 s22, s4, 1
s_xor_b32 s22, s22, 1
v_mfma_f32_16x16x32_bf16 v[72:75], a[168:171], a[104:107], v[72:75]
ds_read_b128 a[136:139], v21 offset:128
v_cvt_pk_bf16_f32 v80, v64, v65
s_add_u32 s21, s21, s22
s_cmp_lt_u32 s5, 30
s_cselect_b32 s33, 1, 0
s_lshl_b32 s22, s21, 8
s_add_u32 s12, s56, s22
s_addc_u32 s13, s57, 0
v_mfma_f32_16x16x32_bf16 v[72:75], a[172:175], a[108:111], v[72:75]
v_exp_f32 v66, v66
s_sub_u32 s14, 8388608, s22
s_cmp_lg_u32 s33, 0
s_cselect_b32 s14, s14, 0
s_cselect_b32 s10, 0x100000, 0
s_mov_b32 s15, 0x20000
s_cselect_b32 s34, 0xffff, 0
s_cmp_eq_u32 s66, 0
s_cselect_b32 s34, s34, 0
s_cmp_eq_u32 s3, 0
s_cselect_b32 s34, s34, 0
v_mfma_f32_16x16x32_bf16 v[128:131], a[224:227], v[84:87], v[128:131]
ds_read_b128 a[140:143], v21 offset:192
v_add_f32 v90, v90, v64
v_add_f32 v91, v91, v65
s_mov_b32 s35, 0
s_lshl_b32 s32, s3, 12
s_mov_b32 s28, 524288
s_mov_b32 s29, 0
v_mfma_f32_16x16x32_bf16 v[132:135], a[228:231], v[84:87], v[132:135]
v_exp_f32 v67, v67
s_mul_i32 s22, s6, 120
s_lshl_b32 s23, s20, 3
s_add_u32 s22, s22, s23
s_lshl_b32 s22, s22, 17
v_mfma_f32_16x16x32_bf16 v[136:139], a[232:235], v[84:87], v[136:139]
ds_read_b128 a[144:147], v21 offset:4352
v_cvt_pk_bf16_f32 v81, v66, v67
s_add_u32 s8, s64, s22
s_addc_u32 s9, s65, 0
s_mov_b32 s11, 0x20000
s_add_u32 s22, s23, 7
s_mul_i32 s23, s23, 4370
v_mfma_f32_16x16x32_bf16 v[140:143], a[236:239], v[84:87], v[140:143]
v_exp_f32 v68, v68
s_mul_i32 s22, s22, 4370
s_lshr_b32 s22, s22, 16
s_lshr_b32 s23, s23, 16
s_lshl_b32 s31, s6, 3
v_mfma_f32_16x16x32_bf16 v[76:79], a[176:179], a[96:99], v[104:107]
ds_read_b128 a[148:151], v21 offset:4416
v_add_f32 v90, v90, v66
v_add_f32 v91, v91, v67
s_add_u32 s22, s22, s31
s_add_u32 s23, s23, s31
s_mul_i32 s22, s22, 16
s_mul_i32 s23, s23, 16
v_mfma_f32_16x16x32_bf16 v[76:79], a[180:183], a[100:103], v[76:79]
v_exp_f32 v69, v69
s_cmp_eq_u32 s3, 0
s_cselect_b32 s22, s22, 0x40000000
s_cselect_b32 s23, s23, 0x40000000
v_lshrrev_b32 v48, 4, v1
v_and_b32 v49, 15, v1
v_lshlrev_b32 v52, 1, v48
v_mfma_f32_16x16x32_bf16 v[76:79], a[184:187], a[104:107], v[76:79]
ds_read_b128 a[152:155], v21 offset:4480
v_cvt_pk_bf16_f32 v82, v68, v69
v_xor_b32 v52, v49, v52
v_xor_b32 v53, 8, v52
s_lshl_b32 s31, s3, 15
v_lshlrev_b32 v54, 11, v48
v_mfma_f32_16x16x32_bf16 v[76:79], a[188:191], a[108:111], v[76:79]
s_waitcnt lgkmcnt(7)
v_exp_f32 v70, v70
v_add_u32 v54, s31, v54
v_lshl_add_u32 v2, v52, 4, v54
v_lshl_add_u32 v3, v53, 4, v54
v_add_u32 v3, 8192, v3
v_mfma_f32_16x16x32_bf16 v[144:147], a[240:243], v[84:87], v[144:147]
v_add_f32 v90, v90, v68
v_add_f32 v91, v91, v69
v_lshl_add_u32 v4, v52, 4, v54
v_add_u32 v4, 16384, v4
v_lshl_add_u32 v5, v53, 4, v54
v_add_u32 v5, 24576, v5
v_mfma_f32_16x16x32_bf16 v[148:151], a[244:247], v[84:87], v[148:151]
v_exp_f32 v71, v71
v_and_b32 v54, 1, v1
v_mov_b32 v8, s22
v_mov_b32 v52, s23
v_cmp_eq_u32 vcc, 1, v54
v_mfma_f32_16x16x32_bf16 v[152:155], a[248:251], v[84:87], v[152:155]
ds_read_b128 a[156:159], v21 offset:4544
v_cvt_pk_bf16_f32 v83, v70, v71
s_lshl_b32 s31, s3, 18
v_lshlrev_b32 v6, 4, v1
v_cndmask_b32 v8, v8, v52, vcc
v_add_u32 v6, s31, v6
v_add_u32 v7, 131072, v6
v_mfma_f32_16x16x32_bf16 v[156:159], a[252:255], v[84:87], v[156:159]
s_waitcnt lgkmcnt(4)
v_add_f32 v90, v90, v70
v_add_f32 v91, v91, v71
v_mfma_f32_16x16x32_bf16 v[64:67], a[128:131], a[64:67], v[96:99]
ds_read_b64_tr_b16 a[192:193], v22 offset:8704
v_exp_f32 v72, v72
v_mfma_f32_16x16x32_bf16 v[64:67], a[132:135], a[68:71], v[64:67]
ds_read_b64_tr_b16 a[194:195], v22 offset:13056
v_exp_f32 v73, v73
v_mfma_f32_16x16x32_bf16 v[64:67], a[136:139], a[72:75], v[64:67]
ds_read_b64_tr_b16 a[196:197], v23 offset:8736
v_cvt_pk_bf16_f32 v84, v72, v73
v_mfma_f32_16x16x32_bf16 v[64:67], a[140:143], a[76:79], v[64:67]
v_exp_f32 v74, v74
v_mfma_f32_16x16x32_bf16 v[160:163], a[224:227], v[80:83], v[160:163]
s_add_u32 m0, s32, 104448
ds_read_b64_tr_b16 a[198:199], v23 offset:13088
v_add_f32 v92, v92, v72
v_add_f32 v93, v93, v73
v_mfma_f32_16x16x32_bf16 v[164:167], a[228:231], v[80:83], v[164:167]
buffer_load_dwordx4 v2, s[12:15], s28 offen  lds
v_exp_f32 v75, v75
v_mfma_f32_16x16x32_bf16 v[168:171], a[232:235], v[80:83], v[168:171]
ds_read_b64_tr_b16 a[200:201], v22 offset:8768
v_cvt_pk_bf16_f32 v85, v74, v75
v_mfma_f32_16x16x32_bf16 v[172:175], a[236:239], v[80:83], v[172:175]
s_waitcnt lgkmcnt(5)
v_exp_f32 v76, v76
v_mfma_f32_16x16x32_bf16 v[68:71], a[144:147], a[64:67], v[96:99]
ds_read_b64_tr_b16 a[202:203], v22 offset:13120
v_add_f32 v92, v92, v74
v_add_f32 v93, v93, v75
v_mfma_f32_16x16x32_bf16 v[68:71], a[148:151], a[68:71], v[68:71]
v_exp_f32 v77, v77
v_mfma_f32_16x16x32_bf16 v[68:71], a[152:155], a[72:75], v[68:71]
s_add_u32 m0, s32, 105472
ds_read_b64_tr_b16 a[204:205], v23 offset:8800
v_cvt_pk_bf16_f32 v86, v76, v77
v_mfma_f32_16x16x32_bf16 v[68:71], a[156:159], a[76:79], v[68:71]
buffer_load_dwordx4 v3, s[12:15], s28 offen  lds
v_exp_f32 v78, v78
v_mfma_f32_16x16x32_bf16 v[176:179], a[240:243], v[80:83], v[176:179]
v_add_f32 v92, v92, v76
v_add_f32 v93, v93, v77
v_mfma_f32_16x16x32_bf16 v[180:183], a[244:247], v[80:83], v[180:183]
v_exp_f32 v79, v79
v_mfma_f32_16x16x32_bf16 v[184:187], a[248:251], v[80:83], v[184:187]
ds_read_b64_tr_b16 a[206:207], v23 offset:13152
v_cvt_pk_bf16_f32 v87, v78, v79
v_mfma_f32_16x16x32_bf16 v[188:191], a[252:255], v[80:83], v[188:191]
s_waitcnt lgkmcnt(6)
v_add_f32 v92, v92, v78
v_add_f32 v93, v93, v79
v_mfma_f32_16x16x32_bf16 v[72:75], a[128:131], a[80:83], v[100:103]
ds_read_b64_tr_b16 a[208:209], v22 offset:8832
v_exp_f32 v64, v64
v_mfma_f32_16x16x32_bf16 v[72:75], a[132:135], a[84:87], v[72:75]
ds_read_b64_tr_b16 a[210:211], v22 offset:13184
v_exp_f32 v65, v65
v_mfma_f32_16x16x32_bf16 v[72:75], a[136:139], a[88:91], v[72:75]
ds_read_b64_tr_b16 a[212:213], v23 offset:8864
v_cvt_pk_bf16_f32 v80, v64, v65
v_mfma_f32_16x16x32_bf16 v[72:75], a[140:143], a[92:95], v[72:75]
v_exp_f32 v66, v66
v_mfma_f32_16x16x32_bf16 v[192:195], a[224:227], v[84:87], v[192:195]
s_add_u32 m0, s32, 106496
ds_read_b64_tr_b16 a[214:215], v23 offset:13216
v_add_f32 v88, v88, v64
v_add_f32 v89, v89, v65
v_mfma_f32_16x16x32_bf16 v[196:199], a[228:231], v[84:87], v[196:199]
buffer_load_dwordx4 v4, s[12:15], s28 offen  lds
v_exp_f32 v67, v67
v_mfma_f32_16x16x32_bf16 v[200:203], a[232:235], v[84:87], v[200:203]
ds_read_b64_tr_b16 a[216:217], v22 offset:8896
v_cvt_pk_bf16_f32 v81, v66, v67
v_mfma_f32_16x16x32_bf16 v[204:207], a[236:239], v[84:87], v[204:207]
v_exp_f32 v68, v68
v_mfma_f32_16x16x32_bf16 v[76:79], a[144:147], a[80:83], v[100:103]
ds_read_b64_tr_b16 a[218:219], v22 offset:13248
v_add_f32 v88, v88, v66
v_add_f32 v89, v89, v67
v_mfma_f32_16x16x32_bf16 v[76:79], a[148:151], a[84:87], v[76:79]
v_exp_f32 v69, v69
v_mfma_f32_16x16x32_bf16 v[76:79], a[152:155], a[88:91], v[76:79]
s_add_u32 m0, s32, 107520
ds_read_b64_tr_b16 a[220:221], v23 offset:8928
v_cvt_pk_bf16_f32 v82, v68, v69
v_mfma_f32_16x16x32_bf16 v[76:79], a[156:159], a[92:95], v[76:79]
buffer_load_dwordx4 v5, s[12:15], s28 offen  lds
v_exp_f32 v70, v70
s_add_u32 s28, s28, 1048576
v_mfma_f32_16x16x32_bf16 v[208:211], a[240:243], v[84:87], v[208:211]
v_add_f32 v88, v88, v68
v_add_f32 v89, v89, v69
v_mfma_f32_16x16x32_bf16 v[212:215], a[244:247], v[84:87], v[212:215]
v_exp_f32 v71, v71
v_mfma_f32_16x16x32_bf16 v[216:219], a[248:251], v[84:87], v[216:219]
ds_read_b64_tr_b16 a[222:223], v23 offset:13280
v_cvt_pk_bf16_f32 v83, v70, v71
v_mfma_f32_16x16x32_bf16 v[220:223], a[252:255], v[84:87], v[220:223]
s_waitcnt lgkmcnt(6)
v_add_f32 v88, v88, v70
v_add_f32 v89, v89, v71
s_waitcnt vmcnt(20)
s_barrier
v_mfma_f32_16x16x32_bf16 v[64:67], a[128:131], a[96:99], v[104:107]
ds_read_b128 a[160:163], v21 offset:17408
v_exp_f32 v72, v72
v_mfma_f32_16x16x32_bf16 v[64:67], a[132:135], a[100:103], v[64:67]
ds_read_b128 a[164:167], v21 offset:17472
v_exp_f32 v73, v73
v_mfma_f32_16x16x32_bf16 v[64:67], a[136:139], a[104:107], v[64:67]
ds_read_b128 a[168:171], v21 offset:17536
v_cvt_pk_bf16_f32 v84, v72, v73
v_mfma_f32_16x16x32_bf16 v[64:67], a[140:143], a[108:111], v[64:67]
v_exp_f32 v74, v74
v_mfma_f32_16x16x32_bf16 v[128:131], a[192:195], v[80:83], v[128:131]
s_add_u32 m0, s32, 121856
ds_read_b128 a[172:175], v21 offset:17600
v_add_f32 v90, v90, v72
v_add_f32 v91, v91, v73
v_mfma_f32_16x16x32_bf16 v[132:135], a[196:199], v[80:83], v[132:135]
buffer_load_dwordx4 v2, s[12:15], s28 offen  lds
v_exp_f32 v75, v75
v_mfma_f32_16x16x32_bf16 v[136:139], a[200:203], v[80:83], v[136:139]
ds_read_b128 a[176:179], v21 offset:21760
v_cvt_pk_bf16_f32 v85, v74, v75
v_mfma_f32_16x16x32_bf16 v[140:143], a[204:207], v[80:83], v[140:143]
v_exp_f32 v76, v76
v_mfma_f32_16x16x32_bf16 v[68:71], a[144:147], a[96:99], v[104:107]
ds_read_b128 a[180:183], v21 offset:21824
v_add_f32 v90, v90, v74
v_add_f32 v91, v91, v75
v_mfma_f32_16x16x32_bf16 v[68:71], a[148:151], a[100:103], v[68:71]
v_exp_f32 v77, v77
v_mfma_f32_16x16x32_bf16 v[68:71], a[152:155], a[104:107], v[68:71]
ds_read_b128 a[184:187], v21 offset:21888
v_cvt_pk_bf16_f32 v86, v76, v77
v_mfma_f32_16x16x32_bf16 v[68:71], a[156:159], a[108:111], v[68:71]
s_waitcnt lgkmcnt(7)
v_exp_f32 v78, v78
v_mfma_f32_16x16x32_bf16 v[144:147], a[208:211], v[80:83], v[144:147]
v_add_f32 v90, v90, v76
v_add_f32 v91, v91, v77
v_mfma_f32_16x16x32_bf16 v[148:151], a[212:215], v[80:83], v[148:151]
v_exp_f32 v79, v79
v_mfma_f32_16x16x32_bf16 v[152:155], a[216:219], v[80:83], v[152:155]
ds_read_b128 a[188:191], v21 offset:21952
v_cvt_pk_bf16_f32 v87, v78, v79
v_mfma_f32_16x16x32_bf16 v[156:159], a[220:223], v[80:83], v[156:159]
s_waitcnt lgkmcnt(4)
v_add_f32 v90, v90, v78
v_add_f32 v91, v91, v79
v_mfma_f32_16x16x32_bf16 v[72:75], a[160:163], a[64:67], v[96:99]
ds_read_b64_tr_b16 a[224:225], v22 offset:26112
v_exp_f32 v64, v64
s_lshl_b32 s22, s21, 8
s_lshl_b32 s23, s20, 19
v_mfma_f32_16x16x32_bf16 v[72:75], a[164:167], a[68:71], v[72:75]
ds_read_b64_tr_b16 a[226:227], v22 offset:30464
v_exp_f32 v65, v65
s_lshl_b32 s31, s6, 11
s_add_u32 s23, s23, s31
s_add_u32 s23, s23, s22
v_mfma_f32_16x16x32_bf16 v[72:75], a[168:171], a[72:75], v[72:75]
ds_read_b64_tr_b16 a[228:229], v23 offset:26144
v_cvt_pk_bf16_f32 v80, v64, v65
s_add_u32 s16, s58, s23
s_addc_u32 s17, s59, 0
s_sub_u32 s18, 7864320, s23
v_mfma_f32_16x16x32_bf16 v[72:75], a[172:175], a[76:79], v[72:75]
v_exp_f32 v66, v66
s_mov_b32 s19, 0x20000
s_mov_b32 s36, 4287102976
v_lshrrev_b32 v50, 2, v49
v_mfma_f32_16x16x32_bf16 v[160:163], a[192:195], v[84:87], v[160:163]
s_add_u32 m0, s32, 122880
ds_read_b64_tr_b16 a[230:231], v23 offset:30496
v_add_f32 v92, v92, v64
v_add_f32 v93, v93, v65
v_and_b32 v51, 3, v49
v_lshl_add_u32 v52, v48, 2, v50
v_and_b32 v53, 7, v52
v_mfma_f32_16x16x32_bf16 v[164:167], a[196:199], v[84:87], v[164:167]
buffer_load_dwordx4 v3, s[12:15], s28 offen  lds
v_exp_f32 v67, v67
v_lshlrev_b32 v52, 8, v52
v_lshl_add_u32 v52, v51, 3, v52
v_mfma_f32_16x16x32_bf16 v[168:171], a[200:203], v[84:87], v[168:171]
ds_read_b64_tr_b16 a[232:233], v22 offset:26176
v_cvt_pk_bf16_f32 v81, v66, v67
v_lshl_add_u32 v52, v53, 5, v52
v_xor_b32 v32, 0, v52
v_xor_b32 v33, 32, v52
v_mfma_f32_16x16x32_bf16 v[172:175], a[204:207], v[84:87], v[172:175]
s_waitcnt lgkmcnt(5)
v_exp_f32 v68, v68
v_xor_b32 v34, 64, v52
v_xor_b32 v35, 96, v52
v_mfma_f32_16x16x32_bf16 v[76:79], a[176:179], a[64:67], v[96:99]
ds_read_b64_tr_b16 a[234:235], v22 offset:30528
v_add_f32 v92, v92, v66
v_add_f32 v93, v93, v67
v_xor_b32 v36, 128, v52
v_xor_b32 v37, 160, v52
v_xor_b32 v38, 192, v52
v_mfma_f32_16x16x32_bf16 v[76:79], a[180:183], a[68:71], v[76:79]
v_exp_f32 v69, v69
v_xor_b32 v39, 224, v52
v_add_u32 v40, 69632, v32
v_add_u32 v41, 69632, v33
v_mfma_f32_16x16x32_bf16 v[76:79], a[184:187], a[72:75], v[76:79]
ds_read_b64_tr_b16 a[236:237], v23 offset:26208
v_cvt_pk_bf16_f32 v82, v68, v69
v_add_u32 v42, 69632, v34
v_add_u32 v43, 69632, v35
v_mfma_f32_16x16x32_bf16 v[76:79], a[188:191], a[76:79], v[76:79]
v_exp_f32 v70, v70
v_add_u32 v44, 69632, v36
v_add_u32 v45, 69632, v37
v_add_u32 v46, 69632, v38
v_mfma_f32_16x16x32_bf16 v[176:179], a[208:211], v[84:87], v[176:179]
v_add_f32 v92, v92, v68
v_add_f32 v93, v93, v69
v_add_u32 v47, 69632, v39
s_lshl_b32 s22, s3, 17
v_mfma_f32_16x16x32_bf16 v[180:183], a[212:215], v[84:87], v[180:183]
v_exp_f32 v71, v71
v_lshlrev_b32 v10, 12, v49
v_and_b32 v52, 1, v48
v_lshl_add_u32 v10, v52, 5, v10
v_mfma_f32_16x16x32_bf16 v[184:187], a[216:219], v[84:87], v[184:187]
ds_read_b64_tr_b16 a[238:239], v23 offset:30560
v_cvt_pk_bf16_f32 v83, v70, v71
v_lshrrev_b32 v52, 1, v48
v_lshl_add_u32 v10, v52, 4, v10
v_add_u32 v10, s22, v10
v_mfma_f32_16x16x32_bf16 v[188:191], a[220:223], v[84:87], v[188:191]
s_waitcnt lgkmcnt(6)
v_add_f32 v92, v92, v70
v_add_f32 v93, v93, v71
v_mfma_f32_16x16x32_bf16 v[64:67], a[160:163], a[80:83], v[100:103]
ds_read_b64_tr_b16 a[240:241], v22 offset:26240
v_exp_f32 v72, v72
v_mfma_f32_16x16x32_bf16 v[64:67], a[164:167], a[84:87], v[64:67]
ds_read_b64_tr_b16 a[242:243], v22 offset:30592
v_exp_f32 v73, v73
v_mfma_f32_16x16x32_bf16 v[64:67], a[168:171], a[88:91], v[64:67]
ds_read_b64_tr_b16 a[244:245], v23 offset:26272
v_cvt_pk_bf16_f32 v84, v72, v73
v_mfma_f32_16x16x32_bf16 v[64:67], a[172:175], a[92:95], v[64:67]
s_add_u32 s41, s41, 34816
v_exp_f32 v74, v74
v_mfma_f32_16x16x32_bf16 v[192:195], a[192:195], v[80:83], v[192:195]
s_add_u32 m0, s32, 123904
ds_read_b64_tr_b16 a[246:247], v23 offset:30624
v_add_f32 v88, v88, v72
v_add_f32 v89, v89, v73
v_mfma_f32_16x16x32_bf16 v[196:199], a[196:199], v[80:83], v[196:199]
s_cmp_eq_u32 s41, 139264
buffer_load_dwordx4 v4, s[12:15], s28 offen  lds
v_exp_f32 v75, v75
v_mfma_f32_16x16x32_bf16 v[200:203], a[200:203], v[80:83], v[200:203]
ds_read_b64_tr_b16 a[248:249], v22 offset:26304
v_cvt_pk_bf16_f32 v85, v74, v75
v_mfma_f32_16x16x32_bf16 v[204:207], a[204:207], v[80:83], v[204:207]
s_cselect_b32 s41, 0, s41
v_exp_f32 v76, v76
v_mfma_f32_16x16x32_bf16 v[68:71], a[176:179], a[80:83], v[100:103]
ds_read_b64_tr_b16 a[250:251], v22 offset:30656
v_add_f32 v88, v88, v74
v_add_f32 v89, v89, v75
v_mfma_f32_16x16x32_bf16 v[68:71], a[180:183], a[84:87], v[68:71]
v_exp_f32 v77, v77
v_mfma_f32_16x16x32_bf16 v[68:71], a[184:187], a[88:91], v[68:71]
s_add_u32 m0, s32, 124928
ds_read_b64_tr_b16 a[252:253], v23 offset:26336
v_cvt_pk_bf16_f32 v86, v76, v77
v_mfma_f32_16x16x32_bf16 v[68:71], a[188:191], a[92:95], v[68:71]
buffer_load_dwordx4 v5, s[12:15], s28 offen  lds
v_exp_f32 v78, v78
s_add_u32 s28, s28, 1048576
v_mfma_f32_16x16x32_bf16 v[208:211], a[208:211], v[80:83], v[208:211]
v_add_f32 v88, v88, v76
v_add_f32 v89, v89, v77
v_mfma_f32_16x16x32_bf16 v[212:215], a[212:215], v[80:83], v[212:215]
v_exp_f32 v79, v79
v_mfma_f32_16x16x32_bf16 v[216:219], a[216:219], v[80:83], v[216:219]
ds_read_b64_tr_b16 a[254:255], v23 offset:30688
v_cvt_pk_bf16_f32 v87, v78, v79
v_mfma_f32_16x16x32_bf16 v[220:223], a[220:223], v[80:83], v[220:223]
s_waitcnt lgkmcnt(6)
v_add_u32 v21, s41, v18
v_add_u32 v22, s41, v19
v_add_u32 v23, s41, v20
v_add_f32 v88, v88, v78
v_add_f32 v89, v89, v79
s_waitcnt vmcnt(20)
s_barrier
v_mfma_f32_16x16x32_bf16 v[72:75], a[160:163], a[96:99], v[104:107]
ds_read_b128 a[128:131], v21 offset:0
v_exp_f32 v64, v64
v_mfma_f32_16x16x32_bf16 v[72:75], a[164:167], a[100:103], v[72:75]
ds_read_b128 a[132:135], v21 offset:64
v_exp_f32 v65, v65
v_mfma_f32_16x16x32_bf16 v[72:75], a[168:171], a[104:107], v[72:75]
ds_read_b128 a[136:139], v21 offset:128
v_cvt_pk_bf16_f32 v80, v64, v65
v_mfma_f32_16x16x32_bf16 v[72:75], a[172:175], a[108:111], v[72:75]
v_exp_f32 v66, v66
v_mfma_f32_16x16x32_bf16 v[128:131], a[224:227], v[84:87], v[128:131]
s_add_u32 m0, s32, 0
ds_read_b128 a[140:143], v21 offset:192
v_add_f32 v90, v90, v64
v_add_f32 v91, v91, v65
v_mfma_f32_16x16x32_bf16 v[132:135], a[228:231], v[84:87], v[132:135]
buffer_load_dwordx4 v2, s[12:15], s28 offen  lds
v_exp_f32 v67, v67
v_mfma_f32_16x16x32_bf16 v[136:139], a[232:235], v[84:87], v[136:139]
ds_read_b128 a[144:147], v21 offset:4352
v_cvt_pk_bf16_f32 v81, v66, v67
v_mfma_f32_16x16x32_bf16 v[140:143], a[236:239], v[84:87], v[140:143]
v_exp_f32 v68, v68
v_mfma_f32_16x16x32_bf16 v[76:79], a[176:179], a[96:99], v[104:107]
ds_read_b128 a[148:151], v21 offset:4416
v_add_f32 v90, v90, v66
v_add_f32 v91, v91, v67
v_mfma_f32_16x16x32_bf16 v[76:79], a[180:183], a[100:103], v[76:79]
v_exp_f32 v69, v69
v_mfma_f32_16x16x32_bf16 v[76:79], a[184:187], a[104:107], v[76:79]
ds_read_b128 a[152:155], v21 offset:4480
v_cvt_pk_bf16_f32 v82, v68, v69
v_mfma_f32_16x16x32_bf16 v[76:79], a[188:191], a[108:111], v[76:79]
s_waitcnt lgkmcnt(7)
v_exp_f32 v70, v70
v_mfma_f32_16x16x32_bf16 v[144:147], a[240:243], v[84:87], v[144:147]
v_add_f32 v90, v90, v68
v_add_f32 v91, v91, v69
v_mfma_f32_16x16x32_bf16 v[148:151], a[244:247], v[84:87], v[148:151]
v_exp_f32 v71, v71
v_mfma_f32_16x16x32_bf16 v[152:155], a[248:251], v[84:87], v[152:155]
ds_read_b128 a[156:159], v21 offset:4544
v_cvt_pk_bf16_f32 v83, v70, v71
v_mfma_f32_16x16x32_bf16 v[156:159], a[252:255], v[84:87], v[156:159]
s_waitcnt lgkmcnt(4)
v_add_f32 v90, v90, v70
v_add_f32 v91, v91, v71
v_mfma_f32_16x16x32_bf16 v[64:67], a[128:131], a[64:67], v[96:99]
ds_read_b64_tr_b16 a[192:193], v22 offset:8704
v_exp_f32 v72, v72
v_mfma_f32_16x16x32_bf16 v[64:67], a[132:135], a[68:71], v[64:67]
ds_read_b64_tr_b16 a[194:195], v22 offset:13056
v_exp_f32 v73, v73
v_mfma_f32_16x16x32_bf16 v[64:67], a[136:139], a[72:75], v[64:67]
ds_read_b64_tr_b16 a[196:197], v23 offset:8736
v_cvt_pk_bf16_f32 v84, v72, v73
v_mfma_f32_16x16x32_bf16 v[64:67], a[140:143], a[76:79], v[64:67]
v_exp_f32 v74, v74
v_mfma_f32_16x16x32_bf16 v[160:163], a[224:227], v[80:83], v[160:163]
s_add_u32 m0, s32, 1024
ds_read_b64_tr_b16 a[198:199], v23 offset:13088
v_add_f32 v92, v92, v72
v_add_f32 v93, v93, v73
v_mfma_f32_16x16x32_bf16 v[164:167], a[228:231], v[80:83], v[164:167]
buffer_load_dwordx4 v3, s[12:15], s28 offen  lds
v_exp_f32 v75, v75
v_mfma_f32_16x16x32_bf16 v[168:171], a[232:235], v[80:83], v[168:171]
ds_read_b64_tr_b16 a[200:201], v22 offset:8768
v_cvt_pk_bf16_f32 v85, v74, v75
v_mfma_f32_16x16x32_bf16 v[172:175], a[236:239], v[80:83], v[172:175]
s_waitcnt lgkmcnt(5)
v_exp_f32 v76, v76
v_mfma_f32_16x16x32_bf16 v[68:71], a[144:147], a[64:67], v[96:99]
ds_read_b64_tr_b16 a[202:203], v22 offset:13120
v_add_f32 v92, v92, v74
v_add_f32 v93, v93, v75
v_mfma_f32_16x16x32_bf16 v[68:71], a[148:151], a[68:71], v[68:71]
v_exp_f32 v77, v77
v_mfma_f32_16x16x32_bf16 v[68:71], a[152:155], a[72:75], v[68:71]
ds_read_b64_tr_b16 a[204:205], v23 offset:8800
v_cvt_pk_bf16_f32 v86, v76, v77
v_mfma_f32_16x16x32_bf16 v[68:71], a[156:159], a[76:79], v[68:71]
v_exp_f32 v78, v78
v_mfma_f32_16x16x32_bf16 v[176:179], a[240:243], v[80:83], v[176:179]
v_add_f32 v92, v92, v76
v_add_f32 v93, v93, v77
v_mfma_f32_16x16x32_bf16 v[180:183], a[244:247], v[80:83], v[180:183]
v_exp_f32 v79, v79
v_mfma_f32_16x16x32_bf16 v[184:187], a[248:251], v[80:83], v[184:187]
ds_read_b64_tr_b16 a[206:207], v23 offset:13152
v_cvt_pk_bf16_f32 v87, v78, v79
v_mfma_f32_16x16x32_bf16 v[188:191], a[252:255], v[80:83], v[188:191]
s_waitcnt lgkmcnt(6)
v_add_f32 v92, v92, v78
v_add_f32 v93, v93, v79
v_mfma_f32_16x16x32_bf16 v[72:75], a[128:131], a[80:83], v[100:103]
ds_read_b64_tr_b16 a[208:209], v22 offset:8832
v_exp_f32 v64, v64
v_mfma_f32_16x16x32_bf16 v[72:75], a[132:135], a[84:87], v[72:75]
ds_read_b64_tr_b16 a[210:211], v22 offset:13184
v_exp_f32 v65, v65
v_mfma_f32_16x16x32_bf16 v[72:75], a[136:139], a[88:91], v[72:75]
ds_read_b64_tr_b16 a[212:213], v23 offset:8864
v_cvt_pk_bf16_f32 v80, v64, v65
v_mfma_f32_16x16x32_bf16 v[72:75], a[140:143], a[92:95], v[72:75]
v_exp_f32 v66, v66
v_mfma_f32_16x16x32_bf16 v[192:195], a[224:227], v[84:87], v[192:195]
s_add_u32 m0, s32, 2048
ds_read_b64_tr_b16 a[214:215], v23 offset:13216
v_add_f32 v88, v88, v64
v_add_f32 v89, v89, v65
v_mfma_f32_16x16x32_bf16 v[196:199], a[228:231], v[84:87], v[196:199]
buffer_load_dwordx4 v4, s[12:15], s28 offen  lds
v_exp_f32 v67, v67
v_mfma_f32_16x16x32_bf16 v[200:203], a[232:235], v[84:87], v[200:203]
ds_read_b64_tr_b16 a[216:217], v22 offset:8896
v_cvt_pk_bf16_f32 v81, v66, v67
v_mfma_f32_16x16x32_bf16 v[204:207], a[236:239], v[84:87], v[204:207]
v_exp_f32 v68, v68
v_mfma_f32_16x16x32_bf16 v[76:79], a[144:147], a[80:83], v[100:103]
ds_read_b64_tr_b16 a[218:219], v22 offset:13248
v_add_f32 v88, v88, v66
v_add_f32 v89, v89, v67
v_mfma_f32_16x16x32_bf16 v[76:79], a[148:151], a[84:87], v[76:79]
v_exp_f32 v69, v69
v_mfma_f32_16x16x32_bf16 v[76:79], a[152:155], a[88:91], v[76:79]
s_add_u32 m0, s32, 3072
ds_read_b64_tr_b16 a[220:221], v23 offset:8928
v_cvt_pk_bf16_f32 v82, v68, v69
v_mfma_f32_16x16x32_bf16 v[76:79], a[156:159], a[92:95], v[76:79]
buffer_load_dwordx4 v5, s[12:15], s28 offen  lds
v_exp_f32 v70, v70
s_add_u32 s28, s28, 1048576
v_mfma_f32_16x16x32_bf16 v[208:211], a[240:243], v[84:87], v[208:211]
v_add_f32 v88, v88, v68
v_add_f32 v89, v89, v69
v_mfma_f32_16x16x32_bf16 v[212:215], a[244:247], v[84:87], v[212:215]
v_exp_f32 v71, v71
v_mfma_f32_16x16x32_bf16 v[216:219], a[248:251], v[84:87], v[216:219]
ds_read_b64_tr_b16 a[222:223], v23 offset:13280
v_cvt_pk_bf16_f32 v83, v70, v71
v_mfma_f32_16x16x32_bf16 v[220:223], a[252:255], v[84:87], v[220:223]
s_waitcnt lgkmcnt(6)
v_add_f32 v88, v88, v70
v_add_f32 v89, v89, v71
s_waitcnt vmcnt(20)
s_barrier
v_mfma_f32_16x16x32_bf16 v[64:67], a[128:131], a[96:99], v[104:107]
ds_read_b128 a[160:163], v21 offset:17408
v_exp_f32 v72, v72
v_mfma_f32_16x16x32_bf16 v[64:67], a[132:135], a[100:103], v[64:67]
ds_read_b128 a[164:167], v21 offset:17472
v_exp_f32 v73, v73
v_mfma_f32_16x16x32_bf16 v[64:67], a[136:139], a[104:107], v[64:67]
ds_read_b128 a[168:171], v21 offset:17536
v_cvt_pk_bf16_f32 v84, v72, v73
v_mfma_f32_16x16x32_bf16 v[64:67], a[140:143], a[108:111], v[64:67]
v_exp_f32 v74, v74
v_mfma_f32_16x16x32_bf16 v[128:131], a[192:195], v[80:83], v[128:131]
s_add_u32 m0, s32, 17408
ds_read_b128 a[172:175], v21 offset:17600
v_add_f32 v90, v90, v72
v_add_f32 v91, v91, v73
v_mfma_f32_16x16x32_bf16 v[132:135], a[196:199], v[80:83], v[132:135]
buffer_load_dwordx4 v2, s[12:15], s28 offen  lds
v_exp_f32 v75, v75
v_mfma_f32_16x16x32_bf16 v[136:139], a[200:203], v[80:83], v[136:139]
ds_read_b128 a[176:179], v21 offset:21760
v_cvt_pk_bf16_f32 v85, v74, v75
v_mfma_f32_16x16x32_bf16 v[140:143], a[204:207], v[80:83], v[140:143]
v_exp_f32 v76, v76
v_mfma_f32_16x16x32_bf16 v[68:71], a[144:147], a[96:99], v[104:107]
ds_read_b128 a[180:183], v21 offset:21824
buffer_load_dwordx4 a[0:3], v6, s[8:11], s29 offen offset:0 sc1
v_add_f32 v90, v90, v74
v_add_f32 v91, v91, v75
v_mfma_f32_16x16x32_bf16 v[68:71], a[148:151], a[100:103], v[68:71]
v_exp_f32 v77, v77
v_mfma_f32_16x16x32_bf16 v[68:71], a[152:155], a[104:107], v[68:71]
ds_read_b128 a[184:187], v21 offset:21888
v_cvt_pk_bf16_f32 v86, v76, v77
v_mfma_f32_16x16x32_bf16 v[68:71], a[156:159], a[108:111], v[68:71]
s_waitcnt lgkmcnt(7)
v_exp_f32 v78, v78
v_mfma_f32_16x16x32_bf16 v[144:147], a[208:211], v[80:83], v[144:147]
buffer_load_dwordx4 a[4:7], v7, s[8:11], s29 offen offset:0 sc1
v_add_f32 v90, v90, v76
v_add_f32 v91, v91, v77
v_mfma_f32_16x16x32_bf16 v[148:151], a[212:215], v[80:83], v[148:151]
v_exp_f32 v79, v79
v_mfma_f32_16x16x32_bf16 v[152:155], a[216:219], v[80:83], v[152:155]
ds_read_b128 a[188:191], v21 offset:21952
v_cvt_pk_bf16_f32 v87, v78, v79
v_mfma_f32_16x16x32_bf16 v[156:159], a[220:223], v[80:83], v[156:159]
s_waitcnt lgkmcnt(4)
v_add_f32 v90, v90, v78
v_add_f32 v91, v91, v79
v_mfma_f32_16x16x32_bf16 v[72:75], a[160:163], a[64:67], v[96:99]
ds_read_b64_tr_b16 a[224:225], v22 offset:26112
v_exp_f32 v64, v64
v_mfma_f32_16x16x32_bf16 v[72:75], a[164:167], a[68:71], v[72:75]
ds_read_b64_tr_b16 a[226:227], v22 offset:30464
v_exp_f32 v65, v65
v_mfma_f32_16x16x32_bf16 v[72:75], a[168:171], a[72:75], v[72:75]
ds_read_b64_tr_b16 a[228:229], v23 offset:26144
v_cvt_pk_bf16_f32 v80, v64, v65
v_mfma_f32_16x16x32_bf16 v[72:75], a[172:175], a[76:79], v[72:75]
v_exp_f32 v66, v66
v_mfma_f32_16x16x32_bf16 v[160:163], a[192:195], v[84:87], v[160:163]
s_add_u32 m0, s32, 18432
ds_read_b64_tr_b16 a[230:231], v23 offset:30496
v_add_f32 v92, v92, v64
v_add_f32 v93, v93, v65
v_mfma_f32_16x16x32_bf16 v[164:167], a[196:199], v[84:87], v[164:167]
buffer_load_dwordx4 v3, s[12:15], s28 offen  lds
v_exp_f32 v67, v67
v_mfma_f32_16x16x32_bf16 v[168:171], a[200:203], v[84:87], v[168:171]
ds_read_b64_tr_b16 a[232:233], v22 offset:26176
v_cvt_pk_bf16_f32 v81, v66, v67
v_mfma_f32_16x16x32_bf16 v[172:175], a[204:207], v[84:87], v[172:175]
s_waitcnt lgkmcnt(5)
v_exp_f32 v68, v68
v_mfma_f32_16x16x32_bf16 v[76:79], a[176:179], a[64:67], v[96:99]
ds_read_b64_tr_b16 a[234:235], v22 offset:30528
buffer_load_dwordx4 a[8:11], v6, s[8:11], s29 offen offset:1024 sc1
v_add_f32 v92, v92, v66
v_add_f32 v93, v93, v67
v_mfma_f32_16x16x32_bf16 v[76:79], a[180:183], a[68:71], v[76:79]
v_exp_f32 v69, v69
v_mfma_f32_16x16x32_bf16 v[76:79], a[184:187], a[72:75], v[76:79]
ds_read_b64_tr_b16 a[236:237], v23 offset:26208
v_cvt_pk_bf16_f32 v82, v68, v69
v_mfma_f32_16x16x32_bf16 v[76:79], a[188:191], a[76:79], v[76:79]
v_exp_f32 v70, v70
v_mfma_f32_16x16x32_bf16 v[176:179], a[208:211], v[84:87], v[176:179]
buffer_load_dwordx4 a[12:15], v7, s[8:11], s29 offen offset:1024 sc1
v_add_f32 v92, v92, v68
v_add_f32 v93, v93, v69
s_add_u32 s29, s29, 2048
v_mfma_f32_16x16x32_bf16 v[180:183], a[212:215], v[84:87], v[180:183]
v_exp_f32 v71, v71
v_mfma_f32_16x16x32_bf16 v[184:187], a[216:219], v[84:87], v[184:187]
ds_read_b64_tr_b16 a[238:239], v23 offset:30560
v_cvt_pk_bf16_f32 v83, v70, v71
v_mfma_f32_16x16x32_bf16 v[188:191], a[220:223], v[84:87], v[188:191]
s_waitcnt lgkmcnt(6)
v_add_f32 v92, v92, v70
v_add_f32 v93, v93, v71
v_mfma_f32_16x16x32_bf16 v[64:67], a[160:163], a[80:83], v[100:103]
ds_read_b64_tr_b16 a[240:241], v22 offset:26240
v_exp_f32 v72, v72
v_mfma_f32_16x16x32_bf16 v[64:67], a[164:167], a[84:87], v[64:67]
ds_read_b64_tr_b16 a[242:243], v22 offset:30592
v_exp_f32 v73, v73
v_mfma_f32_16x16x32_bf16 v[64:67], a[168:171], a[88:91], v[64:67]
ds_read_b64_tr_b16 a[244:245], v23 offset:26272
v_cvt_pk_bf16_f32 v84, v72, v73
v_mfma_f32_16x16x32_bf16 v[64:67], a[172:175], a[92:95], v[64:67]
s_add_u32 s41, s41, 34816
v_exp_f32 v74, v74
v_mfma_f32_16x16x32_bf16 v[192:195], a[192:195], v[80:83], v[192:195]
s_add_u32 m0, s32, 19456
ds_read_b64_tr_b16 a[246:247], v23 offset:30624
v_add_f32 v88, v88, v72
v_add_f32 v89, v89, v73
v_mfma_f32_16x16x32_bf16 v[196:199], a[196:199], v[80:83], v[196:199]
s_cmp_eq_u32 s41, 139264
buffer_load_dwordx4 v4, s[12:15], s28 offen  lds
v_exp_f32 v75, v75
v_mfma_f32_16x16x32_bf16 v[200:203], a[200:203], v[80:83], v[200:203]
ds_read_b64_tr_b16 a[248:249], v22 offset:26304
v_cvt_pk_bf16_f32 v85, v74, v75
v_mfma_f32_16x16x32_bf16 v[204:207], a[204:207], v[80:83], v[204:207]
s_cselect_b32 s41, 0, s41
v_exp_f32 v76, v76
v_mfma_f32_16x16x32_bf16 v[68:71], a[176:179], a[80:83], v[100:103]
ds_read_b64_tr_b16 a[250:251], v22 offset:30656
buffer_load_dwordx4 a[16:19], v6, s[8:11], s29 offen offset:0 sc1
v_add_f32 v88, v88, v74
v_add_f32 v89, v89, v75
v_mfma_f32_16x16x32_bf16 v[68:71], a[180:183], a[84:87], v[68:71]
v_exp_f32 v77, v77
v_mfma_f32_16x16x32_bf16 v[68:71], a[184:187], a[88:91], v[68:71]
s_add_u32 m0, s32, 20480
ds_read_b64_tr_b16 a[252:253], v23 offset:26336
v_cvt_pk_bf16_f32 v86, v76, v77
v_mfma_f32_16x16x32_bf16 v[68:71], a[188:191], a[92:95], v[68:71]
buffer_load_dwordx4 v5, s[12:15], s28 offen  lds
v_exp_f32 v78, v78
s_add_u32 s28, s28, 1048576
v_mfma_f32_16x16x32_bf16 v[208:211], a[208:211], v[80:83], v[208:211]
buffer_load_dwordx4 a[20:23], v7, s[8:11], s29 offen offset:0 sc1
v_add_f32 v88, v88, v76
v_add_f32 v89, v89, v77
v_mfma_f32_16x16x32_bf16 v[212:215], a[212:215], v[80:83], v[212:215]
v_exp_f32 v79, v79
v_mfma_f32_16x16x32_bf16 v[216:219], a[216:219], v[80:83], v[216:219]
ds_read_b64_tr_b16 a[254:255], v23 offset:30688
v_cvt_pk_bf16_f32 v87, v78, v79
v_mfma_f32_16x16x32_bf16 v[220:223], a[220:223], v[80:83], v[220:223]
s_waitcnt lgkmcnt(6)
v_add_u32 v21, s41, v18
v_add_u32 v22, s41, v19
v_add_u32 v23, s41, v20
v_add_f32 v88, v88, v78
v_add_f32 v89, v89, v79
s_waitcnt vmcnt(26)
s_barrier
v_mfma_f32_16x16x32_bf16 v[72:75], a[160:163], a[96:99], v[104:107]
ds_read_b128 a[128:131], v21 offset:0
v_exp_f32 v64, v64
v_mfma_f32_16x16x32_bf16 v[72:75], a[164:167], a[100:103], v[72:75]
ds_read_b128 a[132:135], v21 offset:64
v_exp_f32 v65, v65
v_mfma_f32_16x16x32_bf16 v[72:75], a[168:171], a[104:107], v[72:75]
ds_read_b128 a[136:139], v21 offset:128
v_cvt_pk_bf16_f32 v80, v64, v65
v_mfma_f32_16x16x32_bf16 v[72:75], a[172:175], a[108:111], v[72:75]
v_exp_f32 v66, v66
v_mfma_f32_16x16x32_bf16 v[128:131], a[224:227], v[84:87], v[128:131]
s_add_u32 m0, s32, 34816
ds_read_b128 a[140:143], v21 offset:192
v_add_f32 v90, v90, v64
v_add_f32 v91, v91, v65
v_mfma_f32_16x16x32_bf16 v[132:135], a[228:231], v[84:87], v[132:135]
buffer_load_dwordx4 v2, s[12:15], s28 offen  lds
v_exp_f32 v67, v67
v_mfma_f32_16x16x32_bf16 v[136:139], a[232:235], v[84:87], v[136:139]
ds_read_b128 a[144:147], v21 offset:4352
v_cvt_pk_bf16_f32 v81, v66, v67
v_mfma_f32_16x16x32_bf16 v[140:143], a[236:239], v[84:87], v[140:143]
v_exp_f32 v68, v68
v_mfma_f32_16x16x32_bf16 v[76:79], a[176:179], a[96:99], v[104:107]
ds_read_b128 a[148:151], v21 offset:4416
buffer_load_dwordx4 a[24:27], v6, s[8:11], s29 offen offset:1024 sc1
v_add_f32 v90, v90, v66
v_add_f32 v91, v91, v67
v_mfma_f32_16x16x32_bf16 v[76:79], a[180:183], a[100:103], v[76:79]
v_exp_f32 v69, v69
v_mfma_f32_16x16x32_bf16 v[76:79], a[184:187], a[104:107], v[76:79]
ds_read_b128 a[152:155], v21 offset:4480
v_cvt_pk_bf16_f32 v82, v68, v69
v_mfma_f32_16x16x32_bf16 v[76:79], a[188:191], a[108:111], v[76:79]
s_waitcnt lgkmcnt(7)
v_exp_f32 v70, v70
v_mfma_f32_16x16x32_bf16 v[144:147], a[240:243], v[84:87], v[144:147]
buffer_load_dwordx4 a[28:31], v7, s[8:11], s29 offen offset:1024 sc1
v_add_f32 v90, v90, v68
v_add_f32 v91, v91, v69
s_add_u32 s29, s29, 2048
v_mfma_f32_16x16x32_bf16 v[148:151], a[244:247], v[84:87], v[148:151]
v_exp_f32 v71, v71
v_mfma_f32_16x16x32_bf16 v[152:155], a[248:251], v[84:87], v[152:155]
ds_read_b128 a[156:159], v21 offset:4544
v_cvt_pk_bf16_f32 v83, v70, v71
v_mfma_f32_16x16x32_bf16 v[156:159], a[252:255], v[84:87], v[156:159]
s_waitcnt lgkmcnt(4)
v_add_f32 v90, v90, v70
v_add_f32 v91, v91, v71
v_mfma_f32_16x16x32_bf16 v[64:67], a[128:131], a[64:67], v[96:99]
ds_read_b64_tr_b16 a[192:193], v22 offset:8704
v_exp_f32 v72, v72
v_mfma_f32_16x16x32_bf16 v[64:67], a[132:135], a[68:71], v[64:67]
ds_read_b64_tr_b16 a[194:195], v22 offset:13056
v_exp_f32 v73, v73
v_mfma_f32_16x16x32_bf16 v[64:67], a[136:139], a[72:75], v[64:67]
ds_read_b64_tr_b16 a[196:197], v23 offset:8736
v_cvt_pk_bf16_f32 v84, v72, v73
v_mfma_f32_16x16x32_bf16 v[64:67], a[140:143], a[76:79], v[64:67]
v_exp_f32 v74, v74
v_mfma_f32_16x16x32_bf16 v[160:163], a[224:227], v[80:83], v[160:163]
s_add_u32 m0, s32, 35840
ds_read_b64_tr_b16 a[198:199], v23 offset:13088
v_add_f32 v92, v92, v72
v_add_f32 v93, v93, v73
v_mfma_f32_16x16x32_bf16 v[164:167], a[228:231], v[80:83], v[164:167]
buffer_load_dwordx4 v3, s[12:15], s28 offen  lds
v_exp_f32 v75, v75
v_mfma_f32_16x16x32_bf16 v[168:171], a[232:235], v[80:83], v[168:171]
ds_read_b64_tr_b16 a[200:201], v22 offset:8768
v_cvt_pk_bf16_f32 v85, v74, v75
v_mfma_f32_16x16x32_bf16 v[172:175], a[236:239], v[80:83], v[172:175]
s_waitcnt lgkmcnt(5)
v_exp_f32 v76, v76
v_mfma_f32_16x16x32_bf16 v[68:71], a[144:147], a[64:67], v[96:99]
ds_read_b64_tr_b16 a[202:203], v22 offset:13120
buffer_load_dwordx4 a[32:35], v6, s[8:11], s29 offen offset:0 sc1
v_add_f32 v92, v92, v74
v_add_f32 v93, v93, v75
v_mfma_f32_16x16x32_bf16 v[68:71], a[148:151], a[68:71], v[68:71]
v_exp_f32 v77, v77
v_mfma_f32_16x16x32_bf16 v[68:71], a[152:155], a[72:75], v[68:71]
ds_read_b64_tr_b16 a[204:205], v23 offset:8800
v_cvt_pk_bf16_f32 v86, v76, v77
v_mfma_f32_16x16x32_bf16 v[68:71], a[156:159], a[76:79], v[68:71]
v_exp_f32 v78, v78
v_mfma_f32_16x16x32_bf16 v[176:179], a[240:243], v[80:83], v[176:179]
buffer_load_dwordx4 a[36:39], v7, s[8:11], s29 offen offset:0 sc1
v_add_f32 v92, v92, v76
v_add_f32 v93, v93, v77
v_mfma_f32_16x16x32_bf16 v[180:183], a[244:247], v[80:83], v[180:183]
v_exp_f32 v79, v79
v_mfma_f32_16x16x32_bf16 v[184:187], a[248:251], v[80:83], v[184:187]
ds_read_b64_tr_b16 a[206:207], v23 offset:13152
v_cvt_pk_bf16_f32 v87, v78, v79
v_mfma_f32_16x16x32_bf16 v[188:191], a[252:255], v[80:83], v[188:191]
s_waitcnt lgkmcnt(6)
v_add_f32 v92, v92, v78
v_add_f32 v93, v93, v79
v_mfma_f32_16x16x32_bf16 v[72:75], a[128:131], a[80:83], v[100:103]
ds_read_b64_tr_b16 a[208:209], v22 offset:8832
v_exp_f32 v64, v64
v_mfma_f32_16x16x32_bf16 v[72:75], a[132:135], a[84:87], v[72:75]
ds_read_b64_tr_b16 a[210:211], v22 offset:13184
v_exp_f32 v65, v65
v_mfma_f32_16x16x32_bf16 v[72:75], a[136:139], a[88:91], v[72:75]
ds_read_b64_tr_b16 a[212:213], v23 offset:8864
v_cvt_pk_bf16_f32 v80, v64, v65
v_mfma_f32_16x16x32_bf16 v[72:75], a[140:143], a[92:95], v[72:75]
v_exp_f32 v66, v66
v_mfma_f32_16x16x32_bf16 v[192:195], a[224:227], v[84:87], v[192:195]
s_add_u32 m0, s32, 36864
ds_read_b64_tr_b16 a[214:215], v23 offset:13216
v_add_f32 v88, v88, v64
v_add_f32 v89, v89, v65
v_mfma_f32_16x16x32_bf16 v[196:199], a[228:231], v[84:87], v[196:199]
buffer_load_dwordx4 v4, s[12:15], s28 offen  lds
v_exp_f32 v67, v67
v_mfma_f32_16x16x32_bf16 v[200:203], a[232:235], v[84:87], v[200:203]
ds_read_b64_tr_b16 a[216:217], v22 offset:8896
v_cvt_pk_bf16_f32 v81, v66, v67
v_mfma_f32_16x16x32_bf16 v[204:207], a[236:239], v[84:87], v[204:207]
v_exp_f32 v68, v68
v_mfma_f32_16x16x32_bf16 v[76:79], a[144:147], a[80:83], v[100:103]
ds_read_b64_tr_b16 a[218:219], v22 offset:13248
buffer_load_dwordx4 a[40:43], v6, s[8:11], s29 offen offset:1024 sc1
v_add_f32 v88, v88, v66
v_add_f32 v89, v89, v67
v_mfma_f32_16x16x32_bf16 v[76:79], a[148:151], a[84:87], v[76:79]
v_exp_f32 v69, v69
v_mfma_f32_16x16x32_bf16 v[76:79], a[152:155], a[88:91], v[76:79]
s_add_u32 m0, s32, 37888
ds_read_b64_tr_b16 a[220:221], v23 offset:8928
v_cvt_pk_bf16_f32 v82, v68, v69
v_mfma_f32_16x16x32_bf16 v[76:79], a[156:159], a[92:95], v[76:79]
buffer_load_dwordx4 v5, s[12:15], s28 offen  lds
v_exp_f32 v70, v70
s_add_u32 s28, s28, 1048576
v_mfma_f32_16x16x32_bf16 v[208:211], a[240:243], v[84:87], v[208:211]
buffer_load_dwordx4 a[44:47], v7, s[8:11], s29 offen offset:1024 sc1
v_add_f32 v88, v88, v68
v_add_f32 v89, v89, v69
s_add_u32 s29, s29, 2048
v_mfma_f32_16x16x32_bf16 v[212:215], a[244:247], v[84:87], v[212:215]
v_exp_f32 v71, v71
v_mfma_f32_16x16x32_bf16 v[216:219], a[248:251], v[84:87], v[216:219]
ds_read_b64_tr_b16 a[222:223], v23 offset:13280
v_cvt_pk_bf16_f32 v83, v70, v71
v_mfma_f32_16x16x32_bf16 v[220:223], a[252:255], v[84:87], v[220:223]
s_waitcnt lgkmcnt(6)
v_add_f32 v88, v88, v70
v_add_f32 v89, v89, v71
s_waitcnt vmcnt(32)
s_barrier
v_mfma_f32_16x16x32_bf16 v[64:67], a[128:131], a[96:99], v[104:107]
ds_read_b128 a[160:163], v21 offset:17408
v_exp_f32 v72, v72
v_mfma_f32_16x16x32_bf16 v[64:67], a[132:135], a[100:103], v[64:67]
ds_read_b128 a[164:167], v21 offset:17472
v_exp_f32 v73, v73
v_mfma_f32_16x16x32_bf16 v[64:67], a[136:139], a[104:107], v[64:67]
ds_read_b128 a[168:171], v21 offset:17536
v_cvt_pk_bf16_f32 v84, v72, v73
v_mfma_f32_16x16x32_bf16 v[64:67], a[140:143], a[108:111], v[64:67]
v_exp_f32 v74, v74
v_mfma_f32_16x16x32_bf16 v[128:131], a[192:195], v[80:83], v[128:131]
s_add_u32 m0, s32, 52224
ds_read_b128 a[172:175], v21 offset:17600
v_add_f32 v90, v90, v72
v_add_f32 v91, v91, v73
v_mfma_f32_16x16x32_bf16 v[132:135], a[196:199], v[80:83], v[132:135]
buffer_load_dwordx4 v2, s[12:15], s28 offen  lds
v_exp_f32 v75, v75
v_mfma_f32_16x16x32_bf16 v[136:139], a[200:203], v[80:83], v[136:139]
ds_read_b128 a[176:179], v21 offset:21760
v_cvt_pk_bf16_f32 v85, v74, v75
v_mfma_f32_16x16x32_bf16 v[140:143], a[204:207], v[80:83], v[140:143]
v_exp_f32 v76, v76
v_mfma_f32_16x16x32_bf16 v[68:71], a[144:147], a[96:99], v[104:107]
ds_read_b128 a[180:183], v21 offset:21824
buffer_load_dwordx4 a[48:51], v6, s[8:11], s29 offen offset:0 sc1
v_add_f32 v90, v90, v74
v_add_f32 v91, v91, v75
v_mfma_f32_16x16x32_bf16 v[68:71], a[148:151], a[100:103], v[68:71]
v_exp_f32 v77, v77
v_mfma_f32_16x16x32_bf16 v[68:71], a[152:155], a[104:107], v[68:71]
ds_read_b128 a[184:187], v21 offset:21888
v_cvt_pk_bf16_f32 v86, v76, v77
v_mfma_f32_16x16x32_bf16 v[68:71], a[156:159], a[108:111], v[68:71]
s_waitcnt lgkmcnt(7)
v_exp_f32 v78, v78
v_mfma_f32_16x16x32_bf16 v[144:147], a[208:211], v[80:83], v[144:147]
buffer_load_dwordx4 a[52:55], v7, s[8:11], s29 offen offset:0 sc1
v_add_f32 v90, v90, v76
v_add_f32 v91, v91, v77
v_mfma_f32_16x16x32_bf16 v[148:151], a[212:215], v[80:83], v[148:151]
v_exp_f32 v79, v79
v_mfma_f32_16x16x32_bf16 v[152:155], a[216:219], v[80:83], v[152:155]
ds_read_b128 a[188:191], v21 offset:21952
v_cvt_pk_bf16_f32 v87, v78, v79
v_mfma_f32_16x16x32_bf16 v[156:159], a[220:223], v[80:83], v[156:159]
s_waitcnt lgkmcnt(4)
v_add_f32 v90, v90, v78
v_add_f32 v91, v91, v79
v_mfma_f32_16x16x32_bf16 v[72:75], a[160:163], a[64:67], v[96:99]
ds_read_b64_tr_b16 a[224:225], v22 offset:26112
v_exp_f32 v64, v64
v_mfma_f32_16x16x32_bf16 v[72:75], a[164:167], a[68:71], v[72:75]
ds_read_b64_tr_b16 a[226:227], v22 offset:30464
v_exp_f32 v65, v65
v_mfma_f32_16x16x32_bf16 v[72:75], a[168:171], a[72:75], v[72:75]
ds_read_b64_tr_b16 a[228:229], v23 offset:26144
v_cvt_pk_bf16_f32 v80, v64, v65
v_mfma_f32_16x16x32_bf16 v[72:75], a[172:175], a[76:79], v[72:75]
v_exp_f32 v66, v66
v_mfma_f32_16x16x32_bf16 v[160:163], a[192:195], v[84:87], v[160:163]
s_add_u32 m0, s32, 53248
ds_read_b64_tr_b16 a[230:231], v23 offset:30496
v_add_f32 v92, v92, v64
v_add_f32 v93, v93, v65
v_mfma_f32_16x16x32_bf16 v[164:167], a[196:199], v[84:87], v[164:167]
buffer_load_dwordx4 v3, s[12:15], s28 offen  lds
v_exp_f32 v67, v67
v_mfma_f32_16x16x32_bf16 v[168:171], a[200:203], v[84:87], v[168:171]
ds_read_b64_tr_b16 a[232:233], v22 offset:26176
v_cvt_pk_bf16_f32 v81, v66, v67
v_mfma_f32_16x16x32_bf16 v[172:175], a[204:207], v[84:87], v[172:175]
s_waitcnt lgkmcnt(5)
v_exp_f32 v68, v68
v_mfma_f32_16x16x32_bf16 v[76:79], a[176:179], a[64:67], v[96:99]
ds_read_b64_tr_b16 a[234:235], v22 offset:30528
buffer_load_dwordx4 a[56:59], v6, s[8:11], s29 offen offset:1024 sc1
v_add_f32 v92, v92, v66
v_add_f32 v93, v93, v67
v_mfma_f32_16x16x32_bf16 v[76:79], a[180:183], a[68:71], v[76:79]
v_exp_f32 v69, v69
v_mfma_f32_16x16x32_bf16 v[76:79], a[184:187], a[72:75], v[76:79]
ds_read_b64_tr_b16 a[236:237], v23 offset:26208
v_cvt_pk_bf16_f32 v82, v68, v69
v_mfma_f32_16x16x32_bf16 v[76:79], a[188:191], a[76:79], v[76:79]
v_exp_f32 v70, v70
v_mfma_f32_16x16x32_bf16 v[176:179], a[208:211], v[84:87], v[176:179]
buffer_load_dwordx4 a[60:63], v7, s[8:11], s29 offen offset:1024 sc1
v_add_f32 v92, v92, v68
v_add_f32 v93, v93, v69
s_add_u32 s29, s29, 2048
v_mfma_f32_16x16x32_bf16 v[180:183], a[212:215], v[84:87], v[180:183]
v_exp_f32 v71, v71
v_mfma_f32_16x16x32_bf16 v[184:187], a[216:219], v[84:87], v[184:187]
ds_read_b64_tr_b16 a[238:239], v23 offset:30560
v_cvt_pk_bf16_f32 v83, v70, v71
v_mfma_f32_16x16x32_bf16 v[188:191], a[220:223], v[84:87], v[188:191]
s_waitcnt lgkmcnt(6)
v_add_f32 v92, v92, v70
v_add_f32 v93, v93, v71
v_mfma_f32_16x16x32_bf16 v[64:67], a[160:163], a[80:83], v[100:103]
ds_read_b64_tr_b16 a[240:241], v22 offset:26240
v_exp_f32 v72, v72
v_mfma_f32_16x16x32_bf16 v[64:67], a[164:167], a[84:87], v[64:67]
ds_read_b64_tr_b16 a[242:243], v22 offset:30592
v_exp_f32 v73, v73
v_mfma_f32_16x16x32_bf16 v[64:67], a[168:171], a[88:91], v[64:67]
ds_read_b64_tr_b16 a[244:245], v23 offset:26272
v_cvt_pk_bf16_f32 v84, v72, v73
v_mfma_f32_16x16x32_bf16 v[64:67], a[172:175], a[92:95], v[64:67]
s_add_u32 s41, s41, 34816
v_exp_f32 v74, v74
v_mfma_f32_16x16x32_bf16 v[192:195], a[192:195], v[80:83], v[192:195]
s_add_u32 m0, s32, 54272
ds_read_b64_tr_b16 a[246:247], v23 offset:30624
v_add_f32 v88, v88, v72
v_add_f32 v89, v89, v73
v_mfma_f32_16x16x32_bf16 v[196:199], a[196:199], v[80:83], v[196:199]
s_cmp_eq_u32 s41, 139264
buffer_load_dwordx4 v4, s[12:15], s28 offen  lds
v_exp_f32 v75, v75
v_mfma_f32_16x16x32_bf16 v[200:203], a[200:203], v[80:83], v[200:203]
ds_read_b64_tr_b16 a[248:249], v22 offset:26304
v_cvt_pk_bf16_f32 v85, v74, v75
v_mfma_f32_16x16x32_bf16 v[204:207], a[204:207], v[80:83], v[204:207]
s_cselect_b32 s41, 0, s41
v_exp_f32 v76, v76
v_mfma_f32_16x16x32_bf16 v[68:71], a[176:179], a[80:83], v[100:103]
ds_read_b64_tr_b16 a[250:251], v22 offset:30656
v_add_f32 v88, v88, v74
v_add_f32 v89, v89, v75
v_mfma_f32_16x16x32_bf16 v[68:71], a[180:183], a[84:87], v[68:71]
v_exp_f32 v77, v77
v_mfma_f32_16x16x32_bf16 v[68:71], a[184:187], a[88:91], v[68:71]
s_add_u32 m0, s32, 55296
ds_read_b64_tr_b16 a[252:253], v23 offset:26336
v_cvt_pk_bf16_f32 v86, v76, v77
v_mfma_f32_16x16x32_bf16 v[68:71], a[188:191], a[92:95], v[68:71]
buffer_load_dwordx4 v5, s[12:15], s28 offen  lds
v_exp_f32 v78, v78
s_add_u32 s28, s28, 1048576
v_mfma_f32_16x16x32_bf16 v[208:211], a[208:211], v[80:83], v[208:211]
v_add_f32 v88, v88, v76
v_add_f32 v89, v89, v77
v_mfma_f32_16x16x32_bf16 v[212:215], a[212:215], v[80:83], v[212:215]
v_exp_f32 v79, v79
v_mfma_f32_16x16x32_bf16 v[216:219], a[216:219], v[80:83], v[216:219]
ds_read_b64_tr_b16 a[254:255], v23 offset:30688
v_cvt_pk_bf16_f32 v87, v78, v79
v_mfma_f32_16x16x32_bf16 v[220:223], a[220:223], v[80:83], v[220:223]
s_waitcnt lgkmcnt(6)
v_add_u32 v21, s41, v18
v_add_u32 v22, s41, v19
v_add_u32 v23, s41, v20
v_add_f32 v88, v88, v78
v_add_f32 v89, v89, v79
s_barrier
v_mfma_f32_16x16x32_bf16 v[72:75], a[160:163], a[96:99], v[104:107]
v_exp_f32 v64, v64
v_mfma_f32_16x16x32_bf16 v[72:75], a[164:167], a[100:103], v[72:75]
v_exp_f32 v65, v65
v_mfma_f32_16x16x32_bf16 v[72:75], a[168:171], a[104:107], v[72:75]
v_cvt_pk_bf16_f32 v80, v64, v65
v_mfma_f32_16x16x32_bf16 v[72:75], a[172:175], a[108:111], v[72:75]
v_exp_f32 v66, v66
v_mfma_f32_16x16x32_bf16 v[128:131], a[224:227], v[84:87], v[128:131]
s_add_u32 m0, s32, 69632
v_add_f32 v90, v90, v64
v_add_f32 v91, v91, v65
v_mfma_f32_16x16x32_bf16 v[132:135], a[228:231], v[84:87], v[132:135]
buffer_load_dwordx4 v2, s[12:15], s28 offen  lds
v_exp_f32 v67, v67
v_mfma_f32_16x16x32_bf16 v[136:139], a[232:235], v[84:87], v[136:139]
v_cvt_pk_bf16_f32 v81, v66, v67
v_mfma_f32_16x16x32_bf16 v[140:143], a[236:239], v[84:87], v[140:143]
v_exp_f32 v68, v68
v_mfma_f32_16x16x32_bf16 v[76:79], a[176:179], a[96:99], v[104:107]
v_add_f32 v90, v90, v66
v_add_f32 v91, v91, v67
v_mfma_f32_16x16x32_bf16 v[76:79], a[180:183], a[100:103], v[76:79]
v_exp_f32 v69, v69
v_mfma_f32_16x16x32_bf16 v[76:79], a[184:187], a[104:107], v[76:79]
v_cvt_pk_bf16_f32 v82, v68, v69
v_mfma_f32_16x16x32_bf16 v[76:79], a[188:191], a[108:111], v[76:79]
s_waitcnt lgkmcnt(0)
v_exp_f32 v70, v70
v_mfma_f32_16x16x32_bf16 v[144:147], a[240:243], v[84:87], v[144:147]
v_add_f32 v90, v90, v68
v_add_f32 v91, v91, v69
v_mfma_f32_16x16x32_bf16 v[148:151], a[244:247], v[84:87], v[148:151]
v_exp_f32 v71, v71
v_mfma_f32_16x16x32_bf16 v[152:155], a[248:251], v[84:87], v[152:155]
v_cvt_pk_bf16_f32 v83, v70, v71
v_mfma_f32_16x16x32_bf16 v[156:159], a[252:255], v[84:87], v[156:159]
v_add_f32 v90, v90, v70
v_add_f32 v91, v91, v71
v_exp_f32 v72, v72
v_exp_f32 v73, v73
s_nop 0
v_cvt_pk_bf16_f32 v84, v72, v73
v_exp_f32 v74, v74
v_mfma_f32_16x16x32_bf16 v[160:163], a[224:227], v[80:83], v[160:163]
s_add_u32 m0, s32, 70656
buffer_load_dwordx4 a[64:67], v6, s[8:11], s29 offen offset:0 sc1
v_add_f32 v92, v92, v72
v_add_f32 v93, v93, v73
v_mfma_f32_16x16x32_bf16 v[164:167], a[228:231], v[80:83], v[164:167]
buffer_load_dwordx4 v3, s[12:15], s28 offen  lds
buffer_load_dwordx4 a[68:71], v7, s[8:11], s29 offen offset:0 sc1
v_exp_f32 v75, v75
v_mfma_f32_16x16x32_bf16 v[168:171], a[232:235], v[80:83], v[168:171]
buffer_load_dwordx4 a[72:75], v6, s[8:11], s29 offen offset:1024 sc1
v_cvt_pk_bf16_f32 v85, v74, v75
v_mfma_f32_16x16x32_bf16 v[172:175], a[236:239], v[80:83], v[172:175]
buffer_load_dwordx4 a[76:79], v7, s[8:11], s29 offen offset:1024 sc1
v_exp_f32 v76, v76
s_add_u32 s29, s29, 2048
v_add_f32 v92, v92, v74
v_add_f32 v93, v93, v75
v_exp_f32 v77, v77
s_nop 0
v_cvt_pk_bf16_f32 v86, v76, v77
v_exp_f32 v78, v78
v_mfma_f32_16x16x32_bf16 v[176:179], a[240:243], v[80:83], v[176:179]
buffer_load_dwordx4 a[80:83], v6, s[8:11], s29 offen offset:0 sc1
v_add_f32 v92, v92, v76
v_add_f32 v93, v93, v77
v_mfma_f32_16x16x32_bf16 v[180:183], a[244:247], v[80:83], v[180:183]
buffer_load_dwordx4 a[84:87], v7, s[8:11], s29 offen offset:0 sc1
v_exp_f32 v79, v79
v_mfma_f32_16x16x32_bf16 v[184:187], a[248:251], v[80:83], v[184:187]
buffer_load_dwordx4 a[88:91], v6, s[8:11], s29 offen offset:1024 sc1
v_cvt_pk_bf16_f32 v87, v78, v79
v_mfma_f32_16x16x32_bf16 v[188:191], a[252:255], v[80:83], v[188:191]
buffer_load_dwordx4 a[92:95], v7, s[8:11], s29 offen offset:1024 sc1
v_add_f32 v92, v92, v78
v_add_f32 v93, v93, v79
s_add_u32 s29, s29, 2048
v_mfma_f32_16x16x32_bf16 v[192:195], a[224:227], v[84:87], v[192:195]
s_add_u32 m0, s32, 71680
buffer_load_dwordx4 a[96:99], v6, s[8:11], s29 offen offset:0 sc1
v_mfma_f32_16x16x32_bf16 v[196:199], a[228:231], v[84:87], v[196:199]
buffer_load_dwordx4 v4, s[12:15], s28 offen  lds
buffer_load_dwordx4 a[100:103], v7, s[8:11], s29 offen offset:0 sc1
v_mfma_f32_16x16x32_bf16 v[200:203], a[232:235], v[84:87], v[200:203]
buffer_load_dwordx4 a[104:107], v6, s[8:11], s29 offen offset:1024 sc1
v_mfma_f32_16x16x32_bf16 v[204:207], a[236:239], v[84:87], v[204:207]
buffer_load_dwordx4 a[108:111], v7, s[8:11], s29 offen offset:1024 sc1
s_add_u32 s29, s29, 2048
s_add_u32 m0, s32, 72704
s_nop 0
buffer_load_dwordx4 v5, s[12:15], s28 offen  lds
s_add_u32 s28, s28, 1048576
v_mfma_f32_16x16x32_bf16 v[208:211], a[240:243], v[84:87], v[208:211]
v_mfma_f32_16x16x32_bf16 v[212:215], a[244:247], v[84:87], v[212:215]
v_mfma_f32_16x16x32_bf16 v[216:219], a[248:251], v[84:87], v[216:219]
v_mfma_f32_16x16x32_bf16 v[220:223], a[252:255], v[84:87], v[220:223]
s_nop 7
v_add_f32 v116, v88, v89
v_mov_b32 v88, 0
v_mov_b32 v89, 0
v_mov_b32 v27, v116
s_nop 1
v_permlane32_swap_b32 v116, v27
s_nop 1
v_add_f32 v116, v116, v27
v_mov_b32 v27, v116
s_nop 1
v_permlane16_swap_b32 v116, v27
s_nop 1
v_add_f32 v116, v116, v27
v_cmp_nge_f32 vcc, 0x4e800000, v116
v_rcp_f32 v116, v116
s_nop 1
s_nop 0
s_or_b64 s[46:47], s[46:47], vcc
v_add_f32 v117, v90, v91
v_mov_b32 v90, 0
v_mov_b32 v91, 0
v_mov_b32 v27, v117
s_nop 1
v_permlane32_swap_b32 v117, v27
s_nop 1
v_add_f32 v117, v117, v27
v_mov_b32 v27, v117
s_nop 1
v_permlane16_swap_b32 v117, v27
s_nop 1
v_add_f32 v117, v117, v27
v_cmp_nge_f32 vcc, 0x4e800000, v117
v_rcp_f32 v117, v117
s_nop 1
s_nop 0
s_or_b64 s[46:47], s[46:47], vcc
v_add_f32 v118, v92, v93
v_mov_b32 v92, 0
v_mov_b32 v93, 0
v_mov_b32 v27, v118
s_nop 1
v_permlane32_swap_b32 v118, v27
s_nop 1
v_add_f32 v118, v118, v27
v_mov_b32 v27, v118
s_nop 1
v_permlane16_swap_b32 v118, v27
s_nop 1
v_add_f32 v118, v118, v27
v_cmp_nge_f32 vcc, 0x4e800000, v118
v_rcp_f32 v118, v118
s_nop 1
s_nop 0
s_or_b64 s[46:47], s[46:47], vcc
s_mov_b32 s43, 65536
v_pk_mul_f32 v[128:129], v[128:129], v[116:117] op_sel:[0,0] op_sel_hi:[1,0]
v_pk_mul_f32 v[130:131], v[130:131], v[116:117] op_sel:[0,0] op_sel_hi:[1,0]
v_pk_mul_f32 v[132:133], v[132:133], v[116:117] op_sel:[0,0] op_sel_hi:[1,0]
v_pk_mul_f32 v[134:135], v[134:135], v[116:117] op_sel:[0,0] op_sel_hi:[1,0]
v_cvt_pk_bf16_f32 v120, v128, v129
v_cvt_pk_bf16_f32 v121, v130, v131
v_cvt_pk_bf16_f32 v122, v132, v133
v_cvt_pk_bf16_f32 v123, v134, v135
buffer_store_dwordx4 v[120:123], v26, s[24:27], s43 offen offset:0 sc1
v_pk_mul_f32 v[136:137], v[136:137], v[116:117] op_sel:[0,0] op_sel_hi:[1,0]
v_pk_mul_f32 v[138:139], v[138:139], v[116:117] op_sel:[0,0] op_sel_hi:[1,0]
v_pk_mul_f32 v[140:141], v[140:141], v[116:117] op_sel:[0,0] op_sel_hi:[1,0]
v_pk_mul_f32 v[142:143], v[142:143], v[116:117] op_sel:[0,0] op_sel_hi:[1,0]
v_cvt_pk_bf16_f32 v124, v136, v137
v_cvt_pk_bf16_f32 v125, v138, v139
v_cvt_pk_bf16_f32 v126, v140, v141
v_cvt_pk_bf16_f32 v127, v142, v143
buffer_store_dwordx4 v[124:127], v26, s[24:27], s43 offen offset:1024 sc1
s_mov_b32 s43, 98304
v_pk_mul_f32 v[144:145], v[144:145], v[116:117] op_sel:[0,0] op_sel_hi:[1,0]
v_pk_mul_f32 v[146:147], v[146:147], v[116:117] op_sel:[0,0] op_sel_hi:[1,0]
v_pk_mul_f32 v[148:149], v[148:149], v[116:117] op_sel:[0,0] op_sel_hi:[1,0]
v_pk_mul_f32 v[150:151], v[150:151], v[116:117] op_sel:[0,0] op_sel_hi:[1,0]
v_cvt_pk_bf16_f32 v120, v144, v145
v_cvt_pk_bf16_f32 v121, v146, v147
v_cvt_pk_bf16_f32 v122, v148, v149
v_cvt_pk_bf16_f32 v123, v150, v151
buffer_store_dwordx4 v[120:123], v26, s[24:27], s43 offen offset:0 sc1
v_pk_mul_f32 v[152:153], v[152:153], v[116:117] op_sel:[0,0] op_sel_hi:[1,0]
v_pk_mul_f32 v[154:155], v[154:155], v[116:117] op_sel:[0,0] op_sel_hi:[1,0]
v_pk_mul_f32 v[156:157], v[156:157], v[116:117] op_sel:[0,0] op_sel_hi:[1,0]
v_pk_mul_f32 v[158:159], v[158:159], v[116:117] op_sel:[0,0] op_sel_hi:[1,0]
v_cvt_pk_bf16_f32 v124, v152, v153
v_cvt_pk_bf16_f32 v125, v154, v155
v_cvt_pk_bf16_f32 v126, v156, v157
v_cvt_pk_bf16_f32 v127, v158, v159
buffer_store_dwordx4 v[124:127], v26, s[24:27], s43 offen offset:1024 sc1
s_mov_b32 s43, 196608
v_pk_mul_f32 v[160:161], v[160:161], v[116:117] op_sel:[0,1] op_sel_hi:[1,1]
v_pk_mul_f32 v[162:163], v[162:163], v[116:117] op_sel:[0,1] op_sel_hi:[1,1]
v_pk_mul_f32 v[164:165], v[164:165], v[116:117] op_sel:[0,1] op_sel_hi:[1,1]
v_pk_mul_f32 v[166:167], v[166:167], v[116:117] op_sel:[0,1] op_sel_hi:[1,1]
v_cvt_pk_bf16_f32 v120, v160, v161
v_cvt_pk_bf16_f32 v121, v162, v163
v_cvt_pk_bf16_f32 v122, v164, v165
v_cvt_pk_bf16_f32 v123, v166, v167
buffer_store_dwordx4 v[120:123], v26, s[24:27], s43 offen offset:0 sc1
v_pk_mul_f32 v[168:169], v[168:169], v[116:117] op_sel:[0,1] op_sel_hi:[1,1]
v_pk_mul_f32 v[170:171], v[170:171], v[116:117] op_sel:[0,1] op_sel_hi:[1,1]
v_pk_mul_f32 v[172:173], v[172:173], v[116:117] op_sel:[0,1] op_sel_hi:[1,1]
v_pk_mul_f32 v[174:175], v[174:175], v[116:117] op_sel:[0,1] op_sel_hi:[1,1]
v_cvt_pk_bf16_f32 v124, v168, v169
v_cvt_pk_bf16_f32 v125, v170, v171
v_cvt_pk_bf16_f32 v126, v172, v173
v_cvt_pk_bf16_f32 v127, v174, v175
buffer_store_dwordx4 v[124:127], v26, s[24:27], s43 offen offset:1024 sc1
s_mov_b32 s43, 229376
v_pk_mul_f32 v[176:177], v[176:177], v[116:117] op_sel:[0,1] op_sel_hi:[1,1]
v_pk_mul_f32 v[178:179], v[178:179], v[116:117] op_sel:[0,1] op_sel_hi:[1,1]
v_pk_mul_f32 v[180:181], v[180:181], v[116:117] op_sel:[0,1] op_sel_hi:[1,1]
v_pk_mul_f32 v[182:183], v[182:183], v[116:117] op_sel:[0,1] op_sel_hi:[1,1]
v_cvt_pk_bf16_f32 v120, v176, v177
v_cvt_pk_bf16_f32 v121, v178, v179
v_cvt_pk_bf16_f32 v122, v180, v181
v_cvt_pk_bf16_f32 v123, v182, v183
buffer_store_dwordx4 v[120:123], v26, s[24:27], s43 offen offset:0 sc1
v_pk_mul_f32 v[184:185], v[184:185], v[116:117] op_sel:[0,1] op_sel_hi:[1,1]
v_pk_mul_f32 v[186:187], v[186:187], v[116:117] op_sel:[0,1] op_sel_hi:[1,1]
v_pk_mul_f32 v[188:189], v[188:189], v[116:117] op_sel:[0,1] op_sel_hi:[1,1]
v_pk_mul_f32 v[190:191], v[190:191], v[116:117] op_sel:[0,1] op_sel_hi:[1,1]
v_cvt_pk_bf16_f32 v124, v184, v185
v_cvt_pk_bf16_f32 v125, v186, v187
v_cvt_pk_bf16_f32 v126, v188, v189
v_cvt_pk_bf16_f32 v127, v190, v191
s_waitcnt vmcnt(62)
buffer_store_dwordx4 v[124:127], v26, s[24:27], s43 offen offset:1024 sc1
s_mov_b32 s43, 327680
v_pk_mul_f32 v[192:193], v[192:193], v[118:119] op_sel:[0,0] op_sel_hi:[1,0]
v_pk_mul_f32 v[194:195], v[194:195], v[118:119] op_sel:[0,0] op_sel_hi:[1,0]
v_pk_mul_f32 v[196:197], v[196:197], v[118:119] op_sel:[0,0] op_sel_hi:[1,0]
v_pk_mul_f32 v[198:199], v[198:199], v[118:119] op_sel:[0,0] op_sel_hi:[1,0]
v_cvt_pk_bf16_f32 v120, v192, v193
v_cvt_pk_bf16_f32 v121, v194, v195
v_cvt_pk_bf16_f32 v122, v196, v197
v_cvt_pk_bf16_f32 v123, v198, v199
s_waitcnt vmcnt(62)
buffer_store_dwordx4 v[120:123], v26, s[24:27], s43 offen offset:0 sc1
v_pk_mul_f32 v[200:201], v[200:201], v[118:119] op_sel:[0,0] op_sel_hi:[1,0]
v_pk_mul_f32 v[202:203], v[202:203], v[118:119] op_sel:[0,0] op_sel_hi:[1,0]
v_pk_mul_f32 v[204:205], v[204:205], v[118:119] op_sel:[0,0] op_sel_hi:[1,0]
v_pk_mul_f32 v[206:207], v[206:207], v[118:119] op_sel:[0,0] op_sel_hi:[1,0]
v_cvt_pk_bf16_f32 v124, v200, v201
v_cvt_pk_bf16_f32 v125, v202, v203
v_cvt_pk_bf16_f32 v126, v204, v205
v_cvt_pk_bf16_f32 v127, v206, v207
s_waitcnt vmcnt(62)
buffer_store_dwordx4 v[124:127], v26, s[24:27], s43 offen offset:1024 sc1
s_mov_b32 s43, 360448
v_pk_mul_f32 v[208:209], v[208:209], v[118:119] op_sel:[0,0] op_sel_hi:[1,0]
v_pk_mul_f32 v[210:211], v[210:211], v[118:119] op_sel:[0,0] op_sel_hi:[1,0]
v_pk_mul_f32 v[212:213], v[212:213], v[118:119] op_sel:[0,0] op_sel_hi:[1,0]
v_pk_mul_f32 v[214:215], v[214:215], v[118:119] op_sel:[0,0] op_sel_hi:[1,0]
v_cvt_pk_bf16_f32 v120, v208, v209
v_cvt_pk_bf16_f32 v121, v210, v211
v_cvt_pk_bf16_f32 v122, v212, v213
v_cvt_pk_bf16_f32 v123, v214, v215
s_waitcnt vmcnt(62)
buffer_store_dwordx4 v[120:123], v26, s[24:27], s43 offen offset:0 sc1
v_pk_mul_f32 v[216:217], v[216:217], v[118:119] op_sel:[0,0] op_sel_hi:[1,0]
v_pk_mul_f32 v[218:219], v[218:219], v[118:119] op_sel:[0,0] op_sel_hi:[1,0]
v_pk_mul_f32 v[220:221], v[220:221], v[118:119] op_sel:[0,0] op_sel_hi:[1,0]
v_pk_mul_f32 v[222:223], v[222:223], v[118:119] op_sel:[0,0] op_sel_hi:[1,0]
v_cvt_pk_bf16_f32 v124, v216, v217
v_cvt_pk_bf16_f32 v125, v218, v219
v_cvt_pk_bf16_f32 v126, v220, v221
v_cvt_pk_bf16_f32 v127, v222, v223
s_waitcnt vmcnt(62)
buffer_store_dwordx4 v[124:127], v26, s[24:27], s43 offen offset:1024 sc1
s_branch L_fuse
L_tm3:
v_lshrrev_b32 v27, 4, v1
v_and_b32 v28, 15, v1
v_lshlrev_b32 v31, 8, v28
v_lshl_add_u32 v31, v27, 4, v31
v_mov_b32 v192, 0xff7fffff
v_mov_b32 v193, 0xff7fffff
v_mov_b32 v194, 0xff7fffff
s_mov_b32 s37, 0
s_mov_b32 s32, 64
L_tm3_0:
s_waitcnt vmcnt(62)
buffer_load_dwordx4 v[32:35], v31, s[16:19], s37 offen offset:0
s_waitcnt vmcnt(62)
buffer_load_dwordx4 v[36:39], v31, s[16:19], s37 offen offset:64
s_waitcnt vmcnt(62)
buffer_load_dwordx4 v[40:43], v31, s[16:19], s37 offen offset:128
s_waitcnt vmcnt(62)
buffer_load_dwordx4 v[44:47], v31, s[16:19], s37 offen offset:192
s_waitcnt vmcnt(0)
v_mfma_f32_16x16x32_bf16 v[128:131], v[32:35], a[0:3], 0
v_mfma_f32_16x16x32_bf16 v[128:131], v[36:39], a[4:7], v[128:131]
v_mfma_f32_16x16x32_bf16 v[128:131], v[40:43], a[8:11], v[128:131]
v_mfma_f32_16x16x32_bf16 v[128:131], v[44:47], a[12:15], v[128:131]
v_mfma_f32_16x16x32_bf16 v[132:135], v[32:35], a[16:19], 0
v_mfma_f32_16x16x32_bf16 v[132:135], v[36:39], a[20:23], v[132:135]
v_mfma_f32_16x16x32_bf16 v[132:135], v[40:43], a[24:27], v[132:135]
v_mfma_f32_16x16x32_bf16 v[132:135], v[44:47], a[28:31], v[132:135]
v_mfma_f32_16x16x32_bf16 v[136:139], v[32:35], a[32:35], 0
v_mfma_f32_16x16x32_bf16 v[136:139], v[36:39], a[36:39], v[136:139]
v_mfma_f32_16x16x32_bf16 v[136:139], v[40:43], a[40:43], v[136:139]
v_mfma_f32_16x16x32_bf16 v[136:139], v[44:47], a[44:47], v[136:139]
s_nop 7
v_max3_f32 v192, v192, v128, v129
v_max3_f32 v192, v192, v130, v131
v_max3_f32 v193, v193, v132, v133
v_max3_f32 v193, v193, v134, v135
v_max3_f32 v194, v194, v136, v137
v_max3_f32 v194, v194, v138, v139
s_add_u32 s37, s37, 4096
s_sub_u32 s32, s32, 1
s_cmp_lg_u32 s32, 0
s_cbranch_scc1 L_tm3_0
v_mov_b32 v195, 0xff7fffff
v_mov_b32 v196, 0xff7fffff
v_mov_b32 v197, 0xff7fffff
s_mov_b32 s37, 262144
s_mov_b32 s32, 64
L_tm3_1:
buffer_load_dwordx4 v[32:35], v31, s[16:19], s37 offen offset:0
buffer_load_dwordx4 v[36:39], v31, s[16:19], s37 offen offset:64
buffer_load_dwordx4 v[40:43], v31, s[16:19], s37 offen offset:128
buffer_load_dwordx4 v[44:47], v31, s[16:19], s37 offen offset:192
s_waitcnt vmcnt(0)
v_mfma_f32_16x16x32_bf16 v[128:131], v[32:35], a[64:67], 0
v_mfma_f32_16x16x32_bf16 v[128:131], v[36:39], a[68:71], v[128:131]
v_mfma_f32_16x16x32_bf16 v[128:131], v[40:43], a[72:75], v[128:131]
v_mfma_f32_16x16x32_bf16 v[128:131], v[44:47], a[76:79], v[128:131]
v_mfma_f32_16x16x32_bf16 v[132:135], v[32:35], a[80:83], 0
v_mfma_f32_16x16x32_bf16 v[132:135], v[36:39], a[84:87], v[132:135]
v_mfma_f32_16x16x32_bf16 v[132:135], v[40:43], a[88:91], v[132:135]
v_mfma_f32_16x16x32_bf16 v[132:135], v[44:47], a[92:95], v[132:135]
v_mfma_f32_16x16x32_bf16 v[136:139], v[32:35], a[96:99], 0
v_mfma_f32_16x16x32_bf16 v[136:139], v[36:39], a[100:103], v[136:139]
v_mfma_f32_16x16x32_bf16 v[136:139], v[40:43], a[104:107], v[136:139]
v_mfma_f32_16x16x32_bf16 v[136:139], v[44:47], a[108:111], v[136:139]
s_nop 7
v_max3_f32 v195, v195, v128, v129
v_max3_f32 v195, v195, v130, v131
v_max3_f32 v196, v196, v132, v133
v_max3_f32 v196, v196, v134, v135
v_max3_f32 v197, v197, v136, v137
v_max3_f32 v197, v197, v138, v139
s_add_u32 s37, s37, 4096
s_sub_u32 s32, s32, 1
s_cmp_lg_u32 s32, 0
s_cbranch_scc1 L_tm3_1
v_mov_b32 v208, v192
v_mov_b32 v209, v193
v_mov_b32 v210, v194
v_mov_b32 v211, v195
v_mov_b32 v212, v196
v_mov_b32 v213, v197
s_nop 1
v_permlane32_swap_b32 v192, v208
v_permlane32_swap_b32 v193, v209
v_permlane32_swap_b32 v194, v210
v_permlane32_swap_b32 v195, v211
v_permlane32_swap_b32 v196, v212
v_permlane32_swap_b32 v197, v213
s_nop 1
v_max_f32 v192, v192, v208
v_max_f32 v193, v193, v209
v_max_f32 v194, v194, v210
v_max_f32 v195, v195, v211
v_max_f32 v196, v196, v212
v_max_f32 v197, v197, v213
v_mov_b32 v208, v192
v_mov_b32 v209, v193
v_mov_b32 v210, v194
v_mov_b32 v211, v195
v_mov_b32 v212, v196
v_mov_b32 v213, v197
s_nop 1
v_permlane16_swap_b32 v192, v208
v_permlane16_swap_b32 v193, v209
v_permlane16_swap_b32 v194, v210
v_permlane16_swap_b32 v195, v211
v_permlane16_swap_b32 v196, v212
v_permlane16_swap_b32 v197, v213
s_nop 1
v_max_f32 v192, v192, v208
v_max_f32 v193, v193, v209
v_max_f32 v194, v194, v210
v_max_f32 v195, v195, v211
v_max_f32 v196, v196, v212
v_max_f32 v197, v197, v213
v_sub_f32 v96, 0, v192
v_sub_f32 v97, 0, v192
v_sub_f32 v98, 0, v192
v_sub_f32 v99, 0, v192
v_sub_f32 v112, 0, v195
v_sub_f32 v100, 0, v193
v_sub_f32 v101, 0, v193
v_sub_f32 v102, 0, v193
v_sub_f32 v103, 0, v193
v_sub_f32 v113, 0, v196
v_sub_f32 v104, 0, v194
v_sub_f32 v105, 0, v194
v_sub_f32 v106, 0, v194
v_sub_f32 v107, 0, v194
v_sub_f32 v114, 0, v197
s_nop 7
s_branch L_attn3
L_end1:
s_endpgm
L_tslow:
s_mov_b32 s38, 0x4000
L_tslow_spin:
buffer_load_dwordx2 v[14:15], v8, s[60:63], 0 offen sc1
s_waitcnt vmcnt(0)
v_and_b32 v16, s34, v14
v_and_b32 v17, s35, v15
v_cmp_ne_u64 vcc, s[34:35], v[16:17]
s_nop 3
s_cbranch_vccz L_tback
s_sub_u32 s38, s38, 1
s_cmp_lg_u32 s38, 0
s_cbranch_scc1 L_tslow_spin
s_branch L_tback
.p2align 6
L_fuse:
s_cmp_eq_u32 s42, 1
s_cbranch_scc1 L_fok
s_cmp_eq_u64 s[46:47], 0
s_cbranch_scc1 L_fok
v_mov_b32 v27, 1
v_mov_b32 v28, 163832
ds_write_b32 v28, v27
L_fok:
s_cmp_eq_u32 s33, 0
s_cbranch_scc1 L_notile
v_mov_b32 v28, 163832
s_lshl_b32 s48, 0x10000, s68
s_lshl_b32 s50, 1, s68
s_lshl_b32 s49, s6, 3
s_add_u32 s49, s49, s7
s_mul_i32 s49, s49, 16
v_mov_b32 v29, s48
v_mov_b32 v30, s49
v_mov_b32 v31, s50
s_waitcnt vmcnt(50)
s_waitcnt lgkmcnt(0)
s_barrier
ds_read_b32 v27, v28
ds_read_b64_tr_b16 v[136:137], v40 offset:34816
ds_read_b64_tr_b16 v[138:139], v40 offset:38912
ds_read_b64_tr_b16 v[140:141], v41 offset:34816
ds_read_b64_tr_b16 v[142:143], v41 offset:38912
ds_read_b64_tr_b16 v[144:145], v42 offset:34816
ds_read_b64_tr_b16 v[146:147], v42 offset:38912
ds_read_b64_tr_b16 v[148:149], v43 offset:34816
ds_read_b64_tr_b16 v[150:151], v43 offset:38912
ds_read_b64_tr_b16 v[152:153], v44 offset:34816
ds_read_b64_tr_b16 v[154:155], v44 offset:38912
ds_read_b64_tr_b16 v[156:157], v45 offset:34816
ds_read_b64_tr_b16 v[158:159], v45 offset:38912
s_waitcnt lgkmcnt(12)
v_readfirstlane_b32 s48, v27
s_nop 3
s_cmp_lg_u32 s48, 0
s_cbranch_scc1 L_redo
s_cmp_eq_u32 s3, 0
s_cselect_b32 s34, 0xff, 0
s_mov_b32 s35, 0
s_mov_b32 s30, 7
s_waitcnt lgkmcnt(8)
v_mfma_f32_16x16x32_bf16 v[72:75], v[136:139], a[0:3], 0
ds_read_b64_tr_b16 v[160:161], v46 offset:34816
v_mfma_f32_16x16x32_bf16 v[76:79], v[136:139], a[4:7], 0
ds_read_b64_tr_b16 v[162:163], v46 offset:38912
v_mfma_f32_16x16x32_bf16 v[80:83], v[140:143], a[0:3], 0
ds_read_b64_tr_b16 v[164:165], v47 offset:34816
v_mfma_f32_16x16x32_bf16 v[84:87], v[140:143], a[4:7], 0
s_waitcnt lgkmcnt(7)
ds_read_b64_tr_b16 v[166:167], v47 offset:38912
v_mfma_f32_16x16x32_bf16 v[88:91], v[144:147], a[0:3], 0
ds_read_b64_tr_b16 v[136:137], v40 offset:43008
v_mfma_f32_16x16x32_bf16 v[92:95], v[144:147], a[4:7], 0
ds_read_b64_tr_b16 v[138:139], v40 offset:47104
v_mfma_f32_16x16x32_bf16 v[96:99], v[148:151], a[0:3], 0
ds_read_b64_tr_b16 v[140:141], v41 offset:43008
v_mfma_f32_16x16x32_bf16 v[100:103], v[148:151], a[4:7], 0
s_waitcnt lgkmcnt(7)
ds_read_b64_tr_b16 v[142:143], v41 offset:47104
v_mfma_f32_16x16x32_bf16 v[104:107], v[152:155], a[0:3], 0
ds_read_b64_tr_b16 v[144:145], v42 offset:43008
v_mfma_f32_16x16x32_bf16 v[108:111], v[152:155], a[4:7], 0
ds_read_b64_tr_b16 v[146:147], v42 offset:47104
v_mfma_f32_16x16x32_bf16 v[112:115], v[156:159], a[0:3], 0
ds_read_b64_tr_b16 v[148:149], v43 offset:43008
v_mfma_f32_16x16x32_bf16 v[116:119], v[156:159], a[4:7], 0
s_waitcnt lgkmcnt(7)
ds_read_b64_tr_b16 v[150:151], v43 offset:47104
v_mfma_f32_16x16x32_bf16 v[120:123], v[160:163], a[0:3], 0
ds_read_b64_tr_b16 v[152:153], v44 offset:43008
v_mfma_f32_16x16x32_bf16 v[124:127], v[160:163], a[4:7], 0
ds_read_b64_tr_b16 v[154:155], v44 offset:47104
v_mfma_f32_16x16x32_bf16 v[128:131], v[164:167], a[0:3], 0
ds_read_b64_tr_b16 v[156:157], v45 offset:43008
v_mfma_f32_16x16x32_bf16 v[132:135], v[164:167], a[4:7], 0
s_waitcnt lgkmcnt(7)
ds_read_b64_tr_b16 v[158:159], v45 offset:47104
v_mfma_f32_16x16x32_bf16 v[72:75], v[136:139], a[8:11], v[72:75]
ds_read_b64_tr_b16 v[160:161], v46 offset:43008
v_mfma_f32_16x16x32_bf16 v[76:79], v[136:139], a[12:15], v[76:79]
ds_read_b64_tr_b16 v[162:163], v46 offset:47104
v_mfma_f32_16x16x32_bf16 v[80:83], v[140:143], a[8:11], v[80:83]
ds_read_b64_tr_b16 v[164:165], v47 offset:43008
v_mfma_f32_16x16x32_bf16 v[84:87], v[140:143], a[12:15], v[84:87]
s_waitcnt lgkmcnt(7)
ds_read_b64_tr_b16 v[166:167], v47 offset:47104
s_waitcnt vmcnt(43)
s_barrier
v_mfma_f32_16x16x32_bf16 v[88:91], v[144:147], a[8:11], v[88:91]
s_add_u32 m0, s32, 87040
ds_read_b64_tr_b16 v[136:137], v40 offset:52224
v_mfma_f32_16x16x32_bf16 v[92:95], v[144:147], a[12:15], v[92:95]
ds_read_b64_tr_b16 v[138:139], v40 offset:56320
buffer_load_dwordx4 v2, s[12:15], s28 offen  lds
v_mfma_f32_16x16x32_bf16 v[96:99], v[148:151], a[8:11], v[96:99]
ds_read_b64_tr_b16 v[140:141], v41 offset:52224
v_mfma_f32_16x16x32_bf16 v[100:103], v[148:151], a[12:15], v[100:103]
s_waitcnt lgkmcnt(7)
ds_read_b64_tr_b16 v[142:143], v41 offset:56320
v_mfma_f32_16x16x32_bf16 v[104:107], v[152:155], a[8:11], v[104:107]
ds_read_b64_tr_b16 v[144:145], v42 offset:52224
v_mfma_f32_16x16x32_bf16 v[108:111], v[152:155], a[12:15], v[108:111]
ds_read_b64_tr_b16 v[146:147], v42 offset:56320
buffer_load_dwordx4 a[112:115], v6, s[8:11], s29 offen offset:0 sc1
v_mfma_f32_16x16x32_bf16 v[112:115], v[156:159], a[8:11], v[112:115]
ds_read_b64_tr_b16 v[148:149], v43 offset:52224
v_mfma_f32_16x16x32_bf16 v[116:119], v[156:159], a[12:15], v[116:119]
s_waitcnt lgkmcnt(7)
ds_read_b64_tr_b16 v[150:151], v43 offset:56320
v_mfma_f32_16x16x32_bf16 v[120:123], v[160:163], a[8:11], v[120:123]
s_add_u32 m0, s32, 88064
ds_read_b64_tr_b16 v[152:153], v44 offset:52224
v_mfma_f32_16x16x32_bf16 v[124:127], v[160:163], a[12:15], v[124:127]
ds_read_b64_tr_b16 v[154:155], v44 offset:56320
buffer_load_dwordx4 v3, s[12:15], s28 offen  lds
v_mfma_f32_16x16x32_bf16 v[128:131], v[164:167], a[8:11], v[128:131]
ds_read_b64_tr_b16 v[156:157], v45 offset:52224
v_mfma_f32_16x16x32_bf16 v[132:135], v[164:167], a[12:15], v[132:135]
s_waitcnt lgkmcnt(7)
ds_read_b64_tr_b16 v[158:159], v45 offset:56320
v_mfma_f32_16x16x32_bf16 v[72:75], v[136:139], a[16:19], v[72:75]
ds_read_b64_tr_b16 v[160:161], v46 offset:52224
v_mfma_f32_16x16x32_bf16 v[76:79], v[136:139], a[20:23], v[76:79]
ds_read_b64_tr_b16 v[162:163], v46 offset:56320
buffer_load_dwordx4 a[116:119], v7, s[8:11], s29 offen offset:0 sc1
v_mfma_f32_16x16x32_bf16 v[80:83], v[140:143], a[16:19], v[80:83]
ds_read_b64_tr_b16 v[164:165], v47 offset:52224
v_mfma_f32_16x16x32_bf16 v[84:87], v[140:143], a[20:23], v[84:87]
s_waitcnt lgkmcnt(7)
ds_read_b64_tr_b16 v[166:167], v47 offset:56320
v_mfma_f32_16x16x32_bf16 v[88:91], v[144:147], a[16:19], v[88:91]
s_add_u32 m0, s32, 89088
ds_read_b64_tr_b16 v[136:137], v40 offset:60416
v_mfma_f32_16x16x32_bf16 v[92:95], v[144:147], a[20:23], v[92:95]
ds_read_b64_tr_b16 v[138:139], v40 offset:64512
buffer_load_dwordx4 v4, s[12:15], s28 offen  lds
v_mfma_f32_16x16x32_bf16 v[96:99], v[148:151], a[16:19], v[96:99]
ds_read_b64_tr_b16 v[140:141], v41 offset:60416
v_mfma_f32_16x16x32_bf16 v[100:103], v[148:151], a[20:23], v[100:103]
s_waitcnt lgkmcnt(7)
ds_read_b64_tr_b16 v[142:143], v41 offset:64512
v_mfma_f32_16x16x32_bf16 v[104:107], v[152:155], a[16:19], v[104:107]
ds_read_b64_tr_b16 v[144:145], v42 offset:60416
v_mfma_f32_16x16x32_bf16 v[108:111], v[152:155], a[20:23], v[108:111]
ds_read_b64_tr_b16 v[146:147], v42 offset:64512
buffer_load_dwordx4 a[120:123], v6, s[8:11], s29 offen offset:1024 sc1
v_mfma_f32_16x16x32_bf16 v[112:115], v[156:159], a[16:19], v[112:115]
ds_read_b64_tr_b16 v[148:149], v43 offset:60416
v_mfma_f32_16x16x32_bf16 v[116:119], v[156:159], a[20:23], v[116:119]
s_waitcnt lgkmcnt(7)
ds_read_b64_tr_b16 v[150:151], v43 offset:64512
v_mfma_f32_16x16x32_bf16 v[120:123], v[160:163], a[16:19], v[120:123]
s_add_u32 m0, s32, 90112
ds_read_b64_tr_b16 v[152:153], v44 offset:60416
v_mfma_f32_16x16x32_bf16 v[124:127], v[160:163], a[20:23], v[124:127]
ds_read_b64_tr_b16 v[154:155], v44 offset:64512
buffer_load_dwordx4 v5, s[12:15], s28 offen  lds
v_mfma_f32_16x16x32_bf16 v[128:131], v[164:167], a[16:19], v[128:131]
ds_read_b64_tr_b16 v[156:157], v45 offset:60416
v_mfma_f32_16x16x32_bf16 v[132:135], v[164:167], a[20:23], v[132:135]
s_waitcnt lgkmcnt(7)
ds_read_b64_tr_b16 v[158:159], v45 offset:64512
v_mfma_f32_16x16x32_bf16 v[72:75], v[136:139], a[24:27], v[72:75]
ds_read_b64_tr_b16 v[160:161], v46 offset:60416
v_mfma_f32_16x16x32_bf16 v[76:79], v[136:139], a[28:31], v[76:79]
ds_read_b64_tr_b16 v[162:163], v46 offset:64512
buffer_load_dwordx4 a[124:127], v7, s[8:11], s29 offen offset:1024 sc1
v_mfma_f32_16x16x32_bf16 v[80:83], v[140:143], a[24:27], v[80:83]
s_add_u32 s28, s28, s36
ds_read_b64_tr_b16 v[164:165], v47 offset:60416
v_mfma_f32_16x16x32_bf16 v[84:87], v[140:143], a[28:31], v[84:87]
s_waitcnt lgkmcnt(7)
s_add_u32 s29, s29, 2048
ds_read_b64_tr_b16 v[166:167], v47 offset:64512
s_waitcnt vmcnt(44)
s_barrier
v_mfma_f32_16x16x32_bf16 v[88:91], v[144:147], a[24:27], v[88:91]
s_xor_b32 s36, s36, 0x120000
s_add_u32 m0, s32, 104448
ds_read_b64_tr_b16 v[136:137], v32 offset:0
v_mfma_f32_16x16x32_bf16 v[92:95], v[144:147], a[28:31], v[92:95]
ds_read_b64_tr_b16 v[138:139], v32 offset:4096
buffer_load_dwordx4 v2, s[12:15], s28 offen  lds
v_mfma_f32_16x16x32_bf16 v[96:99], v[148:151], a[24:27], v[96:99]
ds_read_b64_tr_b16 v[140:141], v33 offset:0
v_mfma_f32_16x16x32_bf16 v[100:103], v[148:151], a[28:31], v[100:103]
s_waitcnt lgkmcnt(7)
ds_read_b64_tr_b16 v[142:143], v33 offset:4096
v_mfma_f32_16x16x32_bf16 v[104:107], v[152:155], a[24:27], v[104:107]
ds_read_b64_tr_b16 v[144:145], v34 offset:0
v_mfma_f32_16x16x32_bf16 v[108:111], v[152:155], a[28:31], v[108:111]
ds_read_b64_tr_b16 v[146:147], v34 offset:4096
buffer_load_dwordx4 a[0:3], v6, s[8:11], s29 offen offset:0 sc1
v_mfma_f32_16x16x32_bf16 v[112:115], v[156:159], a[24:27], v[112:115]
ds_read_b64_tr_b16 v[148:149], v35 offset:0
v_mfma_f32_16x16x32_bf16 v[116:119], v[156:159], a[28:31], v[116:119]
s_waitcnt lgkmcnt(7)
ds_read_b64_tr_b16 v[150:151], v35 offset:4096
v_mfma_f32_16x16x32_bf16 v[120:123], v[160:163], a[24:27], v[120:123]
s_add_u32 m0, s32, 105472
ds_read_b64_tr_b16 v[152:153], v36 offset:0
v_mfma_f32_16x16x32_bf16 v[124:127], v[160:163], a[28:31], v[124:127]
ds_read_b64_tr_b16 v[154:155], v36 offset:4096
buffer_load_dwordx4 v3, s[12:15], s28 offen  lds
v_mfma_f32_16x16x32_bf16 v[128:131], v[164:167], a[24:27], v[128:131]
ds_read_b64_tr_b16 v[156:157], v37 offset:0
v_mfma_f32_16x16x32_bf16 v[132:135], v[164:167], a[28:31], v[132:135]
s_waitcnt lgkmcnt(7)
ds_read_b64_tr_b16 v[158:159], v37 offset:4096
v_mfma_f32_16x16x32_bf16 v[72:75], v[136:139], a[32:35], v[72:75]
ds_read_b64_tr_b16 v[160:161], v38 offset:0
v_mfma_f32_16x16x32_bf16 v[76:79], v[136:139], a[36:39], v[76:79]
ds_read_b64_tr_b16 v[162:163], v38 offset:4096
buffer_load_dwordx4 a[4:7], v7, s[8:11], s29 offen offset:0 sc1
v_mfma_f32_16x16x32_bf16 v[80:83], v[140:143], a[32:35], v[80:83]
ds_read_b64_tr_b16 v[164:165], v39 offset:0
v_mfma_f32_16x16x32_bf16 v[84:87], v[140:143], a[36:39], v[84:87]
s_waitcnt lgkmcnt(7)
ds_read_b64_tr_b16 v[166:167], v39 offset:4096
v_mfma_f32_16x16x32_bf16 v[88:91], v[144:147], a[32:35], v[88:91]
s_add_u32 m0, s32, 106496
ds_read_b64_tr_b16 v[136:137], v32 offset:8192
v_mfma_f32_16x16x32_bf16 v[92:95], v[144:147], a[36:39], v[92:95]
ds_read_b64_tr_b16 v[138:139], v32 offset:12288
buffer_load_dwordx4 v4, s[12:15], s28 offen  lds
v_mfma_f32_16x16x32_bf16 v[96:99], v[148:151], a[32:35], v[96:99]
ds_read_b64_tr_b16 v[140:141], v33 offset:8192
v_mfma_f32_16x16x32_bf16 v[100:103], v[148:151], a[36:39], v[100:103]
s_waitcnt lgkmcnt(7)
ds_read_b64_tr_b16 v[142:143], v33 offset:12288
v_mfma_f32_16x16x32_bf16 v[104:107], v[152:155], a[32:35], v[104:107]
ds_read_b64_tr_b16 v[144:145], v34 offset:8192
v_mfma_f32_16x16x32_bf16 v[108:111], v[152:155], a[36:39], v[108:111]
ds_read_b64_tr_b16 v[146:147], v34 offset:12288
buffer_load_dwordx4 a[8:11], v6, s[8:11], s29 offen offset:1024 sc1
v_mfma_f32_16x16x32_bf16 v[112:115], v[156:159], a[32:35], v[112:115]
ds_read_b64_tr_b16 v[148:149], v35 offset:8192
v_mfma_f32_16x16x32_bf16 v[116:119], v[156:159], a[36:39], v[116:119]
s_waitcnt lgkmcnt(7)
ds_read_b64_tr_b16 v[150:151], v35 offset:12288
v_mfma_f32_16x16x32_bf16 v[120:123], v[160:163], a[32:35], v[120:123]
s_add_u32 m0, s32, 107520
ds_read_b64_tr_b16 v[152:153], v36 offset:8192
v_mfma_f32_16x16x32_bf16 v[124:127], v[160:163], a[36:39], v[124:127]
ds_read_b64_tr_b16 v[154:155], v36 offset:12288
buffer_load_dwordx4 v5, s[12:15], s28 offen  lds
v_mfma_f32_16x16x32_bf16 v[128:131], v[164:167], a[32:35], v[128:131]
ds_read_b64_tr_b16 v[156:157], v37 offset:8192
v_mfma_f32_16x16x32_bf16 v[132:135], v[164:167], a[36:39], v[132:135]
s_waitcnt lgkmcnt(7)
ds_read_b64_tr_b16 v[158:159], v37 offset:12288
v_mfma_f32_16x16x32_bf16 v[72:75], v[136:139], a[40:43], v[72:75]
ds_read_b64_tr_b16 v[160:161], v38 offset:8192
v_mfma_f32_16x16x32_bf16 v[76:79], v[136:139], a[44:47], v[76:79]
ds_read_b64_tr_b16 v[162:163], v38 offset:12288
buffer_load_dwordx4 a[12:15], v7, s[8:11], s29 offen offset:1024 sc1
v_mfma_f32_16x16x32_bf16 v[80:83], v[140:143], a[40:43], v[80:83]
s_add_u32 s28, s28, 1048576
ds_read_b64_tr_b16 v[164:165], v39 offset:8192
v_mfma_f32_16x16x32_bf16 v[84:87], v[140:143], a[44:47], v[84:87]
s_waitcnt lgkmcnt(7)
s_add_u32 s29, s29, 2048
ds_read_b64_tr_b16 v[166:167], v39 offset:12288
s_waitcnt vmcnt(46)
s_barrier
v_mfma_f32_16x16x32_bf16 v[88:91], v[144:147], a[40:43], v[88:91]
s_add_u32 m0, s32, 121856
ds_read_b64_tr_b16 v[136:137], v32 offset:17408
v_mfma_f32_16x16x32_bf16 v[92:95], v[144:147], a[44:47], v[92:95]
ds_read_b64_tr_b16 v[138:139], v32 offset:21504
buffer_load_dwordx4 v2, s[12:15], s28 offen  lds
v_mfma_f32_16x16x32_bf16 v[96:99], v[148:151], a[40:43], v[96:99]
ds_read_b64_tr_b16 v[140:141], v33 offset:17408
buffer_load_dwordx2 v[14:15], v8, s[60:63], 0 offen sc1
v_mfma_f32_16x16x32_bf16 v[100:103], v[148:151], a[44:47], v[100:103]
s_waitcnt lgkmcnt(7)
ds_read_b64_tr_b16 v[142:143], v33 offset:21504
v_mfma_f32_16x16x32_bf16 v[104:107], v[152:155], a[40:43], v[104:107]
ds_read_b64_tr_b16 v[144:145], v34 offset:17408
v_mfma_f32_16x16x32_bf16 v[108:111], v[152:155], a[44:47], v[108:111]
ds_read_b64_tr_b16 v[146:147], v34 offset:21504
buffer_load_dwordx4 a[16:19], v6, s[8:11], s29 offen offset:0 sc1
v_mfma_f32_16x16x32_bf16 v[112:115], v[156:159], a[40:43], v[112:115]
ds_read_b64_tr_b16 v[148:149], v35 offset:17408
v_mfma_f32_16x16x32_bf16 v[116:119], v[156:159], a[44:47], v[116:119]
s_waitcnt lgkmcnt(7)
ds_read_b64_tr_b16 v[150:151], v35 offset:21504
v_mfma_f32_16x16x32_bf16 v[120:123], v[160:163], a[40:43], v[120:123]
s_add_u32 m0, s32, 122880
ds_read_b64_tr_b16 v[152:153], v36 offset:17408
v_mfma_f32_16x16x32_bf16 v[124:127], v[160:163], a[44:47], v[124:127]
ds_read_b64_tr_b16 v[154:155], v36 offset:21504
buffer_load_dwordx4 v3, s[12:15], s28 offen  lds
v_mfma_f32_16x16x32_bf16 v[128:131], v[164:167], a[40:43], v[128:131]
ds_read_b64_tr_b16 v[156:157], v37 offset:17408
v_mfma_f32_16x16x32_bf16 v[132:135], v[164:167], a[44:47], v[132:135]
s_waitcnt lgkmcnt(7)
ds_read_b64_tr_b16 v[158:159], v37 offset:21504
v_mfma_f32_16x16x32_bf16 v[72:75], v[136:139], a[48:51], v[72:75]
ds_read_b64_tr_b16 v[160:161], v38 offset:17408
v_mfma_f32_16x16x32_bf16 v[76:79], v[136:139], a[52:55], v[76:79]
ds_read_b64_tr_b16 v[162:163], v38 offset:21504
buffer_load_dwordx4 a[20:23], v7, s[8:11], s29 offen offset:0 sc1
v_mfma_f32_16x16x32_bf16 v[80:83], v[140:143], a[48:51], v[80:83]
ds_read_b64_tr_b16 v[164:165], v39 offset:17408
v_mfma_f32_16x16x32_bf16 v[84:87], v[140:143], a[52:55], v[84:87]
s_waitcnt lgkmcnt(7)
ds_read_b64_tr_b16 v[166:167], v39 offset:21504
v_mfma_f32_16x16x32_bf16 v[88:91], v[144:147], a[48:51], v[88:91]
s_add_u32 m0, s32, 123904
ds_read_b64_tr_b16 v[136:137], v32 offset:25600
v_mfma_f32_16x16x32_bf16 v[92:95], v[144:147], a[52:55], v[92:95]
ds_read_b64_tr_b16 v[138:139], v32 offset:29696
buffer_load_dwordx4 v4, s[12:15], s28 offen  lds
v_mfma_f32_16x16x32_bf16 v[96:99], v[148:151], a[48:51], v[96:99]
ds_read_b64_tr_b16 v[140:141], v33 offset:25600
v_mfma_f32_16x16x32_bf16 v[100:103], v[148:151], a[52:55], v[100:103]
s_waitcnt lgkmcnt(7)
ds_read_b64_tr_b16 v[142:143], v33 offset:29696
v_mfma_f32_16x16x32_bf16 v[104:107], v[152:155], a[48:51], v[104:107]
ds_read_b64_tr_b16 v[144:145], v34 offset:25600
v_mfma_f32_16x16x32_bf16 v[108:111], v[152:155], a[52:55], v[108:111]
ds_read_b64_tr_b16 v[146:147], v34 offset:29696
buffer_load_dwordx4 a[24:27], v6, s[8:11], s29 offen offset:1024 sc1
v_mfma_f32_16x16x32_bf16 v[112:115], v[156:159], a[48:51], v[112:115]
ds_read_b64_tr_b16 v[148:149], v35 offset:25600
v_mfma_f32_16x16x32_bf16 v[116:119], v[156:159], a[52:55], v[116:119]
s_waitcnt lgkmcnt(7)
ds_read_b64_tr_b16 v[150:151], v35 offset:29696
v_mfma_f32_16x16x32_bf16 v[120:123], v[160:163], a[48:51], v[120:123]
s_add_u32 m0, s32, 124928
ds_read_b64_tr_b16 v[152:153], v36 offset:25600
v_mfma_f32_16x16x32_bf16 v[124:127], v[160:163], a[52:55], v[124:127]
ds_read_b64_tr_b16 v[154:155], v36 offset:29696
buffer_load_dwordx4 v5, s[12:15], s28 offen  lds
v_mfma_f32_16x16x32_bf16 v[128:131], v[164:167], a[48:51], v[128:131]
ds_read_b64_tr_b16 v[156:157], v37 offset:25600
v_mfma_f32_16x16x32_bf16 v[132:135], v[164:167], a[52:55], v[132:135]
s_waitcnt lgkmcnt(7)
ds_read_b64_tr_b16 v[158:159], v37 offset:29696
v_mfma_f32_16x16x32_bf16 v[72:75], v[136:139], a[56:59], v[72:75]
ds_read_b64_tr_b16 v[160:161], v38 offset:25600
v_mfma_f32_16x16x32_bf16 v[76:79], v[136:139], a[60:63], v[76:79]
ds_read_b64_tr_b16 v[162:163], v38 offset:29696
buffer_load_dwordx4 a[28:31], v7, s[8:11], s29 offen offset:1024 sc1
v_mfma_f32_16x16x32_bf16 v[80:83], v[140:143], a[56:59], v[80:83]
s_add_u32 s28, s28, 1048576
ds_read_b64_tr_b16 v[164:165], v39 offset:25600
v_mfma_f32_16x16x32_bf16 v[84:87], v[140:143], a[60:63], v[84:87]
s_waitcnt lgkmcnt(7)
s_add_u32 s29, s29, 2048
ds_read_b64_tr_b16 v[166:167], v39 offset:29696
s_waitcnt vmcnt(47)
s_barrier
v_mfma_f32_16x16x32_bf16 v[88:91], v[144:147], a[56:59], v[88:91]
s_add_u32 m0, s32, 0
ds_read_b64_tr_b16 v[136:137], v32 offset:34816
v_mfma_f32_16x16x32_bf16 v[92:95], v[144:147], a[60:63], v[92:95]
ds_read_b64_tr_b16 v[138:139], v32 offset:38912
buffer_load_dwordx4 v2, s[12:15], s28 offen  lds
v_mfma_f32_16x16x32_bf16 v[96:99], v[148:151], a[56:59], v[96:99]
ds_read_b64_tr_b16 v[140:141], v33 offset:34816
v_mfma_f32_16x16x32_bf16 v[100:103], v[148:151], a[60:63], v[100:103]
s_waitcnt lgkmcnt(7)
ds_read_b64_tr_b16 v[142:143], v33 offset:38912
v_mfma_f32_16x16x32_bf16 v[104:107], v[152:155], a[56:59], v[104:107]
ds_read_b64_tr_b16 v[144:145], v34 offset:34816
v_mfma_f32_16x16x32_bf16 v[108:111], v[152:155], a[60:63], v[108:111]
ds_read_b64_tr_b16 v[146:147], v34 offset:38912
buffer_load_dwordx4 a[32:35], v6, s[8:11], s29 offen offset:0 sc1
v_mfma_f32_16x16x32_bf16 v[112:115], v[156:159], a[56:59], v[112:115]
ds_read_b64_tr_b16 v[148:149], v35 offset:34816
v_mfma_f32_16x16x32_bf16 v[116:119], v[156:159], a[60:63], v[116:119]
s_waitcnt lgkmcnt(7)
ds_read_b64_tr_b16 v[150:151], v35 offset:38912
v_mfma_f32_16x16x32_bf16 v[120:123], v[160:163], a[56:59], v[120:123]
s_add_u32 m0, s32, 1024
ds_read_b64_tr_b16 v[152:153], v36 offset:34816
v_mfma_f32_16x16x32_bf16 v[124:127], v[160:163], a[60:63], v[124:127]
ds_read_b64_tr_b16 v[154:155], v36 offset:38912
buffer_load_dwordx4 v3, s[12:15], s28 offen  lds
v_mfma_f32_16x16x32_bf16 v[128:131], v[164:167], a[56:59], v[128:131]
ds_read_b64_tr_b16 v[156:157], v37 offset:34816
v_mfma_f32_16x16x32_bf16 v[132:135], v[164:167], a[60:63], v[132:135]
s_waitcnt lgkmcnt(7)
ds_read_b64_tr_b16 v[158:159], v37 offset:38912
v_mfma_f32_16x16x32_bf16 v[72:75], v[136:139], a[64:67], v[72:75]
ds_read_b64_tr_b16 v[160:161], v38 offset:34816
v_mfma_f32_16x16x32_bf16 v[76:79], v[136:139], a[68:71], v[76:79]
ds_read_b64_tr_b16 v[162:163], v38 offset:38912
buffer_load_dwordx4 a[36:39], v7, s[8:11], s29 offen offset:0 sc1
v_mfma_f32_16x16x32_bf16 v[80:83], v[140:143], a[64:67], v[80:83]
ds_read_b64_tr_b16 v[164:165], v39 offset:34816
v_mfma_f32_16x16x32_bf16 v[84:87], v[140:143], a[68:71], v[84:87]
s_waitcnt lgkmcnt(7)
ds_read_b64_tr_b16 v[166:167], v39 offset:38912
v_mfma_f32_16x16x32_bf16 v[88:91], v[144:147], a[64:67], v[88:91]
s_add_u32 m0, s32, 2048
ds_read_b64_tr_b16 v[136:137], v32 offset:43008
v_mfma_f32_16x16x32_bf16 v[92:95], v[144:147], a[68:71], v[92:95]
ds_read_b64_tr_b16 v[138:139], v32 offset:47104
buffer_load_dwordx4 v4, s[12:15], s28 offen  lds
v_mfma_f32_16x16x32_bf16 v[96:99], v[148:151], a[64:67], v[96:99]
ds_read_b64_tr_b16 v[140:141], v33 offset:43008
v_mfma_f32_16x16x32_bf16 v[100:103], v[148:151], a[68:71], v[100:103]
s_waitcnt lgkmcnt(7)
ds_read_b64_tr_b16 v[142:143], v33 offset:47104
v_mfma_f32_16x16x32_bf16 v[104:107], v[152:155], a[64:67], v[104:107]
ds_read_b64_tr_b16 v[144:145], v34 offset:43008
v_mfma_f32_16x16x32_bf16 v[108:111], v[152:155], a[68:71], v[108:111]
ds_read_b64_tr_b16 v[146:147], v34 offset:47104
buffer_load_dwordx4 a[40:43], v6, s[8:11], s29 offen offset:1024 sc1
v_mfma_f32_16x16x32_bf16 v[112:115], v[156:159], a[64:67], v[112:115]
ds_read_b64_tr_b16 v[148:149], v35 offset:43008
v_mfma_f32_16x16x32_bf16 v[116:119], v[156:159], a[68:71], v[116:119]
s_waitcnt lgkmcnt(7)
ds_read_b64_tr_b16 v[150:151], v35 offset:47104
v_mfma_f32_16x16x32_bf16 v[120:123], v[160:163], a[64:67], v[120:123]
s_add_u32 m0, s32, 3072
ds_read_b64_tr_b16 v[152:153], v36 offset:43008
v_mfma_f32_16x16x32_bf16 v[124:127], v[160:163], a[68:71], v[124:127]
ds_read_b64_tr_b16 v[154:155], v36 offset:47104
buffer_load_dwordx4 v5, s[12:15], s28 offen  lds
v_mfma_f32_16x16x32_bf16 v[128:131], v[164:167], a[64:67], v[128:131]
ds_read_b64_tr_b16 v[156:157], v37 offset:43008
v_mfma_f32_16x16x32_bf16 v[132:135], v[164:167], a[68:71], v[132:135]
s_waitcnt lgkmcnt(7)
ds_read_b64_tr_b16 v[158:159], v37 offset:47104
v_mfma_f32_16x16x32_bf16 v[72:75], v[136:139], a[72:75], v[72:75]
ds_read_b64_tr_b16 v[160:161], v38 offset:43008
v_mfma_f32_16x16x32_bf16 v[76:79], v[136:139], a[76:79], v[76:79]
ds_read_b64_tr_b16 v[162:163], v38 offset:47104
buffer_load_dwordx4 a[44:47], v7, s[8:11], s29 offen offset:1024 sc1
v_mfma_f32_16x16x32_bf16 v[80:83], v[140:143], a[72:75], v[80:83]
s_add_u32 s28, s28, 1048576
ds_read_b64_tr_b16 v[164:165], v39 offset:43008
v_mfma_f32_16x16x32_bf16 v[84:87], v[140:143], a[76:79], v[84:87]
s_waitcnt lgkmcnt(7)
s_add_u32 s29, s29, 2048
ds_read_b64_tr_b16 v[166:167], v39 offset:47104
s_waitcnt vmcnt(51)
s_barrier
v_mfma_f32_16x16x32_bf16 v[88:91], v[144:147], a[72:75], v[88:91]
s_add_u32 m0, s32, 17408
ds_read_b64_tr_b16 v[136:137], v32 offset:52224
v_mfma_f32_16x16x32_bf16 v[92:95], v[144:147], a[76:79], v[92:95]
ds_read_b64_tr_b16 v[138:139], v32 offset:56320
buffer_load_dwordx4 v2, s[12:15], s28 offen  lds
v_mfma_f32_16x16x32_bf16 v[96:99], v[148:151], a[72:75], v[96:99]
ds_read_b64_tr_b16 v[140:141], v33 offset:52224
v_mfma_f32_16x16x32_bf16 v[100:103], v[148:151], a[76:79], v[100:103]
s_waitcnt lgkmcnt(7)
ds_read_b64_tr_b16 v[142:143], v33 offset:56320
v_mfma_f32_16x16x32_bf16 v[104:107], v[152:155], a[72:75], v[104:107]
ds_read_b64_tr_b16 v[144:145], v34 offset:52224
v_mfma_f32_16x16x32_bf16 v[108:111], v[152:155], a[76:79], v[108:111]
ds_read_b64_tr_b16 v[146:147], v34 offset:56320
buffer_load_dwordx4 a[48:51], v6, s[8:11], s29 offen offset:0 sc1
v_mfma_f32_16x16x32_bf16 v[112:115], v[156:159], a[72:75], v[112:115]
ds_read_b64_tr_b16 v[148:149], v35 offset:52224
v_mfma_f32_16x16x32_bf16 v[116:119], v[156:159], a[76:79], v[116:119]
s_waitcnt lgkmcnt(7)
ds_read_b64_tr_b16 v[150:151], v35 offset:56320
v_mfma_f32_16x16x32_bf16 v[120:123], v[160:163], a[72:75], v[120:123]
s_add_u32 m0, s32, 18432
ds_read_b64_tr_b16 v[152:153], v36 offset:52224
v_mfma_f32_16x16x32_bf16 v[124:127], v[160:163], a[76:79], v[124:127]
ds_read_b64_tr_b16 v[154:155], v36 offset:56320
buffer_load_dwordx4 v3, s[12:15], s28 offen  lds
v_mfma_f32_16x16x32_bf16 v[128:131], v[164:167], a[72:75], v[128:131]
ds_read_b64_tr_b16 v[156:157], v37 offset:52224
v_mfma_f32_16x16x32_bf16 v[132:135], v[164:167], a[76:79], v[132:135]
s_waitcnt lgkmcnt(7)
ds_read_b64_tr_b16 v[158:159], v37 offset:56320
v_mfma_f32_16x16x32_bf16 v[72:75], v[136:139], a[80:83], v[72:75]
ds_read_b64_tr_b16 v[160:161], v38 offset:52224
v_mfma_f32_16x16x32_bf16 v[76:79], v[136:139], a[84:87], v[76:79]
ds_read_b64_tr_b16 v[162:163], v38 offset:56320
buffer_load_dwordx4 a[52:55], v7, s[8:11], s29 offen offset:0 sc1
v_mfma_f32_16x16x32_bf16 v[80:83], v[140:143], a[80:83], v[80:83]
ds_read_b64_tr_b16 v[164:165], v39 offset:52224
v_mfma_f32_16x16x32_bf16 v[84:87], v[140:143], a[84:87], v[84:87]
s_waitcnt lgkmcnt(7)
ds_read_b64_tr_b16 v[166:167], v39 offset:56320
v_mfma_f32_16x16x32_bf16 v[88:91], v[144:147], a[80:83], v[88:91]
s_add_u32 m0, s32, 19456
ds_read_b64_tr_b16 v[136:137], v32 offset:60416
v_mfma_f32_16x16x32_bf16 v[92:95], v[144:147], a[84:87], v[92:95]
ds_read_b64_tr_b16 v[138:139], v32 offset:64512
buffer_load_dwordx4 v4, s[12:15], s28 offen  lds
v_mfma_f32_16x16x32_bf16 v[96:99], v[148:151], a[80:83], v[96:99]
ds_read_b64_tr_b16 v[140:141], v33 offset:60416
v_mfma_f32_16x16x32_bf16 v[100:103], v[148:151], a[84:87], v[100:103]
s_waitcnt lgkmcnt(7)
ds_read_b64_tr_b16 v[142:143], v33 offset:64512
v_mfma_f32_16x16x32_bf16 v[104:107], v[152:155], a[80:83], v[104:107]
ds_read_b64_tr_b16 v[144:145], v34 offset:60416
v_mfma_f32_16x16x32_bf16 v[108:111], v[152:155], a[84:87], v[108:111]
ds_read_b64_tr_b16 v[146:147], v34 offset:64512
buffer_load_dwordx4 a[56:59], v6, s[8:11], s29 offen offset:1024 sc1
v_mfma_f32_16x16x32_bf16 v[112:115], v[156:159], a[80:83], v[112:115]
ds_read_b64_tr_b16 v[148:149], v35 offset:60416
v_mfma_f32_16x16x32_bf16 v[116:119], v[156:159], a[84:87], v[116:119]
s_waitcnt lgkmcnt(7)
ds_read_b64_tr_b16 v[150:151], v35 offset:64512
v_mfma_f32_16x16x32_bf16 v[120:123], v[160:163], a[80:83], v[120:123]
s_add_u32 m0, s32, 20480
ds_read_b64_tr_b16 v[152:153], v36 offset:60416
v_mfma_f32_16x16x32_bf16 v[124:127], v[160:163], a[84:87], v[124:127]
ds_read_b64_tr_b16 v[154:155], v36 offset:64512
buffer_load_dwordx4 v5, s[12:15], s28 offen  lds
v_mfma_f32_16x16x32_bf16 v[128:131], v[164:167], a[80:83], v[128:131]
ds_read_b64_tr_b16 v[156:157], v37 offset:60416
v_mfma_f32_16x16x32_bf16 v[132:135], v[164:167], a[84:87], v[132:135]
s_waitcnt lgkmcnt(7)
ds_read_b64_tr_b16 v[158:159], v37 offset:64512
v_mfma_f32_16x16x32_bf16 v[72:75], v[136:139], a[88:91], v[72:75]
ds_read_b64_tr_b16 v[160:161], v38 offset:60416
v_mfma_f32_16x16x32_bf16 v[76:79], v[136:139], a[92:95], v[76:79]
ds_read_b64_tr_b16 v[162:163], v38 offset:64512
buffer_load_dwordx4 a[60:63], v7, s[8:11], s29 offen offset:1024 sc1
v_mfma_f32_16x16x32_bf16 v[80:83], v[140:143], a[88:91], v[80:83]
s_add_u32 s28, s28, 1048576
ds_read_b64_tr_b16 v[164:165], v39 offset:60416
v_mfma_f32_16x16x32_bf16 v[84:87], v[140:143], a[92:95], v[84:87]
s_waitcnt lgkmcnt(7)
s_add_u32 s29, s29, 2048
ds_read_b64_tr_b16 v[166:167], v39 offset:64512
s_waitcnt vmcnt(53)
s_barrier
v_mfma_f32_16x16x32_bf16 v[88:91], v[144:147], a[88:91], v[88:91]
s_add_u32 m0, s32, 34816
ds_read_b64_tr_b16 v[136:137], v40 offset:0
v_mfma_f32_16x16x32_bf16 v[92:95], v[144:147], a[92:95], v[92:95]
ds_read_b64_tr_b16 v[138:139], v40 offset:4096
buffer_load_dwordx4 v2, s[12:15], s28 offen  lds
v_mfma_f32_16x16x32_bf16 v[96:99], v[148:151], a[88:91], v[96:99]
ds_read_b64_tr_b16 v[140:141], v41 offset:0
v_mfma_f32_16x16x32_bf16 v[100:103], v[148:151], a[92:95], v[100:103]
s_waitcnt lgkmcnt(7)
ds_read_b64_tr_b16 v[142:143], v41 offset:4096
v_mfma_f32_16x16x32_bf16 v[104:107], v[152:155], a[88:91], v[104:107]
ds_read_b64_tr_b16 v[144:145], v42 offset:0
v_mfma_f32_16x16x32_bf16 v[108:111], v[152:155], a[92:95], v[108:111]
ds_read_b64_tr_b16 v[146:147], v42 offset:4096
buffer_load_dwordx4 a[64:67], v6, s[8:11], s29 offen offset:0 sc1
v_mfma_f32_16x16x32_bf16 v[112:115], v[156:159], a[88:91], v[112:115]
ds_read_b64_tr_b16 v[148:149], v43 offset:0
v_mfma_f32_16x16x32_bf16 v[116:119], v[156:159], a[92:95], v[116:119]
s_waitcnt lgkmcnt(7)
ds_read_b64_tr_b16 v[150:151], v43 offset:4096
v_mfma_f32_16x16x32_bf16 v[120:123], v[160:163], a[88:91], v[120:123]
s_add_u32 m0, s32, 35840
ds_read_b64_tr_b16 v[152:153], v44 offset:0
v_mfma_f32_16x16x32_bf16 v[124:127], v[160:163], a[92:95], v[124:127]
ds_read_b64_tr_b16 v[154:155], v44 offset:4096
buffer_load_dwordx4 v3, s[12:15], s28 offen  lds
v_mfma_f32_16x16x32_bf16 v[128:131], v[164:167], a[88:91], v[128:131]
ds_read_b64_tr_b16 v[156:157], v45 offset:0
v_mfma_f32_16x16x32_bf16 v[132:135], v[164:167], a[92:95], v[132:135]
s_waitcnt lgkmcnt(7)
ds_read_b64_tr_b16 v[158:159], v45 offset:4096
v_mfma_f32_16x16x32_bf16 v[72:75], v[136:139], a[96:99], v[72:75]
ds_read_b64_tr_b16 v[160:161], v46 offset:0
v_mfma_f32_16x16x32_bf16 v[76:79], v[136:139], a[100:103], v[76:79]
ds_read_b64_tr_b16 v[162:163], v46 offset:4096
buffer_load_dwordx4 a[68:71], v7, s[8:11], s29 offen offset:0 sc1
v_mfma_f32_16x16x32_bf16 v[80:83], v[140:143], a[96:99], v[80:83]
ds_read_b64_tr_b16 v[164:165], v47 offset:0
v_mfma_f32_16x16x32_bf16 v[84:87], v[140:143], a[100:103], v[84:87]
s_waitcnt lgkmcnt(7)
ds_read_b64_tr_b16 v[166:167], v47 offset:4096
v_mfma_f32_16x16x32_bf16 v[88:91], v[144:147], a[96:99], v[88:91]
s_add_u32 m0, s32, 36864
ds_read_b64_tr_b16 v[136:137], v40 offset:8192
v_mfma_f32_16x16x32_bf16 v[92:95], v[144:147], a[100:103], v[92:95]
ds_read_b64_tr_b16 v[138:139], v40 offset:12288
buffer_load_dwordx4 v4, s[12:15], s28 offen  lds
v_mfma_f32_16x16x32_bf16 v[96:99], v[148:151], a[96:99], v[96:99]
ds_read_b64_tr_b16 v[140:141], v41 offset:8192
v_mfma_f32_16x16x32_bf16 v[100:103], v[148:151], a[100:103], v[100:103]
s_waitcnt lgkmcnt(7)
ds_read_b64_tr_b16 v[142:143], v41 offset:12288
v_mfma_f32_16x16x32_bf16 v[104:107], v[152:155], a[96:99], v[104:107]
ds_read_b64_tr_b16 v[144:145], v42 offset:8192
v_mfma_f32_16x16x32_bf16 v[108:111], v[152:155], a[100:103], v[108:111]
ds_read_b64_tr_b16 v[146:147], v42 offset:12288
buffer_load_dwordx4 a[72:75], v6, s[8:11], s29 offen offset:1024 sc1
v_mfma_f32_16x16x32_bf16 v[112:115], v[156:159], a[96:99], v[112:115]
ds_read_b64_tr_b16 v[148:149], v43 offset:8192
v_mfma_f32_16x16x32_bf16 v[116:119], v[156:159], a[100:103], v[116:119]
s_waitcnt lgkmcnt(7)
ds_read_b64_tr_b16 v[150:151], v43 offset:12288
v_mfma_f32_16x16x32_bf16 v[120:123], v[160:163], a[96:99], v[120:123]
s_add_u32 m0, s32, 37888
ds_read_b64_tr_b16 v[152:153], v44 offset:8192
v_mfma_f32_16x16x32_bf16 v[124:127], v[160:163], a[100:103], v[124:127]
ds_read_b64_tr_b16 v[154:155], v44 offset:12288
buffer_load_dwordx4 v5, s[12:15], s28 offen  lds
v_mfma_f32_16x16x32_bf16 v[128:131], v[164:167], a[96:99], v[128:131]
ds_read_b64_tr_b16 v[156:157], v45 offset:8192
v_mfma_f32_16x16x32_bf16 v[132:135], v[164:167], a[100:103], v[132:135]
s_waitcnt lgkmcnt(7)
ds_read_b64_tr_b16 v[158:159], v45 offset:12288
v_mfma_f32_16x16x32_bf16 v[72:75], v[136:139], a[104:107], v[72:75]
ds_read_b64_tr_b16 v[160:161], v46 offset:8192
v_mfma_f32_16x16x32_bf16 v[76:79], v[136:139], a[108:111], v[76:79]
ds_read_b64_tr_b16 v[162:163], v46 offset:12288
buffer_load_dwordx4 a[76:79], v7, s[8:11], s29 offen offset:1024 sc1
v_mfma_f32_16x16x32_bf16 v[80:83], v[140:143], a[104:107], v[80:83]
s_add_u32 s28, s28, 1048576
ds_read_b64_tr_b16 v[164:165], v47 offset:8192
v_mfma_f32_16x16x32_bf16 v[84:87], v[140:143], a[108:111], v[84:87]
s_waitcnt lgkmcnt(7)
s_add_u32 s29, s29, 2048
ds_read_b64_tr_b16 v[166:167], v47 offset:12288
s_waitcnt vmcnt(41)
s_barrier
v_mfma_f32_16x16x32_bf16 v[88:91], v[144:147], a[104:107], v[88:91]
s_add_u32 m0, s32, 52224
ds_read_b64_tr_b16 v[136:137], v40 offset:17408
s_cmp_lg_u32 s3, 0
s_cbranch_scc1 L_fnosig
s_mov_b64 exec, 1
buffer_atomic_or v29, v30, s[60:63], 0 offen
buffer_atomic_or v31, v30, s[60:63], 0 offen offset:4
s_mov_b64 exec, -1
L_fnosig:
v_mfma_f32_16x16x32_bf16 v[92:95], v[144:147], a[108:111], v[92:95]
ds_read_b64_tr_b16 v[138:139], v40 offset:21504
buffer_load_dwordx4 v2, s[12:15], s28 offen  lds
v_mfma_f32_16x16x32_bf16 v[96:99], v[148:151], a[104:107], v[96:99]
ds_read_b64_tr_b16 v[140:141], v41 offset:17408
v_mfma_f32_16x16x32_bf16 v[100:103], v[148:151], a[108:111], v[100:103]
s_waitcnt lgkmcnt(7)
ds_read_b64_tr_b16 v[142:143], v41 offset:21504
v_mfma_f32_16x16x32_bf16 v[104:107], v[152:155], a[104:107], v[104:107]
ds_read_b64_tr_b16 v[144:145], v42 offset:17408
v_mfma_f32_16x16x32_bf16 v[108:111], v[152:155], a[108:111], v[108:111]
ds_read_b64_tr_b16 v[146:147], v42 offset:21504
buffer_load_dwordx4 a[80:83], v6, s[8:11], s29 offen offset:0 sc1
v_mfma_f32_16x16x32_bf16 v[112:115], v[156:159], a[104:107], v[112:115]
ds_read_b64_tr_b16 v[148:149], v43 offset:17408
v_mfma_f32_16x16x32_bf16 v[116:119], v[156:159], a[108:111], v[116:119]
s_waitcnt lgkmcnt(7)
ds_read_b64_tr_b16 v[150:151], v43 offset:21504
v_mfma_f32_16x16x32_bf16 v[120:123], v[160:163], a[104:107], v[120:123]
s_add_u32 m0, s32, 53248
ds_read_b64_tr_b16 v[152:153], v44 offset:17408
v_mfma_f32_16x16x32_bf16 v[124:127], v[160:163], a[108:111], v[124:127]
ds_read_b64_tr_b16 v[154:155], v44 offset:21504
buffer_load_dwordx4 v3, s[12:15], s28 offen  lds
v_mfma_f32_16x16x32_bf16 v[128:131], v[164:167], a[104:107], v[128:131]
ds_read_b64_tr_b16 v[156:157], v45 offset:17408
v_mfma_f32_16x16x32_bf16 v[132:135], v[164:167], a[108:111], v[132:135]
s_waitcnt lgkmcnt(7)
ds_read_b64_tr_b16 v[158:159], v45 offset:21504
v_mfma_f32_16x16x32_bf16 v[72:75], v[136:139], a[112:115], v[72:75]
ds_read_b64_tr_b16 v[160:161], v46 offset:17408
v_mfma_f32_16x16x32_bf16 v[76:79], v[136:139], a[116:119], v[76:79]
ds_read_b64_tr_b16 v[162:163], v46 offset:21504
buffer_load_dwordx4 a[84:87], v7, s[8:11], s29 offen offset:0 sc1
v_mfma_f32_16x16x32_bf16 v[80:83], v[140:143], a[112:115], v[80:83]
ds_read_b64_tr_b16 v[164:165], v47 offset:17408
v_mfma_f32_16x16x32_bf16 v[84:87], v[140:143], a[116:119], v[84:87]
s_waitcnt lgkmcnt(7)
ds_read_b64_tr_b16 v[166:167], v47 offset:21504
v_mfma_f32_16x16x32_bf16 v[88:91], v[144:147], a[112:115], v[88:91]
s_add_u32 m0, s32, 54272
ds_read_b64_tr_b16 v[136:137], v40 offset:25600
v_mfma_f32_16x16x32_bf16 v[92:95], v[144:147], a[116:119], v[92:95]
ds_read_b64_tr_b16 v[138:139], v40 offset:29696
buffer_load_dwordx4 v4, s[12:15], s28 offen  lds
v_mfma_f32_16x16x32_bf16 v[96:99], v[148:151], a[112:115], v[96:99]
ds_read_b64_tr_b16 v[140:141], v41 offset:25600
v_mfma_f32_16x16x32_bf16 v[100:103], v[148:151], a[116:119], v[100:103]
s_waitcnt lgkmcnt(7)
ds_read_b64_tr_b16 v[142:143], v41 offset:29696
v_mfma_f32_16x16x32_bf16 v[104:107], v[152:155], a[112:115], v[104:107]
ds_read_b64_tr_b16 v[144:145], v42 offset:25600
v_mfma_f32_16x16x32_bf16 v[108:111], v[152:155], a[116:119], v[108:111]
ds_read_b64_tr_b16 v[146:147], v42 offset:29696
buffer_load_dwordx4 a[88:91], v6, s[8:11], s29 offen offset:1024 sc1
v_mfma_f32_16x16x32_bf16 v[112:115], v[156:159], a[112:115], v[112:115]
ds_read_b64_tr_b16 v[148:149], v43 offset:25600
v_mfma_f32_16x16x32_bf16 v[116:119], v[156:159], a[116:119], v[116:119]
s_waitcnt lgkmcnt(7)
ds_read_b64_tr_b16 v[150:151], v43 offset:29696
v_mfma_f32_16x16x32_bf16 v[120:123], v[160:163], a[112:115], v[120:123]
s_add_u32 m0, s32, 55296
ds_read_b64_tr_b16 v[152:153], v44 offset:25600
v_mfma_f32_16x16x32_bf16 v[124:127], v[160:163], a[116:119], v[124:127]
ds_read_b64_tr_b16 v[154:155], v44 offset:29696
buffer_load_dwordx4 v5, s[12:15], s28 offen  lds
v_mfma_f32_16x16x32_bf16 v[128:131], v[164:167], a[112:115], v[128:131]
ds_read_b64_tr_b16 v[156:157], v45 offset:25600
v_mfma_f32_16x16x32_bf16 v[132:135], v[164:167], a[116:119], v[132:135]
s_waitcnt lgkmcnt(7)
ds_read_b64_tr_b16 v[158:159], v45 offset:29696
v_mfma_f32_16x16x32_bf16 v[72:75], v[136:139], a[120:123], v[72:75]
ds_read_b64_tr_b16 v[160:161], v46 offset:25600
v_mfma_f32_16x16x32_bf16 v[76:79], v[136:139], a[124:127], v[76:79]
ds_read_b64_tr_b16 v[162:163], v46 offset:29696
buffer_load_dwordx4 a[92:95], v7, s[8:11], s29 offen offset:1024 sc1
v_mfma_f32_16x16x32_bf16 v[80:83], v[140:143], a[120:123], v[80:83]
s_add_u32 s28, s28, 1048576
ds_read_b64_tr_b16 v[164:165], v47 offset:25600
v_mfma_f32_16x16x32_bf16 v[84:87], v[140:143], a[124:127], v[84:87]
s_waitcnt lgkmcnt(7)
s_add_u32 s29, s29, 2048
ds_read_b64_tr_b16 v[166:167], v47 offset:29696
s_waitcnt vmcnt(41)
s_barrier
v_mfma_f32_16x16x32_bf16 v[88:91], v[144:147], a[120:123], v[88:91]
s_add_u32 m0, s32, 69632
ds_read_b64_tr_b16 v[136:137], v40 offset:34816
v_mfma_f32_16x16x32_bf16 v[92:95], v[144:147], a[124:127], v[92:95]
ds_read_b64_tr_b16 v[138:139], v40 offset:38912
buffer_load_dwordx4 v2, s[12:15], s28 offen  lds
v_mfma_f32_16x16x32_bf16 v[96:99], v[148:151], a[120:123], v[96:99]
ds_read_b64_tr_b16 v[140:141], v41 offset:34816
v_mfma_f32_16x16x32_bf16 v[100:103], v[148:151], a[124:127], v[100:103]
s_waitcnt lgkmcnt(7)
ds_read_b64_tr_b16 v[142:143], v41 offset:38912
v_mfma_f32_16x16x32_bf16 v[104:107], v[152:155], a[120:123], v[104:107]
ds_read_b64_tr_b16 v[144:145], v42 offset:34816
v_mfma_f32_16x16x32_bf16 v[108:111], v[152:155], a[124:127], v[108:111]
ds_read_b64_tr_b16 v[146:147], v42 offset:38912
buffer_load_dwordx4 a[96:99], v6, s[8:11], s29 offen offset:0 sc1
v_mfma_f32_16x16x32_bf16 v[112:115], v[156:159], a[120:123], v[112:115]
ds_read_b64_tr_b16 v[148:149], v43 offset:34816
v_mfma_f32_16x16x32_bf16 v[116:119], v[156:159], a[124:127], v[116:119]
s_waitcnt lgkmcnt(7)
ds_read_b64_tr_b16 v[150:151], v43 offset:38912
v_mfma_f32_16x16x32_bf16 v[120:123], v[160:163], a[120:123], v[120:123]
s_add_u32 m0, s32, 70656
ds_read_b64_tr_b16 v[152:153], v44 offset:34816
v_mfma_f32_16x16x32_bf16 v[124:127], v[160:163], a[124:127], v[124:127]
ds_read_b64_tr_b16 v[154:155], v44 offset:38912
buffer_load_dwordx4 v3, s[12:15], s28 offen  lds
v_mfma_f32_16x16x32_bf16 v[128:131], v[164:167], a[120:123], v[128:131]
ds_read_b64_tr_b16 v[156:157], v45 offset:34816
v_mfma_f32_16x16x32_bf16 v[132:135], v[164:167], a[124:127], v[132:135]
s_waitcnt lgkmcnt(7)
ds_read_b64_tr_b16 v[158:159], v45 offset:38912
s_sub_u32 s30, s30, 1
s_cmp_lg_u32 s30, 0
s_mov_b32 s30, 6
L_k2:
v_mfma_f32_16x16x32_bf16 v[72:75], v[136:139], a[0:3], v[72:75]
ds_read_b64_tr_b16 v[160:161], v46 offset:34816
v_mfma_f32_16x16x32_bf16 v[76:79], v[136:139], a[4:7], v[76:79]
ds_read_b64_tr_b16 v[162:163], v46 offset:38912
buffer_load_dwordx4 a[100:103], v7, s[8:11], s29 offen offset:0 sc1
v_mfma_f32_16x16x32_bf16 v[80:83], v[140:143], a[0:3], v[80:83]
ds_read_b64_tr_b16 v[164:165], v47 offset:34816
v_mfma_f32_16x16x32_bf16 v[84:87], v[140:143], a[4:7], v[84:87]
s_waitcnt lgkmcnt(7)
ds_read_b64_tr_b16 v[166:167], v47 offset:38912
v_mfma_f32_16x16x32_bf16 v[88:91], v[144:147], a[0:3], v[88:91]
s_add_u32 m0, s32, 71680
ds_read_b64_tr_b16 v[136:137], v40 offset:43008
v_mfma_f32_16x16x32_bf16 v[92:95], v[144:147], a[4:7], v[92:95]
ds_read_b64_tr_b16 v[138:139], v40 offset:47104
buffer_load_dwordx4 v4, s[12:15], s28 offen  lds
v_mfma_f32_16x16x32_bf16 v[96:99], v[148:151], a[0:3], v[96:99]
ds_read_b64_tr_b16 v[140:141], v41 offset:43008
v_mfma_f32_16x16x32_bf16 v[100:103], v[148:151], a[4:7], v[100:103]
s_waitcnt lgkmcnt(7)
ds_read_b64_tr_b16 v[142:143], v41 offset:47104
v_mfma_f32_16x16x32_bf16 v[104:107], v[152:155], a[0:3], v[104:107]
ds_read_b64_tr_b16 v[144:145], v42 offset:43008
v_mfma_f32_16x16x32_bf16 v[108:111], v[152:155], a[4:7], v[108:111]
ds_read_b64_tr_b16 v[146:147], v42 offset:47104
buffer_load_dwordx4 a[104:107], v6, s[8:11], s29 offen offset:1024 sc1
v_mfma_f32_16x16x32_bf16 v[112:115], v[156:159], a[0:3], v[112:115]
ds_read_b64_tr_b16 v[148:149], v43 offset:43008
v_mfma_f32_16x16x32_bf16 v[116:119], v[156:159], a[4:7], v[116:119]
s_waitcnt lgkmcnt(7)
ds_read_b64_tr_b16 v[150:151], v43 offset:47104
v_mfma_f32_16x16x32_bf16 v[120:123], v[160:163], a[0:3], v[120:123]
s_add_u32 m0, s32, 72704
ds_read_b64_tr_b16 v[152:153], v44 offset:43008
v_mfma_f32_16x16x32_bf16 v[124:127], v[160:163], a[4:7], v[124:127]
ds_read_b64_tr_b16 v[154:155], v44 offset:47104
buffer_load_dwordx4 v5, s[12:15], s28 offen  lds
v_mfma_f32_16x16x32_bf16 v[128:131], v[164:167], a[0:3], v[128:131]
ds_read_b64_tr_b16 v[156:157], v45 offset:43008
v_mfma_f32_16x16x32_bf16 v[132:135], v[164:167], a[4:7], v[132:135]
s_waitcnt lgkmcnt(7)
ds_read_b64_tr_b16 v[158:159], v45 offset:47104
v_mfma_f32_16x16x32_bf16 v[72:75], v[136:139], a[8:11], v[72:75]
ds_read_b64_tr_b16 v[160:161], v46 offset:43008
v_mfma_f32_16x16x32_bf16 v[76:79], v[136:139], a[12:15], v[76:79]
ds_read_b64_tr_b16 v[162:163], v46 offset:47104
buffer_load_dwordx4 a[108:111], v7, s[8:11], s29 offen offset:1024 sc1
v_mfma_f32_16x16x32_bf16 v[80:83], v[140:143], a[8:11], v[80:83]
s_add_u32 s28, s28, 1048576
ds_read_b64_tr_b16 v[164:165], v47 offset:43008
v_mfma_f32_16x16x32_bf16 v[84:87], v[140:143], a[12:15], v[84:87]
s_waitcnt lgkmcnt(7)
s_add_u32 s29, s29, 2048
ds_read_b64_tr_b16 v[166:167], v47 offset:47104
s_waitcnt vmcnt(40)
s_barrier
v_mfma_f32_16x16x32_bf16 v[88:91], v[144:147], a[8:11], v[88:91]
s_add_u32 m0, s32, 87040
ds_read_b64_tr_b16 v[136:137], v40 offset:52224
v_mfma_f32_16x16x32_bf16 v[92:95], v[144:147], a[12:15], v[92:95]
ds_read_b64_tr_b16 v[138:139], v40 offset:56320
buffer_load_dwordx4 v2, s[12:15], s28 offen  lds
v_mfma_f32_16x16x32_bf16 v[96:99], v[148:151], a[8:11], v[96:99]
ds_read_b64_tr_b16 v[140:141], v41 offset:52224
v_mfma_f32_16x16x32_bf16 v[100:103], v[148:151], a[12:15], v[100:103]
s_waitcnt lgkmcnt(7)
ds_read_b64_tr_b16 v[142:143], v41 offset:56320
v_mfma_f32_16x16x32_bf16 v[104:107], v[152:155], a[8:11], v[104:107]
ds_read_b64_tr_b16 v[144:145], v42 offset:52224
v_mfma_f32_16x16x32_bf16 v[108:111], v[152:155], a[12:15], v[108:111]
ds_read_b64_tr_b16 v[146:147], v42 offset:56320
buffer_load_dwordx4 a[112:115], v6, s[8:11], s29 offen offset:0 sc1
v_mfma_f32_16x16x32_bf16 v[112:115], v[156:159], a[8:11], v[112:115]
ds_read_b64_tr_b16 v[148:149], v43 offset:52224
v_mfma_f32_16x16x32_bf16 v[116:119], v[156:159], a[12:15], v[116:119]
s_waitcnt lgkmcnt(7)
ds_read_b64_tr_b16 v[150:151], v43 offset:56320
v_mfma_f32_16x16x32_bf16 v[120:123], v[160:163], a[8:11], v[120:123]
s_add_u32 m0, s32, 88064
ds_read_b64_tr_b16 v[152:153], v44 offset:52224
v_mfma_f32_16x16x32_bf16 v[124:127], v[160:163], a[12:15], v[124:127]
ds_read_b64_tr_b16 v[154:155], v44 offset:56320
buffer_load_dwordx4 v3, s[12:15], s28 offen  lds
v_mfma_f32_16x16x32_bf16 v[128:131], v[164:167], a[8:11], v[128:131]
ds_read_b64_tr_b16 v[156:157], v45 offset:52224
v_mfma_f32_16x16x32_bf16 v[132:135], v[164:167], a[12:15], v[132:135]
s_waitcnt lgkmcnt(7)
ds_read_b64_tr_b16 v[158:159], v45 offset:56320
v_mfma_f32_16x16x32_bf16 v[72:75], v[136:139], a[16:19], v[72:75]
ds_read_b64_tr_b16 v[160:161], v46 offset:52224
v_mfma_f32_16x16x32_bf16 v[76:79], v[136:139], a[20:23], v[76:79]
ds_read_b64_tr_b16 v[162:163], v46 offset:56320
buffer_load_dwordx4 a[116:119], v7, s[8:11], s29 offen offset:0 sc1
v_mfma_f32_16x16x32_bf16 v[80:83], v[140:143], a[16:19], v[80:83]
ds_read_b64_tr_b16 v[164:165], v47 offset:52224
v_mfma_f32_16x16x32_bf16 v[84:87], v[140:143], a[20:23], v[84:87]
s_waitcnt lgkmcnt(7)
ds_read_b64_tr_b16 v[166:167], v47 offset:56320
v_mfma_f32_16x16x32_bf16 v[88:91], v[144:147], a[16:19], v[88:91]
s_add_u32 m0, s32, 89088
ds_read_b64_tr_b16 v[136:137], v40 offset:60416
v_mfma_f32_16x16x32_bf16 v[92:95], v[144:147], a[20:23], v[92:95]
ds_read_b64_tr_b16 v[138:139], v40 offset:64512
buffer_load_dwordx4 v4, s[12:15], s28 offen  lds
v_mfma_f32_16x16x32_bf16 v[96:99], v[148:151], a[16:19], v[96:99]
ds_read_b64_tr_b16 v[140:141], v41 offset:60416
v_mfma_f32_16x16x32_bf16 v[100:103], v[148:151], a[20:23], v[100:103]
s_waitcnt lgkmcnt(7)
ds_read_b64_tr_b16 v[142:143], v41 offset:64512
v_mfma_f32_16x16x32_bf16 v[104:107], v[152:155], a[16:19], v[104:107]
ds_read_b64_tr_b16 v[144:145], v42 offset:60416
v_mfma_f32_16x16x32_bf16 v[108:111], v[152:155], a[20:23], v[108:111]
ds_read_b64_tr_b16 v[146:147], v42 offset:64512
buffer_load_dwordx4 a[120:123], v6, s[8:11], s29 offen offset:1024 sc1
v_mfma_f32_16x16x32_bf16 v[112:115], v[156:159], a[16:19], v[112:115]
ds_read_b64_tr_b16 v[148:149], v43 offset:60416
v_mfma_f32_16x16x32_bf16 v[116:119], v[156:159], a[20:23], v[116:119]
s_waitcnt lgkmcnt(7)
ds_read_b64_tr_b16 v[150:151], v43 offset:64512
v_mfma_f32_16x16x32_bf16 v[120:123], v[160:163], a[16:19], v[120:123]
s_add_u32 m0, s32, 90112
ds_read_b64_tr_b16 v[152:153], v44 offset:60416
v_mfma_f32_16x16x32_bf16 v[124:127], v[160:163], a[20:23], v[124:127]
ds_read_b64_tr_b16 v[154:155], v44 offset:64512
buffer_load_dwordx4 v5, s[12:15], s28 offen  lds
v_and_b32 v16, s34, v14
v_mfma_f32_16x16x32_bf16 v[128:131], v[164:167], a[16:19], v[128:131]
ds_read_b64_tr_b16 v[156:157], v45 offset:60416
v_and_b32 v17, s35, v15
v_mfma_f32_16x16x32_bf16 v[132:135], v[164:167], a[20:23], v[132:135]
s_waitcnt lgkmcnt(7)
ds_read_b64_tr_b16 v[158:159], v45 offset:64512
v_cmp_ne_u64 vcc, s[34:35], v[16:17]
v_mfma_f32_16x16x32_bf16 v[72:75], v[136:139], a[24:27], v[72:75]
ds_read_b64_tr_b16 v[160:161], v46 offset:60416
v_mfma_f32_16x16x32_bf16 v[76:79], v[136:139], a[28:31], v[76:79]
ds_read_b64_tr_b16 v[162:163], v46 offset:64512
buffer_load_dwordx4 a[124:127], v7, s[8:11], s29 offen offset:1024 sc1
s_cbranch_vccnz L_k2slow_l
L_k2back_l:
v_mfma_f32_16x16x32_bf16 v[80:83], v[140:143], a[24:27], v[80:83]
s_add_u32 s28, s28, s36
ds_read_b64_tr_b16 v[164:165], v47 offset:60416
s_lshl_b64 s[34:35], s[34:35], 8
v_mfma_f32_16x16x32_bf16 v[84:87], v[140:143], a[28:31], v[84:87]
s_waitcnt lgkmcnt(7)
s_add_u32 s29, s29, 2048
ds_read_b64_tr_b16 v[166:167], v47 offset:64512
s_waitcnt vmcnt(40)
s_barrier
v_mfma_f32_16x16x32_bf16 v[88:91], v[144:147], a[24:27], v[88:91]
s_xor_b32 s36, s36, 0x120000
s_add_u32 m0, s32, 104448
ds_read_b64_tr_b16 v[136:137], v32 offset:0
v_mfma_f32_16x16x32_bf16 v[92:95], v[144:147], a[28:31], v[92:95]
ds_read_b64_tr_b16 v[138:139], v32 offset:4096
buffer_load_dwordx4 v2, s[12:15], s28 offen  lds
v_mfma_f32_16x16x32_bf16 v[96:99], v[148:151], a[24:27], v[96:99]
ds_read_b64_tr_b16 v[140:141], v33 offset:0
v_mfma_f32_16x16x32_bf16 v[100:103], v[148:151], a[28:31], v[100:103]
s_waitcnt lgkmcnt(7)
ds_read_b64_tr_b16 v[142:143], v33 offset:4096
v_mfma_f32_16x16x32_bf16 v[104:107], v[152:155], a[24:27], v[104:107]
ds_read_b64_tr_b16 v[144:145], v34 offset:0
v_mfma_f32_16x16x32_bf16 v[108:111], v[152:155], a[28:31], v[108:111]
ds_read_b64_tr_b16 v[146:147], v34 offset:4096
buffer_load_dwordx4 a[0:3], v6, s[8:11], s29 offen offset:0 sc1
v_mfma_f32_16x16x32_bf16 v[112:115], v[156:159], a[24:27], v[112:115]
ds_read_b64_tr_b16 v[148:149], v35 offset:0
v_mfma_f32_16x16x32_bf16 v[116:119], v[156:159], a[28:31], v[116:119]
s_waitcnt lgkmcnt(7)
ds_read_b64_tr_b16 v[150:151], v35 offset:4096
v_mfma_f32_16x16x32_bf16 v[120:123], v[160:163], a[24:27], v[120:123]
s_add_u32 m0, s32, 105472
ds_read_b64_tr_b16 v[152:153], v36 offset:0
v_mfma_f32_16x16x32_bf16 v[124:127], v[160:163], a[28:31], v[124:127]
ds_read_b64_tr_b16 v[154:155], v36 offset:4096
buffer_load_dwordx4 v3, s[12:15], s28 offen  lds
v_mfma_f32_16x16x32_bf16 v[128:131], v[164:167], a[24:27], v[128:131]
ds_read_b64_tr_b16 v[156:157], v37 offset:0
v_mfma_f32_16x16x32_bf16 v[132:135], v[164:167], a[28:31], v[132:135]
s_waitcnt lgkmcnt(7)
ds_read_b64_tr_b16 v[158:159], v37 offset:4096
v_mfma_f32_16x16x32_bf16 v[72:75], v[136:139], a[32:35], v[72:75]
ds_read_b64_tr_b16 v[160:161], v38 offset:0
v_mfma_f32_16x16x32_bf16 v[76:79], v[136:139], a[36:39], v[76:79]
ds_read_b64_tr_b16 v[162:163], v38 offset:4096
buffer_load_dwordx4 a[4:7], v7, s[8:11], s29 offen offset:0 sc1
v_mfma_f32_16x16x32_bf16 v[80:83], v[140:143], a[32:35], v[80:83]
ds_read_b64_tr_b16 v[164:165], v39 offset:0
v_mfma_f32_16x16x32_bf16 v[84:87], v[140:143], a[36:39], v[84:87]
s_waitcnt lgkmcnt(7)
ds_read_b64_tr_b16 v[166:167], v39 offset:4096
v_mfma_f32_16x16x32_bf16 v[88:91], v[144:147], a[32:35], v[88:91]
s_add_u32 m0, s32, 106496
ds_read_b64_tr_b16 v[136:137], v32 offset:8192
v_mfma_f32_16x16x32_bf16 v[92:95], v[144:147], a[36:39], v[92:95]
ds_read_b64_tr_b16 v[138:139], v32 offset:12288
buffer_load_dwordx4 v4, s[12:15], s28 offen  lds
v_mfma_f32_16x16x32_bf16 v[96:99], v[148:151], a[32:35], v[96:99]
ds_read_b64_tr_b16 v[140:141], v33 offset:8192
v_mfma_f32_16x16x32_bf16 v[100:103], v[148:151], a[36:39], v[100:103]
s_waitcnt lgkmcnt(7)
ds_read_b64_tr_b16 v[142:143], v33 offset:12288
v_mfma_f32_16x16x32_bf16 v[104:107], v[152:155], a[32:35], v[104:107]
ds_read_b64_tr_b16 v[144:145], v34 offset:8192
v_mfma_f32_16x16x32_bf16 v[108:111], v[152:155], a[36:39], v[108:111]
ds_read_b64_tr_b16 v[146:147], v34 offset:12288
buffer_load_dwordx4 a[8:11], v6, s[8:11], s29 offen offset:1024 sc1
v_mfma_f32_16x16x32_bf16 v[112:115], v[156:159], a[32:35], v[112:115]
ds_read_b64_tr_b16 v[148:149], v35 offset:8192
v_mfma_f32_16x16x32_bf16 v[116:119], v[156:159], a[36:39], v[116:119]
s_waitcnt lgkmcnt(7)
ds_read_b64_tr_b16 v[150:151], v35 offset:12288
v_mfma_f32_16x16x32_bf16 v[120:123], v[160:163], a[32:35], v[120:123]
s_add_u32 m0, s32, 107520
ds_read_b64_tr_b16 v[152:153], v36 offset:8192
v_mfma_f32_16x16x32_bf16 v[124:127], v[160:163], a[36:39], v[124:127]
ds_read_b64_tr_b16 v[154:155], v36 offset:12288
buffer_load_dwordx4 v5, s[12:15], s28 offen  lds
v_mfma_f32_16x16x32_bf16 v[128:131], v[164:167], a[32:35], v[128:131]
ds_read_b64_tr_b16 v[156:157], v37 offset:8192
v_mfma_f32_16x16x32_bf16 v[132:135], v[164:167], a[36:39], v[132:135]
s_waitcnt lgkmcnt(7)
ds_read_b64_tr_b16 v[158:159], v37 offset:12288
v_mfma_f32_16x16x32_bf16 v[72:75], v[136:139], a[40:43], v[72:75]
ds_read_b64_tr_b16 v[160:161], v38 offset:8192
v_mfma_f32_16x16x32_bf16 v[76:79], v[136:139], a[44:47], v[76:79]
ds_read_b64_tr_b16 v[162:163], v38 offset:12288
buffer_load_dwordx4 a[12:15], v7, s[8:11], s29 offen offset:1024 sc1
v_mfma_f32_16x16x32_bf16 v[80:83], v[140:143], a[40:43], v[80:83]
s_add_u32 s28, s28, 1048576
ds_read_b64_tr_b16 v[164:165], v39 offset:8192
v_mfma_f32_16x16x32_bf16 v[84:87], v[140:143], a[44:47], v[84:87]
s_waitcnt lgkmcnt(7)
s_add_u32 s29, s29, 2048
ds_read_b64_tr_b16 v[166:167], v39 offset:12288
s_waitcnt vmcnt(40)
s_barrier
v_mfma_f32_16x16x32_bf16 v[88:91], v[144:147], a[40:43], v[88:91]
s_add_u32 m0, s32, 121856
ds_read_b64_tr_b16 v[136:137], v32 offset:17408
v_mfma_f32_16x16x32_bf16 v[92:95], v[144:147], a[44:47], v[92:95]
ds_read_b64_tr_b16 v[138:139], v32 offset:21504
buffer_load_dwordx4 v2, s[12:15], s28 offen  lds
v_mfma_f32_16x16x32_bf16 v[96:99], v[148:151], a[40:43], v[96:99]
ds_read_b64_tr_b16 v[140:141], v33 offset:17408
buffer_load_dwordx2 v[14:15], v8, s[60:63], 0 offen sc1
v_mfma_f32_16x16x32_bf16 v[100:103], v[148:151], a[44:47], v[100:103]
s_waitcnt lgkmcnt(7)
ds_read_b64_tr_b16 v[142:143], v33 offset:21504
v_mfma_f32_16x16x32_bf16 v[104:107], v[152:155], a[40:43], v[104:107]
ds_read_b64_tr_b16 v[144:145], v34 offset:17408
v_mfma_f32_16x16x32_bf16 v[108:111], v[152:155], a[44:47], v[108:111]
ds_read_b64_tr_b16 v[146:147], v34 offset:21504
buffer_load_dwordx4 a[16:19], v6, s[8:11], s29 offen offset:0 sc1
v_mfma_f32_16x16x32_bf16 v[112:115], v[156:159], a[40:43], v[112:115]
ds_read_b64_tr_b16 v[148:149], v35 offset:17408
v_mfma_f32_16x16x32_bf16 v[116:119], v[156:159], a[44:47], v[116:119]
s_waitcnt lgkmcnt(7)
ds_read_b64_tr_b16 v[150:151], v35 offset:21504
v_mfma_f32_16x16x32_bf16 v[120:123], v[160:163], a[40:43], v[120:123]
s_add_u32 m0, s32, 122880
ds_read_b64_tr_b16 v[152:153], v36 offset:17408
v_mfma_f32_16x16x32_bf16 v[124:127], v[160:163], a[44:47], v[124:127]
ds_read_b64_tr_b16 v[154:155], v36 offset:21504
buffer_load_dwordx4 v3, s[12:15], s28 offen  lds
v_mfma_f32_16x16x32_bf16 v[128:131], v[164:167], a[40:43], v[128:131]
ds_read_b64_tr_b16 v[156:157], v37 offset:17408
v_mfma_f32_16x16x32_bf16 v[132:135], v[164:167], a[44:47], v[132:135]
s_waitcnt lgkmcnt(7)
ds_read_b64_tr_b16 v[158:159], v37 offset:21504
v_mfma_f32_16x16x32_bf16 v[72:75], v[136:139], a[48:51], v[72:75]
ds_read_b64_tr_b16 v[160:161], v38 offset:17408
v_mfma_f32_16x16x32_bf16 v[76:79], v[136:139], a[52:55], v[76:79]
ds_read_b64_tr_b16 v[162:163], v38 offset:21504
buffer_load_dwordx4 a[20:23], v7, s[8:11], s29 offen offset:0 sc1
v_mfma_f32_16x16x32_bf16 v[80:83], v[140:143], a[48:51], v[80:83]
ds_read_b64_tr_b16 v[164:165], v39 offset:17408
v_mfma_f32_16x16x32_bf16 v[84:87], v[140:143], a[52:55], v[84:87]
s_waitcnt lgkmcnt(7)
ds_read_b64_tr_b16 v[166:167], v39 offset:21504
v_mfma_f32_16x16x32_bf16 v[88:91], v[144:147], a[48:51], v[88:91]
s_add_u32 m0, s32, 123904
ds_read_b64_tr_b16 v[136:137], v32 offset:25600
v_mfma_f32_16x16x32_bf16 v[92:95], v[144:147], a[52:55], v[92:95]
ds_read_b64_tr_b16 v[138:139], v32 offset:29696
buffer_load_dwordx4 v4, s[12:15], s28 offen  lds
v_mfma_f32_16x16x32_bf16 v[96:99], v[148:151], a[48:51], v[96:99]
ds_read_b64_tr_b16 v[140:141], v33 offset:25600
v_mfma_f32_16x16x32_bf16 v[100:103], v[148:151], a[52:55], v[100:103]
s_waitcnt lgkmcnt(7)
ds_read_b64_tr_b16 v[142:143], v33 offset:29696
v_mfma_f32_16x16x32_bf16 v[104:107], v[152:155], a[48:51], v[104:107]
ds_read_b64_tr_b16 v[144:145], v34 offset:25600
v_mfma_f32_16x16x32_bf16 v[108:111], v[152:155], a[52:55], v[108:111]
ds_read_b64_tr_b16 v[146:147], v34 offset:29696
buffer_load_dwordx4 a[24:27], v6, s[8:11], s29 offen offset:1024 sc1
v_mfma_f32_16x16x32_bf16 v[112:115], v[156:159], a[48:51], v[112:115]
ds_read_b64_tr_b16 v[148:149], v35 offset:25600
v_mfma_f32_16x16x32_bf16 v[116:119], v[156:159], a[52:55], v[116:119]
s_waitcnt lgkmcnt(7)
ds_read_b64_tr_b16 v[150:151], v35 offset:29696
v_mfma_f32_16x16x32_bf16 v[120:123], v[160:163], a[48:51], v[120:123]
s_add_u32 m0, s32, 124928
ds_read_b64_tr_b16 v[152:153], v36 offset:25600
v_mfma_f32_16x16x32_bf16 v[124:127], v[160:163], a[52:55], v[124:127]
ds_read_b64_tr_b16 v[154:155], v36 offset:29696
buffer_load_dwordx4 v5, s[12:15], s28 offen  lds
v_mfma_f32_16x16x32_bf16 v[128:131], v[164:167], a[48:51], v[128:131]
ds_read_b64_tr_b16 v[156:157], v37 offset:25600
v_mfma_f32_16x16x32_bf16 v[132:135], v[164:167], a[52:55], v[132:135]
s_waitcnt lgkmcnt(7)
ds_read_b64_tr_b16 v[158:159], v37 offset:29696
v_mfma_f32_16x16x32_bf16 v[72:75], v[136:139], a[56:59], v[72:75]
ds_read_b64_tr_b16 v[160:161], v38 offset:25600
v_mfma_f32_16x16x32_bf16 v[76:79], v[136:139], a[60:63], v[76:79]
ds_read_b64_tr_b16 v[162:163], v38 offset:29696
buffer_load_dwordx4 a[28:31], v7, s[8:11], s29 offen offset:1024 sc1
v_mfma_f32_16x16x32_bf16 v[80:83], v[140:143], a[56:59], v[80:83]
s_add_u32 s28, s28, 1048576
ds_read_b64_tr_b16 v[164:165], v39 offset:25600
v_mfma_f32_16x16x32_bf16 v[84:87], v[140:143], a[60:63], v[84:87]
s_waitcnt lgkmcnt(7)
s_add_u32 s29, s29, 2048
ds_read_b64_tr_b16 v[166:167], v39 offset:29696
s_waitcnt vmcnt(41)
s_barrier
v_mfma_f32_16x16x32_bf16 v[88:91], v[144:147], a[56:59], v[88:91]
s_add_u32 m0, s32, 0
ds_read_b64_tr_b16 v[136:137], v32 offset:34816
v_mfma_f32_16x16x32_bf16 v[92:95], v[144:147], a[60:63], v[92:95]
ds_read_b64_tr_b16 v[138:139], v32 offset:38912
buffer_load_dwordx4 v2, s[12:15], s28 offen  lds
v_mfma_f32_16x16x32_bf16 v[96:99], v[148:151], a[56:59], v[96:99]
ds_read_b64_tr_b16 v[140:141], v33 offset:34816
v_mfma_f32_16x16x32_bf16 v[100:103], v[148:151], a[60:63], v[100:103]
s_waitcnt lgkmcnt(7)
ds_read_b64_tr_b16 v[142:143], v33 offset:38912
v_mfma_f32_16x16x32_bf16 v[104:107], v[152:155], a[56:59], v[104:107]
ds_read_b64_tr_b16 v[144:145], v34 offset:34816
v_mfma_f32_16x16x32_bf16 v[108:111], v[152:155], a[60:63], v[108:111]
ds_read_b64_tr_b16 v[146:147], v34 offset:38912
buffer_load_dwordx4 a[32:35], v6, s[8:11], s29 offen offset:0 sc1
v_mfma_f32_16x16x32_bf16 v[112:115], v[156:159], a[56:59], v[112:115]
ds_read_b64_tr_b16 v[148:149], v35 offset:34816
v_mfma_f32_16x16x32_bf16 v[116:119], v[156:159], a[60:63], v[116:119]
s_waitcnt lgkmcnt(7)
ds_read_b64_tr_b16 v[150:151], v35 offset:38912
v_mfma_f32_16x16x32_bf16 v[120:123], v[160:163], a[56:59], v[120:123]
s_add_u32 m0, s32, 1024
ds_read_b64_tr_b16 v[152:153], v36 offset:34816
v_mfma_f32_16x16x32_bf16 v[124:127], v[160:163], a[60:63], v[124:127]
ds_read_b64_tr_b16 v[154:155], v36 offset:38912
buffer_load_dwordx4 v3, s[12:15], s28 offen  lds
v_mfma_f32_16x16x32_bf16 v[128:131], v[164:167], a[56:59], v[128:131]
ds_read_b64_tr_b16 v[156:157], v37 offset:34816
v_mfma_f32_16x16x32_bf16 v[132:135], v[164:167], a[60:63], v[132:135]
s_waitcnt lgkmcnt(7)
ds_read_b64_tr_b16 v[158:159], v37 offset:38912
v_mfma_f32_16x16x32_bf16 v[72:75], v[136:139], a[64:67], v[72:75]
ds_read_b64_tr_b16 v[160:161], v38 offset:34816
v_mfma_f32_16x16x32_bf16 v[76:79], v[136:139], a[68:71], v[76:79]
ds_read_b64_tr_b16 v[162:163], v38 offset:38912
buffer_load_dwordx4 a[36:39], v7, s[8:11], s29 offen offset:0 sc1
v_mfma_f32_16x16x32_bf16 v[80:83], v[140:143], a[64:67], v[80:83]
ds_read_b64_tr_b16 v[164:165], v39 offset:34816
v_mfma_f32_16x16x32_bf16 v[84:87], v[140:143], a[68:71], v[84:87]
s_waitcnt lgkmcnt(7)
ds_read_b64_tr_b16 v[166:167], v39 offset:38912
v_mfma_f32_16x16x32_bf16 v[88:91], v[144:147], a[64:67], v[88:91]
s_add_u32 m0, s32, 2048
ds_read_b64_tr_b16 v[136:137], v32 offset:43008
v_mfma_f32_16x16x32_bf16 v[92:95], v[144:147], a[68:71], v[92:95]
ds_read_b64_tr_b16 v[138:139], v32 offset:47104
buffer_load_dwordx4 v4, s[12:15], s28 offen  lds
v_mfma_f32_16x16x32_bf16 v[96:99], v[148:151], a[64:67], v[96:99]
ds_read_b64_tr_b16 v[140:141], v33 offset:43008
v_mfma_f32_16x16x32_bf16 v[100:103], v[148:151], a[68:71], v[100:103]
s_waitcnt lgkmcnt(7)
ds_read_b64_tr_b16 v[142:143], v33 offset:47104
v_mfma_f32_16x16x32_bf16 v[104:107], v[152:155], a[64:67], v[104:107]
ds_read_b64_tr_b16 v[144:145], v34 offset:43008
v_mfma_f32_16x16x32_bf16 v[108:111], v[152:155], a[68:71], v[108:111]
ds_read_b64_tr_b16 v[146:147], v34 offset:47104
buffer_load_dwordx4 a[40:43], v6, s[8:11], s29 offen offset:1024 sc1
v_mfma_f32_16x16x32_bf16 v[112:115], v[156:159], a[64:67], v[112:115]
ds_read_b64_tr_b16 v[148:149], v35 offset:43008
v_mfma_f32_16x16x32_bf16 v[116:119], v[156:159], a[68:71], v[116:119]
s_waitcnt lgkmcnt(7)
ds_read_b64_tr_b16 v[150:151], v35 offset:47104
v_mfma_f32_16x16x32_bf16 v[120:123], v[160:163], a[64:67], v[120:123]
s_add_u32 m0, s32, 3072
ds_read_b64_tr_b16 v[152:153], v36 offset:43008
v_mfma_f32_16x16x32_bf16 v[124:127], v[160:163], a[68:71], v[124:127]
ds_read_b64_tr_b16 v[154:155], v36 offset:47104
buffer_load_dwordx4 v5, s[12:15], s28 offen  lds
v_mfma_f32_16x16x32_bf16 v[128:131], v[164:167], a[64:67], v[128:131]
ds_read_b64_tr_b16 v[156:157], v37 offset:43008
v_mfma_f32_16x16x32_bf16 v[132:135], v[164:167], a[68:71], v[132:135]
s_waitcnt lgkmcnt(7)
ds_read_b64_tr_b16 v[158:159], v37 offset:47104
v_mfma_f32_16x16x32_bf16 v[72:75], v[136:139], a[72:75], v[72:75]
ds_read_b64_tr_b16 v[160:161], v38 offset:43008
v_mfma_f32_16x16x32_bf16 v[76:79], v[136:139], a[76:79], v[76:79]
ds_read_b64_tr_b16 v[162:163], v38 offset:47104
buffer_load_dwordx4 a[44:47], v7, s[8:11], s29 offen offset:1024 sc1
v_mfma_f32_16x16x32_bf16 v[80:83], v[140:143], a[72:75], v[80:83]
s_add_u32 s28, s28, 1048576
ds_read_b64_tr_b16 v[164:165], v39 offset:43008
v_mfma_f32_16x16x32_bf16 v[84:87], v[140:143], a[76:79], v[84:87]
s_waitcnt lgkmcnt(7)
s_add_u32 s29, s29, 2048
ds_read_b64_tr_b16 v[166:167], v39 offset:47104
s_waitcnt vmcnt(41)
s_barrier
v_mfma_f32_16x16x32_bf16 v[88:91], v[144:147], a[72:75], v[88:91]
s_add_u32 m0, s32, 17408
ds_read_b64_tr_b16 v[136:137], v32 offset:52224
v_mfma_f32_16x16x32_bf16 v[92:95], v[144:147], a[76:79], v[92:95]
ds_read_b64_tr_b16 v[138:139], v32 offset:56320
buffer_load_dwordx4 v2, s[12:15], s28 offen  lds
v_mfma_f32_16x16x32_bf16 v[96:99], v[148:151], a[72:75], v[96:99]
ds_read_b64_tr_b16 v[140:141], v33 offset:52224
v_mfma_f32_16x16x32_bf16 v[100:103], v[148:151], a[76:79], v[100:103]
s_waitcnt lgkmcnt(7)
ds_read_b64_tr_b16 v[142:143], v33 offset:56320
v_mfma_f32_16x16x32_bf16 v[104:107], v[152:155], a[72:75], v[104:107]
ds_read_b64_tr_b16 v[144:145], v34 offset:52224
v_mfma_f32_16x16x32_bf16 v[108:111], v[152:155], a[76:79], v[108:111]
ds_read_b64_tr_b16 v[146:147], v34 offset:56320
buffer_load_dwordx4 a[48:51], v6, s[8:11], s29 offen offset:0 sc1
v_mfma_f32_16x16x32_bf16 v[112:115], v[156:159], a[72:75], v[112:115]
ds_read_b64_tr_b16 v[148:149], v35 offset:52224
v_mfma_f32_16x16x32_bf16 v[116:119], v[156:159], a[76:79], v[116:119]
s_waitcnt lgkmcnt(7)
ds_read_b64_tr_b16 v[150:151], v35 offset:56320
v_mfma_f32_16x16x32_bf16 v[120:123], v[160:163], a[72:75], v[120:123]
s_add_u32 m0, s32, 18432
ds_read_b64_tr_b16 v[152:153], v36 offset:52224
v_mfma_f32_16x16x32_bf16 v[124:127], v[160:163], a[76:79], v[124:127]
ds_read_b64_tr_b16 v[154:155], v36 offset:56320
buffer_load_dwordx4 v3, s[12:15], s28 offen  lds
v_mfma_f32_16x16x32_bf16 v[128:131], v[164:167], a[72:75], v[128:131]
ds_read_b64_tr_b16 v[156:157], v37 offset:52224
v_mfma_f32_16x16x32_bf16 v[132:135], v[164:167], a[76:79], v[132:135]
s_waitcnt lgkmcnt(7)
ds_read_b64_tr_b16 v[158:159], v37 offset:56320
v_mfma_f32_16x16x32_bf16 v[72:75], v[136:139], a[80:83], v[72:75]
ds_read_b64_tr_b16 v[160:161], v38 offset:52224
v_mfma_f32_16x16x32_bf16 v[76:79], v[136:139], a[84:87], v[76:79]
ds_read_b64_tr_b16 v[162:163], v38 offset:56320
buffer_load_dwordx4 a[52:55], v7, s[8:11], s29 offen offset:0 sc1
v_mfma_f32_16x16x32_bf16 v[80:83], v[140:143], a[80:83], v[80:83]
ds_read_b64_tr_b16 v[164:165], v39 offset:52224
v_mfma_f32_16x16x32_bf16 v[84:87], v[140:143], a[84:87], v[84:87]
s_waitcnt lgkmcnt(7)
ds_read_b64_tr_b16 v[166:167], v39 offset:56320
v_mfma_f32_16x16x32_bf16 v[88:91], v[144:147], a[80:83], v[88:91]
s_add_u32 m0, s32, 19456
ds_read_b64_tr_b16 v[136:137], v32 offset:60416
v_mfma_f32_16x16x32_bf16 v[92:95], v[144:147], a[84:87], v[92:95]
ds_read_b64_tr_b16 v[138:139], v32 offset:64512
buffer_load_dwordx4 v4, s[12:15], s28 offen  lds
v_mfma_f32_16x16x32_bf16 v[96:99], v[148:151], a[80:83], v[96:99]
ds_read_b64_tr_b16 v[140:141], v33 offset:60416
v_mfma_f32_16x16x32_bf16 v[100:103], v[148:151], a[84:87], v[100:103]
s_waitcnt lgkmcnt(7)
ds_read_b64_tr_b16 v[142:143], v33 offset:64512
v_mfma_f32_16x16x32_bf16 v[104:107], v[152:155], a[80:83], v[104:107]
ds_read_b64_tr_b16 v[144:145], v34 offset:60416
v_mfma_f32_16x16x32_bf16 v[108:111], v[152:155], a[84:87], v[108:111]
ds_read_b64_tr_b16 v[146:147], v34 offset:64512
buffer_load_dwordx4 a[56:59], v6, s[8:11], s29 offen offset:1024 sc1
v_mfma_f32_16x16x32_bf16 v[112:115], v[156:159], a[80:83], v[112:115]
ds_read_b64_tr_b16 v[148:149], v35 offset:60416
v_mfma_f32_16x16x32_bf16 v[116:119], v[156:159], a[84:87], v[116:119]
s_waitcnt lgkmcnt(7)
ds_read_b64_tr_b16 v[150:151], v35 offset:64512
v_mfma_f32_16x16x32_bf16 v[120:123], v[160:163], a[80:83], v[120:123]
s_add_u32 m0, s32, 20480
ds_read_b64_tr_b16 v[152:153], v36 offset:60416
v_mfma_f32_16x16x32_bf16 v[124:127], v[160:163], a[84:87], v[124:127]
ds_read_b64_tr_b16 v[154:155], v36 offset:64512
buffer_load_dwordx4 v5, s[12:15], s28 offen  lds
v_mfma_f32_16x16x32_bf16 v[128:131], v[164:167], a[80:83], v[128:131]
ds_read_b64_tr_b16 v[156:157], v37 offset:60416
v_mfma_f32_16x16x32_bf16 v[132:135], v[164:167], a[84:87], v[132:135]
s_waitcnt lgkmcnt(7)
ds_read_b64_tr_b16 v[158:159], v37 offset:64512
v_mfma_f32_16x16x32_bf16 v[72:75], v[136:139], a[88:91], v[72:75]
ds_read_b64_tr_b16 v[160:161], v38 offset:60416
v_mfma_f32_16x16x32_bf16 v[76:79], v[136:139], a[92:95], v[76:79]
ds_read_b64_tr_b16 v[162:163], v38 offset:64512
buffer_load_dwordx4 a[60:63], v7, s[8:11], s29 offen offset:1024 sc1
v_mfma_f32_16x16x32_bf16 v[80:83], v[140:143], a[88:91], v[80:83]
s_add_u32 s28, s28, 1048576
ds_read_b64_tr_b16 v[164:165], v39 offset:60416
v_mfma_f32_16x16x32_bf16 v[84:87], v[140:143], a[92:95], v[84:87]
s_waitcnt lgkmcnt(7)
s_add_u32 s29, s29, 2048
ds_read_b64_tr_b16 v[166:167], v39 offset:64512
s_waitcnt vmcnt(41)
s_barrier
v_mfma_f32_16x16x32_bf16 v[88:91], v[144:147], a[88:91], v[88:91]
s_add_u32 m0, s32, 34816
ds_read_b64_tr_b16 v[136:137], v40 offset:0
v_mfma_f32_16x16x32_bf16 v[92:95], v[144:147], a[92:95], v[92:95]
ds_read_b64_tr_b16 v[138:139], v40 offset:4096
buffer_load_dwordx4 v2, s[12:15], s28 offen  lds
v_mfma_f32_16x16x32_bf16 v[96:99], v[148:151], a[88:91], v[96:99]
ds_read_b64_tr_b16 v[140:141], v41 offset:0
v_mfma_f32_16x16x32_bf16 v[100:103], v[148:151], a[92:95], v[100:103]
s_waitcnt lgkmcnt(7)
ds_read_b64_tr_b16 v[142:143], v41 offset:4096
v_mfma_f32_16x16x32_bf16 v[104:107], v[152:155], a[88:91], v[104:107]
ds_read_b64_tr_b16 v[144:145], v42 offset:0
v_mfma_f32_16x16x32_bf16 v[108:111], v[152:155], a[92:95], v[108:111]
ds_read_b64_tr_b16 v[146:147], v42 offset:4096
buffer_load_dwordx4 a[64:67], v6, s[8:11], s29 offen offset:0 sc1
v_mfma_f32_16x16x32_bf16 v[112:115], v[156:159], a[88:91], v[112:115]
ds_read_b64_tr_b16 v[148:149], v43 offset:0
v_mfma_f32_16x16x32_bf16 v[116:119], v[156:159], a[92:95], v[116:119]
s_waitcnt lgkmcnt(7)
ds_read_b64_tr_b16 v[150:151], v43 offset:4096
v_mfma_f32_16x16x32_bf16 v[120:123], v[160:163], a[88:91], v[120:123]
s_add_u32 m0, s32, 35840
ds_read_b64_tr_b16 v[152:153], v44 offset:0
v_mfma_f32_16x16x32_bf16 v[124:127], v[160:163], a[92:95], v[124:127]
ds_read_b64_tr_b16 v[154:155], v44 offset:4096
buffer_load_dwordx4 v3, s[12:15], s28 offen  lds
v_mfma_f32_16x16x32_bf16 v[128:131], v[164:167], a[88:91], v[128:131]
ds_read_b64_tr_b16 v[156:157], v45 offset:0
v_mfma_f32_16x16x32_bf16 v[132:135], v[164:167], a[92:95], v[132:135]
s_waitcnt lgkmcnt(7)
ds_read_b64_tr_b16 v[158:159], v45 offset:4096
v_mfma_f32_16x16x32_bf16 v[72:75], v[136:139], a[96:99], v[72:75]
ds_read_b64_tr_b16 v[160:161], v46 offset:0
v_mfma_f32_16x16x32_bf16 v[76:79], v[136:139], a[100:103], v[76:79]
ds_read_b64_tr_b16 v[162:163], v46 offset:4096
buffer_load_dwordx4 a[68:71], v7, s[8:11], s29 offen offset:0 sc1
v_mfma_f32_16x16x32_bf16 v[80:83], v[140:143], a[96:99], v[80:83]
ds_read_b64_tr_b16 v[164:165], v47 offset:0
v_mfma_f32_16x16x32_bf16 v[84:87], v[140:143], a[100:103], v[84:87]
s_waitcnt lgkmcnt(7)
ds_read_b64_tr_b16 v[166:167], v47 offset:4096
v_mfma_f32_16x16x32_bf16 v[88:91], v[144:147], a[96:99], v[88:91]
s_add_u32 m0, s32, 36864
ds_read_b64_tr_b16 v[136:137], v40 offset:8192
v_mfma_f32_16x16x32_bf16 v[92:95], v[144:147], a[100:103], v[92:95]
ds_read_b64_tr_b16 v[138:139], v40 offset:12288
buffer_load_dwordx4 v4, s[12:15], s28 offen  lds
v_mfma_f32_16x16x32_bf16 v[96:99], v[148:151], a[96:99], v[96:99]
ds_read_b64_tr_b16 v[140:141], v41 offset:8192
v_mfma_f32_16x16x32_bf16 v[100:103], v[148:151], a[100:103], v[100:103]
s_waitcnt lgkmcnt(7)
ds_read_b64_tr_b16 v[142:143], v41 offset:12288
v_mfma_f32_16x16x32_bf16 v[104:107], v[152:155], a[96:99], v[104:107]
ds_read_b64_tr_b16 v[144:145], v42 offset:8192
v_mfma_f32_16x16x32_bf16 v[108:111], v[152:155], a[100:103], v[108:111]
ds_read_b64_tr_b16 v[146:147], v42 offset:12288
buffer_load_dwordx4 a[72:75], v6, s[8:11], s29 offen offset:1024 sc1
v_mfma_f32_16x16x32_bf16 v[112:115], v[156:159], a[96:99], v[112:115]
ds_read_b64_tr_b16 v[148:149], v43 offset:8192
v_mfma_f32_16x16x32_bf16 v[116:119], v[156:159], a[100:103], v[116:119]
s_waitcnt lgkmcnt(7)
ds_read_b64_tr_b16 v[150:151], v43 offset:12288
v_mfma_f32_16x16x32_bf16 v[120:123], v[160:163], a[96:99], v[120:123]
s_add_u32 m0, s32, 37888
ds_read_b64_tr_b16 v[152:153], v44 offset:8192
v_mfma_f32_16x16x32_bf16 v[124:127], v[160:163], a[100:103], v[124:127]
ds_read_b64_tr_b16 v[154:155], v44 offset:12288
buffer_load_dwordx4 v5, s[12:15], s28 offen  lds
v_mfma_f32_16x16x32_bf16 v[128:131], v[164:167], a[96:99], v[128:131]
ds_read_b64_tr_b16 v[156:157], v45 offset:8192
v_mfma_f32_16x16x32_bf16 v[132:135], v[164:167], a[100:103], v[132:135]
s_waitcnt lgkmcnt(7)
ds_read_b64_tr_b16 v[158:159], v45 offset:12288
v_mfma_f32_16x16x32_bf16 v[72:75], v[136:139], a[104:107], v[72:75]
ds_read_b64_tr_b16 v[160:161], v46 offset:8192
v_mfma_f32_16x16x32_bf16 v[76:79], v[136:139], a[108:111], v[76:79]
ds_read_b64_tr_b16 v[162:163], v46 offset:12288
buffer_load_dwordx4 a[76:79], v7, s[8:11], s29 offen offset:1024 sc1
v_mfma_f32_16x16x32_bf16 v[80:83], v[140:143], a[104:107], v[80:83]
s_add_u32 s28, s28, 1048576
ds_read_b64_tr_b16 v[164:165], v47 offset:8192
v_mfma_f32_16x16x32_bf16 v[84:87], v[140:143], a[108:111], v[84:87]
s_waitcnt lgkmcnt(7)
s_add_u32 s29, s29, 2048
ds_read_b64_tr_b16 v[166:167], v47 offset:12288
s_waitcnt vmcnt(41)
s_barrier
v_mfma_f32_16x16x32_bf16 v[88:91], v[144:147], a[104:107], v[88:91]
s_add_u32 m0, s32, 52224
ds_read_b64_tr_b16 v[136:137], v40 offset:17408
v_mfma_f32_16x16x32_bf16 v[92:95], v[144:147], a[108:111], v[92:95]
ds_read_b64_tr_b16 v[138:139], v40 offset:21504
buffer_load_dwordx4 v2, s[12:15], s28 offen  lds
v_mfma_f32_16x16x32_bf16 v[96:99], v[148:151], a[104:107], v[96:99]
ds_read_b64_tr_b16 v[140:141], v41 offset:17408
v_mfma_f32_16x16x32_bf16 v[100:103], v[148:151], a[108:111], v[100:103]
s_waitcnt lgkmcnt(7)
ds_read_b64_tr_b16 v[142:143], v41 offset:21504
v_mfma_f32_16x16x32_bf16 v[104:107], v[152:155], a[104:107], v[104:107]
ds_read_b64_tr_b16 v[144:145], v42 offset:17408
v_mfma_f32_16x16x32_bf16 v[108:111], v[152:155], a[108:111], v[108:111]
ds_read_b64_tr_b16 v[146:147], v42 offset:21504
buffer_load_dwordx4 a[80:83], v6, s[8:11], s29 offen offset:0 sc1
v_mfma_f32_16x16x32_bf16 v[112:115], v[156:159], a[104:107], v[112:115]
ds_read_b64_tr_b16 v[148:149], v43 offset:17408
v_mfma_f32_16x16x32_bf16 v[116:119], v[156:159], a[108:111], v[116:119]
s_waitcnt lgkmcnt(7)
ds_read_b64_tr_b16 v[150:151], v43 offset:21504
v_mfma_f32_16x16x32_bf16 v[120:123], v[160:163], a[104:107], v[120:123]
s_add_u32 m0, s32, 53248
ds_read_b64_tr_b16 v[152:153], v44 offset:17408
v_mfma_f32_16x16x32_bf16 v[124:127], v[160:163], a[108:111], v[124:127]
ds_read_b64_tr_b16 v[154:155], v44 offset:21504
buffer_load_dwordx4 v3, s[12:15], s28 offen  lds
v_mfma_f32_16x16x32_bf16 v[128:131], v[164:167], a[104:107], v[128:131]
ds_read_b64_tr_b16 v[156:157], v45 offset:17408
v_mfma_f32_16x16x32_bf16 v[132:135], v[164:167], a[108:111], v[132:135]
s_waitcnt lgkmcnt(7)
ds_read_b64_tr_b16 v[158:159], v45 offset:21504
v_mfma_f32_16x16x32_bf16 v[72:75], v[136:139], a[112:115], v[72:75]
ds_read_b64_tr_b16 v[160:161], v46 offset:17408
v_mfma_f32_16x16x32_bf16 v[76:79], v[136:139], a[116:119], v[76:79]
ds_read_b64_tr_b16 v[162:163], v46 offset:21504
buffer_load_dwordx4 a[84:87], v7, s[8:11], s29 offen offset:0 sc1
v_mfma_f32_16x16x32_bf16 v[80:83], v[140:143], a[112:115], v[80:83]
ds_read_b64_tr_b16 v[164:165], v47 offset:17408
v_mfma_f32_16x16x32_bf16 v[84:87], v[140:143], a[116:119], v[84:87]
s_waitcnt lgkmcnt(7)
ds_read_b64_tr_b16 v[166:167], v47 offset:21504
v_mfma_f32_16x16x32_bf16 v[88:91], v[144:147], a[112:115], v[88:91]
s_add_u32 m0, s32, 54272
ds_read_b64_tr_b16 v[136:137], v40 offset:25600
v_mfma_f32_16x16x32_bf16 v[92:95], v[144:147], a[116:119], v[92:95]
ds_read_b64_tr_b16 v[138:139], v40 offset:29696
buffer_load_dwordx4 v4, s[12:15], s28 offen  lds
v_mfma_f32_16x16x32_bf16 v[96:99], v[148:151], a[112:115], v[96:99]
ds_read_b64_tr_b16 v[140:141], v41 offset:25600
v_mfma_f32_16x16x32_bf16 v[100:103], v[148:151], a[116:119], v[100:103]
s_waitcnt lgkmcnt(7)
ds_read_b64_tr_b16 v[142:143], v41 offset:29696
v_mfma_f32_16x16x32_bf16 v[104:107], v[152:155], a[112:115], v[104:107]
ds_read_b64_tr_b16 v[144:145], v42 offset:25600
v_mfma_f32_16x16x32_bf16 v[108:111], v[152:155], a[116:119], v[108:111]
ds_read_b64_tr_b16 v[146:147], v42 offset:29696
buffer_load_dwordx4 a[88:91], v6, s[8:11], s29 offen offset:1024 sc1
v_mfma_f32_16x16x32_bf16 v[112:115], v[156:159], a[112:115], v[112:115]
ds_read_b64_tr_b16 v[148:149], v43 offset:25600
v_mfma_f32_16x16x32_bf16 v[116:119], v[156:159], a[116:119], v[116:119]
s_waitcnt lgkmcnt(7)
ds_read_b64_tr_b16 v[150:151], v43 offset:29696
v_mfma_f32_16x16x32_bf16 v[120:123], v[160:163], a[112:115], v[120:123]
s_add_u32 m0, s32, 55296
ds_read_b64_tr_b16 v[152:153], v44 offset:25600
v_mfma_f32_16x16x32_bf16 v[124:127], v[160:163], a[116:119], v[124:127]
ds_read_b64_tr_b16 v[154:155], v44 offset:29696
buffer_load_dwordx4 v5, s[12:15], s28 offen  lds
v_mfma_f32_16x16x32_bf16 v[128:131], v[164:167], a[112:115], v[128:131]
ds_read_b64_tr_b16 v[156:157], v45 offset:25600
v_mfma_f32_16x16x32_bf16 v[132:135], v[164:167], a[116:119], v[132:135]
s_waitcnt lgkmcnt(7)
ds_read_b64_tr_b16 v[158:159], v45 offset:29696
v_mfma_f32_16x16x32_bf16 v[72:75], v[136:139], a[120:123], v[72:75]
ds_read_b64_tr_b16 v[160:161], v46 offset:25600
v_mfma_f32_16x16x32_bf16 v[76:79], v[136:139], a[124:127], v[76:79]
ds_read_b64_tr_b16 v[162:163], v46 offset:29696
buffer_load_dwordx4 a[92:95], v7, s[8:11], s29 offen offset:1024 sc1
v_mfma_f32_16x16x32_bf16 v[80:83], v[140:143], a[120:123], v[80:83]
s_add_u32 s28, s28, 1048576
ds_read_b64_tr_b16 v[164:165], v47 offset:25600
v_mfma_f32_16x16x32_bf16 v[84:87], v[140:143], a[124:127], v[84:87]
s_waitcnt lgkmcnt(7)
s_add_u32 s29, s29, 2048
ds_read_b64_tr_b16 v[166:167], v47 offset:29696
s_waitcnt vmcnt(41)
s_barrier
v_mfma_f32_16x16x32_bf16 v[88:91], v[144:147], a[120:123], v[88:91]
s_add_u32 m0, s32, 69632
ds_read_b64_tr_b16 v[136:137], v40 offset:34816
v_mfma_f32_16x16x32_bf16 v[92:95], v[144:147], a[124:127], v[92:95]
ds_read_b64_tr_b16 v[138:139], v40 offset:38912
buffer_load_dwordx4 v2, s[12:15], s28 offen  lds
v_mfma_f32_16x16x32_bf16 v[96:99], v[148:151], a[120:123], v[96:99]
ds_read_b64_tr_b16 v[140:141], v41 offset:34816
v_mfma_f32_16x16x32_bf16 v[100:103], v[148:151], a[124:127], v[100:103]
s_waitcnt lgkmcnt(7)
ds_read_b64_tr_b16 v[142:143], v41 offset:38912
v_mfma_f32_16x16x32_bf16 v[104:107], v[152:155], a[120:123], v[104:107]
ds_read_b64_tr_b16 v[144:145], v42 offset:34816
v_mfma_f32_16x16x32_bf16 v[108:111], v[152:155], a[124:127], v[108:111]
ds_read_b64_tr_b16 v[146:147], v42 offset:38912
buffer_load_dwordx4 a[96:99], v6, s[8:11], s29 offen offset:0 sc1
v_mfma_f32_16x16x32_bf16 v[112:115], v[156:159], a[120:123], v[112:115]
ds_read_b64_tr_b16 v[148:149], v43 offset:34816
v_mfma_f32_16x16x32_bf16 v[116:119], v[156:159], a[124:127], v[116:119]
s_waitcnt lgkmcnt(7)
ds_read_b64_tr_b16 v[150:151], v43 offset:38912
v_mfma_f32_16x16x32_bf16 v[120:123], v[160:163], a[120:123], v[120:123]
s_add_u32 m0, s32, 70656
ds_read_b64_tr_b16 v[152:153], v44 offset:34816
v_mfma_f32_16x16x32_bf16 v[124:127], v[160:163], a[124:127], v[124:127]
ds_read_b64_tr_b16 v[154:155], v44 offset:38912
buffer_load_dwordx4 v3, s[12:15], s28 offen  lds
v_mfma_f32_16x16x32_bf16 v[128:131], v[164:167], a[120:123], v[128:131]
ds_read_b64_tr_b16 v[156:157], v45 offset:34816
v_mfma_f32_16x16x32_bf16 v[132:135], v[164:167], a[124:127], v[132:135]
s_waitcnt lgkmcnt(7)
ds_read_b64_tr_b16 v[158:159], v45 offset:38912
s_sub_u32 s30, s30, 1
s_cmp_lg_u32 s30, 0
s_cbranch_scc1 L_k2
v_mfma_f32_16x16x32_bf16 v[72:75], v[136:139], a[0:3], v[72:75]
ds_read_b64_tr_b16 v[160:161], v46 offset:34816
v_mfma_f32_16x16x32_bf16 v[76:79], v[136:139], a[4:7], v[76:79]
ds_read_b64_tr_b16 v[162:163], v46 offset:38912
buffer_load_dwordx4 a[100:103], v7, s[8:11], s29 offen offset:0 sc1
v_mfma_f32_16x16x32_bf16 v[80:83], v[140:143], a[0:3], v[80:83]
ds_read_b64_tr_b16 v[164:165], v47 offset:34816
v_mfma_f32_16x16x32_bf16 v[84:87], v[140:143], a[4:7], v[84:87]
s_waitcnt lgkmcnt(7)
ds_read_b64_tr_b16 v[166:167], v47 offset:38912
v_mfma_f32_16x16x32_bf16 v[88:91], v[144:147], a[0:3], v[88:91]
s_add_u32 m0, s32, 71680
ds_read_b64_tr_b16 v[136:137], v40 offset:43008
v_mfma_f32_16x16x32_bf16 v[92:95], v[144:147], a[4:7], v[92:95]
ds_read_b64_tr_b16 v[138:139], v40 offset:47104
buffer_load_dwordx4 v4, s[12:15], s28 offen  lds
v_mfma_f32_16x16x32_bf16 v[96:99], v[148:151], a[0:3], v[96:99]
ds_read_b64_tr_b16 v[140:141], v41 offset:43008
v_mfma_f32_16x16x32_bf16 v[100:103], v[148:151], a[4:7], v[100:103]
s_waitcnt lgkmcnt(7)
ds_read_b64_tr_b16 v[142:143], v41 offset:47104
v_mfma_f32_16x16x32_bf16 v[104:107], v[152:155], a[0:3], v[104:107]
ds_read_b64_tr_b16 v[144:145], v42 offset:43008
v_mfma_f32_16x16x32_bf16 v[108:111], v[152:155], a[4:7], v[108:111]
ds_read_b64_tr_b16 v[146:147], v42 offset:47104
buffer_load_dwordx4 a[104:107], v6, s[8:11], s29 offen offset:1024 sc1
v_mfma_f32_16x16x32_bf16 v[112:115], v[156:159], a[0:3], v[112:115]
ds_read_b64_tr_b16 v[148:149], v43 offset:43008
v_mfma_f32_16x16x32_bf16 v[116:119], v[156:159], a[4:7], v[116:119]
s_waitcnt lgkmcnt(7)
ds_read_b64_tr_b16 v[150:151], v43 offset:47104
v_mfma_f32_16x16x32_bf16 v[120:123], v[160:163], a[0:3], v[120:123]
s_add_u32 m0, s32, 72704
ds_read_b64_tr_b16 v[152:153], v44 offset:43008
v_mfma_f32_16x16x32_bf16 v[124:127], v[160:163], a[4:7], v[124:127]
ds_read_b64_tr_b16 v[154:155], v44 offset:47104
buffer_load_dwordx4 v5, s[12:15], s28 offen  lds
v_mfma_f32_16x16x32_bf16 v[128:131], v[164:167], a[0:3], v[128:131]
ds_read_b64_tr_b16 v[156:157], v45 offset:43008
v_mfma_f32_16x16x32_bf16 v[132:135], v[164:167], a[4:7], v[132:135]
s_waitcnt lgkmcnt(7)
ds_read_b64_tr_b16 v[158:159], v45 offset:47104
v_mfma_f32_16x16x32_bf16 v[72:75], v[136:139], a[8:11], v[72:75]
ds_read_b64_tr_b16 v[160:161], v46 offset:43008
v_mfma_f32_16x16x32_bf16 v[76:79], v[136:139], a[12:15], v[76:79]
ds_read_b64_tr_b16 v[162:163], v46 offset:47104
buffer_load_dwordx4 a[108:111], v7, s[8:11], s29 offen offset:1024 sc1
v_mfma_f32_16x16x32_bf16 v[80:83], v[140:143], a[8:11], v[80:83]
s_add_u32 s28, s28, 1048576
ds_read_b64_tr_b16 v[164:165], v47 offset:43008
v_mfma_f32_16x16x32_bf16 v[84:87], v[140:143], a[12:15], v[84:87]
s_waitcnt lgkmcnt(7)
s_add_u32 s29, s29, 2048
ds_read_b64_tr_b16 v[166:167], v47 offset:47104
s_waitcnt vmcnt(40)
s_barrier
v_mfma_f32_16x16x32_bf16 v[88:91], v[144:147], a[8:11], v[88:91]
s_add_u32 m0, s32, 87040
ds_read_b64_tr_b16 v[136:137], v40 offset:52224
v_mfma_f32_16x16x32_bf16 v[92:95], v[144:147], a[12:15], v[92:95]
ds_read_b64_tr_b16 v[138:139], v40 offset:56320
buffer_load_dwordx4 v2, s[12:15], s28 offen  lds
v_mfma_f32_16x16x32_bf16 v[96:99], v[148:151], a[8:11], v[96:99]
ds_read_b64_tr_b16 v[140:141], v41 offset:52224
v_mfma_f32_16x16x32_bf16 v[100:103], v[148:151], a[12:15], v[100:103]
s_waitcnt lgkmcnt(7)
ds_read_b64_tr_b16 v[142:143], v41 offset:56320
v_mfma_f32_16x16x32_bf16 v[104:107], v[152:155], a[8:11], v[104:107]
ds_read_b64_tr_b16 v[144:145], v42 offset:52224
v_mfma_f32_16x16x32_bf16 v[108:111], v[152:155], a[12:15], v[108:111]
ds_read_b64_tr_b16 v[146:147], v42 offset:56320
buffer_load_dwordx4 a[112:115], v6, s[8:11], s29 offen offset:0 sc1
v_mfma_f32_16x16x32_bf16 v[112:115], v[156:159], a[8:11], v[112:115]
ds_read_b64_tr_b16 v[148:149], v43 offset:52224
v_mfma_f32_16x16x32_bf16 v[116:119], v[156:159], a[12:15], v[116:119]
s_waitcnt lgkmcnt(7)
ds_read_b64_tr_b16 v[150:151], v43 offset:56320
v_mfma_f32_16x16x32_bf16 v[120:123], v[160:163], a[8:11], v[120:123]
s_add_u32 m0, s32, 88064
ds_read_b64_tr_b16 v[152:153], v44 offset:52224
v_mfma_f32_16x16x32_bf16 v[124:127], v[160:163], a[12:15], v[124:127]
ds_read_b64_tr_b16 v[154:155], v44 offset:56320
buffer_load_dwordx4 v3, s[12:15], s28 offen  lds
v_mfma_f32_16x16x32_bf16 v[128:131], v[164:167], a[8:11], v[128:131]
ds_read_b64_tr_b16 v[156:157], v45 offset:52224
v_mfma_f32_16x16x32_bf16 v[132:135], v[164:167], a[12:15], v[132:135]
s_waitcnt lgkmcnt(7)
ds_read_b64_tr_b16 v[158:159], v45 offset:56320
v_mfma_f32_16x16x32_bf16 v[72:75], v[136:139], a[16:19], v[72:75]
ds_read_b64_tr_b16 v[160:161], v46 offset:52224
v_mfma_f32_16x16x32_bf16 v[76:79], v[136:139], a[20:23], v[76:79]
ds_read_b64_tr_b16 v[162:163], v46 offset:56320
buffer_load_dwordx4 a[116:119], v7, s[8:11], s29 offen offset:0 sc1
v_mfma_f32_16x16x32_bf16 v[80:83], v[140:143], a[16:19], v[80:83]
ds_read_b64_tr_b16 v[164:165], v47 offset:52224
v_mfma_f32_16x16x32_bf16 v[84:87], v[140:143], a[20:23], v[84:87]
s_waitcnt lgkmcnt(7)
ds_read_b64_tr_b16 v[166:167], v47 offset:56320
v_mfma_f32_16x16x32_bf16 v[88:91], v[144:147], a[16:19], v[88:91]
s_add_u32 m0, s32, 89088
ds_read_b64_tr_b16 v[136:137], v40 offset:60416
v_mfma_f32_16x16x32_bf16 v[92:95], v[144:147], a[20:23], v[92:95]
ds_read_b64_tr_b16 v[138:139], v40 offset:64512
buffer_load_dwordx4 v4, s[12:15], s28 offen  lds
v_mfma_f32_16x16x32_bf16 v[96:99], v[148:151], a[16:19], v[96:99]
ds_read_b64_tr_b16 v[140:141], v41 offset:60416
v_mfma_f32_16x16x32_bf16 v[100:103], v[148:151], a[20:23], v[100:103]
s_waitcnt lgkmcnt(7)
ds_read_b64_tr_b16 v[142:143], v41 offset:64512
v_mfma_f32_16x16x32_bf16 v[104:107], v[152:155], a[16:19], v[104:107]
ds_read_b64_tr_b16 v[144:145], v42 offset:60416
v_mfma_f32_16x16x32_bf16 v[108:111], v[152:155], a[20:23], v[108:111]
ds_read_b64_tr_b16 v[146:147], v42 offset:64512
buffer_load_dwordx4 a[120:123], v6, s[8:11], s29 offen offset:1024 sc1
v_mfma_f32_16x16x32_bf16 v[112:115], v[156:159], a[16:19], v[112:115]
ds_read_b64_tr_b16 v[148:149], v43 offset:60416
v_mfma_f32_16x16x32_bf16 v[116:119], v[156:159], a[20:23], v[116:119]
s_waitcnt lgkmcnt(7)
ds_read_b64_tr_b16 v[150:151], v43 offset:64512
v_mfma_f32_16x16x32_bf16 v[120:123], v[160:163], a[16:19], v[120:123]
s_add_u32 m0, s32, 90112
ds_read_b64_tr_b16 v[152:153], v44 offset:60416
v_mfma_f32_16x16x32_bf16 v[124:127], v[160:163], a[20:23], v[124:127]
ds_read_b64_tr_b16 v[154:155], v44 offset:64512
buffer_load_dwordx4 v5, s[12:15], s28 offen  lds
v_mfma_f32_16x16x32_bf16 v[128:131], v[164:167], a[16:19], v[128:131]
ds_read_b64_tr_b16 v[156:157], v45 offset:60416
v_mfma_f32_16x16x32_bf16 v[132:135], v[164:167], a[20:23], v[132:135]
s_waitcnt lgkmcnt(7)
ds_read_b64_tr_b16 v[158:159], v45 offset:64512
v_mfma_f32_16x16x32_bf16 v[72:75], v[136:139], a[24:27], v[72:75]
ds_read_b64_tr_b16 v[160:161], v46 offset:60416
v_mfma_f32_16x16x32_bf16 v[76:79], v[136:139], a[28:31], v[76:79]
ds_read_b64_tr_b16 v[162:163], v46 offset:64512
buffer_load_dwordx4 a[124:127], v7, s[8:11], s29 offen offset:1024 sc1
v_mfma_f32_16x16x32_bf16 v[80:83], v[140:143], a[24:27], v[80:83]
s_add_u32 s28, s28, s36
ds_read_b64_tr_b16 v[164:165], v47 offset:60416
v_mfma_f32_16x16x32_bf16 v[84:87], v[140:143], a[28:31], v[84:87]
s_waitcnt lgkmcnt(7)
s_add_u32 s29, s29, 2048
ds_read_b64_tr_b16 v[166:167], v47 offset:64512
s_waitcnt vmcnt(40)
s_barrier
v_mfma_f32_16x16x32_bf16 v[88:91], v[144:147], a[24:27], v[88:91]
s_xor_b32 s36, s36, 0x120000
ds_read_b64_tr_b16 v[136:137], v32 offset:0
v_mfma_f32_16x16x32_bf16 v[92:95], v[144:147], a[28:31], v[92:95]
ds_read_b64_tr_b16 v[138:139], v32 offset:4096
v_mfma_f32_16x16x32_bf16 v[96:99], v[148:151], a[24:27], v[96:99]
ds_read_b64_tr_b16 v[140:141], v33 offset:0
v_mfma_f32_16x16x32_bf16 v[100:103], v[148:151], a[28:31], v[100:103]
s_waitcnt lgkmcnt(7)
ds_read_b64_tr_b16 v[142:143], v33 offset:4096
v_mfma_f32_16x16x32_bf16 v[104:107], v[152:155], a[24:27], v[104:107]
ds_read_b64_tr_b16 v[144:145], v34 offset:0
v_mfma_f32_16x16x32_bf16 v[108:111], v[152:155], a[28:31], v[108:111]
ds_read_b64_tr_b16 v[146:147], v34 offset:4096
v_mfma_f32_16x16x32_bf16 v[112:115], v[156:159], a[24:27], v[112:115]
ds_read_b64_tr_b16 v[148:149], v35 offset:0
v_mfma_f32_16x16x32_bf16 v[116:119], v[156:159], a[28:31], v[116:119]
s_waitcnt lgkmcnt(7)
ds_read_b64_tr_b16 v[150:151], v35 offset:4096
v_mfma_f32_16x16x32_bf16 v[120:123], v[160:163], a[24:27], v[120:123]
ds_read_b64_tr_b16 v[152:153], v36 offset:0
v_mfma_f32_16x16x32_bf16 v[124:127], v[160:163], a[28:31], v[124:127]
ds_read_b64_tr_b16 v[154:155], v36 offset:4096
v_mfma_f32_16x16x32_bf16 v[128:131], v[164:167], a[24:27], v[128:131]
ds_read_b64_tr_b16 v[156:157], v37 offset:0
v_mfma_f32_16x16x32_bf16 v[132:135], v[164:167], a[28:31], v[132:135]
s_waitcnt lgkmcnt(7)
ds_read_b64_tr_b16 v[158:159], v37 offset:4096
v_mfma_f32_16x16x32_bf16 v[72:75], v[136:139], a[32:35], v[72:75]
ds_read_b64_tr_b16 v[160:161], v38 offset:0
v_mfma_f32_16x16x32_bf16 v[76:79], v[136:139], a[36:39], v[76:79]
ds_read_b64_tr_b16 v[162:163], v38 offset:4096
v_mfma_f32_16x16x32_bf16 v[80:83], v[140:143], a[32:35], v[80:83]
ds_read_b64_tr_b16 v[164:165], v39 offset:0
v_mfma_f32_16x16x32_bf16 v[84:87], v[140:143], a[36:39], v[84:87]
s_waitcnt lgkmcnt(7)
ds_read_b64_tr_b16 v[166:167], v39 offset:4096
v_mfma_f32_16x16x32_bf16 v[88:91], v[144:147], a[32:35], v[88:91]
ds_read_b64_tr_b16 v[136:137], v32 offset:8192
v_mfma_f32_16x16x32_bf16 v[92:95], v[144:147], a[36:39], v[92:95]
ds_read_b64_tr_b16 v[138:139], v32 offset:12288
v_mfma_f32_16x16x32_bf16 v[96:99], v[148:151], a[32:35], v[96:99]
ds_read_b64_tr_b16 v[140:141], v33 offset:8192
v_mfma_f32_16x16x32_bf16 v[100:103], v[148:151], a[36:39], v[100:103]
s_waitcnt lgkmcnt(7)
ds_read_b64_tr_b16 v[142:143], v33 offset:12288
v_mfma_f32_16x16x32_bf16 v[104:107], v[152:155], a[32:35], v[104:107]
ds_read_b64_tr_b16 v[144:145], v34 offset:8192
v_mfma_f32_16x16x32_bf16 v[108:111], v[152:155], a[36:39], v[108:111]
ds_read_b64_tr_b16 v[146:147], v34 offset:12288
v_mfma_f32_16x16x32_bf16 v[112:115], v[156:159], a[32:35], v[112:115]
ds_read_b64_tr_b16 v[148:149], v35 offset:8192
v_mfma_f32_16x16x32_bf16 v[116:119], v[156:159], a[36:39], v[116:119]
s_waitcnt lgkmcnt(7)
ds_read_b64_tr_b16 v[150:151], v35 offset:12288
v_mfma_f32_16x16x32_bf16 v[120:123], v[160:163], a[32:35], v[120:123]
ds_read_b64_tr_b16 v[152:153], v36 offset:8192
v_mfma_f32_16x16x32_bf16 v[124:127], v[160:163], a[36:39], v[124:127]
ds_read_b64_tr_b16 v[154:155], v36 offset:12288
v_mfma_f32_16x16x32_bf16 v[128:131], v[164:167], a[32:35], v[128:131]
ds_read_b64_tr_b16 v[156:157], v37 offset:8192
v_mfma_f32_16x16x32_bf16 v[132:135], v[164:167], a[36:39], v[132:135]
s_waitcnt lgkmcnt(7)
ds_read_b64_tr_b16 v[158:159], v37 offset:12288
v_mfma_f32_16x16x32_bf16 v[72:75], v[136:139], a[40:43], v[72:75]
ds_read_b64_tr_b16 v[160:161], v38 offset:8192
v_mfma_f32_16x16x32_bf16 v[76:79], v[136:139], a[44:47], v[76:79]
ds_read_b64_tr_b16 v[162:163], v38 offset:12288
v_mfma_f32_16x16x32_bf16 v[80:83], v[140:143], a[40:43], v[80:83]
ds_read_b64_tr_b16 v[164:165], v39 offset:8192
v_mfma_f32_16x16x32_bf16 v[84:87], v[140:143], a[44:47], v[84:87]
s_waitcnt lgkmcnt(7)
ds_read_b64_tr_b16 v[166:167], v39 offset:12288
s_waitcnt vmcnt(32)
s_barrier
v_mfma_f32_16x16x32_bf16 v[88:91], v[144:147], a[40:43], v[88:91]
ds_read_b64_tr_b16 v[136:137], v32 offset:17408
v_mfma_f32_16x16x32_bf16 v[92:95], v[144:147], a[44:47], v[92:95]
ds_read_b64_tr_b16 v[138:139], v32 offset:21504
v_mfma_f32_16x16x32_bf16 v[96:99], v[148:151], a[40:43], v[96:99]
ds_read_b64_tr_b16 v[140:141], v33 offset:17408
v_mfma_f32_16x16x32_bf16 v[100:103], v[148:151], a[44:47], v[100:103]
s_waitcnt lgkmcnt(7)
ds_read_b64_tr_b16 v[142:143], v33 offset:21504
v_mfma_f32_16x16x32_bf16 v[104:107], v[152:155], a[40:43], v[104:107]
ds_read_b64_tr_b16 v[144:145], v34 offset:17408
v_mfma_f32_16x16x32_bf16 v[108:111], v[152:155], a[44:47], v[108:111]
ds_read_b64_tr_b16 v[146:147], v34 offset:21504
v_mfma_f32_16x16x32_bf16 v[112:115], v[156:159], a[40:43], v[112:115]
ds_read_b64_tr_b16 v[148:149], v35 offset:17408
v_mfma_f32_16x16x32_bf16 v[116:119], v[156:159], a[44:47], v[116:119]
s_waitcnt lgkmcnt(7)
ds_read_b64_tr_b16 v[150:151], v35 offset:21504
v_mfma_f32_16x16x32_bf16 v[120:123], v[160:163], a[40:43], v[120:123]
ds_read_b64_tr_b16 v[152:153], v36 offset:17408
v_mfma_f32_16x16x32_bf16 v[124:127], v[160:163], a[44:47], v[124:127]
ds_read_b64_tr_b16 v[154:155], v36 offset:21504
v_mfma_f32_16x16x32_bf16 v[128:131], v[164:167], a[40:43], v[128:131]
ds_read_b64_tr_b16 v[156:157], v37 offset:17408
v_mfma_f32_16x16x32_bf16 v[132:135], v[164:167], a[44:47], v[132:135]
s_waitcnt lgkmcnt(7)
ds_read_b64_tr_b16 v[158:159], v37 offset:21504
v_mfma_f32_16x16x32_bf16 v[72:75], v[136:139], a[48:51], v[72:75]
ds_read_b64_tr_b16 v[160:161], v38 offset:17408
v_mfma_f32_16x16x32_bf16 v[76:79], v[136:139], a[52:55], v[76:79]
ds_read_b64_tr_b16 v[162:163], v38 offset:21504
v_mfma_f32_16x16x32_bf16 v[80:83], v[140:143], a[48:51], v[80:83]
ds_read_b64_tr_b16 v[164:165], v39 offset:17408
v_mfma_f32_16x16x32_bf16 v[84:87], v[140:143], a[52:55], v[84:87]
s_waitcnt lgkmcnt(7)
ds_read_b64_tr_b16 v[166:167], v39 offset:21504
v_mfma_f32_16x16x32_bf16 v[88:91], v[144:147], a[48:51], v[88:91]
ds_read_b64_tr_b16 v[136:137], v32 offset:25600
v_mfma_f32_16x16x32_bf16 v[92:95], v[144:147], a[52:55], v[92:95]
ds_read_b64_tr_b16 v[138:139], v32 offset:29696
v_mfma_f32_16x16x32_bf16 v[96:99], v[148:151], a[48:51], v[96:99]
ds_read_b64_tr_b16 v[140:141], v33 offset:25600
v_mfma_f32_16x16x32_bf16 v[100:103], v[148:151], a[52:55], v[100:103]
s_waitcnt lgkmcnt(7)
ds_read_b64_tr_b16 v[142:143], v33 offset:29696
v_mfma_f32_16x16x32_bf16 v[104:107], v[152:155], a[48:51], v[104:107]
ds_read_b64_tr_b16 v[144:145], v34 offset:25600
v_mfma_f32_16x16x32_bf16 v[108:111], v[152:155], a[52:55], v[108:111]
ds_read_b64_tr_b16 v[146:147], v34 offset:29696
v_mfma_f32_16x16x32_bf16 v[112:115], v[156:159], a[48:51], v[112:115]
ds_read_b64_tr_b16 v[148:149], v35 offset:25600
v_mfma_f32_16x16x32_bf16 v[116:119], v[156:159], a[52:55], v[116:119]
s_waitcnt lgkmcnt(7)
ds_read_b64_tr_b16 v[150:151], v35 offset:29696
v_mfma_f32_16x16x32_bf16 v[120:123], v[160:163], a[48:51], v[120:123]
ds_read_b64_tr_b16 v[152:153], v36 offset:25600
v_mfma_f32_16x16x32_bf16 v[124:127], v[160:163], a[52:55], v[124:127]
ds_read_b64_tr_b16 v[154:155], v36 offset:29696
v_mfma_f32_16x16x32_bf16 v[128:131], v[164:167], a[48:51], v[128:131]
ds_read_b64_tr_b16 v[156:157], v37 offset:25600
v_mfma_f32_16x16x32_bf16 v[132:135], v[164:167], a[52:55], v[132:135]
s_waitcnt lgkmcnt(7)
ds_read_b64_tr_b16 v[158:159], v37 offset:29696
v_mfma_f32_16x16x32_bf16 v[72:75], v[136:139], a[56:59], v[72:75]
ds_read_b64_tr_b16 v[160:161], v38 offset:25600
v_mfma_f32_16x16x32_bf16 v[76:79], v[136:139], a[60:63], v[76:79]
ds_read_b64_tr_b16 v[162:163], v38 offset:29696
v_mfma_f32_16x16x32_bf16 v[80:83], v[140:143], a[56:59], v[80:83]
ds_read_b64_tr_b16 v[164:165], v39 offset:25600
v_mfma_f32_16x16x32_bf16 v[84:87], v[140:143], a[60:63], v[84:87]
s_waitcnt lgkmcnt(7)
ds_read_b64_tr_b16 v[166:167], v39 offset:29696
s_waitcnt vmcnt(0)
s_barrier
v_mfma_f32_16x16x32_bf16 v[88:91], v[144:147], a[56:59], v[88:91]
ds_read_b64_tr_b16 v[136:137], v32 offset:34816
v_mfma_f32_16x16x32_bf16 v[92:95], v[144:147], a[60:63], v[92:95]
ds_read_b64_tr_b16 v[138:139], v32 offset:38912
v_mfma_f32_16x16x32_bf16 v[96:99], v[148:151], a[56:59], v[96:99]
ds_read_b64_tr_b16 v[140:141], v33 offset:34816
v_mfma_f32_16x16x32_bf16 v[100:103], v[148:151], a[60:63], v[100:103]
s_waitcnt lgkmcnt(7)
ds_read_b64_tr_b16 v[142:143], v33 offset:38912
v_mfma_f32_16x16x32_bf16 v[104:107], v[152:155], a[56:59], v[104:107]
ds_read_b64_tr_b16 v[144:145], v32 offset:43008
v_mfma_f32_16x16x32_bf16 v[108:111], v[152:155], a[60:63], v[108:111]
ds_read_b64_tr_b16 v[146:147], v32 offset:47104
v_mfma_f32_16x16x32_bf16 v[112:115], v[156:159], a[56:59], v[112:115]
ds_read_b64_tr_b16 v[148:149], v33 offset:43008
v_mfma_f32_16x16x32_bf16 v[116:119], v[156:159], a[60:63], v[116:119]
s_waitcnt lgkmcnt(7)
ds_read_b64_tr_b16 v[150:151], v33 offset:47104
v_mfma_f32_16x16x32_bf16 v[120:123], v[160:163], a[56:59], v[120:123]
ds_read_b64_tr_b16 v[152:153], v32 offset:52224
v_mfma_f32_16x16x32_bf16 v[124:127], v[160:163], a[60:63], v[124:127]
ds_read_b64_tr_b16 v[154:155], v32 offset:56320
v_mfma_f32_16x16x32_bf16 v[128:131], v[164:167], a[56:59], v[128:131]
ds_read_b64_tr_b16 v[156:157], v33 offset:52224
v_mfma_f32_16x16x32_bf16 v[132:135], v[164:167], a[60:63], v[132:135]
s_waitcnt lgkmcnt(7)
ds_read_b64_tr_b16 v[158:159], v33 offset:56320
v_mfma_f32_16x16x32_bf16 v[72:75], v[136:139], a[64:67], v[72:75]
ds_read_b64_tr_b16 v[160:161], v32 offset:60416
s_mov_b32 s31, 65536
v_mfma_f32_16x16x32_bf16 v[76:79], v[136:139], a[68:71], v[76:79]
ds_read_b64_tr_b16 v[162:163], v32 offset:64512
v_mfma_f32_16x16x32_bf16 v[80:83], v[140:143], a[64:67], v[80:83]
ds_read_b64_tr_b16 v[164:165], v33 offset:60416
v_mfma_f32_16x16x32_bf16 v[84:87], v[140:143], a[68:71], v[84:87]
s_waitcnt lgkmcnt(7)
ds_read_b64_tr_b16 v[166:167], v33 offset:64512
v_mfma_f32_16x16x32_bf16 v[72:75], v[144:147], a[72:75], v[72:75]
ds_read_b64_tr_b16 v[136:137], v40 offset:0
v_mfma_f32_16x16x32_bf16 v[76:79], v[144:147], a[76:79], v[76:79]
ds_read_b64_tr_b16 v[138:139], v40 offset:4096
v_mfma_f32_16x16x32_bf16 v[80:83], v[148:151], a[72:75], v[80:83]
ds_read_b64_tr_b16 v[140:141], v41 offset:0
v_mfma_f32_16x16x32_bf16 v[84:87], v[148:151], a[76:79], v[84:87]
s_waitcnt lgkmcnt(7)
ds_read_b64_tr_b16 v[142:143], v41 offset:4096
v_mfma_f32_16x16x32_bf16 v[72:75], v[152:155], a[80:83], v[72:75]
ds_read_b64_tr_b16 v[144:145], v40 offset:8192
v_mfma_f32_16x16x32_bf16 v[76:79], v[152:155], a[84:87], v[76:79]
ds_read_b64_tr_b16 v[146:147], v40 offset:12288
v_mfma_f32_16x16x32_bf16 v[80:83], v[156:159], a[80:83], v[80:83]
ds_read_b64_tr_b16 v[148:149], v41 offset:8192
v_mfma_f32_16x16x32_bf16 v[84:87], v[156:159], a[84:87], v[84:87]
s_waitcnt lgkmcnt(7)
ds_read_b64_tr_b16 v[150:151], v41 offset:12288
v_mfma_f32_16x16x32_bf16 v[72:75], v[160:163], a[88:91], v[72:75]
ds_read_b64_tr_b16 v[152:153], v40 offset:17408
v_mfma_f32_16x16x32_bf16 v[76:79], v[160:163], a[92:95], v[76:79]
ds_read_b64_tr_b16 v[154:155], v40 offset:21504
v_mfma_f32_16x16x32_bf16 v[80:83], v[164:167], a[88:91], v[80:83]
ds_read_b64_tr_b16 v[156:157], v41 offset:17408
v_mfma_f32_16x16x32_bf16 v[84:87], v[164:167], a[92:95], v[84:87]
s_waitcnt lgkmcnt(7)
ds_read_b64_tr_b16 v[158:159], v41 offset:21504
v_mfma_f32_16x16x32_bf16 v[72:75], v[136:139], a[96:99], v[72:75]
ds_read_b64_tr_b16 v[160:161], v40 offset:25600
v_mfma_f32_16x16x32_bf16 v[76:79], v[136:139], a[100:103], v[76:79]
ds_read_b64_tr_b16 v[162:163], v40 offset:29696
v_mfma_f32_16x16x32_bf16 v[80:83], v[140:143], a[96:99], v[80:83]
ds_read_b64_tr_b16 v[164:165], v41 offset:25600
v_mfma_f32_16x16x32_bf16 v[84:87], v[140:143], a[100:103], v[84:87]
s_waitcnt lgkmcnt(7)
ds_read_b64_tr_b16 v[166:167], v41 offset:29696
v_mfma_f32_16x16x32_bf16 v[72:75], v[144:147], a[104:107], v[72:75]
ds_read_b64_tr_b16 v[136:137], v34 offset:34816
v_mfma_f32_16x16x32_bf16 v[76:79], v[144:147], a[108:111], v[76:79]
ds_read_b64_tr_b16 v[138:139], v34 offset:38912
v_mfma_f32_16x16x32_bf16 v[80:83], v[148:151], a[104:107], v[80:83]
ds_read_b64_tr_b16 v[140:141], v35 offset:34816
v_mfma_f32_16x16x32_bf16 v[84:87], v[148:151], a[108:111], v[84:87]
s_waitcnt lgkmcnt(7)
ds_read_b64_tr_b16 v[142:143], v35 offset:38912
v_mfma_f32_16x16x32_bf16 v[72:75], v[152:155], a[112:115], v[72:75]
ds_read_b64_tr_b16 v[144:145], v34 offset:43008
v_mfma_f32_16x16x32_bf16 v[76:79], v[152:155], a[116:119], v[76:79]
ds_read_b64_tr_b16 v[146:147], v34 offset:47104
v_mfma_f32_16x16x32_bf16 v[80:83], v[156:159], a[112:115], v[80:83]
ds_read_b64_tr_b16 v[148:149], v35 offset:43008
v_mfma_f32_16x16x32_bf16 v[84:87], v[156:159], a[116:119], v[84:87]
s_waitcnt lgkmcnt(7)
ds_read_b64_tr_b16 v[150:151], v35 offset:47104
v_mfma_f32_16x16x32_bf16 v[72:75], v[160:163], a[120:123], v[72:75]
ds_read_b64_tr_b16 v[152:153], v34 offset:52224
v_mfma_f32_16x16x32_bf16 v[76:79], v[160:163], a[124:127], v[76:79]
ds_read_b64_tr_b16 v[154:155], v34 offset:56320
v_mfma_f32_16x16x32_bf16 v[80:83], v[164:167], a[120:123], v[80:83]
ds_read_b64_tr_b16 v[156:157], v35 offset:52224
v_mfma_f32_16x16x32_bf16 v[84:87], v[164:167], a[124:127], v[84:87]
s_waitcnt lgkmcnt(7)
ds_read_b64_tr_b16 v[158:159], v35 offset:56320
v_mfma_f32_16x16x32_bf16 v[88:91], v[136:139], a[64:67], v[88:91]
ds_read_b64_tr_b16 v[160:161], v34 offset:60416
v_mfma_f32_16x16x32_bf16 v[92:95], v[136:139], a[68:71], v[92:95]
ds_read_b64_tr_b16 v[162:163], v34 offset:64512
v_mfma_f32_16x16x32_bf16 v[96:99], v[140:143], a[64:67], v[96:99]
ds_read_b64_tr_b16 v[164:165], v35 offset:60416
v_mfma_f32_16x16x32_bf16 v[100:103], v[140:143], a[68:71], v[100:103]
s_waitcnt lgkmcnt(7)
ds_read_b64_tr_b16 v[166:167], v35 offset:64512
v_mfma_f32_16x16x32_bf16 v[88:91], v[144:147], a[72:75], v[88:91]
ds_read_b64_tr_b16 v[136:137], v42 offset:0
v_cvt_pk_bf16_f32 v168, v72, v73
v_mfma_f32_16x16x32_bf16 v[92:95], v[144:147], a[76:79], v[92:95]
ds_read_b64_tr_b16 v[138:139], v42 offset:4096
v_cvt_pk_bf16_f32 v169, v74, v75
v_mfma_f32_16x16x32_bf16 v[96:99], v[148:151], a[72:75], v[96:99]
ds_read_b64_tr_b16 v[140:141], v43 offset:0
v_cvt_pk_bf16_f32 v170, v80, v81
v_mfma_f32_16x16x32_bf16 v[100:103], v[148:151], a[76:79], v[100:103]
s_waitcnt lgkmcnt(7)
ds_read_b64_tr_b16 v[142:143], v43 offset:4096
v_cvt_pk_bf16_f32 v171, v82, v83
v_mfma_f32_16x16x32_bf16 v[88:91], v[152:155], a[80:83], v[88:91]
ds_read_b64_tr_b16 v[144:145], v42 offset:8192
v_mfma_f32_16x16x32_bf16 v[92:95], v[152:155], a[84:87], v[92:95]
ds_read_b64_tr_b16 v[146:147], v42 offset:12288
v_mfma_f32_16x16x32_bf16 v[96:99], v[156:159], a[80:83], v[96:99]
ds_read_b64_tr_b16 v[148:149], v43 offset:8192
v_permlane16_swap_b32 v168, v170
v_mfma_f32_16x16x32_bf16 v[100:103], v[156:159], a[84:87], v[100:103]
s_waitcnt lgkmcnt(7)
ds_read_b64_tr_b16 v[150:151], v43 offset:12288
v_permlane16_swap_b32 v169, v171
v_mfma_f32_16x16x32_bf16 v[88:91], v[160:163], a[88:91], v[88:91]
ds_read_b64_tr_b16 v[152:153], v42 offset:17408
buffer_store_dwordx4 v[168:171], v10, s[16:19], 0 offen offset:0 sc1
v_mfma_f32_16x16x32_bf16 v[92:95], v[160:163], a[92:95], v[92:95]
ds_read_b64_tr_b16 v[154:155], v42 offset:21504
v_cvt_pk_bf16_f32 v172, v76, v77
v_mfma_f32_16x16x32_bf16 v[96:99], v[164:167], a[88:91], v[96:99]
ds_read_b64_tr_b16 v[156:157], v43 offset:17408
v_cvt_pk_bf16_f32 v173, v78, v79
v_mfma_f32_16x16x32_bf16 v[100:103], v[164:167], a[92:95], v[100:103]
s_waitcnt lgkmcnt(7)
ds_read_b64_tr_b16 v[158:159], v43 offset:21504
v_cvt_pk_bf16_f32 v174, v84, v85
v_mfma_f32_16x16x32_bf16 v[88:91], v[136:139], a[96:99], v[88:91]
ds_read_b64_tr_b16 v[160:161], v42 offset:25600
v_cvt_pk_bf16_f32 v175, v86, v87
v_mfma_f32_16x16x32_bf16 v[92:95], v[136:139], a[100:103], v[92:95]
ds_read_b64_tr_b16 v[162:163], v42 offset:29696
v_mfma_f32_16x16x32_bf16 v[96:99], v[140:143], a[96:99], v[96:99]
ds_read_b64_tr_b16 v[164:165], v43 offset:25600
v_mfma_f32_16x16x32_bf16 v[100:103], v[140:143], a[100:103], v[100:103]
s_waitcnt lgkmcnt(7)
ds_read_b64_tr_b16 v[166:167], v43 offset:29696
v_permlane16_swap_b32 v172, v174
v_mfma_f32_16x16x32_bf16 v[88:91], v[144:147], a[104:107], v[88:91]
ds_read_b64_tr_b16 v[136:137], v36 offset:34816
v_permlane16_swap_b32 v173, v175
v_mfma_f32_16x16x32_bf16 v[92:95], v[144:147], a[108:111], v[92:95]
ds_read_b64_tr_b16 v[138:139], v36 offset:38912
buffer_store_dwordx4 v[172:175], v10, s[16:19], s31 offen offset:0 sc1
v_mfma_f32_16x16x32_bf16 v[96:99], v[148:151], a[104:107], v[96:99]
ds_read_b64_tr_b16 v[140:141], v37 offset:34816
v_mfma_f32_16x16x32_bf16 v[100:103], v[148:151], a[108:111], v[100:103]
s_waitcnt lgkmcnt(7)
ds_read_b64_tr_b16 v[142:143], v37 offset:38912
v_mfma_f32_16x16x32_bf16 v[88:91], v[152:155], a[112:115], v[88:91]
ds_read_b64_tr_b16 v[144:145], v36 offset:43008
v_mfma_f32_16x16x32_bf16 v[92:95], v[152:155], a[116:119], v[92:95]
ds_read_b64_tr_b16 v[146:147], v36 offset:47104
v_mfma_f32_16x16x32_bf16 v[96:99], v[156:159], a[112:115], v[96:99]
ds_read_b64_tr_b16 v[148:149], v37 offset:43008
v_mfma_f32_16x16x32_bf16 v[100:103], v[156:159], a[116:119], v[100:103]
s_waitcnt lgkmcnt(7)
ds_read_b64_tr_b16 v[150:151], v37 offset:47104
v_mfma_f32_16x16x32_bf16 v[88:91], v[160:163], a[120:123], v[88:91]
ds_read_b64_tr_b16 v[152:153], v36 offset:52224
v_mfma_f32_16x16x32_bf16 v[92:95], v[160:163], a[124:127], v[92:95]
ds_read_b64_tr_b16 v[154:155], v36 offset:56320
v_mfma_f32_16x16x32_bf16 v[96:99], v[164:167], a[120:123], v[96:99]
ds_read_b64_tr_b16 v[156:157], v37 offset:52224
v_mfma_f32_16x16x32_bf16 v[100:103], v[164:167], a[124:127], v[100:103]
s_waitcnt lgkmcnt(7)
ds_read_b64_tr_b16 v[158:159], v37 offset:56320
v_mfma_f32_16x16x32_bf16 v[104:107], v[136:139], a[64:67], v[104:107]
ds_read_b64_tr_b16 v[160:161], v36 offset:60416
v_mfma_f32_16x16x32_bf16 v[108:111], v[136:139], a[68:71], v[108:111]
ds_read_b64_tr_b16 v[162:163], v36 offset:64512
v_mfma_f32_16x16x32_bf16 v[112:115], v[140:143], a[64:67], v[112:115]
ds_read_b64_tr_b16 v[164:165], v37 offset:60416
v_mfma_f32_16x16x32_bf16 v[116:119], v[140:143], a[68:71], v[116:119]
s_waitcnt lgkmcnt(7)
ds_read_b64_tr_b16 v[166:167], v37 offset:64512
v_mfma_f32_16x16x32_bf16 v[104:107], v[144:147], a[72:75], v[104:107]
ds_read_b64_tr_b16 v[136:137], v44 offset:0
v_cvt_pk_bf16_f32 v176, v88, v89
v_mfma_f32_16x16x32_bf16 v[108:111], v[144:147], a[76:79], v[108:111]
ds_read_b64_tr_b16 v[138:139], v44 offset:4096
v_cvt_pk_bf16_f32 v177, v90, v91
v_mfma_f32_16x16x32_bf16 v[112:115], v[148:151], a[72:75], v[112:115]
ds_read_b64_tr_b16 v[140:141], v45 offset:0
v_cvt_pk_bf16_f32 v178, v96, v97
v_mfma_f32_16x16x32_bf16 v[116:119], v[148:151], a[76:79], v[116:119]
s_waitcnt lgkmcnt(7)
ds_read_b64_tr_b16 v[142:143], v45 offset:4096
v_cvt_pk_bf16_f32 v179, v98, v99
v_mfma_f32_16x16x32_bf16 v[104:107], v[152:155], a[80:83], v[104:107]
ds_read_b64_tr_b16 v[144:145], v44 offset:8192
v_mfma_f32_16x16x32_bf16 v[108:111], v[152:155], a[84:87], v[108:111]
ds_read_b64_tr_b16 v[146:147], v44 offset:12288
v_mfma_f32_16x16x32_bf16 v[112:115], v[156:159], a[80:83], v[112:115]
ds_read_b64_tr_b16 v[148:149], v45 offset:8192
v_permlane16_swap_b32 v176, v178
v_mfma_f32_16x16x32_bf16 v[116:119], v[156:159], a[84:87], v[116:119]
s_waitcnt lgkmcnt(7)
ds_read_b64_tr_b16 v[150:151], v45 offset:12288
v_permlane16_swap_b32 v177, v179
v_mfma_f32_16x16x32_bf16 v[104:107], v[160:163], a[88:91], v[104:107]
ds_read_b64_tr_b16 v[152:153], v44 offset:17408
buffer_store_dwordx4 v[176:179], v10, s[16:19], 0 offen offset:64 sc1
v_mfma_f32_16x16x32_bf16 v[108:111], v[160:163], a[92:95], v[108:111]
ds_read_b64_tr_b16 v[154:155], v44 offset:21504
v_cvt_pk_bf16_f32 v180, v92, v93
v_mfma_f32_16x16x32_bf16 v[112:115], v[164:167], a[88:91], v[112:115]
ds_read_b64_tr_b16 v[156:157], v45 offset:17408
v_cvt_pk_bf16_f32 v181, v94, v95
v_mfma_f32_16x16x32_bf16 v[116:119], v[164:167], a[92:95], v[116:119]
s_waitcnt lgkmcnt(7)
ds_read_b64_tr_b16 v[158:159], v45 offset:21504
v_cvt_pk_bf16_f32 v182, v100, v101
v_mfma_f32_16x16x32_bf16 v[104:107], v[136:139], a[96:99], v[104:107]
ds_read_b64_tr_b16 v[160:161], v44 offset:25600
v_cvt_pk_bf16_f32 v183, v102, v103
v_mfma_f32_16x16x32_bf16 v[108:111], v[136:139], a[100:103], v[108:111]
ds_read_b64_tr_b16 v[162:163], v44 offset:29696
v_mfma_f32_16x16x32_bf16 v[112:115], v[140:143], a[96:99], v[112:115]
ds_read_b64_tr_b16 v[164:165], v45 offset:25600
v_mfma_f32_16x16x32_bf16 v[116:119], v[140:143], a[100:103], v[116:119]
s_waitcnt lgkmcnt(7)
ds_read_b64_tr_b16 v[166:167], v45 offset:29696
v_permlane16_swap_b32 v180, v182
v_mfma_f32_16x16x32_bf16 v[104:107], v[144:147], a[104:107], v[104:107]
ds_read_b64_tr_b16 v[136:137], v38 offset:34816
v_permlane16_swap_b32 v181, v183
v_mfma_f32_16x16x32_bf16 v[108:111], v[144:147], a[108:111], v[108:111]
ds_read_b64_tr_b16 v[138:139], v38 offset:38912
buffer_store_dwordx4 v[180:183], v10, s[16:19], s31 offen offset:64 sc1
v_mfma_f32_16x16x32_bf16 v[112:115], v[148:151], a[104:107], v[112:115]
ds_read_b64_tr_b16 v[140:141], v39 offset:34816
v_mfma_f32_16x16x32_bf16 v[116:119], v[148:151], a[108:111], v[116:119]
s_waitcnt lgkmcnt(7)
ds_read_b64_tr_b16 v[142:143], v39 offset:38912
v_mfma_f32_16x16x32_bf16 v[104:107], v[152:155], a[112:115], v[104:107]
ds_read_b64_tr_b16 v[144:145], v38 offset:43008
v_mfma_f32_16x16x32_bf16 v[108:111], v[152:155], a[116:119], v[108:111]
ds_read_b64_tr_b16 v[146:147], v38 offset:47104
v_mfma_f32_16x16x32_bf16 v[112:115], v[156:159], a[112:115], v[112:115]
ds_read_b64_tr_b16 v[148:149], v39 offset:43008
v_mfma_f32_16x16x32_bf16 v[116:119], v[156:159], a[116:119], v[116:119]
s_waitcnt lgkmcnt(7)
ds_read_b64_tr_b16 v[150:151], v39 offset:47104
v_mfma_f32_16x16x32_bf16 v[104:107], v[160:163], a[120:123], v[104:107]
ds_read_b64_tr_b16 v[152:153], v38 offset:52224
v_mfma_f32_16x16x32_bf16 v[108:111], v[160:163], a[124:127], v[108:111]
ds_read_b64_tr_b16 v[154:155], v38 offset:56320
v_mfma_f32_16x16x32_bf16 v[112:115], v[164:167], a[120:123], v[112:115]
ds_read_b64_tr_b16 v[156:157], v39 offset:52224
v_mfma_f32_16x16x32_bf16 v[116:119], v[164:167], a[124:127], v[116:119]
s_waitcnt lgkmcnt(7)
ds_read_b64_tr_b16 v[158:159], v39 offset:56320
v_mfma_f32_16x16x32_bf16 v[120:123], v[136:139], a[64:67], v[120:123]
ds_read_b64_tr_b16 v[160:161], v38 offset:60416
v_mfma_f32_16x16x32_bf16 v[124:127], v[136:139], a[68:71], v[124:127]
ds_read_b64_tr_b16 v[162:163], v38 offset:64512
v_mfma_f32_16x16x32_bf16 v[128:131], v[140:143], a[64:67], v[128:131]
ds_read_b64_tr_b16 v[164:165], v39 offset:60416
v_mfma_f32_16x16x32_bf16 v[132:135], v[140:143], a[68:71], v[132:135]
s_waitcnt lgkmcnt(7)
ds_read_b64_tr_b16 v[166:167], v39 offset:64512
v_mfma_f32_16x16x32_bf16 v[120:123], v[144:147], a[72:75], v[120:123]
ds_read_b64_tr_b16 v[136:137], v46 offset:0
v_cvt_pk_bf16_f32 v184, v104, v105
v_mfma_f32_16x16x32_bf16 v[124:127], v[144:147], a[76:79], v[124:127]
ds_read_b64_tr_b16 v[138:139], v46 offset:4096
v_cvt_pk_bf16_f32 v185, v106, v107
v_mfma_f32_16x16x32_bf16 v[128:131], v[148:151], a[72:75], v[128:131]
ds_read_b64_tr_b16 v[140:141], v47 offset:0
v_cvt_pk_bf16_f32 v186, v112, v113
v_mfma_f32_16x16x32_bf16 v[132:135], v[148:151], a[76:79], v[132:135]
s_waitcnt lgkmcnt(7)
ds_read_b64_tr_b16 v[142:143], v47 offset:4096
v_cvt_pk_bf16_f32 v187, v114, v115
v_mfma_f32_16x16x32_bf16 v[120:123], v[152:155], a[80:83], v[120:123]
ds_read_b64_tr_b16 v[144:145], v46 offset:8192
v_mfma_f32_16x16x32_bf16 v[124:127], v[152:155], a[84:87], v[124:127]
ds_read_b64_tr_b16 v[146:147], v46 offset:12288
v_mfma_f32_16x16x32_bf16 v[128:131], v[156:159], a[80:83], v[128:131]
ds_read_b64_tr_b16 v[148:149], v47 offset:8192
v_permlane16_swap_b32 v184, v186
v_mfma_f32_16x16x32_bf16 v[132:135], v[156:159], a[84:87], v[132:135]
s_waitcnt lgkmcnt(7)
ds_read_b64_tr_b16 v[150:151], v47 offset:12288
v_permlane16_swap_b32 v185, v187
v_mfma_f32_16x16x32_bf16 v[120:123], v[160:163], a[88:91], v[120:123]
ds_read_b64_tr_b16 v[152:153], v46 offset:17408
buffer_store_dwordx4 v[184:187], v10, s[16:19], 0 offen offset:128 sc1
v_mfma_f32_16x16x32_bf16 v[124:127], v[160:163], a[92:95], v[124:127]
ds_read_b64_tr_b16 v[154:155], v46 offset:21504
v_cvt_pk_bf16_f32 v188, v108, v109
v_mfma_f32_16x16x32_bf16 v[128:131], v[164:167], a[88:91], v[128:131]
ds_read_b64_tr_b16 v[156:157], v47 offset:17408
v_cvt_pk_bf16_f32 v189, v110, v111
v_mfma_f32_16x16x32_bf16 v[132:135], v[164:167], a[92:95], v[132:135]
s_waitcnt lgkmcnt(7)
ds_read_b64_tr_b16 v[158:159], v47 offset:21504
v_cvt_pk_bf16_f32 v190, v116, v117
v_mfma_f32_16x16x32_bf16 v[120:123], v[136:139], a[96:99], v[120:123]
ds_read_b64_tr_b16 v[160:161], v46 offset:25600
v_cvt_pk_bf16_f32 v191, v118, v119
v_mfma_f32_16x16x32_bf16 v[124:127], v[136:139], a[100:103], v[124:127]
ds_read_b64_tr_b16 v[162:163], v46 offset:29696
v_mfma_f32_16x16x32_bf16 v[128:131], v[140:143], a[96:99], v[128:131]
ds_read_b64_tr_b16 v[164:165], v47 offset:25600
v_mfma_f32_16x16x32_bf16 v[132:135], v[140:143], a[100:103], v[132:135]
s_waitcnt lgkmcnt(7)
ds_read_b64_tr_b16 v[166:167], v47 offset:29696
v_permlane16_swap_b32 v188, v190
v_mfma_f32_16x16x32_bf16 v[120:123], v[144:147], a[104:107], v[120:123]
v_permlane16_swap_b32 v189, v191
v_mfma_f32_16x16x32_bf16 v[124:127], v[144:147], a[108:111], v[124:127]
buffer_store_dwordx4 v[188:191], v10, s[16:19], s31 offen offset:128 sc1
v_mfma_f32_16x16x32_bf16 v[128:131], v[148:151], a[104:107], v[128:131]
v_mfma_f32_16x16x32_bf16 v[132:135], v[148:151], a[108:111], v[132:135]
s_waitcnt lgkmcnt(4)
v_mfma_f32_16x16x32_bf16 v[120:123], v[152:155], a[112:115], v[120:123]
v_mfma_f32_16x16x32_bf16 v[124:127], v[152:155], a[116:119], v[124:127]
v_mfma_f32_16x16x32_bf16 v[128:131], v[156:159], a[112:115], v[128:131]
v_mfma_f32_16x16x32_bf16 v[132:135], v[156:159], a[116:119], v[132:135]
s_waitcnt lgkmcnt(0)
v_mfma_f32_16x16x32_bf16 v[120:123], v[160:163], a[120:123], v[120:123]
v_mfma_f32_16x16x32_bf16 v[124:127], v[160:163], a[124:127], v[124:127]
v_mfma_f32_16x16x32_bf16 v[128:131], v[164:167], a[120:123], v[128:131]
v_mfma_f32_16x16x32_bf16 v[132:135], v[164:167], a[124:127], v[132:135]
s_sub_u32 s30, s30, 1
s_cmp_lg_u32 s30, 0
s_nop 7
s_mov_b32 s31, 0
v_cvt_pk_bf16_f32 v136, v120, v121
v_cvt_pk_bf16_f32 v137, v122, v123
v_cvt_pk_bf16_f32 v138, v128, v129
v_cvt_pk_bf16_f32 v139, v130, v131
s_nop 1
v_permlane16_swap_b32 v136, v138
v_permlane16_swap_b32 v137, v139
buffer_store_dwordx4 v[136:139], v10, s[16:19], s31 offen offset:192 sc1
s_mov_b32 s31, 65536
v_cvt_pk_bf16_f32 v140, v124, v125
v_cvt_pk_bf16_f32 v141, v126, v127
v_cvt_pk_bf16_f32 v142, v132, v133
v_cvt_pk_bf16_f32 v143, v134, v135
s_nop 1
v_permlane16_swap_b32 v140, v142
v_permlane16_swap_b32 v141, v143
buffer_store_dwordx4 v[140:143], v10, s[16:19], s31 offen offset:192 sc1
s_endpgm
L_k2slow_l:
s_mov_b32 s38, 0x4000
L_k2slow_l_spin:
buffer_load_dwordx2 v[14:15], v8, s[60:63], 0 offen sc1
s_waitcnt vmcnt(0)
v_and_b32 v16, s34, v14
v_and_b32 v17, s35, v15
v_cmp_ne_u64 vcc, s[34:35], v[16:17]
s_nop 3
s_cbranch_vccz L_k2back_l
s_sub_u32 s38, s38, 1
s_cmp_lg_u32 s38, 0
s_cbranch_scc1 L_k2slow_l_spin
s_branch L_k2back_l
L_redo:
s_mov_b32 s42, 1
s_waitcnt vmcnt(0) lgkmcnt(0)
s_barrier
s_branch L_restart
L_notile:
s_lshl_b32 s48, 0x10000, s68
s_lshl_b32 s50, 1, s68
s_lshl_b32 s49, s6, 3
s_add_u32 s49, s49, s7
s_mul_i32 s49, s49, 16
v_mov_b32 v29, s48
v_mov_b32 v30, s49
v_mov_b32 v31, s50
v_mov_b32 v28, 163832
s_waitcnt vmcnt(0) lgkmcnt(0)
s_barrier
ds_read_b32 v27, v28
s_waitcnt lgkmcnt(0)
v_readfirstlane_b32 s48, v27
s_nop 3
s_cmp_lg_u32 s48, 0
s_cbranch_scc1 L_redo
s_cmp_lg_u32 s3, 0
s_cbranch_scc1 L_fnosig2
s_mov_b64 exec, 1
buffer_atomic_or v29, v30, s[60:63], 0 offen
buffer_atomic_or v31, v30, s[60:63], 0 offen offset:4
s_mov_b64 exec, -1
L_fnosig2:
s_endpgm
L_endall:
.section .rodata,"a"
.p2align 6
.amdhsa_kernel concat_heads__mha_block_cached__gqa_block_cached__near_ridge_kernel
  .amdhsa_next_free_vgpr 512
  .amdhsa_next_free_sgpr 102
  .amdhsa_accum_offset 256
  .amdhsa_group_segment_fixed_size 0
  .amdhsa_kernarg_size 104
  .amdhsa_user_sgpr_count 2
  .amdhsa_user_sgpr_kernarg_segment_ptr 1
  .amdhsa_system_sgpr_workgroup_id_x 1
.end_amdhsa_kernel
```
